```python
import torch

def _softmax(x, axis=-1):
    return torch.softmax(x, dim=axis)
def _gelu(x):
    return torch.nn.functional.gelu(x, approximate="tanh")
def _silu(x):
    return torch.nn.functional.silu(x)
def _sigmoid(x):
    return torch.sigmoid(x)
def _layernorm(x, axis=-1, eps=1e-5):
    m = x.mean(dim=axis, keepdim=True)
    v = x.var(dim=axis, keepdim=True, unbiased=False)
    return (x - m) / torch.sqrt(v + eps)
def _scatter_add(tgt, idx, src, axis=0):
    return tgt.clone().index_add_(axis, idx, src)
def _segment_sum(src, seg, n):
    out = torch.zeros((n,) + src.shape[1:], dtype=src.dtype)
    return out.index_add_(0, seg, src)
def _pad(x, pw):
    flat = tuple(v for pair in reversed(pw) for v in pair)
    return torch.nn.functional.pad(x, flat)

kernel_name = 'concat_heads__compressed_kv_cla__linear_kernel_hedgehog__prompt'

def setup_inputs():

    _w = (lambda a: (lambda t: t.to(torch.bfloat16) if t.is_floating_point() else t)(torch.as_tensor(a)))
    def _A_setup():
        B, H, Sq, Sk, D, M = 1, 32, 2048, 2048, 128, 576
        Dc = 4 * D
        return {
            "x": _w((lambda *s: torch.randn(*s, dtype=torch.bfloat16) * 0.8)(B, Sq, M)),
            "c_kv": _w((lambda *s: torch.randn(*s, dtype=torch.bfloat16) * 0.4)(B, Sk, Dc)),
            "w_q": _w((lambda *s: torch.randn(*s, dtype=torch.bfloat16) * 6.4)(M, H, D) * (M ** -0.5)),
            "w_uk": _w((lambda *s: torch.randn(*s, dtype=torch.bfloat16) * 6.4)(Dc, H, D) * (Dc ** -0.5)),
            "w_uv": _w((lambda *s: torch.randn(*s, dtype=torch.bfloat16) * 0.4)(Dc, H, D) * (Dc ** -0.5)),
            "w_o": _w((lambda *s: torch.randn(*s, dtype=torch.bfloat16) * 0.4)(H, D, M) * ((H * D) ** -0.5)),
        }
    _A_in = _A_setup()

    def _B_setup():
        B, S, D, H = 1, 2048, 576, 32
        Dh = D // H
        return {
            "x": _w((lambda *s: torch.randn(*s, dtype=torch.bfloat16) * 0.4)(B, S, D)),
            "wqkv": _w((lambda *s: torch.randn(*s, dtype=torch.bfloat16) * 0.4)(D, 3 * D)),
            "w_phi": _w((lambda *s: torch.randn(*s, dtype=torch.bfloat16) * 0.4)(H, Dh, Dh) * (Dh ** -0.5)),
            "wo": _w((lambda *s: torch.randn(*s, dtype=torch.bfloat16) * 0.05)(D, D)),
        }
    _B_in = _B_setup()

    return {
        "A_x": _A_in["x"],
        "A_c_kv": _A_in["c_kv"],
        "A_w_q": _A_in["w_q"],
        "A_w_uk": _A_in["w_uk"],
        "A_w_uv": _A_in["w_uv"],
        "A_w_o": _A_in["w_o"],
        "B_x": _B_in["x"],
        "B_wqkv": _B_in["wqkv"],
        "B_w_phi": _B_in["w_phi"],
        "B_wo": _B_in["wo"],
    }

def reference(A_x, A_c_kv, A_w_q, A_w_uk, A_w_uv, A_w_o, B_x, B_wqkv, B_w_phi, B_wo):
    def _A_ref(x, c_kv, w_q, w_uk, w_uv, w_o):
        B, Sq, M = x.shape[0], x.shape[1], x.shape[2]
        Sk = c_kv.shape[1]
        H, D = w_q.shape[1], w_q.shape[2]
        q = torch.einsum("bqm,mhd->bhqd", x, w_q)
        k = torch.einsum("bkc,chd->bhkd", c_kv, w_uk)
        v = torch.einsum("bkc,chd->bhkd", c_kv, w_uv)
        scores = torch.einsum("bhqd,bhkd->bhqk", q, k) * (D ** -0.5)
        off = Sk - Sq
        qi = torch.arange(Sq)[:, None]
        kj = torch.arange(Sk)[None, :]
        cmask = kj <= (qi + off)
        scores = torch.where(cmask[None, None], scores, -1e9)
        p = _softmax(scores, axis=-1)
        ctx = torch.einsum("bhqk,bhkd->bhqd", p, v)
        return torch.einsum("bhqd,hdm->bqm", ctx, w_o)

    def _B_ref(x, wqkv, w_phi, wo):
        B, S, D = x.shape
        H = 32; Dh = D // H
        qkv = (lambda x, *d: x.permute(*d))((x @ wqkv).reshape(B, S, 3, H, Dh), 2, 0, 3, 1, 4)
        q, k, v = qkv[0], qkv[1], qkv[2]
        pq = torch.einsum("bhsd,hdf->bhsf", q, w_phi)
        pk = torch.einsum("bhsd,hdf->bhsf", k, w_phi)
        phi_q = torch.concatenate([_softmax(pq, axis=-1), _softmax(-pq, axis=-1)], axis=-1)
        phi_k = torch.concatenate([_softmax(pk, axis=-1), _softmax(-pk, axis=-1)], axis=-1)
        kv = torch.einsum("bhsf,bhsd->bhfd", phi_k, v)
        z  = torch.einsum("bhsf->bhf", phi_k)
        num = torch.einsum("bhqf,bhfd->bhqd", phi_q, kv)
        den = torch.einsum("bhqf,bhf->bhq", phi_q, z)[..., None] + 1e-6
        o = num / den
        return (lambda x, *d: x.permute(*d))(o, 0, 2, 1, 3).reshape(B, S, D) @ wo

    a = _A_ref(A_x, A_c_kv, A_w_q, A_w_uk, A_w_uv, A_w_o)
    b = _B_ref(B_x, B_wqkv, B_w_phi, B_wo)
    return torch.concatenate([a, b], axis=-1)
```

```asm
; @launch kernel=kf_kernel grid=(256,1,1) block=(512,1,1) lds=163840
; @launch kernel=k3_kernel grid=(256,1,1) block=(256,1,1) lds=73728
.amdgcn_target "amdgcn-amd-amdhsa--gfx950"
.text
    .globl kf_kernel
    .p2align 8
    .type kf_kernel,@function
kf_kernel:
    s_cmp_ge_u32 s2, 256
    s_cbranch_scc1 kf_end
    s_load_dwordx16 s[64:79], s[0:1], 0
    s_load_dwordx8 s[80:87], s[0:1], 64
    s_load_dwordx2 s[88:89], s[0:1], 96
    v_lshrrev_b32 v5, 6, v0
    v_and_b32 v1, 63, v0
    v_readfirstlane_b32 s3, v5
    v_and_b32 v2, 15, v1
    v_lshrrev_b32 v3, 4, v1
    v_lshlrev_b32 v4, 4, v1
    s_and_b32 s32, s2, 7
    s_lshr_b32 s33, s2, 3
    s_lshr_b32 s4, s2, 6
    s_lshl_b32 s34, s32, 2
    s_add_u32 s4, s4, s34
    s_and_b32 s5, s33, 7
    s_lshr_b32 s7, s32, 1
    s_lshl_b32 s7, s7, 2
    s_lshr_b32 s34, s5, 1
    s_add_u32 s7, s7, s34
    s_lshr_b32 s6, s2, 6
    s_lshl_b32 s6, s6, 1
    s_and_b32 s34, s32, 1
    s_add_u32 s6, s6, s34
    s_lshl_b32 s6, s6, 1
    s_and_b32 s34, s5, 1
    s_add_u32 s6, s6, s34
    s_and_b32 s40, s3, 3
    s_lshl_b32 s61, s33, 2
    s_add_u32 s61, s61, s40
    s_lshr_b32 s45, s3, 2
    s_and_b32 s46, s3, 1
    s_lshr_b32 s47, s3, 1
    s_and_b32 s47, s47, 1
    s_lshl_b32 s42, s40, 11
    s_lshl_b32 s43, s40, 10
    s_lshl_b32 s60, s3, 10
    s_lshl_b32 s92, s40, 12
    v_lshrrev_b32 v5, 3, v1
    v_lshlrev_b32 v5, 10, v5
    v_and_b32 v6, 7, v1
    v_xor_b32 v6, v6, v3
    v_lshl_add_u32 v9, v6, 4, v5
    v_xor_b32 v6, 4, v6
    v_lshl_add_u32 v12, v6, 4, v5
    v_add_u32 v12, 8192, v12
    s_lshl_b32 s32, s3, 1
    s_and_b32 s32, s32, 4
    v_or_b32 v7, s32, v3
    v_lshlrev_b32 v7, 1, v7
    v_xor_b32 v7, v7, v2
    s_lshl_b32 s32, s40, 2
    v_add_u32 v8, s32, v3
    v_lshlrev_b32 v5, 13, v8
    v_lshl_add_u32 v10, v7, 4, v5
    s_lshl_b32 s35, s5, 18
    s_lshl_b32 s32, s40, 15
    s_add_u32 s35, s35, s32
    s_lshl_b32 s36, s4, 8
    s_waitcnt lgkmcnt(0)
    s_mov_b32 s8, s66
    s_and_b32 s9, s67, 0xffff
    s_mov_b32 s10, 2097152
    s_mov_b32 s11, 0x20000
    s_mov_b32 s12, s70
    s_and_b32 s13, s71, 0xffff
    s_mov_b32 s14, 4194304
    s_mov_b32 s15, 0x20000
    s_mov_b32 s16, s72
    s_and_b32 s17, s73, 0xffff
    s_mov_b32 s18, 4194304
    s_mov_b32 s19, 0x20000
    s_cmp_eq_u32 s45, 1
    s_cbranch_scc1 kf_kv1
kf_kv0:
    s_add_u32 m0, s43, 147456
    s_add_u32 s39, s36, 0
    buffer_load_dwordx4 v10, s[12:15], s39 offen nt lds
    s_add_u32 m0, s43, 151552
    s_add_u32 s39, s36, 131072
    buffer_load_dwordx4 v10, s[12:15], s39 offen nt lds
    s_add_u32 m0, s92, 65536
    s_add_u32 s39, s35, 0
    buffer_load_dwordx4 v9, s[8:11], s39 offen lds
    s_add_u32 m0, s92, 66560
    s_add_u32 s39, s35, 0
    buffer_load_dwordx4 v12, s[8:11], s39 offen lds
    s_add_u32 m0, s92, 81920
    s_add_u32 s39, s35, 131072
    buffer_load_dwordx4 v9, s[8:11], s39 offen lds
    s_add_u32 m0, s92, 82944
    s_add_u32 s39, s35, 131072
    buffer_load_dwordx4 v12, s[8:11], s39 offen lds
    s_add_u32 m0, s43, 98304
    s_add_u32 s39, s36, 262144
    buffer_load_dwordx4 v10, s[12:15], s39 offen nt lds
    s_add_u32 m0, s43, 102400
    s_add_u32 s39, s36, 393216
    buffer_load_dwordx4 v10, s[12:15], s39 offen nt lds
    s_mov_b32 s20, s88
    s_and_b32 s21, s89, 0xffff
    s_mov_b32 s22, 268435456
    s_mov_b32 s23, 0x20000
    v_mov_b32 v27, 66846720
    v_mov_b32 v26, 0
    s_mov_b32 s63, 0
    s_lshl_b32 s32, s46, 7
    v_add_u32 v5, s32, v2
    v_lshlrev_b32 v5, 7, v5
    v_lshrrev_b32 v6, 1, v2
    v_or_b32 v7, 0, v3
    v_xor_b32 v6, v6, v7
    v_lshl_add_u32 v13, v6, 4, v5
    s_lshl_b32 s32, s46, 7
    v_add_u32 v5, s32, v2
    v_lshlrev_b32 v5, 7, v5
    v_lshrrev_b32 v6, 1, v2
    v_or_b32 v7, 4, v3
    v_xor_b32 v6, v6, v7
    v_lshl_add_u32 v30, v6, 4, v5
    v_lshrrev_b32 v5, 2, v2
    v_lshl_add_u32 v8, v3, 3, v5
    v_lshlrev_b32 v8, 8, v8
    v_and_b32 v7, 1, v3
    v_lshl_or_b32 v7, v7, 2, v5
    v_and_b32 v5, 3, v2
    v_lshl_add_u32 v8, v5, 3, v8
    s_lshl_b32 s33, s45, 13
    v_add_u32 v8, s33, v8
    s_lshl_b32 s32, s47, 2
    s_add_u32 s32, s32, 0
    v_xor_b32 v5, s32, v7
    v_lshl_add_u32 v14, v5, 5, v8
    s_lshl_b32 s32, s47, 2
    s_add_u32 s32, s32, 1
    v_xor_b32 v5, s32, v7
    v_lshl_add_u32 v15, v5, 5, v8
    s_lshl_b32 s32, s47, 2
    s_add_u32 s32, s32, 2
    v_xor_b32 v5, s32, v7
    v_lshl_add_u32 v16, v5, 5, v8
    s_lshl_b32 s32, s47, 2
    s_add_u32 s32, s32, 3
    v_xor_b32 v5, s32, v7
    v_lshl_add_u32 v17, v5, 5, v8
    v_mov_b64 v[128:129], 0
    v_mov_b64 v[130:131], 0
    v_mov_b64 v[132:133], 0
    v_mov_b64 v[134:135], 0
    v_mov_b64 v[136:137], 0
    v_mov_b64 v[138:139], 0
    v_mov_b64 v[140:141], 0
    v_mov_b64 v[142:143], 0
    v_mov_b64 v[144:145], 0
    v_mov_b64 v[146:147], 0
    v_mov_b64 v[148:149], 0
    v_mov_b64 v[150:151], 0
    v_mov_b64 v[152:153], 0
    v_mov_b64 v[154:155], 0
    v_mov_b64 v[156:157], 0
    v_mov_b64 v[158:159], 0
    v_mov_b64 v[160:161], 0
    v_mov_b64 v[162:163], 0
    v_mov_b64 v[164:165], 0
    v_mov_b64 v[166:167], 0
    v_mov_b64 v[168:169], 0
    v_mov_b64 v[170:171], 0
    v_mov_b64 v[172:173], 0
    v_mov_b64 v[174:175], 0
    v_mov_b64 v[176:177], 0
    v_mov_b64 v[178:179], 0
    v_mov_b64 v[180:181], 0
    v_mov_b64 v[182:183], 0
    v_mov_b64 v[184:185], 0
    v_mov_b64 v[186:187], 0
    v_mov_b64 v[188:189], 0
    v_mov_b64 v[190:191], 0
    s_add_u32 m0, s43, 114688
    s_add_u32 s39, s36, 524288
    buffer_load_dwordx4 v10, s[12:15], s39 offen nt lds
    s_add_u32 m0, s43, 118784
    s_add_u32 s39, s36, 655360
    buffer_load_dwordx4 v10, s[12:15], s39 offen nt lds
    s_add_u32 m0, s92, 0
    s_add_u32 s39, s35, 128
    buffer_load_dwordx4 v9, s[8:11], s39 offen lds
    s_add_u32 m0, s92, 1024
    s_add_u32 s39, s35, 128
    buffer_load_dwordx4 v12, s[8:11], s39 offen lds
    s_add_u32 m0, s92, 16384
    s_add_u32 s39, s35, 131200
    buffer_load_dwordx4 v9, s[8:11], s39 offen lds
    s_add_u32 m0, s92, 17408
    s_add_u32 s39, s35, 131200
    buffer_load_dwordx4 v12, s[8:11], s39 offen lds
    s_add_u32 m0, s43, 131072
    s_add_u32 s39, s36, 786432
    buffer_load_dwordx4 v10, s[12:15], s39 offen nt lds
    s_add_u32 m0, s43, 135168
    s_add_u32 s39, s36, 917504
    buffer_load_dwordx4 v10, s[12:15], s39 offen nt lds
    s_add_u32 m0, s92, 32768
    s_add_u32 s39, s35, 256
    buffer_load_dwordx4 v9, s[8:11], s39 offen lds
    s_add_u32 m0, s92, 33792
    s_add_u32 s39, s35, 256
    buffer_load_dwordx4 v12, s[8:11], s39 offen lds
    s_add_u32 m0, s92, 49152
    s_add_u32 s39, s35, 131328
    buffer_load_dwordx4 v9, s[8:11], s39 offen lds
    s_add_u32 m0, s92, 50176
    s_add_u32 s39, s35, 131328
    buffer_load_dwordx4 v12, s[8:11], s39 offen lds
    v_mov_b64 v[192:193], 0
    v_mov_b64 v[194:195], 0
    v_mov_b64 v[196:197], 0
    v_mov_b64 v[198:199], 0
    v_mov_b64 v[200:201], 0
    v_mov_b64 v[202:203], 0
    v_mov_b64 v[204:205], 0
    v_mov_b64 v[206:207], 0
    v_mov_b64 v[208:209], 0
    v_mov_b64 v[210:211], 0
    v_mov_b64 v[212:213], 0
    v_mov_b64 v[214:215], 0
    v_mov_b64 v[216:217], 0
    v_mov_b64 v[218:219], 0
    v_mov_b64 v[220:221], 0
    v_mov_b64 v[222:223], 0
    v_mov_b64 v[224:225], 0
    v_mov_b64 v[226:227], 0
    v_mov_b64 v[228:229], 0
    v_mov_b64 v[230:231], 0
    v_mov_b64 v[232:233], 0
    v_mov_b64 v[234:235], 0
    v_mov_b64 v[236:237], 0
    v_mov_b64 v[238:239], 0
    v_mov_b64 v[240:241], 0
    v_mov_b64 v[242:243], 0
    v_mov_b64 v[244:245], 0
    v_mov_b64 v[246:247], 0
    v_mov_b64 v[248:249], 0
    v_mov_b64 v[250:251], 0
    v_mov_b64 v[252:253], 0
    v_mov_b64 v[254:255], 0
    v_add_u32 v18, 65536, v13
    v_add_u32 v19, 147456, v14
    v_add_u32 v20, 147456, v15
    v_add_u32 v21, 147456, v16
    v_add_u32 v22, 147456, v17
    s_waitcnt vmcnt(14)
    s_barrier
    ds_read_b64_tr_b16 v[64:65], v19 offset:0
    ds_read_b64_tr_b16 v[66:67], v19 offset:1024
    ds_read_b128 v[32:35], v18 offset:0
    ds_read_b128 v[36:39], v18 offset:2048
    ds_read_b64_tr_b16 v[68:69], v20 offset:0
    ds_read_b64_tr_b16 v[70:71], v20 offset:1024
    ds_read_b128 v[40:43], v18 offset:4096
    ds_read_b128 v[44:47], v18 offset:6144
    ds_read_b64_tr_b16 v[72:73], v21 offset:0
    ds_read_b64_tr_b16 v[74:75], v21 offset:1024
    ds_read_b128 v[48:51], v18 offset:8192
    ds_read_b128 v[52:55], v18 offset:10240
    ds_read_b64_tr_b16 v[76:77], v22 offset:0
    ds_read_b64_tr_b16 v[78:79], v22 offset:1024
    ds_read_b128 v[56:59], v18 offset:12288
    ds_read_b128 v[60:63], v18 offset:14336
    v_add_u32 v18, 65536, v30
    v_add_u32 v19, 98304, v14
    v_add_u32 v20, 98304, v15
    v_add_u32 v21, 98304, v16
    v_add_u32 v22, 98304, v17
    s_waitcnt vmcnt(12) lgkmcnt(0)
    s_barrier
    v_mfma_f32_16x16x32_bf16 v[128:131], v[64:67], v[32:35], v[128:131]
    ds_read_b64_tr_b16 v[112:113], v19 offset:0
    v_mfma_f32_16x16x32_bf16 v[132:135], v[68:71], v[32:35], v[132:135]
    ds_read_b64_tr_b16 v[114:115], v19 offset:1024
    v_mfma_f32_16x16x32_bf16 v[136:139], v[72:75], v[32:35], v[136:139]
    ds_read_b128 v[80:83], v18 offset:0
    v_mfma_f32_16x16x32_bf16 v[140:143], v[76:79], v[32:35], v[140:143]
    ds_read_b128 v[84:87], v18 offset:2048
    v_mfma_f32_16x16x32_bf16 v[144:147], v[64:67], v[36:39], v[144:147]
    ds_read_b64_tr_b16 v[116:117], v20 offset:0
    v_mfma_f32_16x16x32_bf16 v[148:151], v[68:71], v[36:39], v[148:151]
    ds_read_b64_tr_b16 v[118:119], v20 offset:1024
    v_mfma_f32_16x16x32_bf16 v[152:155], v[72:75], v[36:39], v[152:155]
    ds_read_b128 v[88:91], v18 offset:4096
    v_mfma_f32_16x16x32_bf16 v[156:159], v[76:79], v[36:39], v[156:159]
    ds_read_b128 v[92:95], v18 offset:6144
    v_mfma_f32_16x16x32_bf16 v[160:163], v[64:67], v[40:43], v[160:163]
    ds_read_b64_tr_b16 v[120:121], v21 offset:0
    v_mfma_f32_16x16x32_bf16 v[164:167], v[68:71], v[40:43], v[164:167]
    ds_read_b64_tr_b16 v[122:123], v21 offset:1024
    v_mfma_f32_16x16x32_bf16 v[168:171], v[72:75], v[40:43], v[168:171]
    ds_read_b128 v[96:99], v18 offset:8192
    v_mfma_f32_16x16x32_bf16 v[172:175], v[76:79], v[40:43], v[172:175]
    ds_read_b128 v[100:103], v18 offset:10240
    v_mfma_f32_16x16x32_bf16 v[176:179], v[64:67], v[44:47], v[176:179]
    ds_read_b64_tr_b16 v[124:125], v22 offset:0
    s_add_u32 m0, s43, 147456
    s_add_u32 s39, s36, 1048576
    buffer_load_dwordx4 v10, s[12:15], s39 offen nt lds
    v_mfma_f32_16x16x32_bf16 v[180:183], v[68:71], v[44:47], v[180:183]
    ds_read_b64_tr_b16 v[126:127], v22 offset:1024
    v_mfma_f32_16x16x32_bf16 v[184:187], v[72:75], v[44:47], v[184:187]
    ds_read_b128 v[104:107], v18 offset:12288
    v_mfma_f32_16x16x32_bf16 v[188:191], v[76:79], v[44:47], v[188:191]
    ds_read_b128 v[108:111], v18 offset:14336
    v_mfma_f32_16x16x32_bf16 v[192:195], v[64:67], v[48:51], v[192:195]
    s_add_u32 m0, s43, 151552
    s_add_u32 s39, s36, 1179648
    buffer_load_dwordx4 v10, s[12:15], s39 offen nt lds
    v_mfma_f32_16x16x32_bf16 v[196:199], v[68:71], v[48:51], v[196:199]
    v_mfma_f32_16x16x32_bf16 v[200:203], v[72:75], v[48:51], v[200:203]
    v_mfma_f32_16x16x32_bf16 v[204:207], v[76:79], v[48:51], v[204:207]
    v_mfma_f32_16x16x32_bf16 v[208:211], v[64:67], v[52:55], v[208:211]
    s_add_u32 m0, s43, 155648
    s_add_u32 s39, s36, 1048576
    buffer_load_dwordx4 v10, s[16:19], s39 offen nt lds
    v_mfma_f32_16x16x32_bf16 v[212:215], v[68:71], v[52:55], v[212:215]
    v_mfma_f32_16x16x32_bf16 v[216:219], v[72:75], v[52:55], v[216:219]
    v_mfma_f32_16x16x32_bf16 v[220:223], v[76:79], v[52:55], v[220:223]
    v_mfma_f32_16x16x32_bf16 v[224:227], v[64:67], v[56:59], v[224:227]
    s_add_u32 m0, s43, 159744
    s_add_u32 s39, s36, 1179648
    buffer_load_dwordx4 v10, s[16:19], s39 offen nt lds
    v_mfma_f32_16x16x32_bf16 v[228:231], v[68:71], v[56:59], v[228:231]
    v_mfma_f32_16x16x32_bf16 v[232:235], v[72:75], v[56:59], v[232:235]
    v_mfma_f32_16x16x32_bf16 v[236:239], v[76:79], v[56:59], v[236:239]
    v_mfma_f32_16x16x32_bf16 v[240:243], v[64:67], v[60:63], v[240:243]
    v_mfma_f32_16x16x32_bf16 v[244:247], v[68:71], v[60:63], v[244:247]
    v_add_u32 v18, 0, v13
    v_add_u32 v19, 114688, v14
    v_mfma_f32_16x16x32_bf16 v[248:251], v[72:75], v[60:63], v[248:251]
    v_add_u32 v20, 114688, v15
    v_add_u32 v21, 114688, v16
    v_mfma_f32_16x16x32_bf16 v[252:255], v[76:79], v[60:63], v[252:255]
    v_add_u32 v22, 114688, v17
    s_waitcnt vmcnt(10) lgkmcnt(0)
    s_barrier
    v_mfma_f32_16x16x32_bf16 v[128:131], v[112:115], v[80:83], v[128:131]
    ds_read_b64_tr_b16 v[64:65], v19 offset:0
    v_mfma_f32_16x16x32_bf16 v[132:135], v[116:119], v[80:83], v[132:135]
    ds_read_b64_tr_b16 v[66:67], v19 offset:1024
    v_mfma_f32_16x16x32_bf16 v[136:139], v[120:123], v[80:83], v[136:139]
    ds_read_b128 v[32:35], v18 offset:0
    v_mfma_f32_16x16x32_bf16 v[140:143], v[124:127], v[80:83], v[140:143]
    ds_read_b128 v[36:39], v18 offset:2048
    v_mfma_f32_16x16x32_bf16 v[144:147], v[112:115], v[84:87], v[144:147]
    ds_read_b64_tr_b16 v[68:69], v20 offset:0
    v_mfma_f32_16x16x32_bf16 v[148:151], v[116:119], v[84:87], v[148:151]
    ds_read_b64_tr_b16 v[70:71], v20 offset:1024
    v_mfma_f32_16x16x32_bf16 v[152:155], v[120:123], v[84:87], v[152:155]
    ds_read_b128 v[40:43], v18 offset:4096
    v_mfma_f32_16x16x32_bf16 v[156:159], v[124:127], v[84:87], v[156:159]
    ds_read_b128 v[44:47], v18 offset:6144
    v_mfma_f32_16x16x32_bf16 v[160:163], v[112:115], v[88:91], v[160:163]
    ds_read_b64_tr_b16 v[72:73], v21 offset:0
    v_mfma_f32_16x16x32_bf16 v[164:167], v[116:119], v[88:91], v[164:167]
    ds_read_b64_tr_b16 v[74:75], v21 offset:1024
    v_mfma_f32_16x16x32_bf16 v[168:171], v[120:123], v[88:91], v[168:171]
    ds_read_b128 v[48:51], v18 offset:8192
    v_mfma_f32_16x16x32_bf16 v[172:175], v[124:127], v[88:91], v[172:175]
    ds_read_b128 v[52:55], v18 offset:10240
    v_mfma_f32_16x16x32_bf16 v[176:179], v[112:115], v[92:95], v[176:179]
    ds_read_b64_tr_b16 v[76:77], v22 offset:0
    s_add_u32 m0, s43, 98304
    s_add_u32 s39, s36, 1310720
    buffer_load_dwordx4 v10, s[12:15], s39 offen nt lds
    v_mfma_f32_16x16x32_bf16 v[180:183], v[116:119], v[92:95], v[180:183]
    ds_read_b64_tr_b16 v[78:79], v22 offset:1024
    v_mfma_f32_16x16x32_bf16 v[184:187], v[120:123], v[92:95], v[184:187]
    ds_read_b128 v[56:59], v18 offset:12288
    s_add_u32 m0, s43, 102400
    s_add_u32 s39, s36, 1441792
    buffer_load_dwordx4 v10, s[12:15], s39 offen nt lds
    v_mfma_f32_16x16x32_bf16 v[188:191], v[124:127], v[92:95], v[188:191]
    ds_read_b128 v[60:63], v18 offset:14336
    v_mfma_f32_16x16x32_bf16 v[192:195], v[112:115], v[96:99], v[192:195]
    s_add_u32 m0, s43, 106496
    s_add_u32 s39, s36, 1310720
    buffer_load_dwordx4 v10, s[16:19], s39 offen nt lds
    v_mfma_f32_16x16x32_bf16 v[196:199], v[116:119], v[96:99], v[196:199]
    v_mfma_f32_16x16x32_bf16 v[200:203], v[120:123], v[96:99], v[200:203]
    s_add_u32 m0, s43, 110592
    s_add_u32 s39, s36, 1441792
    buffer_load_dwordx4 v10, s[16:19], s39 offen nt lds
    v_mfma_f32_16x16x32_bf16 v[204:207], v[124:127], v[96:99], v[204:207]
    v_mfma_f32_16x16x32_bf16 v[208:211], v[112:115], v[100:103], v[208:211]
    s_add_u32 m0, s92, 65536
    s_add_u32 s39, s35, 384
    buffer_load_dwordx4 v9, s[8:11], s39 offen lds
    v_mfma_f32_16x16x32_bf16 v[212:215], v[116:119], v[100:103], v[212:215]
    v_mfma_f32_16x16x32_bf16 v[216:219], v[120:123], v[100:103], v[216:219]
    s_add_u32 m0, s92, 66560
    s_add_u32 s39, s35, 384
    buffer_load_dwordx4 v12, s[8:11], s39 offen lds
    v_mfma_f32_16x16x32_bf16 v[220:223], v[124:127], v[100:103], v[220:223]
    v_mfma_f32_16x16x32_bf16 v[224:227], v[112:115], v[104:107], v[224:227]
    s_add_u32 m0, s92, 67584
    s_add_u32 s39, s35, 16768
    buffer_load_dwordx4 v9, s[8:11], s39 offen lds
    v_mfma_f32_16x16x32_bf16 v[228:231], v[116:119], v[104:107], v[228:231]
    v_mfma_f32_16x16x32_bf16 v[232:235], v[120:123], v[104:107], v[232:235]
    s_add_u32 m0, s92, 68608
    s_add_u32 s39, s35, 16768
    buffer_load_dwordx4 v12, s[8:11], s39 offen lds
    v_mfma_f32_16x16x32_bf16 v[236:239], v[124:127], v[104:107], v[236:239]
    v_mfma_f32_16x16x32_bf16 v[240:243], v[112:115], v[108:111], v[240:243]
    v_mfma_f32_16x16x32_bf16 v[244:247], v[116:119], v[108:111], v[244:247]
    v_add_u32 v18, 0, v30
    v_add_u32 v19, 131072, v14
    v_mfma_f32_16x16x32_bf16 v[248:251], v[120:123], v[108:111], v[248:251]
    v_add_u32 v20, 131072, v15
    v_add_u32 v21, 131072, v16
    v_mfma_f32_16x16x32_bf16 v[252:255], v[124:127], v[108:111], v[252:255]
    v_add_u32 v22, 131072, v17
    s_waitcnt vmcnt(16) lgkmcnt(0)
    s_barrier
    v_mfma_f32_16x16x32_bf16 v[128:131], v[64:67], v[32:35], v[128:131]
    ds_read_b64_tr_b16 v[112:113], v19 offset:0
    v_mfma_f32_16x16x32_bf16 v[132:135], v[68:71], v[32:35], v[132:135]
    ds_read_b64_tr_b16 v[114:115], v19 offset:1024
    v_mfma_f32_16x16x32_bf16 v[136:139], v[72:75], v[32:35], v[136:139]
    ds_read_b128 v[80:83], v18 offset:0
    v_mfma_f32_16x16x32_bf16 v[140:143], v[76:79], v[32:35], v[140:143]
    ds_read_b128 v[84:87], v18 offset:2048
    v_mfma_f32_16x16x32_bf16 v[144:147], v[64:67], v[36:39], v[144:147]
    ds_read_b64_tr_b16 v[116:117], v20 offset:0
    v_mfma_f32_16x16x32_bf16 v[148:151], v[68:71], v[36:39], v[148:151]
    ds_read_b64_tr_b16 v[118:119], v20 offset:1024
    v_mfma_f32_16x16x32_bf16 v[152:155], v[72:75], v[36:39], v[152:155]
    ds_read_b128 v[88:91], v18 offset:4096
    v_mfma_f32_16x16x32_bf16 v[156:159], v[76:79], v[36:39], v[156:159]
    ds_read_b128 v[92:95], v18 offset:6144
    v_mfma_f32_16x16x32_bf16 v[160:163], v[64:67], v[40:43], v[160:163]
    ds_read_b64_tr_b16 v[120:121], v21 offset:0
    v_mfma_f32_16x16x32_bf16 v[164:167], v[68:71], v[40:43], v[164:167]
    ds_read_b64_tr_b16 v[122:123], v21 offset:1024
    v_mfma_f32_16x16x32_bf16 v[168:171], v[72:75], v[40:43], v[168:171]
    ds_read_b128 v[96:99], v18 offset:8192
    v_mfma_f32_16x16x32_bf16 v[172:175], v[76:79], v[40:43], v[172:175]
    ds_read_b128 v[100:103], v18 offset:10240
    v_mfma_f32_16x16x32_bf16 v[176:179], v[64:67], v[44:47], v[176:179]
    ds_read_b64_tr_b16 v[124:125], v22 offset:0
    s_add_u32 m0, s43, 114688
    s_add_u32 s39, s36, 1572864
    buffer_load_dwordx4 v10, s[12:15], s39 offen nt lds
    v_mfma_f32_16x16x32_bf16 v[180:183], v[68:71], v[44:47], v[180:183]
    ds_read_b64_tr_b16 v[126:127], v22 offset:1024
    v_mfma_f32_16x16x32_bf16 v[184:187], v[72:75], v[44:47], v[184:187]
    ds_read_b128 v[104:107], v18 offset:12288
    s_add_u32 m0, s43, 118784
    s_add_u32 s39, s36, 1703936
    buffer_load_dwordx4 v10, s[12:15], s39 offen nt lds
    v_mfma_f32_16x16x32_bf16 v[188:191], v[76:79], v[44:47], v[188:191]
    ds_read_b128 v[108:111], v18 offset:14336
    v_mfma_f32_16x16x32_bf16 v[192:195], v[64:67], v[48:51], v[192:195]
    s_add_u32 m0, s43, 122880
    s_add_u32 s39, s36, 1572864
    buffer_load_dwordx4 v10, s[16:19], s39 offen nt lds
    v_mfma_f32_16x16x32_bf16 v[196:199], v[68:71], v[48:51], v[196:199]
    v_mfma_f32_16x16x32_bf16 v[200:203], v[72:75], v[48:51], v[200:203]
    s_add_u32 m0, s43, 126976
    s_add_u32 s39, s36, 1703936
    buffer_load_dwordx4 v10, s[16:19], s39 offen nt lds
    v_mfma_f32_16x16x32_bf16 v[204:207], v[76:79], v[48:51], v[204:207]
    v_mfma_f32_16x16x32_bf16 v[208:211], v[64:67], v[52:55], v[208:211]
    s_add_u32 m0, s92, 81920
    s_add_u32 s39, s35, 131456
    buffer_load_dwordx4 v9, s[8:11], s39 offen lds
    v_mfma_f32_16x16x32_bf16 v[212:215], v[68:71], v[52:55], v[212:215]
    v_mfma_f32_16x16x32_bf16 v[216:219], v[72:75], v[52:55], v[216:219]
    s_add_u32 m0, s92, 82944
    s_add_u32 s39, s35, 131456
    buffer_load_dwordx4 v12, s[8:11], s39 offen lds
    v_mfma_f32_16x16x32_bf16 v[220:223], v[76:79], v[52:55], v[220:223]
    v_mfma_f32_16x16x32_bf16 v[224:227], v[64:67], v[56:59], v[224:227]
    s_add_u32 m0, s92, 83968
    s_add_u32 s39, s35, 147840
    buffer_load_dwordx4 v9, s[8:11], s39 offen lds
    v_mfma_f32_16x16x32_bf16 v[228:231], v[68:71], v[56:59], v[228:231]
    v_mfma_f32_16x16x32_bf16 v[232:235], v[72:75], v[56:59], v[232:235]
    s_add_u32 m0, s92, 84992
    s_add_u32 s39, s35, 147840
    buffer_load_dwordx4 v12, s[8:11], s39 offen lds
    v_mfma_f32_16x16x32_bf16 v[236:239], v[76:79], v[56:59], v[236:239]
    v_mfma_f32_16x16x32_bf16 v[240:243], v[64:67], v[60:63], v[240:243]
    v_mfma_f32_16x16x32_bf16 v[244:247], v[68:71], v[60:63], v[244:247]
    v_add_u32 v18, 32768, v13
    v_add_u32 v19, 147456, v14
    v_mfma_f32_16x16x32_bf16 v[248:251], v[72:75], v[60:63], v[248:251]
    v_add_u32 v20, 147456, v15
    v_add_u32 v21, 147456, v16
    v_mfma_f32_16x16x32_bf16 v[252:255], v[76:79], v[60:63], v[252:255]
    v_add_u32 v22, 147456, v17
    s_waitcnt vmcnt(16) lgkmcnt(0)
    s_barrier
    v_mfma_f32_16x16x32_bf16 v[128:131], v[112:115], v[80:83], v[128:131]
    ds_read_b64_tr_b16 v[64:65], v19 offset:0
    v_mfma_f32_16x16x32_bf16 v[132:135], v[116:119], v[80:83], v[132:135]
    ds_read_b64_tr_b16 v[66:67], v19 offset:1024
    v_mfma_f32_16x16x32_bf16 v[136:139], v[120:123], v[80:83], v[136:139]
    ds_read_b128 v[32:35], v18 offset:0
    v_mfma_f32_16x16x32_bf16 v[140:143], v[124:127], v[80:83], v[140:143]
    ds_read_b128 v[36:39], v18 offset:2048
    v_mfma_f32_16x16x32_bf16 v[144:147], v[112:115], v[84:87], v[144:147]
    ds_read_b64_tr_b16 v[68:69], v20 offset:0
    v_mfma_f32_16x16x32_bf16 v[148:151], v[116:119], v[84:87], v[148:151]
    ds_read_b64_tr_b16 v[70:71], v20 offset:1024
    v_mfma_f32_16x16x32_bf16 v[152:155], v[120:123], v[84:87], v[152:155]
    ds_read_b128 v[40:43], v18 offset:4096
    v_mfma_f32_16x16x32_bf16 v[156:159], v[124:127], v[84:87], v[156:159]
    ds_read_b128 v[44:47], v18 offset:6144
    v_mfma_f32_16x16x32_bf16 v[160:163], v[112:115], v[88:91], v[160:163]
    ds_read_b64_tr_b16 v[72:73], v21 offset:0
    v_mfma_f32_16x16x32_bf16 v[164:167], v[116:119], v[88:91], v[164:167]
    ds_read_b64_tr_b16 v[74:75], v21 offset:1024
    v_mfma_f32_16x16x32_bf16 v[168:171], v[120:123], v[88:91], v[168:171]
    ds_read_b128 v[48:51], v18 offset:8192
    v_mfma_f32_16x16x32_bf16 v[172:175], v[124:127], v[88:91], v[172:175]
    ds_read_b128 v[52:55], v18 offset:10240
    v_mfma_f32_16x16x32_bf16 v[176:179], v[112:115], v[92:95], v[176:179]
    ds_read_b64_tr_b16 v[76:77], v22 offset:0
    s_add_u32 m0, s43, 131072
    s_add_u32 s39, s36, 1835008
    buffer_load_dwordx4 v10, s[12:15], s39 offen nt lds
    v_mfma_f32_16x16x32_bf16 v[180:183], v[116:119], v[92:95], v[180:183]
    ds_read_b64_tr_b16 v[78:79], v22 offset:1024
    v_mfma_f32_16x16x32_bf16 v[184:187], v[120:123], v[92:95], v[184:187]
    ds_read_b128 v[56:59], v18 offset:12288
    s_add_u32 m0, s43, 135168
    s_add_u32 s39, s36, 1966080
    buffer_load_dwordx4 v10, s[12:15], s39 offen nt lds
    v_mfma_f32_16x16x32_bf16 v[188:191], v[124:127], v[92:95], v[188:191]
    ds_read_b128 v[60:63], v18 offset:14336
    v_mfma_f32_16x16x32_bf16 v[192:195], v[112:115], v[96:99], v[192:195]
    s_add_u32 m0, s43, 139264
    s_add_u32 s39, s36, 1835008
    buffer_load_dwordx4 v10, s[16:19], s39 offen nt lds
    v_mfma_f32_16x16x32_bf16 v[196:199], v[116:119], v[96:99], v[196:199]
    v_mfma_f32_16x16x32_bf16 v[200:203], v[120:123], v[96:99], v[200:203]
    s_add_u32 m0, s43, 143360
    s_add_u32 s39, s36, 1966080
    buffer_load_dwordx4 v10, s[16:19], s39 offen nt lds
    v_mfma_f32_16x16x32_bf16 v[204:207], v[124:127], v[96:99], v[204:207]
    v_mfma_f32_16x16x32_bf16 v[208:211], v[112:115], v[100:103], v[208:211]
    s_add_u32 m0, s92, 0
    s_add_u32 s39, s35, 512
    buffer_load_dwordx4 v9, s[8:11], s39 offen lds
    v_mfma_f32_16x16x32_bf16 v[212:215], v[116:119], v[100:103], v[212:215]
    v_mfma_f32_16x16x32_bf16 v[216:219], v[120:123], v[100:103], v[216:219]
    s_add_u32 m0, s92, 1024
    s_add_u32 s39, s35, 512
    buffer_load_dwordx4 v12, s[8:11], s39 offen lds
    v_mfma_f32_16x16x32_bf16 v[220:223], v[124:127], v[100:103], v[220:223]
    v_mfma_f32_16x16x32_bf16 v[224:227], v[112:115], v[104:107], v[224:227]
    s_add_u32 m0, s92, 2048
    s_add_u32 s39, s35, 16896
    buffer_load_dwordx4 v9, s[8:11], s39 offen lds
    v_mfma_f32_16x16x32_bf16 v[228:231], v[116:119], v[104:107], v[228:231]
    v_mfma_f32_16x16x32_bf16 v[232:235], v[120:123], v[104:107], v[232:235]
    s_add_u32 m0, s92, 3072
    s_add_u32 s39, s35, 16896
    buffer_load_dwordx4 v12, s[8:11], s39 offen lds
    v_mfma_f32_16x16x32_bf16 v[236:239], v[124:127], v[104:107], v[236:239]
    v_mfma_f32_16x16x32_bf16 v[240:243], v[112:115], v[108:111], v[240:243]
    v_mfma_f32_16x16x32_bf16 v[244:247], v[116:119], v[108:111], v[244:247]
    v_add_u32 v18, 32768, v30
    v_add_u32 v19, 98304, v14
    v_mfma_f32_16x16x32_bf16 v[248:251], v[120:123], v[108:111], v[248:251]
    v_add_u32 v20, 98304, v15
    v_add_u32 v21, 98304, v16
    v_mfma_f32_16x16x32_bf16 v[252:255], v[124:127], v[108:111], v[252:255]
    v_add_u32 v22, 98304, v17
    s_waitcnt vmcnt(20) lgkmcnt(0)
    s_barrier
    v_mfma_f32_16x16x32_bf16 v[128:131], v[64:67], v[32:35], v[128:131]
    ds_read_b64_tr_b16 v[112:113], v19 offset:0
    v_mfma_f32_16x16x32_bf16 v[132:135], v[68:71], v[32:35], v[132:135]
    ds_read_b64_tr_b16 v[114:115], v19 offset:1024
    v_mfma_f32_16x16x32_bf16 v[136:139], v[72:75], v[32:35], v[136:139]
    ds_read_b128 v[80:83], v18 offset:0
    v_mfma_f32_16x16x32_bf16 v[140:143], v[76:79], v[32:35], v[140:143]
    ds_read_b128 v[84:87], v18 offset:2048
    v_mfma_f32_16x16x32_bf16 v[144:147], v[64:67], v[36:39], v[144:147]
    ds_read_b64_tr_b16 v[116:117], v20 offset:0
    v_mfma_f32_16x16x32_bf16 v[148:151], v[68:71], v[36:39], v[148:151]
    ds_read_b64_tr_b16 v[118:119], v20 offset:1024
    v_mfma_f32_16x16x32_bf16 v[152:155], v[72:75], v[36:39], v[152:155]
    ds_read_b128 v[88:91], v18 offset:4096
    v_mfma_f32_16x16x32_bf16 v[156:159], v[76:79], v[36:39], v[156:159]
    ds_read_b128 v[92:95], v18 offset:6144
    v_mfma_f32_16x16x32_bf16 v[160:163], v[64:67], v[40:43], v[160:163]
    ds_read_b64_tr_b16 v[120:121], v21 offset:0
    v_mfma_f32_16x16x32_bf16 v[164:167], v[68:71], v[40:43], v[164:167]
    ds_read_b64_tr_b16 v[122:123], v21 offset:1024
    v_mfma_f32_16x16x32_bf16 v[168:171], v[72:75], v[40:43], v[168:171]
    ds_read_b128 v[96:99], v18 offset:8192
    v_mfma_f32_16x16x32_bf16 v[172:175], v[76:79], v[40:43], v[172:175]
    ds_read_b128 v[100:103], v18 offset:10240
    v_mfma_f32_16x16x32_bf16 v[176:179], v[64:67], v[44:47], v[176:179]
    ds_read_b64_tr_b16 v[124:125], v22 offset:0
    s_add_u32 m0, s43, 147456
    s_add_u32 s39, s36, 2097152
    buffer_load_dwordx4 v10, s[12:15], s39 offen nt lds
    v_mfma_f32_16x16x32_bf16 v[180:183], v[68:71], v[44:47], v[180:183]
    ds_read_b64_tr_b16 v[126:127], v22 offset:1024
    v_mfma_f32_16x16x32_bf16 v[184:187], v[72:75], v[44:47], v[184:187]
    ds_read_b128 v[104:107], v18 offset:12288
    s_add_u32 m0, s43, 151552
    s_add_u32 s39, s36, 2228224
    buffer_load_dwordx4 v10, s[12:15], s39 offen nt lds
    v_mfma_f32_16x16x32_bf16 v[188:191], v[76:79], v[44:47], v[188:191]
    ds_read_b128 v[108:111], v18 offset:14336
    v_mfma_f32_16x16x32_bf16 v[192:195], v[64:67], v[48:51], v[192:195]
    s_add_u32 m0, s43, 155648
    s_add_u32 s39, s36, 2097152
    buffer_load_dwordx4 v10, s[16:19], s39 offen nt lds
    v_mfma_f32_16x16x32_bf16 v[196:199], v[68:71], v[48:51], v[196:199]
    v_mfma_f32_16x16x32_bf16 v[200:203], v[72:75], v[48:51], v[200:203]
    s_add_u32 m0, s43, 159744
    s_add_u32 s39, s36, 2228224
    buffer_load_dwordx4 v10, s[16:19], s39 offen nt lds
    v_mfma_f32_16x16x32_bf16 v[204:207], v[76:79], v[48:51], v[204:207]
    v_mfma_f32_16x16x32_bf16 v[208:211], v[64:67], v[52:55], v[208:211]
    s_add_u32 m0, s92, 16384
    s_add_u32 s39, s35, 131584
    buffer_load_dwordx4 v9, s[8:11], s39 offen lds
    v_mfma_f32_16x16x32_bf16 v[212:215], v[68:71], v[52:55], v[212:215]
    v_mfma_f32_16x16x32_bf16 v[216:219], v[72:75], v[52:55], v[216:219]
    s_add_u32 m0, s92, 17408
    s_add_u32 s39, s35, 131584
    buffer_load_dwordx4 v12, s[8:11], s39 offen lds
    v_mfma_f32_16x16x32_bf16 v[220:223], v[76:79], v[52:55], v[220:223]
    v_mfma_f32_16x16x32_bf16 v[224:227], v[64:67], v[56:59], v[224:227]
    s_add_u32 m0, s92, 18432
    s_add_u32 s39, s35, 147968
    buffer_load_dwordx4 v9, s[8:11], s39 offen lds
    v_mfma_f32_16x16x32_bf16 v[228:231], v[68:71], v[56:59], v[228:231]
    v_mfma_f32_16x16x32_bf16 v[232:235], v[72:75], v[56:59], v[232:235]
    s_add_u32 m0, s92, 19456
    s_add_u32 s39, s35, 147968
    buffer_load_dwordx4 v12, s[8:11], s39 offen lds
    v_mfma_f32_16x16x32_bf16 v[236:239], v[76:79], v[56:59], v[236:239]
    v_mfma_f32_16x16x32_bf16 v[240:243], v[64:67], v[60:63], v[240:243]
    v_mfma_f32_16x16x32_bf16 v[244:247], v[68:71], v[60:63], v[244:247]
    v_add_u32 v18, 65536, v13
    v_add_u32 v19, 114688, v14
    v_mfma_f32_16x16x32_bf16 v[248:251], v[72:75], v[60:63], v[248:251]
    v_add_u32 v20, 114688, v15
    v_add_u32 v21, 114688, v16
    v_mfma_f32_16x16x32_bf16 v[252:255], v[76:79], v[60:63], v[252:255]
    v_add_u32 v22, 114688, v17
    s_waitcnt vmcnt(16) lgkmcnt(0)
    s_barrier
    v_mfma_f32_16x16x32_bf16 v[128:131], v[112:115], v[80:83], v[128:131]
    ds_read_b64_tr_b16 v[64:65], v19 offset:0
    v_lshrrev_b32 v5, 3, v1
    v_mul_u32_u24 v5, 1152, v5
    v_and_b32 v6, 7, v1
    v_xor_b32 v6, v6, v3
    v_mfma_f32_16x16x32_bf16 v[132:135], v[116:119], v[80:83], v[132:135]
    ds_read_b64_tr_b16 v[66:67], v19 offset:1024
    v_mfma_f32_16x16x32_bf16 v[136:139], v[120:123], v[80:83], v[136:139]
    ds_read_b128 v[32:35], v18 offset:0
    v_lshl_add_u32 v11, v6, 4, v5
    v_xor_b32 v6, 4, v6
    v_lshl_add_u32 v24, v6, 4, v5
    v_add_u32 v24, 9216, v24
    v_mfma_f32_16x16x32_bf16 v[140:143], v[124:127], v[80:83], v[140:143]
    ds_read_b128 v[36:39], v18 offset:2048
    v_mfma_f32_16x16x32_bf16 v[144:147], v[112:115], v[84:87], v[144:147]
    ds_read_b64_tr_b16 v[68:69], v20 offset:0
    s_lshl_b32 s32, s7, 2
    s_add_u32 s32, s32, s40
    s_mul_i32 s37, s32, 36864
    s_mul_i32 s44, s6, 72
    v_mfma_f32_16x16x32_bf16 v[148:151], v[116:119], v[84:87], v[148:151]
    ds_read_b64_tr_b16 v[70:71], v20 offset:1024
    v_mfma_f32_16x16x32_bf16 v[152:155], v[120:123], v[84:87], v[152:155]
    ds_read_b128 v[40:43], v18 offset:4096
    s_and_b32 s44, s44, 15
    s_mul_i32 s38, s6, 147456
    s_add_u32 s38, s38, s43
    s_add_u32 s38, s38, 69206016
    v_mfma_f32_16x16x32_bf16 v[156:159], v[124:127], v[84:87], v[156:159]
    ds_read_b128 v[44:47], v18 offset:6144
    v_mfma_f32_16x16x32_bf16 v[160:163], v[112:115], v[88:91], v[160:163]
    ds_read_b64_tr_b16 v[72:73], v21 offset:0
    v_mfma_f32_16x16x32_bf16 v[164:167], v[116:119], v[88:91], v[164:167]
    ds_read_b64_tr_b16 v[74:75], v21 offset:1024
    s_sub_u32 s32, 15, s5
    s_lshl_b32 s32, s32, 7
    s_lshl_b32 s33, s40, 5
    s_add_u32 s59, s32, s33
    v_mfma_f32_16x16x32_bf16 v[168:171], v[120:123], v[88:91], v[168:171]
    ds_read_b128 v[48:51], v18 offset:8192
    v_mfma_f32_16x16x32_bf16 v[172:175], v[124:127], v[88:91], v[172:175]
    ds_read_b128 v[52:55], v18 offset:10240
    s_lshl_b32 s32, s5, 7
    s_add_u32 s32, s32, s33
    s_mul_i32 s90, s32, 1152
    s_mul_i32 s91, s59, 1152
    v_mfma_f32_16x16x32_bf16 v[176:179], v[112:115], v[92:95], v[176:179]
    ds_read_b64_tr_b16 v[76:77], v22 offset:0
    s_add_u32 m0, s43, 98304
    s_add_u32 s39, s36, 2359296
    buffer_load_dwordx4 v10, s[12:15], s39 offen nt lds
    v_mfma_f32_16x16x32_bf16 v[180:183], v[116:119], v[92:95], v[180:183]
    ds_read_b64_tr_b16 v[78:79], v22 offset:1024
    s_cmp_eq_u32 s45, 0
    s_cselect_b32 s58, s32, s59
    v_mfma_f32_16x16x32_bf16 v[184:187], v[120:123], v[92:95], v[184:187]
    ds_read_b128 v[56:59], v18 offset:12288
    s_add_u32 m0, s43, 102400
    s_add_u32 s39, s36, 2490368
    buffer_load_dwordx4 v10, s[12:15], s39 offen nt lds
    v_mfma_f32_16x16x32_bf16 v[188:191], v[124:127], v[92:95], v[188:191]
    ds_read_b128 v[60:63], v18 offset:14336
    v_mfma_f32_16x16x32_bf16 v[192:195], v[112:115], v[96:99], v[192:195]
    s_add_u32 m0, s43, 106496
    s_add_u32 s39, s36, 2359296
    buffer_load_dwordx4 v10, s[16:19], s39 offen nt lds
    v_mfma_f32_16x16x32_bf16 v[196:199], v[116:119], v[96:99], v[196:199]
    v_mfma_f32_16x16x32_bf16 v[200:203], v[120:123], v[96:99], v[200:203]
    s_add_u32 m0, s43, 110592
    s_add_u32 s39, s36, 2490368
    buffer_load_dwordx4 v10, s[16:19], s39 offen nt lds
    v_mfma_f32_16x16x32_bf16 v[204:207], v[124:127], v[96:99], v[204:207]
    v_mfma_f32_16x16x32_bf16 v[208:211], v[112:115], v[100:103], v[208:211]
    s_add_u32 m0, s92, 32768
    s_add_u32 s39, s35, 640
    buffer_load_dwordx4 v9, s[8:11], s39 offen lds
    v_mfma_f32_16x16x32_bf16 v[212:215], v[116:119], v[100:103], v[212:215]
    v_mfma_f32_16x16x32_bf16 v[216:219], v[120:123], v[100:103], v[216:219]
    s_add_u32 m0, s92, 33792
    s_add_u32 s39, s35, 640
    buffer_load_dwordx4 v12, s[8:11], s39 offen lds
    v_mfma_f32_16x16x32_bf16 v[220:223], v[124:127], v[100:103], v[220:223]
    v_mfma_f32_16x16x32_bf16 v[224:227], v[112:115], v[104:107], v[224:227]
    s_add_u32 m0, s92, 34816
    s_add_u32 s39, s35, 17024
    buffer_load_dwordx4 v9, s[8:11], s39 offen lds
    v_mfma_f32_16x16x32_bf16 v[228:231], v[116:119], v[104:107], v[228:231]
    v_mfma_f32_16x16x32_bf16 v[232:235], v[120:123], v[104:107], v[232:235]
    s_add_u32 m0, s92, 35840
    s_add_u32 s39, s35, 17024
    buffer_load_dwordx4 v12, s[8:11], s39 offen lds
    v_mfma_f32_16x16x32_bf16 v[236:239], v[124:127], v[104:107], v[236:239]
    v_mfma_f32_16x16x32_bf16 v[240:243], v[112:115], v[108:111], v[240:243]
    v_mfma_f32_16x16x32_bf16 v[244:247], v[116:119], v[108:111], v[244:247]
    v_add_u32 v18, 65536, v30
    v_add_u32 v19, 131072, v14
    v_mfma_f32_16x16x32_bf16 v[248:251], v[120:123], v[108:111], v[248:251]
    v_add_u32 v20, 131072, v15
    v_add_u32 v21, 131072, v16
    v_mfma_f32_16x16x32_bf16 v[252:255], v[124:127], v[108:111], v[252:255]
    v_add_u32 v22, 131072, v17
    s_waitcnt vmcnt(20) lgkmcnt(0)
    s_barrier
    v_mfma_f32_16x16x32_bf16 v[128:131], v[64:67], v[32:35], v[128:131]
    ds_read_b64_tr_b16 v[112:113], v19 offset:0
    v_mfma_f32_16x16x32_bf16 v[132:135], v[68:71], v[32:35], v[132:135]
    ds_read_b64_tr_b16 v[114:115], v19 offset:1024
    v_mfma_f32_16x16x32_bf16 v[136:139], v[72:75], v[32:35], v[136:139]
    ds_read_b128 v[80:83], v18 offset:0
    v_mfma_f32_16x16x32_bf16 v[140:143], v[76:79], v[32:35], v[140:143]
    ds_read_b128 v[84:87], v18 offset:2048
    v_mfma_f32_16x16x32_bf16 v[144:147], v[64:67], v[36:39], v[144:147]
    ds_read_b64_tr_b16 v[116:117], v20 offset:0
    v_mfma_f32_16x16x32_bf16 v[148:151], v[68:71], v[36:39], v[148:151]
    ds_read_b64_tr_b16 v[118:119], v20 offset:1024
    v_mfma_f32_16x16x32_bf16 v[152:155], v[72:75], v[36:39], v[152:155]
    ds_read_b128 v[88:91], v18 offset:4096
    v_mfma_f32_16x16x32_bf16 v[156:159], v[76:79], v[36:39], v[156:159]
    ds_read_b128 v[92:95], v18 offset:6144
    v_mfma_f32_16x16x32_bf16 v[160:163], v[64:67], v[40:43], v[160:163]
    ds_read_b64_tr_b16 v[120:121], v21 offset:0
    v_mfma_f32_16x16x32_bf16 v[164:167], v[68:71], v[40:43], v[164:167]
    ds_read_b64_tr_b16 v[122:123], v21 offset:1024
    v_mfma_f32_16x16x32_bf16 v[168:171], v[72:75], v[40:43], v[168:171]
    ds_read_b128 v[96:99], v18 offset:8192
    v_mfma_f32_16x16x32_bf16 v[172:175], v[76:79], v[40:43], v[172:175]
    ds_read_b128 v[100:103], v18 offset:10240
    v_mfma_f32_16x16x32_bf16 v[176:179], v[64:67], v[44:47], v[176:179]
    ds_read_b64_tr_b16 v[124:125], v22 offset:0
    s_add_u32 m0, s43, 114688
    s_add_u32 s39, s36, 2621440
    buffer_load_dwordx4 v10, s[12:15], s39 offen nt lds
    v_mfma_f32_16x16x32_bf16 v[180:183], v[68:71], v[44:47], v[180:183]
    ds_read_b64_tr_b16 v[126:127], v22 offset:1024
    v_mfma_f32_16x16x32_bf16 v[184:187], v[72:75], v[44:47], v[184:187]
    ds_read_b128 v[104:107], v18 offset:12288
    s_add_u32 m0, s43, 118784
    s_add_u32 s39, s36, 2752512
    buffer_load_dwordx4 v10, s[12:15], s39 offen nt lds
    v_mfma_f32_16x16x32_bf16 v[188:191], v[76:79], v[44:47], v[188:191]
    ds_read_b128 v[108:111], v18 offset:14336
    v_mfma_f32_16x16x32_bf16 v[192:195], v[64:67], v[48:51], v[192:195]
    s_add_u32 m0, s43, 122880
    s_add_u32 s39, s36, 2621440
    buffer_load_dwordx4 v10, s[16:19], s39 offen nt lds
    v_mfma_f32_16x16x32_bf16 v[196:199], v[68:71], v[48:51], v[196:199]
    v_mfma_f32_16x16x32_bf16 v[200:203], v[72:75], v[48:51], v[200:203]
    s_add_u32 m0, s43, 126976
    s_add_u32 s39, s36, 2752512
    buffer_load_dwordx4 v10, s[16:19], s39 offen nt lds
    v_mfma_f32_16x16x32_bf16 v[204:207], v[76:79], v[48:51], v[204:207]
    v_mfma_f32_16x16x32_bf16 v[208:211], v[64:67], v[52:55], v[208:211]
    s_add_u32 m0, s92, 49152
    s_add_u32 s39, s35, 131712
    buffer_load_dwordx4 v9, s[8:11], s39 offen lds
    v_mfma_f32_16x16x32_bf16 v[212:215], v[68:71], v[52:55], v[212:215]
    v_mfma_f32_16x16x32_bf16 v[216:219], v[72:75], v[52:55], v[216:219]
    s_add_u32 m0, s92, 50176
    s_add_u32 s39, s35, 131712
    buffer_load_dwordx4 v12, s[8:11], s39 offen lds
    v_mfma_f32_16x16x32_bf16 v[220:223], v[76:79], v[52:55], v[220:223]
    v_mfma_f32_16x16x32_bf16 v[224:227], v[64:67], v[56:59], v[224:227]
    s_add_u32 m0, s92, 51200
    s_add_u32 s39, s35, 148096
    buffer_load_dwordx4 v9, s[8:11], s39 offen lds
    v_mfma_f32_16x16x32_bf16 v[228:231], v[68:71], v[56:59], v[228:231]
    v_mfma_f32_16x16x32_bf16 v[232:235], v[72:75], v[56:59], v[232:235]
    s_add_u32 m0, s92, 52224
    s_add_u32 s39, s35, 148096
    buffer_load_dwordx4 v12, s[8:11], s39 offen lds
    v_mfma_f32_16x16x32_bf16 v[236:239], v[76:79], v[56:59], v[236:239]
    v_mfma_f32_16x16x32_bf16 v[240:243], v[64:67], v[60:63], v[240:243]
    v_mfma_f32_16x16x32_bf16 v[244:247], v[68:71], v[60:63], v[244:247]
    v_add_u32 v18, 0, v13
    v_add_u32 v19, 147456, v14
    v_mfma_f32_16x16x32_bf16 v[248:251], v[72:75], v[60:63], v[248:251]
    v_add_u32 v20, 147456, v15
    v_add_u32 v21, 147456, v16
    v_mfma_f32_16x16x32_bf16 v[252:255], v[76:79], v[60:63], v[252:255]
    v_add_u32 v22, 147456, v17
    s_waitcnt vmcnt(16) lgkmcnt(0)
    s_barrier
    v_mfma_f32_16x16x32_bf16 v[128:131], v[112:115], v[80:83], v[128:131]
    ds_read_b64_tr_b16 v[64:65], v19 offset:0
    v_mfma_f32_16x16x32_bf16 v[132:135], v[116:119], v[80:83], v[132:135]
    ds_read_b64_tr_b16 v[66:67], v19 offset:1024
    v_mfma_f32_16x16x32_bf16 v[136:139], v[120:123], v[80:83], v[136:139]
    ds_read_b128 v[32:35], v18 offset:0
    v_mfma_f32_16x16x32_bf16 v[140:143], v[124:127], v[80:83], v[140:143]
    ds_read_b128 v[36:39], v18 offset:2048
    v_mfma_f32_16x16x32_bf16 v[144:147], v[112:115], v[84:87], v[144:147]
    ds_read_b64_tr_b16 v[68:69], v20 offset:0
    v_mfma_f32_16x16x32_bf16 v[148:151], v[116:119], v[84:87], v[148:151]
    ds_read_b64_tr_b16 v[70:71], v20 offset:1024
    v_mfma_f32_16x16x32_bf16 v[152:155], v[120:123], v[84:87], v[152:155]
    ds_read_b128 v[40:43], v18 offset:4096
    v_mfma_f32_16x16x32_bf16 v[156:159], v[124:127], v[84:87], v[156:159]
    ds_read_b128 v[44:47], v18 offset:6144
    v_mfma_f32_16x16x32_bf16 v[160:163], v[112:115], v[88:91], v[160:163]
    ds_read_b64_tr_b16 v[72:73], v21 offset:0
    v_mfma_f32_16x16x32_bf16 v[164:167], v[116:119], v[88:91], v[164:167]
    ds_read_b64_tr_b16 v[74:75], v21 offset:1024
    v_mfma_f32_16x16x32_bf16 v[168:171], v[120:123], v[88:91], v[168:171]
    ds_read_b128 v[48:51], v18 offset:8192
    v_mfma_f32_16x16x32_bf16 v[172:175], v[124:127], v[88:91], v[172:175]
    ds_read_b128 v[52:55], v18 offset:10240
    v_mfma_f32_16x16x32_bf16 v[176:179], v[112:115], v[92:95], v[176:179]
    ds_read_b64_tr_b16 v[76:77], v22 offset:0
    s_add_u32 m0, s43, 131072
    s_add_u32 s39, s36, 2883584
    buffer_load_dwordx4 v10, s[12:15], s39 offen nt lds
    v_mfma_f32_16x16x32_bf16 v[180:183], v[116:119], v[92:95], v[180:183]
    ds_read_b64_tr_b16 v[78:79], v22 offset:1024
    v_mfma_f32_16x16x32_bf16 v[184:187], v[120:123], v[92:95], v[184:187]
    ds_read_b128 v[56:59], v18 offset:12288
    s_add_u32 m0, s43, 135168
    s_add_u32 s39, s36, 3014656
    buffer_load_dwordx4 v10, s[12:15], s39 offen nt lds
    v_mfma_f32_16x16x32_bf16 v[188:191], v[124:127], v[92:95], v[188:191]
    ds_read_b128 v[60:63], v18 offset:14336
    v_mfma_f32_16x16x32_bf16 v[192:195], v[112:115], v[96:99], v[192:195]
    s_add_u32 m0, s43, 139264
    s_add_u32 s39, s36, 2883584
    buffer_load_dwordx4 v10, s[16:19], s39 offen nt lds
    v_mfma_f32_16x16x32_bf16 v[196:199], v[116:119], v[96:99], v[196:199]
    v_mfma_f32_16x16x32_bf16 v[200:203], v[120:123], v[96:99], v[200:203]
    s_add_u32 m0, s43, 143360
    s_add_u32 s39, s36, 3014656
    buffer_load_dwordx4 v10, s[16:19], s39 offen nt lds
    v_mfma_f32_16x16x32_bf16 v[204:207], v[124:127], v[96:99], v[204:207]
    v_mfma_f32_16x16x32_bf16 v[208:211], v[112:115], v[100:103], v[208:211]
    s_add_u32 m0, s92, 65536
    s_add_u32 s39, s35, 768
    buffer_load_dwordx4 v9, s[8:11], s39 offen lds
    v_mfma_f32_16x16x32_bf16 v[212:215], v[116:119], v[100:103], v[212:215]
    v_mfma_f32_16x16x32_bf16 v[216:219], v[120:123], v[100:103], v[216:219]
    s_add_u32 m0, s92, 66560
    s_add_u32 s39, s35, 768
    buffer_load_dwordx4 v12, s[8:11], s39 offen lds
    v_mfma_f32_16x16x32_bf16 v[220:223], v[124:127], v[100:103], v[220:223]
    v_mfma_f32_16x16x32_bf16 v[224:227], v[112:115], v[104:107], v[224:227]
    s_add_u32 m0, s92, 67584
    s_add_u32 s39, s35, 17152
    buffer_load_dwordx4 v9, s[8:11], s39 offen lds
    v_mfma_f32_16x16x32_bf16 v[228:231], v[116:119], v[104:107], v[228:231]
    v_mfma_f32_16x16x32_bf16 v[232:235], v[120:123], v[104:107], v[232:235]
    s_add_u32 m0, s92, 68608
    s_add_u32 s39, s35, 17152
    buffer_load_dwordx4 v12, s[8:11], s39 offen lds
    v_mfma_f32_16x16x32_bf16 v[236:239], v[124:127], v[104:107], v[236:239]
    v_mfma_f32_16x16x32_bf16 v[240:243], v[112:115], v[108:111], v[240:243]
    v_mfma_f32_16x16x32_bf16 v[244:247], v[116:119], v[108:111], v[244:247]
    v_add_u32 v18, 0, v30
    v_add_u32 v19, 98304, v14
    v_mfma_f32_16x16x32_bf16 v[248:251], v[120:123], v[108:111], v[248:251]
    v_add_u32 v20, 98304, v15
    v_add_u32 v21, 98304, v16
    v_mfma_f32_16x16x32_bf16 v[252:255], v[124:127], v[108:111], v[252:255]
    v_add_u32 v22, 98304, v17
    s_waitcnt vmcnt(20) lgkmcnt(0)
    s_barrier
    v_mfma_f32_16x16x32_bf16 v[128:131], v[64:67], v[32:35], v[128:131]
    ds_read_b64_tr_b16 v[112:113], v19 offset:0
    v_mfma_f32_16x16x32_bf16 v[132:135], v[68:71], v[32:35], v[132:135]
    ds_read_b64_tr_b16 v[114:115], v19 offset:1024
    v_mfma_f32_16x16x32_bf16 v[136:139], v[72:75], v[32:35], v[136:139]
    ds_read_b128 v[80:83], v18 offset:0
    v_mfma_f32_16x16x32_bf16 v[140:143], v[76:79], v[32:35], v[140:143]
    ds_read_b128 v[84:87], v18 offset:2048
    v_mfma_f32_16x16x32_bf16 v[144:147], v[64:67], v[36:39], v[144:147]
    ds_read_b64_tr_b16 v[116:117], v20 offset:0
    v_mfma_f32_16x16x32_bf16 v[148:151], v[68:71], v[36:39], v[148:151]
    ds_read_b64_tr_b16 v[118:119], v20 offset:1024
    v_mfma_f32_16x16x32_bf16 v[152:155], v[72:75], v[36:39], v[152:155]
    ds_read_b128 v[88:91], v18 offset:4096
    v_mfma_f32_16x16x32_bf16 v[156:159], v[76:79], v[36:39], v[156:159]
    ds_read_b128 v[92:95], v18 offset:6144
    v_mfma_f32_16x16x32_bf16 v[160:163], v[64:67], v[40:43], v[160:163]
    ds_read_b64_tr_b16 v[120:121], v21 offset:0
    v_mfma_f32_16x16x32_bf16 v[164:167], v[68:71], v[40:43], v[164:167]
    ds_read_b64_tr_b16 v[122:123], v21 offset:1024
    v_mfma_f32_16x16x32_bf16 v[168:171], v[72:75], v[40:43], v[168:171]
    ds_read_b128 v[96:99], v18 offset:8192
    v_mfma_f32_16x16x32_bf16 v[172:175], v[76:79], v[40:43], v[172:175]
    ds_read_b128 v[100:103], v18 offset:10240
    v_mfma_f32_16x16x32_bf16 v[176:179], v[64:67], v[44:47], v[176:179]
    ds_read_b64_tr_b16 v[124:125], v22 offset:0
    s_add_u32 m0, s43, 147456
    s_add_u32 s39, s36, 3145728
    buffer_load_dwordx4 v10, s[12:15], s39 offen nt lds
    v_mfma_f32_16x16x32_bf16 v[180:183], v[68:71], v[44:47], v[180:183]
    ds_read_b64_tr_b16 v[126:127], v22 offset:1024
    v_mfma_f32_16x16x32_bf16 v[184:187], v[72:75], v[44:47], v[184:187]
    ds_read_b128 v[104:107], v18 offset:12288
    s_add_u32 m0, s43, 151552
    s_add_u32 s39, s36, 3276800
    buffer_load_dwordx4 v10, s[12:15], s39 offen nt lds
    v_mfma_f32_16x16x32_bf16 v[188:191], v[76:79], v[44:47], v[188:191]
    ds_read_b128 v[108:111], v18 offset:14336
    v_mfma_f32_16x16x32_bf16 v[192:195], v[64:67], v[48:51], v[192:195]
    s_add_u32 m0, s43, 155648
    s_add_u32 s39, s36, 3145728
    buffer_load_dwordx4 v10, s[16:19], s39 offen nt lds
    v_mfma_f32_16x16x32_bf16 v[196:199], v[68:71], v[48:51], v[196:199]
    v_mfma_f32_16x16x32_bf16 v[200:203], v[72:75], v[48:51], v[200:203]
    s_add_u32 m0, s43, 159744
    s_add_u32 s39, s36, 3276800
    buffer_load_dwordx4 v10, s[16:19], s39 offen nt lds
    v_mfma_f32_16x16x32_bf16 v[204:207], v[76:79], v[48:51], v[204:207]
    v_mfma_f32_16x16x32_bf16 v[208:211], v[64:67], v[52:55], v[208:211]
    s_add_u32 m0, s92, 81920
    s_add_u32 s39, s35, 131840
    buffer_load_dwordx4 v9, s[8:11], s39 offen lds
    v_mfma_f32_16x16x32_bf16 v[212:215], v[68:71], v[52:55], v[212:215]
    v_mfma_f32_16x16x32_bf16 v[216:219], v[72:75], v[52:55], v[216:219]
    s_add_u32 m0, s92, 82944
    s_add_u32 s39, s35, 131840
    buffer_load_dwordx4 v12, s[8:11], s39 offen lds
    v_mfma_f32_16x16x32_bf16 v[220:223], v[76:79], v[52:55], v[220:223]
    v_mfma_f32_16x16x32_bf16 v[224:227], v[64:67], v[56:59], v[224:227]
    s_add_u32 m0, s92, 83968
    s_add_u32 s39, s35, 148224
    buffer_load_dwordx4 v9, s[8:11], s39 offen lds
    v_mfma_f32_16x16x32_bf16 v[228:231], v[68:71], v[56:59], v[228:231]
    v_mfma_f32_16x16x32_bf16 v[232:235], v[72:75], v[56:59], v[232:235]
    s_add_u32 m0, s92, 84992
    s_add_u32 s39, s35, 148224
    buffer_load_dwordx4 v12, s[8:11], s39 offen lds
    v_mfma_f32_16x16x32_bf16 v[236:239], v[76:79], v[56:59], v[236:239]
    v_mfma_f32_16x16x32_bf16 v[240:243], v[64:67], v[60:63], v[240:243]
    v_mfma_f32_16x16x32_bf16 v[244:247], v[68:71], v[60:63], v[244:247]
    v_add_u32 v18, 32768, v13
    v_add_u32 v19, 114688, v14
    v_mfma_f32_16x16x32_bf16 v[248:251], v[72:75], v[60:63], v[248:251]
    v_add_u32 v20, 114688, v15
    v_add_u32 v21, 114688, v16
    v_mfma_f32_16x16x32_bf16 v[252:255], v[76:79], v[60:63], v[252:255]
    v_add_u32 v22, 114688, v17
    s_waitcnt vmcnt(16) lgkmcnt(0)
    s_barrier
    v_mfma_f32_16x16x32_bf16 v[128:131], v[112:115], v[80:83], v[128:131]
    ds_read_b64_tr_b16 v[64:65], v19 offset:0
    v_mfma_f32_16x16x32_bf16 v[132:135], v[116:119], v[80:83], v[132:135]
    ds_read_b64_tr_b16 v[66:67], v19 offset:1024
    v_mfma_f32_16x16x32_bf16 v[136:139], v[120:123], v[80:83], v[136:139]
    ds_read_b128 v[32:35], v18 offset:0
    v_mfma_f32_16x16x32_bf16 v[140:143], v[124:127], v[80:83], v[140:143]
    ds_read_b128 v[36:39], v18 offset:2048
    v_mfma_f32_16x16x32_bf16 v[144:147], v[112:115], v[84:87], v[144:147]
    ds_read_b64_tr_b16 v[68:69], v20 offset:0
    v_mfma_f32_16x16x32_bf16 v[148:151], v[116:119], v[84:87], v[148:151]
    ds_read_b64_tr_b16 v[70:71], v20 offset:1024
    v_mfma_f32_16x16x32_bf16 v[152:155], v[120:123], v[84:87], v[152:155]
    ds_read_b128 v[40:43], v18 offset:4096
    v_mfma_f32_16x16x32_bf16 v[156:159], v[124:127], v[84:87], v[156:159]
    ds_read_b128 v[44:47], v18 offset:6144
    v_mfma_f32_16x16x32_bf16 v[160:163], v[112:115], v[88:91], v[160:163]
    ds_read_b64_tr_b16 v[72:73], v21 offset:0
    v_mfma_f32_16x16x32_bf16 v[164:167], v[116:119], v[88:91], v[164:167]
    ds_read_b64_tr_b16 v[74:75], v21 offset:1024
    v_mfma_f32_16x16x32_bf16 v[168:171], v[120:123], v[88:91], v[168:171]
    ds_read_b128 v[48:51], v18 offset:8192
    v_mfma_f32_16x16x32_bf16 v[172:175], v[124:127], v[88:91], v[172:175]
    ds_read_b128 v[52:55], v18 offset:10240
    v_mfma_f32_16x16x32_bf16 v[176:179], v[112:115], v[92:95], v[176:179]
    ds_read_b64_tr_b16 v[76:77], v22 offset:0
    s_add_u32 m0, s43, 98304
    s_add_u32 s39, s36, 3407872
    buffer_load_dwordx4 v10, s[12:15], s39 offen nt lds
    v_mfma_f32_16x16x32_bf16 v[180:183], v[116:119], v[92:95], v[180:183]
    ds_read_b64_tr_b16 v[78:79], v22 offset:1024
    v_mfma_f32_16x16x32_bf16 v[184:187], v[120:123], v[92:95], v[184:187]
    ds_read_b128 v[56:59], v18 offset:12288
    s_add_u32 m0, s43, 102400
    s_add_u32 s39, s36, 3538944
    buffer_load_dwordx4 v10, s[12:15], s39 offen nt lds
    v_mfma_f32_16x16x32_bf16 v[188:191], v[124:127], v[92:95], v[188:191]
    ds_read_b128 v[60:63], v18 offset:14336
    v_mfma_f32_16x16x32_bf16 v[192:195], v[112:115], v[96:99], v[192:195]
    s_add_u32 m0, s43, 106496
    s_add_u32 s39, s36, 3407872
    buffer_load_dwordx4 v10, s[16:19], s39 offen nt lds
    v_mfma_f32_16x16x32_bf16 v[196:199], v[116:119], v[96:99], v[196:199]
    v_mfma_f32_16x16x32_bf16 v[200:203], v[120:123], v[96:99], v[200:203]
    s_add_u32 m0, s43, 110592
    s_add_u32 s39, s36, 3538944
    buffer_load_dwordx4 v10, s[16:19], s39 offen nt lds
    v_mfma_f32_16x16x32_bf16 v[204:207], v[124:127], v[96:99], v[204:207]
    v_mfma_f32_16x16x32_bf16 v[208:211], v[112:115], v[100:103], v[208:211]
    s_add_u32 m0, s92, 0
    s_add_u32 s39, s35, 896
    buffer_load_dwordx4 v9, s[8:11], s39 offen lds
    v_mfma_f32_16x16x32_bf16 v[212:215], v[116:119], v[100:103], v[212:215]
    v_mfma_f32_16x16x32_bf16 v[216:219], v[120:123], v[100:103], v[216:219]
    s_add_u32 m0, s92, 1024
    s_add_u32 s39, s35, 896
    buffer_load_dwordx4 v12, s[8:11], s39 offen lds
    v_mfma_f32_16x16x32_bf16 v[220:223], v[124:127], v[100:103], v[220:223]
    v_mfma_f32_16x16x32_bf16 v[224:227], v[112:115], v[104:107], v[224:227]
    s_add_u32 m0, s92, 2048
    s_add_u32 s39, s35, 17280
    buffer_load_dwordx4 v9, s[8:11], s39 offen lds
    v_mfma_f32_16x16x32_bf16 v[228:231], v[116:119], v[104:107], v[228:231]
    v_mfma_f32_16x16x32_bf16 v[232:235], v[120:123], v[104:107], v[232:235]
    s_add_u32 m0, s92, 3072
    s_add_u32 s39, s35, 17280
    buffer_load_dwordx4 v12, s[8:11], s39 offen lds
    v_mfma_f32_16x16x32_bf16 v[236:239], v[124:127], v[104:107], v[236:239]
    v_mfma_f32_16x16x32_bf16 v[240:243], v[112:115], v[108:111], v[240:243]
    v_mfma_f32_16x16x32_bf16 v[244:247], v[116:119], v[108:111], v[244:247]
    v_add_u32 v18, 32768, v30
    v_add_u32 v19, 131072, v14
    v_mfma_f32_16x16x32_bf16 v[248:251], v[120:123], v[108:111], v[248:251]
    v_add_u32 v20, 131072, v15
    v_add_u32 v21, 131072, v16
    v_mfma_f32_16x16x32_bf16 v[252:255], v[124:127], v[108:111], v[252:255]
    v_add_u32 v22, 131072, v17
    s_waitcnt vmcnt(20) lgkmcnt(0)
    s_barrier
    v_mfma_f32_16x16x32_bf16 v[128:131], v[64:67], v[32:35], v[128:131]
    ds_read_b64_tr_b16 v[112:113], v19 offset:0
    v_mfma_f32_16x16x32_bf16 v[132:135], v[68:71], v[32:35], v[132:135]
    ds_read_b64_tr_b16 v[114:115], v19 offset:1024
    v_mfma_f32_16x16x32_bf16 v[136:139], v[72:75], v[32:35], v[136:139]
    ds_read_b128 v[80:83], v18 offset:0
    v_mfma_f32_16x16x32_bf16 v[140:143], v[76:79], v[32:35], v[140:143]
    ds_read_b128 v[84:87], v18 offset:2048
    v_mfma_f32_16x16x32_bf16 v[144:147], v[64:67], v[36:39], v[144:147]
    ds_read_b64_tr_b16 v[116:117], v20 offset:0
    v_mfma_f32_16x16x32_bf16 v[148:151], v[68:71], v[36:39], v[148:151]
    ds_read_b64_tr_b16 v[118:119], v20 offset:1024
    v_mfma_f32_16x16x32_bf16 v[152:155], v[72:75], v[36:39], v[152:155]
    ds_read_b128 v[88:91], v18 offset:4096
    v_mfma_f32_16x16x32_bf16 v[156:159], v[76:79], v[36:39], v[156:159]
    ds_read_b128 v[92:95], v18 offset:6144
    v_mfma_f32_16x16x32_bf16 v[160:163], v[64:67], v[40:43], v[160:163]
    ds_read_b64_tr_b16 v[120:121], v21 offset:0
    v_mfma_f32_16x16x32_bf16 v[164:167], v[68:71], v[40:43], v[164:167]
    ds_read_b64_tr_b16 v[122:123], v21 offset:1024
    v_mfma_f32_16x16x32_bf16 v[168:171], v[72:75], v[40:43], v[168:171]
    ds_read_b128 v[96:99], v18 offset:8192
    v_mfma_f32_16x16x32_bf16 v[172:175], v[76:79], v[40:43], v[172:175]
    ds_read_b128 v[100:103], v18 offset:10240
    v_mfma_f32_16x16x32_bf16 v[176:179], v[64:67], v[44:47], v[176:179]
    ds_read_b64_tr_b16 v[124:125], v22 offset:0
    s_add_u32 m0, s43, 114688
    s_add_u32 s39, s36, 3670016
    buffer_load_dwordx4 v10, s[12:15], s39 offen nt lds
    v_mfma_f32_16x16x32_bf16 v[180:183], v[68:71], v[44:47], v[180:183]
    ds_read_b64_tr_b16 v[126:127], v22 offset:1024
    v_mfma_f32_16x16x32_bf16 v[184:187], v[72:75], v[44:47], v[184:187]
    ds_read_b128 v[104:107], v18 offset:12288
    s_add_u32 m0, s43, 118784
    s_add_u32 s39, s36, 3801088
    buffer_load_dwordx4 v10, s[12:15], s39 offen nt lds
    v_mfma_f32_16x16x32_bf16 v[188:191], v[76:79], v[44:47], v[188:191]
    ds_read_b128 v[108:111], v18 offset:14336
    v_mfma_f32_16x16x32_bf16 v[192:195], v[64:67], v[48:51], v[192:195]
    s_add_u32 m0, s43, 122880
    s_add_u32 s39, s36, 3670016
    buffer_load_dwordx4 v10, s[16:19], s39 offen nt lds
    v_mfma_f32_16x16x32_bf16 v[196:199], v[68:71], v[48:51], v[196:199]
    v_mfma_f32_16x16x32_bf16 v[200:203], v[72:75], v[48:51], v[200:203]
    s_add_u32 m0, s43, 126976
    s_add_u32 s39, s36, 3801088
    buffer_load_dwordx4 v10, s[16:19], s39 offen nt lds
    v_mfma_f32_16x16x32_bf16 v[204:207], v[76:79], v[48:51], v[204:207]
    v_mfma_f32_16x16x32_bf16 v[208:211], v[64:67], v[52:55], v[208:211]
    s_add_u32 m0, s92, 16384
    s_add_u32 s39, s35, 131968
    buffer_load_dwordx4 v9, s[8:11], s39 offen lds
    v_mfma_f32_16x16x32_bf16 v[212:215], v[68:71], v[52:55], v[212:215]
    v_mfma_f32_16x16x32_bf16 v[216:219], v[72:75], v[52:55], v[216:219]
    s_add_u32 m0, s92, 17408
    s_add_u32 s39, s35, 131968
    buffer_load_dwordx4 v12, s[8:11], s39 offen lds
    v_mfma_f32_16x16x32_bf16 v[220:223], v[76:79], v[52:55], v[220:223]
    v_mfma_f32_16x16x32_bf16 v[224:227], v[64:67], v[56:59], v[224:227]
    s_add_u32 m0, s92, 18432
    s_add_u32 s39, s35, 148352
    buffer_load_dwordx4 v9, s[8:11], s39 offen lds
    v_mfma_f32_16x16x32_bf16 v[228:231], v[68:71], v[56:59], v[228:231]
    v_mfma_f32_16x16x32_bf16 v[232:235], v[72:75], v[56:59], v[232:235]
    s_add_u32 m0, s92, 19456
    s_add_u32 s39, s35, 148352
    buffer_load_dwordx4 v12, s[8:11], s39 offen lds
    v_mfma_f32_16x16x32_bf16 v[236:239], v[76:79], v[56:59], v[236:239]
    v_mfma_f32_16x16x32_bf16 v[240:243], v[64:67], v[60:63], v[240:243]
    v_mfma_f32_16x16x32_bf16 v[244:247], v[68:71], v[60:63], v[244:247]
    v_add_u32 v18, 65536, v13
    v_add_u32 v19, 147456, v14
    v_mfma_f32_16x16x32_bf16 v[248:251], v[72:75], v[60:63], v[248:251]
    v_add_u32 v20, 147456, v15
    v_add_u32 v21, 147456, v16
    v_mfma_f32_16x16x32_bf16 v[252:255], v[76:79], v[60:63], v[252:255]
    v_add_u32 v22, 147456, v17
    s_waitcnt vmcnt(16) lgkmcnt(0)
    s_barrier
    v_mfma_f32_16x16x32_bf16 v[128:131], v[112:115], v[80:83], v[128:131]
    ds_read_b64_tr_b16 v[64:65], v19 offset:0
    v_mfma_f32_16x16x32_bf16 v[132:135], v[116:119], v[80:83], v[132:135]
    ds_read_b64_tr_b16 v[66:67], v19 offset:1024
    v_mfma_f32_16x16x32_bf16 v[136:139], v[120:123], v[80:83], v[136:139]
    ds_read_b128 v[32:35], v18 offset:0
    v_mfma_f32_16x16x32_bf16 v[140:143], v[124:127], v[80:83], v[140:143]
    ds_read_b128 v[36:39], v18 offset:2048
    v_mfma_f32_16x16x32_bf16 v[144:147], v[112:115], v[84:87], v[144:147]
    ds_read_b64_tr_b16 v[68:69], v20 offset:0
    v_mfma_f32_16x16x32_bf16 v[148:151], v[116:119], v[84:87], v[148:151]
    ds_read_b64_tr_b16 v[70:71], v20 offset:1024
    v_mfma_f32_16x16x32_bf16 v[152:155], v[120:123], v[84:87], v[152:155]
    ds_read_b128 v[40:43], v18 offset:4096
    v_mfma_f32_16x16x32_bf16 v[156:159], v[124:127], v[84:87], v[156:159]
    ds_read_b128 v[44:47], v18 offset:6144
    v_mfma_f32_16x16x32_bf16 v[160:163], v[112:115], v[88:91], v[160:163]
    ds_read_b64_tr_b16 v[72:73], v21 offset:0
    v_mfma_f32_16x16x32_bf16 v[164:167], v[116:119], v[88:91], v[164:167]
    ds_read_b64_tr_b16 v[74:75], v21 offset:1024
    v_mfma_f32_16x16x32_bf16 v[168:171], v[120:123], v[88:91], v[168:171]
    ds_read_b128 v[48:51], v18 offset:8192
    v_mfma_f32_16x16x32_bf16 v[172:175], v[124:127], v[88:91], v[172:175]
    ds_read_b128 v[52:55], v18 offset:10240
    v_mfma_f32_16x16x32_bf16 v[176:179], v[112:115], v[92:95], v[176:179]
    ds_read_b64_tr_b16 v[76:77], v22 offset:0
    s_mov_b32 s8, s76
    s_and_b32 s9, s77, 0xffff
    s_mov_b32 s10, 2359296
    s_mov_b32 s11, 0x20000
    v_mfma_f32_16x16x32_bf16 v[180:183], v[116:119], v[92:95], v[180:183]
    ds_read_b64_tr_b16 v[78:79], v22 offset:1024
    s_add_u32 m0, s43, 131072
    s_add_u32 s39, s36, 3932160
    buffer_load_dwordx4 v10, s[12:15], s39 offen nt lds
    v_mfma_f32_16x16x32_bf16 v[184:187], v[120:123], v[92:95], v[184:187]
    ds_read_b128 v[56:59], v18 offset:12288
    v_mfma_f32_16x16x32_bf16 v[188:191], v[124:127], v[92:95], v[188:191]
    ds_read_b128 v[60:63], v18 offset:14336
    s_add_u32 m0, s43, 135168
    s_add_u32 s39, s36, 4063232
    buffer_load_dwordx4 v10, s[12:15], s39 offen nt lds
    v_mfma_f32_16x16x32_bf16 v[192:195], v[112:115], v[96:99], v[192:195]
    v_mfma_f32_16x16x32_bf16 v[196:199], v[116:119], v[96:99], v[196:199]
    s_add_u32 m0, s43, 139264
    s_add_u32 s39, s36, 3932160
    buffer_load_dwordx4 v10, s[16:19], s39 offen nt lds
    v_mfma_f32_16x16x32_bf16 v[200:203], v[120:123], v[96:99], v[200:203]
    v_mfma_f32_16x16x32_bf16 v[204:207], v[124:127], v[96:99], v[204:207]
    s_add_u32 m0, s43, 143360
    s_add_u32 s39, s36, 4063232
    buffer_load_dwordx4 v10, s[16:19], s39 offen nt lds
    v_mfma_f32_16x16x32_bf16 v[208:211], v[112:115], v[100:103], v[208:211]
    v_mfma_f32_16x16x32_bf16 v[212:215], v[116:119], v[100:103], v[212:215]
    s_add_u32 m0, s92, 32768
    s_add_u32 s39, s37, 0
    buffer_load_dwordx4 v11, s[8:11], s39 offen lds
    v_mfma_f32_16x16x32_bf16 v[216:219], v[120:123], v[100:103], v[216:219]
    v_mfma_f32_16x16x32_bf16 v[220:223], v[124:127], v[100:103], v[220:223]
    s_add_u32 m0, s92, 33792
    s_add_u32 s39, s37, 0
    buffer_load_dwordx4 v24, s[8:11], s39 offen lds
    v_mfma_f32_16x16x32_bf16 v[224:227], v[112:115], v[104:107], v[224:227]
    v_mfma_f32_16x16x32_bf16 v[228:231], v[116:119], v[104:107], v[228:231]
    s_add_u32 m0, s92, 34816
    s_add_u32 s39, s37, 18432
    buffer_load_dwordx4 v11, s[8:11], s39 offen lds
    v_mfma_f32_16x16x32_bf16 v[232:235], v[120:123], v[104:107], v[232:235]
    v_mfma_f32_16x16x32_bf16 v[236:239], v[124:127], v[104:107], v[236:239]
    s_add_u32 m0, s92, 35840
    s_add_u32 s39, s37, 18432
    buffer_load_dwordx4 v24, s[8:11], s39 offen lds
    v_mfma_f32_16x16x32_bf16 v[240:243], v[112:115], v[108:111], v[240:243]
    v_mfma_f32_16x16x32_bf16 v[244:247], v[116:119], v[108:111], v[244:247]
    v_add_u32 v18, 65536, v30
    v_add_u32 v19, 98304, v14
    v_mfma_f32_16x16x32_bf16 v[248:251], v[120:123], v[108:111], v[248:251]
    v_add_u32 v20, 98304, v15
    v_add_u32 v21, 98304, v16
    v_mfma_f32_16x16x32_bf16 v[252:255], v[124:127], v[108:111], v[252:255]
    v_add_u32 v22, 98304, v17
    s_waitcnt vmcnt(20) lgkmcnt(0)
    s_barrier
    v_mfma_f32_16x16x32_bf16 v[128:131], v[64:67], v[32:35], v[128:131]
    ds_read_b64_tr_b16 v[112:113], v19 offset:0
    v_mfma_f32_16x16x32_bf16 v[132:135], v[68:71], v[32:35], v[132:135]
    ds_read_b64_tr_b16 v[114:115], v19 offset:1024
    v_mfma_f32_16x16x32_bf16 v[136:139], v[72:75], v[32:35], v[136:139]
    ds_read_b128 v[80:83], v18 offset:0
    v_mfma_f32_16x16x32_bf16 v[140:143], v[76:79], v[32:35], v[140:143]
    ds_read_b128 v[84:87], v18 offset:2048
    v_mfma_f32_16x16x32_bf16 v[144:147], v[64:67], v[36:39], v[144:147]
    ds_read_b64_tr_b16 v[116:117], v20 offset:0
    v_mfma_f32_16x16x32_bf16 v[148:151], v[68:71], v[36:39], v[148:151]
    ds_read_b64_tr_b16 v[118:119], v20 offset:1024
    v_mfma_f32_16x16x32_bf16 v[152:155], v[72:75], v[36:39], v[152:155]
    ds_read_b128 v[88:91], v18 offset:4096
    v_mfma_f32_16x16x32_bf16 v[156:159], v[76:79], v[36:39], v[156:159]
    ds_read_b128 v[92:95], v18 offset:6144
    v_mfma_f32_16x16x32_bf16 v[160:163], v[64:67], v[40:43], v[160:163]
    ds_read_b64_tr_b16 v[120:121], v21 offset:0
    v_mfma_f32_16x16x32_bf16 v[164:167], v[68:71], v[40:43], v[164:167]
    ds_read_b64_tr_b16 v[122:123], v21 offset:1024
    v_mfma_f32_16x16x32_bf16 v[168:171], v[72:75], v[40:43], v[168:171]
    ds_read_b128 v[96:99], v18 offset:8192
    v_mfma_f32_16x16x32_bf16 v[172:175], v[76:79], v[40:43], v[172:175]
    ds_read_b128 v[100:103], v18 offset:10240
    v_mfma_f32_16x16x32_bf16 v[176:179], v[64:67], v[44:47], v[176:179]
    ds_read_b64_tr_b16 v[124:125], v22 offset:0
    s_add_u32 m0, s43, 147456
    s_add_u32 s39, s38, 0
    buffer_load_dwordx4 v4, s[20:23], s39 offen sc1 lds
    v_mfma_f32_16x16x32_bf16 v[180:183], v[68:71], v[44:47], v[180:183]
    ds_read_b64_tr_b16 v[126:127], v22 offset:1024
    v_mfma_f32_16x16x32_bf16 v[184:187], v[72:75], v[44:47], v[184:187]
    ds_read_b128 v[104:107], v18 offset:12288
    s_add_u32 m0, s43, 151552
    s_add_u32 s39, s38, 4096
    buffer_load_dwordx4 v4, s[20:23], s39 offen sc1 lds
    v_mfma_f32_16x16x32_bf16 v[188:191], v[76:79], v[44:47], v[188:191]
    ds_read_b128 v[108:111], v18 offset:14336
    v_mfma_f32_16x16x32_bf16 v[192:195], v[64:67], v[48:51], v[192:195]
    s_add_u32 m0, s43, 155648
    s_add_u32 s39, s38, 8192
    buffer_load_dwordx4 v4, s[20:23], s39 offen sc1 lds
    v_mfma_f32_16x16x32_bf16 v[196:199], v[68:71], v[48:51], v[196:199]
    v_mfma_f32_16x16x32_bf16 v[200:203], v[72:75], v[48:51], v[200:203]
    s_add_u32 m0, s43, 159744
    s_add_u32 s39, s38, 12288
    buffer_load_dwordx4 v4, s[20:23], s39 offen sc1 lds
    v_mfma_f32_16x16x32_bf16 v[204:207], v[76:79], v[48:51], v[204:207]
    v_mfma_f32_16x16x32_bf16 v[208:211], v[64:67], v[52:55], v[208:211]
    s_add_u32 m0, s92, 49152
    s_add_u32 s39, s37, 128
    buffer_load_dwordx4 v11, s[8:11], s39 offen lds
    v_mfma_f32_16x16x32_bf16 v[212:215], v[68:71], v[52:55], v[212:215]
    v_mfma_f32_16x16x32_bf16 v[216:219], v[72:75], v[52:55], v[216:219]
    s_add_u32 m0, s92, 50176
    s_add_u32 s39, s37, 128
    buffer_load_dwordx4 v24, s[8:11], s39 offen lds
    v_mfma_f32_16x16x32_bf16 v[220:223], v[76:79], v[52:55], v[220:223]
    v_mfma_f32_16x16x32_bf16 v[224:227], v[64:67], v[56:59], v[224:227]
    s_add_u32 m0, s92, 51200
    s_add_u32 s39, s37, 18560
    buffer_load_dwordx4 v11, s[8:11], s39 offen lds
    v_mfma_f32_16x16x32_bf16 v[228:231], v[68:71], v[56:59], v[228:231]
    v_mfma_f32_16x16x32_bf16 v[232:235], v[72:75], v[56:59], v[232:235]
    s_add_u32 m0, s92, 52224
    s_add_u32 s39, s37, 18560
    buffer_load_dwordx4 v24, s[8:11], s39 offen lds
    v_mfma_f32_16x16x32_bf16 v[236:239], v[76:79], v[56:59], v[236:239]
    v_mfma_f32_16x16x32_bf16 v[240:243], v[64:67], v[60:63], v[240:243]
    v_mfma_f32_16x16x32_bf16 v[244:247], v[68:71], v[60:63], v[244:247]
    v_add_u32 v18, 0, v13
    v_add_u32 v19, 114688, v14
    v_mfma_f32_16x16x32_bf16 v[248:251], v[72:75], v[60:63], v[248:251]
    v_add_u32 v20, 114688, v15
    v_add_u32 v21, 114688, v16
    v_mfma_f32_16x16x32_bf16 v[252:255], v[76:79], v[60:63], v[252:255]
    v_add_u32 v22, 114688, v17
    s_waitcnt vmcnt(16) lgkmcnt(0)
    s_barrier
    v_mfma_f32_16x16x32_bf16 v[128:131], v[112:115], v[80:83], v[128:131]
    ds_read_b64_tr_b16 v[64:65], v19 offset:0
    v_mfma_f32_16x16x32_bf16 v[132:135], v[116:119], v[80:83], v[132:135]
    ds_read_b64_tr_b16 v[66:67], v19 offset:1024
    v_mfma_f32_16x16x32_bf16 v[136:139], v[120:123], v[80:83], v[136:139]
    ds_read_b128 v[32:35], v18 offset:0
    v_mfma_f32_16x16x32_bf16 v[140:143], v[124:127], v[80:83], v[140:143]
    ds_read_b128 v[36:39], v18 offset:2048
    v_mfma_f32_16x16x32_bf16 v[144:147], v[112:115], v[84:87], v[144:147]
    ds_read_b64_tr_b16 v[68:69], v20 offset:0
    v_mfma_f32_16x16x32_bf16 v[148:151], v[116:119], v[84:87], v[148:151]
    ds_read_b64_tr_b16 v[70:71], v20 offset:1024
    v_mfma_f32_16x16x32_bf16 v[152:155], v[120:123], v[84:87], v[152:155]
    ds_read_b128 v[40:43], v18 offset:4096
    v_mfma_f32_16x16x32_bf16 v[156:159], v[124:127], v[84:87], v[156:159]
    ds_read_b128 v[44:47], v18 offset:6144
    v_mfma_f32_16x16x32_bf16 v[160:163], v[112:115], v[88:91], v[160:163]
    ds_read_b64_tr_b16 v[72:73], v21 offset:0
    v_mfma_f32_16x16x32_bf16 v[164:167], v[116:119], v[88:91], v[164:167]
    ds_read_b64_tr_b16 v[74:75], v21 offset:1024
    v_mfma_f32_16x16x32_bf16 v[168:171], v[120:123], v[88:91], v[168:171]
    ds_read_b128 v[48:51], v18 offset:8192
    v_mfma_f32_16x16x32_bf16 v[172:175], v[124:127], v[88:91], v[172:175]
    ds_read_b128 v[52:55], v18 offset:10240
    v_mfma_f32_16x16x32_bf16 v[176:179], v[112:115], v[92:95], v[176:179]
    ds_read_b64_tr_b16 v[76:77], v22 offset:0
    s_add_u32 m0, s43, 98304
    s_add_u32 s39, s38, 16384
    buffer_load_dwordx4 v4, s[20:23], s39 offen sc1 lds
    v_mfma_f32_16x16x32_bf16 v[180:183], v[116:119], v[92:95], v[180:183]
    ds_read_b64_tr_b16 v[78:79], v22 offset:1024
    v_mfma_f32_16x16x32_bf16 v[184:187], v[120:123], v[92:95], v[184:187]
    ds_read_b128 v[56:59], v18 offset:12288
    s_add_u32 m0, s43, 102400
    s_add_u32 s39, s38, 20480
    buffer_load_dwordx4 v4, s[20:23], s39 offen sc1 lds
    v_mfma_f32_16x16x32_bf16 v[188:191], v[124:127], v[92:95], v[188:191]
    ds_read_b128 v[60:63], v18 offset:14336
    v_mfma_f32_16x16x32_bf16 v[192:195], v[112:115], v[96:99], v[192:195]
    s_add_u32 m0, s43, 106496
    s_add_u32 s39, s38, 24576
    buffer_load_dwordx4 v4, s[20:23], s39 offen sc1 lds
    v_mfma_f32_16x16x32_bf16 v[196:199], v[116:119], v[96:99], v[196:199]
    v_mfma_f32_16x16x32_bf16 v[200:203], v[120:123], v[96:99], v[200:203]
    s_add_u32 m0, s43, 110592
    s_add_u32 s39, s38, 28672
    buffer_load_dwordx4 v4, s[20:23], s39 offen sc1 lds
    v_mfma_f32_16x16x32_bf16 v[204:207], v[124:127], v[96:99], v[204:207]
    v_mfma_f32_16x16x32_bf16 v[208:211], v[112:115], v[100:103], v[208:211]
    s_add_u32 m0, s92, 65536
    s_add_u32 s39, s37, 256
    buffer_load_dwordx4 v11, s[8:11], s39 offen lds
    v_mfma_f32_16x16x32_bf16 v[212:215], v[116:119], v[100:103], v[212:215]
    v_mfma_f32_16x16x32_bf16 v[216:219], v[120:123], v[100:103], v[216:219]
    s_add_u32 m0, s92, 66560
    s_add_u32 s39, s37, 256
    buffer_load_dwordx4 v24, s[8:11], s39 offen lds
    v_mfma_f32_16x16x32_bf16 v[220:223], v[124:127], v[100:103], v[220:223]
    v_mfma_f32_16x16x32_bf16 v[224:227], v[112:115], v[104:107], v[224:227]
    s_add_u32 m0, s92, 67584
    s_add_u32 s39, s37, 18688
    buffer_load_dwordx4 v11, s[8:11], s39 offen lds
    v_mfma_f32_16x16x32_bf16 v[228:231], v[116:119], v[104:107], v[228:231]
    v_mfma_f32_16x16x32_bf16 v[232:235], v[120:123], v[104:107], v[232:235]
    s_add_u32 m0, s92, 68608
    s_add_u32 s39, s37, 18688
    buffer_load_dwordx4 v24, s[8:11], s39 offen lds
    v_mfma_f32_16x16x32_bf16 v[236:239], v[124:127], v[104:107], v[236:239]
    v_mfma_f32_16x16x32_bf16 v[240:243], v[112:115], v[108:111], v[240:243]
    v_mfma_f32_16x16x32_bf16 v[244:247], v[116:119], v[108:111], v[244:247]
    v_add_u32 v18, 0, v30
    v_add_u32 v19, 131072, v14
    v_mfma_f32_16x16x32_bf16 v[248:251], v[120:123], v[108:111], v[248:251]
    v_add_u32 v20, 131072, v15
    v_add_u32 v21, 131072, v16
    v_mfma_f32_16x16x32_bf16 v[252:255], v[124:127], v[108:111], v[252:255]
    v_add_u32 v22, 131072, v17
    s_waitcnt vmcnt(20) lgkmcnt(0)
    s_barrier
    v_mfma_f32_16x16x32_bf16 v[128:131], v[64:67], v[32:35], v[128:131]
    ds_read_b64_tr_b16 v[112:113], v19 offset:0
    v_mfma_f32_16x16x32_bf16 v[132:135], v[68:71], v[32:35], v[132:135]
    ds_read_b64_tr_b16 v[114:115], v19 offset:1024
    v_mfma_f32_16x16x32_bf16 v[136:139], v[72:75], v[32:35], v[136:139]
    ds_read_b128 v[80:83], v18 offset:0
    v_mfma_f32_16x16x32_bf16 v[140:143], v[76:79], v[32:35], v[140:143]
    ds_read_b128 v[84:87], v18 offset:2048
    v_mfma_f32_16x16x32_bf16 v[144:147], v[64:67], v[36:39], v[144:147]
    ds_read_b64_tr_b16 v[116:117], v20 offset:0
    v_mfma_f32_16x16x32_bf16 v[148:151], v[68:71], v[36:39], v[148:151]
    ds_read_b64_tr_b16 v[118:119], v20 offset:1024
    v_mfma_f32_16x16x32_bf16 v[152:155], v[72:75], v[36:39], v[152:155]
    ds_read_b128 v[88:91], v18 offset:4096
    v_mfma_f32_16x16x32_bf16 v[156:159], v[76:79], v[36:39], v[156:159]
    ds_read_b128 v[92:95], v18 offset:6144
    v_mfma_f32_16x16x32_bf16 v[160:163], v[64:67], v[40:43], v[160:163]
    ds_read_b64_tr_b16 v[120:121], v21 offset:0
    v_mfma_f32_16x16x32_bf16 v[164:167], v[68:71], v[40:43], v[164:167]
    ds_read_b64_tr_b16 v[122:123], v21 offset:1024
    v_mfma_f32_16x16x32_bf16 v[168:171], v[72:75], v[40:43], v[168:171]
    ds_read_b128 v[96:99], v18 offset:8192
    v_mfma_f32_16x16x32_bf16 v[172:175], v[76:79], v[40:43], v[172:175]
    ds_read_b128 v[100:103], v18 offset:10240
    v_mfma_f32_16x16x32_bf16 v[176:179], v[64:67], v[44:47], v[176:179]
    ds_read_b64_tr_b16 v[124:125], v22 offset:0
    s_add_u32 m0, s43, 114688
    s_add_u32 s39, s38, 32768
    buffer_load_dwordx4 v4, s[20:23], s39 offen sc1 lds
    v_mfma_f32_16x16x32_bf16 v[180:183], v[68:71], v[44:47], v[180:183]
    ds_read_b64_tr_b16 v[126:127], v22 offset:1024
    v_mfma_f32_16x16x32_bf16 v[184:187], v[72:75], v[44:47], v[184:187]
    ds_read_b128 v[104:107], v18 offset:12288
    s_add_u32 m0, s43, 118784
    s_add_u32 s39, s38, 36864
    buffer_load_dwordx4 v4, s[20:23], s39 offen sc1 lds
    v_mfma_f32_16x16x32_bf16 v[188:191], v[76:79], v[44:47], v[188:191]
    ds_read_b128 v[108:111], v18 offset:14336
    v_mfma_f32_16x16x32_bf16 v[192:195], v[64:67], v[48:51], v[192:195]
    s_add_u32 m0, s43, 122880
    s_add_u32 s39, s38, 40960
    buffer_load_dwordx4 v4, s[20:23], s39 offen sc1 lds
    v_mfma_f32_16x16x32_bf16 v[196:199], v[68:71], v[48:51], v[196:199]
    v_mfma_f32_16x16x32_bf16 v[200:203], v[72:75], v[48:51], v[200:203]
    s_add_u32 m0, s43, 126976
    s_add_u32 s39, s38, 45056
    buffer_load_dwordx4 v4, s[20:23], s39 offen sc1 lds
    v_mfma_f32_16x16x32_bf16 v[204:207], v[76:79], v[48:51], v[204:207]
    v_mfma_f32_16x16x32_bf16 v[208:211], v[64:67], v[52:55], v[208:211]
    s_add_u32 m0, s92, 81920
    s_add_u32 s39, s37, 384
    buffer_load_dwordx4 v11, s[8:11], s39 offen lds
    v_mfma_f32_16x16x32_bf16 v[212:215], v[68:71], v[52:55], v[212:215]
    v_mfma_f32_16x16x32_bf16 v[216:219], v[72:75], v[52:55], v[216:219]
    s_add_u32 m0, s92, 82944
    s_add_u32 s39, s37, 384
    buffer_load_dwordx4 v24, s[8:11], s39 offen lds
    v_mfma_f32_16x16x32_bf16 v[220:223], v[76:79], v[52:55], v[220:223]
    v_mfma_f32_16x16x32_bf16 v[224:227], v[64:67], v[56:59], v[224:227]
    s_add_u32 m0, s92, 83968
    s_add_u32 s39, s37, 18816
    buffer_load_dwordx4 v11, s[8:11], s39 offen lds
    v_mfma_f32_16x16x32_bf16 v[228:231], v[68:71], v[56:59], v[228:231]
    v_mfma_f32_16x16x32_bf16 v[232:235], v[72:75], v[56:59], v[232:235]
    s_add_u32 m0, s92, 84992
    s_add_u32 s39, s37, 18816
    buffer_load_dwordx4 v24, s[8:11], s39 offen lds
    v_mfma_f32_16x16x32_bf16 v[236:239], v[76:79], v[56:59], v[236:239]
    v_mfma_f32_16x16x32_bf16 v[240:243], v[64:67], v[60:63], v[240:243]
    v_mfma_f32_16x16x32_bf16 v[244:247], v[68:71], v[60:63], v[244:247]
    v_mfma_f32_16x16x32_bf16 v[248:251], v[72:75], v[60:63], v[248:251]
    v_mfma_f32_16x16x32_bf16 v[252:255], v[76:79], v[60:63], v[252:255]
    s_waitcnt lgkmcnt(0)
    v_mfma_f32_16x16x32_bf16 v[128:131], v[112:115], v[80:83], v[128:131]
    v_mfma_f32_16x16x32_bf16 v[132:135], v[116:119], v[80:83], v[132:135]
    v_mfma_f32_16x16x32_bf16 v[136:139], v[120:123], v[80:83], v[136:139]
    v_mfma_f32_16x16x32_bf16 v[140:143], v[124:127], v[80:83], v[140:143]
    v_mfma_f32_16x16x32_bf16 v[144:147], v[112:115], v[84:87], v[144:147]
    v_mfma_f32_16x16x32_bf16 v[148:151], v[116:119], v[84:87], v[148:151]
    v_mfma_f32_16x16x32_bf16 v[152:155], v[120:123], v[84:87], v[152:155]
    v_mfma_f32_16x16x32_bf16 v[156:159], v[124:127], v[84:87], v[156:159]
    v_mfma_f32_16x16x32_bf16 v[160:163], v[112:115], v[88:91], v[160:163]
    v_mfma_f32_16x16x32_bf16 v[164:167], v[116:119], v[88:91], v[164:167]
    v_mfma_f32_16x16x32_bf16 v[168:171], v[120:123], v[88:91], v[168:171]
    v_mfma_f32_16x16x32_bf16 v[172:175], v[124:127], v[88:91], v[172:175]
    v_mfma_f32_16x16x32_bf16 v[176:179], v[112:115], v[92:95], v[176:179]
    v_mfma_f32_16x16x32_bf16 v[180:183], v[116:119], v[92:95], v[180:183]
    v_mfma_f32_16x16x32_bf16 v[184:187], v[120:123], v[92:95], v[184:187]
    v_mfma_f32_16x16x32_bf16 v[188:191], v[124:127], v[92:95], v[188:191]
    v_mfma_f32_16x16x32_bf16 v[192:195], v[112:115], v[96:99], v[192:195]
    v_mfma_f32_16x16x32_bf16 v[196:199], v[116:119], v[96:99], v[196:199]
    v_mfma_f32_16x16x32_bf16 v[200:203], v[120:123], v[96:99], v[200:203]
    v_mfma_f32_16x16x32_bf16 v[204:207], v[124:127], v[96:99], v[204:207]
    v_mfma_f32_16x16x32_bf16 v[208:211], v[112:115], v[100:103], v[208:211]
    v_mfma_f32_16x16x32_bf16 v[212:215], v[116:119], v[100:103], v[212:215]
    v_mfma_f32_16x16x32_bf16 v[216:219], v[120:123], v[100:103], v[216:219]
    v_mfma_f32_16x16x32_bf16 v[220:223], v[124:127], v[100:103], v[220:223]
    v_mfma_f32_16x16x32_bf16 v[224:227], v[112:115], v[104:107], v[224:227]
    v_mfma_f32_16x16x32_bf16 v[228:231], v[116:119], v[104:107], v[228:231]
    v_mfma_f32_16x16x32_bf16 v[232:235], v[120:123], v[104:107], v[232:235]
    v_mfma_f32_16x16x32_bf16 v[236:239], v[124:127], v[104:107], v[236:239]
    v_mfma_f32_16x16x32_bf16 v[240:243], v[112:115], v[108:111], v[240:243]
    v_mfma_f32_16x16x32_bf16 v[244:247], v[116:119], v[108:111], v[244:247]
    v_mfma_f32_16x16x32_bf16 v[248:251], v[120:123], v[108:111], v[248:251]
    v_mfma_f32_16x16x32_bf16 v[252:255], v[124:127], v[108:111], v[252:255]
    s_branch kf_kvdone
kf_kv1:
    s_add_u32 m0, s43, 155648
    s_add_u32 s39, s36, 0
    buffer_load_dwordx4 v10, s[16:19], s39 offen nt lds
    s_add_u32 m0, s43, 159744
    s_add_u32 s39, s36, 131072
    buffer_load_dwordx4 v10, s[16:19], s39 offen nt lds
    s_add_u32 m0, s92, 67584
    s_add_u32 s39, s35, 16384
    buffer_load_dwordx4 v9, s[8:11], s39 offen lds
    s_add_u32 m0, s92, 68608
    s_add_u32 s39, s35, 16384
    buffer_load_dwordx4 v12, s[8:11], s39 offen lds
    s_add_u32 m0, s92, 83968
    s_add_u32 s39, s35, 147456
    buffer_load_dwordx4 v9, s[8:11], s39 offen lds
    s_add_u32 m0, s92, 84992
    s_add_u32 s39, s35, 147456
    buffer_load_dwordx4 v12, s[8:11], s39 offen lds
    s_add_u32 m0, s43, 106496
    s_add_u32 s39, s36, 262144
    buffer_load_dwordx4 v10, s[16:19], s39 offen nt lds
    s_add_u32 m0, s43, 110592
    s_add_u32 s39, s36, 393216
    buffer_load_dwordx4 v10, s[16:19], s39 offen nt lds
    s_getpc_b64 s[98:99]
pc_1:
    s_add_u32 s98, s98, kf_kernel-pc_1
    s_addc_u32 s99, s99, (kf_kernel-pc_1)>>32
    v_min_u32 v5, 5, v1
    s_mul_i32 s100, s61, 6
    v_add_u32 v5, s100, v5
    v_lshlrev_b32 v5, 7, v5
    v_min_u32 v5, code_end-kf_kernel-4, v5
    global_load_dword v28, v5, s[98:99]
    s_mov_b32 s20, s88
    s_and_b32 s21, s89, 0xffff
    s_mov_b32 s22, 268435456
    s_mov_b32 s23, 0x20000
    v_mov_b32 v27, 66846720
    v_mov_b32 v26, 0
    s_mov_b32 s63, 0
    s_lshl_b32 s32, s46, 7
    v_add_u32 v5, s32, v2
    v_lshlrev_b32 v5, 7, v5
    v_lshrrev_b32 v6, 1, v2
    v_or_b32 v7, 0, v3
    v_xor_b32 v6, v6, v7
    v_lshl_add_u32 v13, v6, 4, v5
    s_lshl_b32 s32, s46, 7
    v_add_u32 v5, s32, v2
    v_lshlrev_b32 v5, 7, v5
    v_lshrrev_b32 v6, 1, v2
    v_or_b32 v7, 4, v3
    v_xor_b32 v6, v6, v7
    v_lshl_add_u32 v30, v6, 4, v5
    v_lshrrev_b32 v5, 2, v2
    v_lshl_add_u32 v8, v3, 3, v5
    v_lshlrev_b32 v8, 8, v8
    v_and_b32 v7, 1, v3
    v_lshl_or_b32 v7, v7, 2, v5
    v_and_b32 v5, 3, v2
    v_lshl_add_u32 v8, v5, 3, v8
    s_lshl_b32 s33, s45, 13
    v_add_u32 v8, s33, v8
    s_lshl_b32 s32, s47, 2
    s_add_u32 s32, s32, 0
    v_xor_b32 v5, s32, v7
    v_lshl_add_u32 v14, v5, 5, v8
    s_lshl_b32 s32, s47, 2
    s_add_u32 s32, s32, 1
    v_xor_b32 v5, s32, v7
    v_lshl_add_u32 v15, v5, 5, v8
    s_lshl_b32 s32, s47, 2
    s_add_u32 s32, s32, 2
    v_xor_b32 v5, s32, v7
    v_lshl_add_u32 v16, v5, 5, v8
    s_lshl_b32 s32, s47, 2
    s_add_u32 s32, s32, 3
    v_xor_b32 v5, s32, v7
    v_lshl_add_u32 v17, v5, 5, v8
    s_lshl_b32 s32, s2, 7
    s_add_u32 s32, s32, 66846720
    v_mov_b32 v29, s32
    buffer_load_dword v29, v29, s[20:23], 0 offen sc1
    s_lshl_b32 s32, s2, 2
    s_add_u32 s32, s32, 66912256
    v_mov_b32 v31, s32
    buffer_load_dword v31, v31, s[20:23], 0 offen sc1
    v_mov_b64 v[128:129], 0
    v_mov_b64 v[130:131], 0
    v_mov_b64 v[132:133], 0
    v_mov_b64 v[134:135], 0
    v_mov_b64 v[136:137], 0
    v_mov_b64 v[138:139], 0
    v_mov_b64 v[140:141], 0
    v_mov_b64 v[142:143], 0
    v_mov_b64 v[144:145], 0
    v_mov_b64 v[146:147], 0
    v_mov_b64 v[148:149], 0
    v_mov_b64 v[150:151], 0
    v_mov_b64 v[152:153], 0
    v_mov_b64 v[154:155], 0
    v_mov_b64 v[156:157], 0
    v_mov_b64 v[158:159], 0
    v_mov_b64 v[160:161], 0
    v_mov_b64 v[162:163], 0
    v_mov_b64 v[164:165], 0
    v_mov_b64 v[166:167], 0
    v_mov_b64 v[168:169], 0
    v_mov_b64 v[170:171], 0
    v_mov_b64 v[172:173], 0
    v_mov_b64 v[174:175], 0
    v_mov_b64 v[176:177], 0
    v_mov_b64 v[178:179], 0
    v_mov_b64 v[180:181], 0
    v_mov_b64 v[182:183], 0
    v_mov_b64 v[184:185], 0
    v_mov_b64 v[186:187], 0
    v_mov_b64 v[188:189], 0
    v_mov_b64 v[190:191], 0
    s_add_u32 m0, s43, 122880
    s_add_u32 s39, s36, 524288
    buffer_load_dwordx4 v10, s[16:19], s39 offen nt lds
    s_add_u32 m0, s43, 126976
    s_add_u32 s39, s36, 655360
    buffer_load_dwordx4 v10, s[16:19], s39 offen nt lds
    s_add_u32 m0, s92, 2048
    s_add_u32 s39, s35, 16512
    buffer_load_dwordx4 v9, s[8:11], s39 offen lds
    s_add_u32 m0, s92, 3072
    s_add_u32 s39, s35, 16512
    buffer_load_dwordx4 v12, s[8:11], s39 offen lds
    s_add_u32 m0, s92, 18432
    s_add_u32 s39, s35, 147584
    buffer_load_dwordx4 v9, s[8:11], s39 offen lds
    s_add_u32 m0, s92, 19456
    s_add_u32 s39, s35, 147584
    buffer_load_dwordx4 v12, s[8:11], s39 offen lds
    s_add_u32 m0, s43, 139264
    s_add_u32 s39, s36, 786432
    buffer_load_dwordx4 v10, s[16:19], s39 offen nt lds
    s_add_u32 m0, s43, 143360
    s_add_u32 s39, s36, 917504
    buffer_load_dwordx4 v10, s[16:19], s39 offen nt lds
    s_add_u32 m0, s92, 34816
    s_add_u32 s39, s35, 16640
    buffer_load_dwordx4 v9, s[8:11], s39 offen lds
    s_add_u32 m0, s92, 35840
    s_add_u32 s39, s35, 16640
    buffer_load_dwordx4 v12, s[8:11], s39 offen lds
    s_add_u32 m0, s92, 51200
    s_add_u32 s39, s35, 147712
    buffer_load_dwordx4 v9, s[8:11], s39 offen lds
    s_add_u32 m0, s92, 52224
    s_add_u32 s39, s35, 147712
    buffer_load_dwordx4 v12, s[8:11], s39 offen lds
    v_mov_b64 v[192:193], 0
    v_mov_b64 v[194:195], 0
    v_mov_b64 v[196:197], 0
    v_mov_b64 v[198:199], 0
    v_mov_b64 v[200:201], 0
    v_mov_b64 v[202:203], 0
    v_mov_b64 v[204:205], 0
    v_mov_b64 v[206:207], 0
    v_mov_b64 v[208:209], 0
    v_mov_b64 v[210:211], 0
    v_mov_b64 v[212:213], 0
    v_mov_b64 v[214:215], 0
    v_mov_b64 v[216:217], 0
    v_mov_b64 v[218:219], 0
    v_mov_b64 v[220:221], 0
    v_mov_b64 v[222:223], 0
    v_mov_b64 v[224:225], 0
    v_mov_b64 v[226:227], 0
    v_mov_b64 v[228:229], 0
    v_mov_b64 v[230:231], 0
    v_mov_b64 v[232:233], 0
    v_mov_b64 v[234:235], 0
    v_mov_b64 v[236:237], 0
    v_mov_b64 v[238:239], 0
    v_mov_b64 v[240:241], 0
    v_mov_b64 v[242:243], 0
    v_mov_b64 v[244:245], 0
    v_mov_b64 v[246:247], 0
    v_mov_b64 v[248:249], 0
    v_mov_b64 v[250:251], 0
    v_mov_b64 v[252:253], 0
    v_mov_b64 v[254:255], 0
    v_add_u32 v18, 65536, v13
    v_add_u32 v19, 147456, v14
    v_add_u32 v20, 147456, v15
    v_add_u32 v21, 147456, v16
    v_add_u32 v22, 147456, v17
    s_waitcnt vmcnt(17)
    s_barrier
    ds_read_b64_tr_b16 v[64:65], v19 offset:0
    ds_read_b64_tr_b16 v[66:67], v19 offset:1024
    ds_read_b128 v[32:35], v18 offset:0
    ds_read_b128 v[36:39], v18 offset:2048
    ds_read_b64_tr_b16 v[68:69], v20 offset:0
    ds_read_b64_tr_b16 v[70:71], v20 offset:1024
    ds_read_b128 v[40:43], v18 offset:4096
    ds_read_b128 v[44:47], v18 offset:6144
    ds_read_b64_tr_b16 v[72:73], v21 offset:0
    ds_read_b64_tr_b16 v[74:75], v21 offset:1024
    ds_read_b128 v[48:51], v18 offset:8192
    ds_read_b128 v[52:55], v18 offset:10240
    ds_read_b64_tr_b16 v[76:77], v22 offset:0
    ds_read_b64_tr_b16 v[78:79], v22 offset:1024
    ds_read_b128 v[56:59], v18 offset:12288
    ds_read_b128 v[60:63], v18 offset:14336
    v_add_u32 v18, 65536, v30
    v_add_u32 v19, 98304, v14
    v_add_u32 v20, 98304, v15
    v_add_u32 v21, 98304, v16
    v_add_u32 v22, 98304, v17
    s_waitcnt vmcnt(15) lgkmcnt(0)
    s_barrier
    v_mfma_f32_16x16x32_bf16 v[128:131], v[32:35], v[64:67], v[128:131]
    ds_read_b64_tr_b16 v[112:113], v19 offset:0
    v_mfma_f32_16x16x32_bf16 v[136:139], v[32:35], v[68:71], v[136:139]
    ds_read_b64_tr_b16 v[114:115], v19 offset:1024
    v_mfma_f32_16x16x32_bf16 v[144:147], v[32:35], v[72:75], v[144:147]
    ds_read_b128 v[80:83], v18 offset:0
    v_mfma_f32_16x16x32_bf16 v[152:155], v[32:35], v[76:79], v[152:155]
    ds_read_b128 v[84:87], v18 offset:2048
    v_mfma_f32_16x16x32_bf16 v[132:135], v[36:39], v[64:67], v[132:135]
    ds_read_b64_tr_b16 v[116:117], v20 offset:0
    v_mfma_f32_16x16x32_bf16 v[140:143], v[36:39], v[68:71], v[140:143]
    ds_read_b64_tr_b16 v[118:119], v20 offset:1024
    v_mfma_f32_16x16x32_bf16 v[148:151], v[36:39], v[72:75], v[148:151]
    ds_read_b128 v[88:91], v18 offset:4096
    v_mfma_f32_16x16x32_bf16 v[156:159], v[36:39], v[76:79], v[156:159]
    ds_read_b128 v[92:95], v18 offset:6144
    v_mfma_f32_16x16x32_bf16 v[160:163], v[40:43], v[64:67], v[160:163]
    ds_read_b64_tr_b16 v[120:121], v21 offset:0
    v_mfma_f32_16x16x32_bf16 v[168:171], v[40:43], v[68:71], v[168:171]
    ds_read_b64_tr_b16 v[122:123], v21 offset:1024
    v_mfma_f32_16x16x32_bf16 v[176:179], v[40:43], v[72:75], v[176:179]
    ds_read_b128 v[96:99], v18 offset:8192
    v_mfma_f32_16x16x32_bf16 v[184:187], v[40:43], v[76:79], v[184:187]
    ds_read_b128 v[100:103], v18 offset:10240
    v_mfma_f32_16x16x32_bf16 v[164:167], v[44:47], v[64:67], v[164:167]
    ds_read_b64_tr_b16 v[124:125], v22 offset:0
    s_mov_b32 s28, s78
    s_and_b32 s29, s79, 0xffff
    s_mov_b32 s30, 1990656
    s_mov_b32 s31, 0x20000
    s_lshl_b32 s32, s7, 2
    s_add_u32 s32, s32, s40
    s_mul_i32 s52, s32, 9
    s_mul_i32 s53, s6, 576
    s_add_u32 s53, s53, s52
    s_lshl_b32 s53, s53, 8
    s_add_u32 s53, s53, 69206016
    s_add_u32 s32, s52, 0
    v_add_u32 v5, s32, v3
    v_and_b32 v11, 3, v5
    v_bfe_u32 v12, v5, 3, 1
    v_lshl_or_b32 v11, v12, 2, v11
    v_lshlrev_b32 v11, 1, v11
    v_xor_b32 v11, v11, v2
    v_min_u32 v11, 14, v11
    v_mul_u32_u24 v12, 13, v11
    v_lshrrev_b32 v12, 6, v12
    v_mul_u32_u24 v12, 1072, v12
    v_lshl_add_u32 v11, v11, 4, v12
    v_mul_u32_u24 v5, 3456, v5
    v_add_u32 v5, v5, v11
    s_mul_i32 s32, s6, 72
    s_andn2_b32 s32, s32, 15
    buffer_load_dwordx4 v[24:27], v5, s[28:31], s32 offen
    v_mfma_f32_16x16x32_bf16 v[172:175], v[44:47], v[68:71], v[172:175]
    ds_read_b64_tr_b16 v[126:127], v22 offset:1024
    v_mfma_f32_16x16x32_bf16 v[180:183], v[44:47], v[72:75], v[180:183]
    ds_read_b128 v[104:107], v18 offset:12288
    v_mfma_f32_16x16x32_bf16 v[188:191], v[44:47], v[76:79], v[188:191]
    ds_read_b128 v[108:111], v18 offset:14336
    v_mfma_f32_16x16x32_bf16 v[192:195], v[48:51], v[64:67], v[192:195]
    v_mfma_f32_16x16x32_bf16 v[200:203], v[48:51], v[68:71], v[200:203]
    v_mfma_f32_16x16x32_bf16 v[208:211], v[48:51], v[72:75], v[208:211]
    v_mfma_f32_16x16x32_bf16 v[216:219], v[48:51], v[76:79], v[216:219]
    v_mfma_f32_16x16x32_bf16 v[196:199], v[52:55], v[64:67], v[196:199]
    s_add_u32 s32, s52, 4
    v_add_u32 v5, s32, v3
    v_and_b32 v11, 3, v5
    v_bfe_u32 v12, v5, 3, 1
    v_lshl_or_b32 v11, v12, 2, v11
    v_lshlrev_b32 v11, 1, v11
    v_xor_b32 v11, v11, v2
    v_min_u32 v11, 14, v11
    v_mul_u32_u24 v12, 13, v11
    v_lshrrev_b32 v12, 6, v12
    v_mul_u32_u24 v12, 1072, v12
    v_lshl_add_u32 v11, v11, 4, v12
    v_mul_u32_u24 v5, 3456, v5
    v_add_u32 v5, v5, v11
    s_mul_i32 s32, s6, 72
    s_andn2_b32 s32, s32, 15
    buffer_load_dwordx4 v[6:9], v5, s[28:31], s32 offen
    v_mfma_f32_16x16x32_bf16 v[204:207], v[52:55], v[68:71], v[204:207]
    v_mfma_f32_16x16x32_bf16 v[212:215], v[52:55], v[72:75], v[212:215]
    v_mfma_f32_16x16x32_bf16 v[220:223], v[52:55], v[76:79], v[220:223]
    v_mfma_f32_16x16x32_bf16 v[224:227], v[56:59], v[64:67], v[224:227]
    v_mfma_f32_16x16x32_bf16 v[232:235], v[56:59], v[68:71], v[232:235]
    v_mfma_f32_16x16x32_bf16 v[240:243], v[56:59], v[72:75], v[240:243]
    v_mfma_f32_16x16x32_bf16 v[248:251], v[56:59], v[76:79], v[248:251]
    v_mfma_f32_16x16x32_bf16 v[228:231], v[60:63], v[64:67], v[228:231]
    v_mfma_f32_16x16x32_bf16 v[236:239], v[60:63], v[68:71], v[236:239]
    v_add_u32 v18, 0, v13
    v_add_u32 v19, 114688, v14
    v_mfma_f32_16x16x32_bf16 v[244:247], v[60:63], v[72:75], v[244:247]
    v_add_u32 v20, 114688, v15
    v_add_u32 v21, 114688, v16
    v_mfma_f32_16x16x32_bf16 v[252:255], v[60:63], v[76:79], v[252:255]
    v_add_u32 v22, 114688, v17
    s_waitcnt vmcnt(8) lgkmcnt(0)
    s_barrier
    v_mfma_f32_16x16x32_bf16 v[128:131], v[80:83], v[112:115], v[128:131]
    ds_read_b64_tr_b16 v[64:65], v19 offset:0
    v_mfma_f32_16x16x32_bf16 v[136:139], v[80:83], v[116:119], v[136:139]
    ds_read_b64_tr_b16 v[66:67], v19 offset:1024
    v_mfma_f32_16x16x32_bf16 v[144:147], v[80:83], v[120:123], v[144:147]
    ds_read_b128 v[32:35], v18 offset:0
    v_mfma_f32_16x16x32_bf16 v[152:155], v[80:83], v[124:127], v[152:155]
    ds_read_b128 v[36:39], v18 offset:2048
    v_mfma_f32_16x16x32_bf16 v[132:135], v[84:87], v[112:115], v[132:135]
    ds_read_b64_tr_b16 v[68:69], v20 offset:0
    v_mfma_f32_16x16x32_bf16 v[140:143], v[84:87], v[116:119], v[140:143]
    ds_read_b64_tr_b16 v[70:71], v20 offset:1024
    v_mfma_f32_16x16x32_bf16 v[148:151], v[84:87], v[120:123], v[148:151]
    ds_read_b128 v[40:43], v18 offset:4096
    v_mfma_f32_16x16x32_bf16 v[156:159], v[84:87], v[124:127], v[156:159]
    ds_read_b128 v[44:47], v18 offset:6144
    v_mfma_f32_16x16x32_bf16 v[160:163], v[88:91], v[112:115], v[160:163]
    ds_read_b64_tr_b16 v[72:73], v21 offset:0
    v_mfma_f32_16x16x32_bf16 v[168:171], v[88:91], v[116:119], v[168:171]
    ds_read_b64_tr_b16 v[74:75], v21 offset:1024
    v_mfma_f32_16x16x32_bf16 v[176:179], v[88:91], v[120:123], v[176:179]
    ds_read_b128 v[48:51], v18 offset:8192
    v_mfma_f32_16x16x32_bf16 v[184:187], v[88:91], v[124:127], v[184:187]
    ds_read_b128 v[52:55], v18 offset:10240
    v_mfma_f32_16x16x32_bf16 v[164:167], v[92:95], v[112:115], v[164:167]
    ds_read_b64_tr_b16 v[76:77], v22 offset:0
    s_cmp_lg_u32 s3, 6
    s_cbranch_scc1 kf_notag
    s_mov_b32 s16, s86
    s_and_b32 s17, s87, 0xffff
    s_mov_b32 s18, 256
    s_mov_b32 s19, 0x20000
    v_readfirstlane_b32 s41, v29
    s_and_b32 s41, s41, 0xff
    s_add_u32 s41, s41, 1
    s_cmp_eq_u32 s41, 256
    s_cselect_b32 s41, 1, s41
    v_readfirstlane_b32 s32, v31
    s_and_b32 s32, s32, 0xff
    s_cmp_eq_u32 s32, s41
    s_cselect_b32 s32, 1, 0
    s_add_u32 s41, s41, s32
    s_cmp_eq_u32 s41, 256
    s_cselect_b32 s41, 1, s41
    s_mov_b32 s63, s41
    v_mov_b32 v29, s41
    v_mov_b32 v31, s2
    s_mov_b64 exec, 1
    buffer_store_byte v29, v31, s[16:19], 0 offen sc0 sc1
    s_mov_b64 exec, -1
kf_notag:
    v_mfma_f32_16x16x32_bf16 v[172:175], v[92:95], v[116:119], v[172:175]
    ds_read_b64_tr_b16 v[78:79], v22 offset:1024
    v_mfma_f32_16x16x32_bf16 v[180:183], v[92:95], v[120:123], v[180:183]
    ds_read_b128 v[56:59], v18 offset:12288
    v_mfma_f32_16x16x32_bf16 v[188:191], v[92:95], v[124:127], v[188:191]
    ds_read_b128 v[60:63], v18 offset:14336
    v_mfma_f32_16x16x32_bf16 v[192:195], v[96:99], v[112:115], v[192:195]
    v_mfma_f32_16x16x32_bf16 v[200:203], v[96:99], v[116:119], v[200:203]
    v_mfma_f32_16x16x32_bf16 v[208:211], v[96:99], v[120:123], v[208:211]
    v_mfma_f32_16x16x32_bf16 v[216:219], v[96:99], v[124:127], v[216:219]
    v_mfma_f32_16x16x32_bf16 v[196:199], v[100:103], v[112:115], v[196:199]
    v_mfma_f32_16x16x32_bf16 v[204:207], v[100:103], v[116:119], v[204:207]
    v_mfma_f32_16x16x32_bf16 v[212:215], v[100:103], v[120:123], v[212:215]
    v_mfma_f32_16x16x32_bf16 v[220:223], v[100:103], v[124:127], v[220:223]
    v_mfma_f32_16x16x32_bf16 v[224:227], v[104:107], v[112:115], v[224:227]
    v_mfma_f32_16x16x32_bf16 v[232:235], v[104:107], v[116:119], v[232:235]
    v_mfma_f32_16x16x32_bf16 v[240:243], v[104:107], v[120:123], v[240:243]
    v_mfma_f32_16x16x32_bf16 v[248:251], v[104:107], v[124:127], v[248:251]
    v_mfma_f32_16x16x32_bf16 v[228:231], v[108:111], v[112:115], v[228:231]
    v_mfma_f32_16x16x32_bf16 v[236:239], v[108:111], v[116:119], v[236:239]
    v_add_u32 v18, 0, v30
    v_add_u32 v19, 131072, v14
    v_mfma_f32_16x16x32_bf16 v[244:247], v[108:111], v[120:123], v[244:247]
    v_add_u32 v20, 131072, v15
    v_add_u32 v21, 131072, v16
    v_mfma_f32_16x16x32_bf16 v[252:255], v[108:111], v[124:127], v[252:255]
    v_add_u32 v22, 131072, v17
    s_waitcnt vmcnt(6) lgkmcnt(0)
    s_barrier
    v_mfma_f32_16x16x32_bf16 v[128:131], v[32:35], v[64:67], v[128:131]
    ds_read_b64_tr_b16 v[112:113], v19 offset:0
    v_mfma_f32_16x16x32_bf16 v[136:139], v[32:35], v[68:71], v[136:139]
    ds_read_b64_tr_b16 v[114:115], v19 offset:1024
    v_mfma_f32_16x16x32_bf16 v[144:147], v[32:35], v[72:75], v[144:147]
    ds_read_b128 v[80:83], v18 offset:0
    v_mfma_f32_16x16x32_bf16 v[152:155], v[32:35], v[76:79], v[152:155]
    ds_read_b128 v[84:87], v18 offset:2048
    v_mfma_f32_16x16x32_bf16 v[132:135], v[36:39], v[64:67], v[132:135]
    ds_read_b64_tr_b16 v[116:117], v20 offset:0
    v_mfma_f32_16x16x32_bf16 v[140:143], v[36:39], v[68:71], v[140:143]
    ds_read_b64_tr_b16 v[118:119], v20 offset:1024
    v_mfma_f32_16x16x32_bf16 v[148:151], v[36:39], v[72:75], v[148:151]
    ds_read_b128 v[88:91], v18 offset:4096
    v_mfma_f32_16x16x32_bf16 v[156:159], v[36:39], v[76:79], v[156:159]
    ds_read_b128 v[92:95], v18 offset:6144
    v_mfma_f32_16x16x32_bf16 v[160:163], v[40:43], v[64:67], v[160:163]
    ds_read_b64_tr_b16 v[120:121], v21 offset:0
    v_mfma_f32_16x16x32_bf16 v[168:171], v[40:43], v[68:71], v[168:171]
    ds_read_b64_tr_b16 v[122:123], v21 offset:1024
    v_mfma_f32_16x16x32_bf16 v[176:179], v[40:43], v[72:75], v[176:179]
    ds_read_b128 v[96:99], v18 offset:8192
    v_mfma_f32_16x16x32_bf16 v[184:187], v[40:43], v[76:79], v[184:187]
    ds_read_b128 v[100:103], v18 offset:10240
    v_mfma_f32_16x16x32_bf16 v[164:167], v[44:47], v[64:67], v[164:167]
    ds_read_b64_tr_b16 v[124:125], v22 offset:0
    s_waitcnt vmcnt(0)
    buffer_store_dwordx4 v[24:27], v4, s[20:23], s53 offen offset:0 sc1
    buffer_store_dwordx4 v[6:9], v4, s[20:23], s53 offen offset:1024 sc1
    v_mfma_f32_16x16x32_bf16 v[172:175], v[44:47], v[68:71], v[172:175]
    ds_read_b64_tr_b16 v[126:127], v22 offset:1024
    v_mfma_f32_16x16x32_bf16 v[180:183], v[44:47], v[72:75], v[180:183]
    ds_read_b128 v[104:107], v18 offset:12288
    v_mfma_f32_16x16x32_bf16 v[188:191], v[44:47], v[76:79], v[188:191]
    ds_read_b128 v[108:111], v18 offset:14336
    v_mfma_f32_16x16x32_bf16 v[192:195], v[48:51], v[64:67], v[192:195]
    v_mfma_f32_16x16x32_bf16 v[200:203], v[48:51], v[68:71], v[200:203]
    s_add_u32 s32, s52, 8
    v_add_u32 v5, s32, v3
    v_and_b32 v11, 3, v5
    v_bfe_u32 v12, v5, 3, 1
    v_lshl_or_b32 v11, v12, 2, v11
    v_lshlrev_b32 v11, 1, v11
    v_xor_b32 v11, v11, v2
    v_min_u32 v11, 14, v11
    v_mul_u32_u24 v12, 13, v11
    v_lshrrev_b32 v12, 6, v12
    v_mul_u32_u24 v12, 1072, v12
    v_lshl_add_u32 v11, v11, 4, v12
    v_mul_u32_u24 v5, 3456, v5
    v_add_u32 v5, v5, v11
    s_mul_i32 s32, s6, 72
    s_andn2_b32 s32, s32, 15
    s_mov_b64 exec, 0xffff
    buffer_load_dwordx4 v[24:27], v5, s[28:31], s32 offen
    s_mov_b64 exec, -1
    v_mfma_f32_16x16x32_bf16 v[208:211], v[48:51], v[72:75], v[208:211]
    v_mfma_f32_16x16x32_bf16 v[216:219], v[48:51], v[76:79], v[216:219]
    v_mfma_f32_16x16x32_bf16 v[196:199], v[52:55], v[64:67], v[196:199]
    v_mfma_f32_16x16x32_bf16 v[204:207], v[52:55], v[68:71], v[204:207]
    v_mfma_f32_16x16x32_bf16 v[212:215], v[52:55], v[72:75], v[212:215]
    v_mfma_f32_16x16x32_bf16 v[220:223], v[52:55], v[76:79], v[220:223]
    s_mov_b32 s24, s76
    s_and_b32 s25, s77, 0xffff
    s_mov_b32 s26, 2359296
    s_mov_b32 s27, 0x20000
    s_mul_i32 s50, s61, 4608
    s_and_b32 s51, s2, 6
    s_mul_i32 s51, s51, 294912
    s_add_u32 s50, s50, s51
    v_min_u32 v29, 35, v1
    v_lshlrev_b32 v29, 7, v29
    buffer_load_dword v28, v29, s[24:27], s50 offen
    s_add_u32 s50, s50, 4608
    v_mfma_f32_16x16x32_bf16 v[224:227], v[56:59], v[64:67], v[224:227]
    v_mfma_f32_16x16x32_bf16 v[232:235], v[56:59], v[68:71], v[232:235]
    v_mfma_f32_16x16x32_bf16 v[240:243], v[56:59], v[72:75], v[240:243]
    v_mfma_f32_16x16x32_bf16 v[248:251], v[56:59], v[76:79], v[248:251]
    v_mfma_f32_16x16x32_bf16 v[228:231], v[60:63], v[64:67], v[228:231]
    v_mfma_f32_16x16x32_bf16 v[236:239], v[60:63], v[68:71], v[236:239]
    v_add_u32 v18, 32768, v13
    v_add_u32 v19, 147456, v14
    v_mfma_f32_16x16x32_bf16 v[244:247], v[60:63], v[72:75], v[244:247]
    v_add_u32 v20, 147456, v15
    v_add_u32 v21, 147456, v16
    v_mfma_f32_16x16x32_bf16 v[252:255], v[60:63], v[76:79], v[252:255]
    v_add_u32 v22, 147456, v17
    s_waitcnt vmcnt(6) lgkmcnt(0)
    s_barrier
    v_mfma_f32_16x16x32_bf16 v[128:131], v[80:83], v[112:115], v[128:131]
    ds_read_b64_tr_b16 v[64:65], v19 offset:0
    v_mfma_f32_16x16x32_bf16 v[136:139], v[80:83], v[116:119], v[136:139]
    ds_read_b64_tr_b16 v[66:67], v19 offset:1024
    v_mfma_f32_16x16x32_bf16 v[144:147], v[80:83], v[120:123], v[144:147]
    ds_read_b128 v[32:35], v18 offset:0
    v_mfma_f32_16x16x32_bf16 v[152:155], v[80:83], v[124:127], v[152:155]
    ds_read_b128 v[36:39], v18 offset:2048
    v_mfma_f32_16x16x32_bf16 v[132:135], v[84:87], v[112:115], v[132:135]
    ds_read_b64_tr_b16 v[68:69], v20 offset:0
    v_mfma_f32_16x16x32_bf16 v[140:143], v[84:87], v[116:119], v[140:143]
    ds_read_b64_tr_b16 v[70:71], v20 offset:1024
    v_mfma_f32_16x16x32_bf16 v[148:151], v[84:87], v[120:123], v[148:151]
    ds_read_b128 v[40:43], v18 offset:4096
    v_mfma_f32_16x16x32_bf16 v[156:159], v[84:87], v[124:127], v[156:159]
    ds_read_b128 v[44:47], v18 offset:6144
    v_mfma_f32_16x16x32_bf16 v[160:163], v[88:91], v[112:115], v[160:163]
    ds_read_b64_tr_b16 v[72:73], v21 offset:0
    v_mfma_f32_16x16x32_bf16 v[168:171], v[88:91], v[116:119], v[168:171]
    ds_read_b64_tr_b16 v[74:75], v21 offset:1024
    v_mfma_f32_16x16x32_bf16 v[176:179], v[88:91], v[120:123], v[176:179]
    ds_read_b128 v[48:51], v18 offset:8192
    v_mfma_f32_16x16x32_bf16 v[184:187], v[88:91], v[124:127], v[184:187]
    ds_read_b128 v[52:55], v18 offset:10240
    v_mfma_f32_16x16x32_bf16 v[164:167], v[92:95], v[112:115], v[164:167]
    ds_read_b64_tr_b16 v[76:77], v22 offset:0
    s_mov_b32 s24, s68
    s_and_b32 s25, s69, 0xffff
    s_mov_b32 s26, 4718592
    s_mov_b32 s27, 0x20000
    s_mul_i32 s50, s61, 40960
    s_and_b32 s51, s2, 7
    s_lshl_b32 s51, s51, 10
    s_add_u32 s50, s50, s51
    v_lshrrev_b32 v29, 3, v1
    v_min_u32 v29, 4, v29
    v_lshlrev_b32 v29, 13, v29
    v_and_b32 v5, 7, v1
    v_lshl_add_u32 v29, v5, 7, v29
    buffer_load_dword v28, v29, s[24:27], s50 offen
    v_mfma_f32_16x16x32_bf16 v[172:175], v[92:95], v[116:119], v[172:175]
    ds_read_b64_tr_b16 v[78:79], v22 offset:1024
    v_mfma_f32_16x16x32_bf16 v[180:183], v[92:95], v[120:123], v[180:183]
    ds_read_b128 v[56:59], v18 offset:12288
    v_mfma_f32_16x16x32_bf16 v[188:191], v[92:95], v[124:127], v[188:191]
    ds_read_b128 v[60:63], v18 offset:14336
    v_mfma_f32_16x16x32_bf16 v[192:195], v[96:99], v[112:115], v[192:195]
    v_mfma_f32_16x16x32_bf16 v[200:203], v[96:99], v[116:119], v[200:203]
    v_mfma_f32_16x16x32_bf16 v[208:211], v[96:99], v[120:123], v[208:211]
    v_mfma_f32_16x16x32_bf16 v[216:219], v[96:99], v[124:127], v[216:219]
    v_mfma_f32_16x16x32_bf16 v[196:199], v[100:103], v[112:115], v[196:199]
    v_mfma_f32_16x16x32_bf16 v[204:207], v[100:103], v[116:119], v[204:207]
    v_mfma_f32_16x16x32_bf16 v[212:215], v[100:103], v[120:123], v[212:215]
    v_mfma_f32_16x16x32_bf16 v[220:223], v[100:103], v[124:127], v[220:223]
    v_mfma_f32_16x16x32_bf16 v[224:227], v[104:107], v[112:115], v[224:227]
    v_mfma_f32_16x16x32_bf16 v[232:235], v[104:107], v[116:119], v[232:235]
    v_mfma_f32_16x16x32_bf16 v[240:243], v[104:107], v[120:123], v[240:243]
    v_mfma_f32_16x16x32_bf16 v[248:251], v[104:107], v[124:127], v[248:251]
    v_mfma_f32_16x16x32_bf16 v[228:231], v[108:111], v[112:115], v[228:231]
    v_mfma_f32_16x16x32_bf16 v[236:239], v[108:111], v[116:119], v[236:239]
    v_add_u32 v18, 32768, v30
    v_add_u32 v19, 98304, v14
    v_mfma_f32_16x16x32_bf16 v[244:247], v[108:111], v[120:123], v[244:247]
    v_add_u32 v20, 98304, v15
    v_add_u32 v21, 98304, v16
    v_mfma_f32_16x16x32_bf16 v[252:255], v[108:111], v[124:127], v[252:255]
    v_add_u32 v22, 98304, v17
    s_waitcnt vmcnt(7) lgkmcnt(0)
    s_barrier
    v_mfma_f32_16x16x32_bf16 v[128:131], v[32:35], v[64:67], v[128:131]
    ds_read_b64_tr_b16 v[112:113], v19 offset:0
    v_mfma_f32_16x16x32_bf16 v[136:139], v[32:35], v[68:71], v[136:139]
    ds_read_b64_tr_b16 v[114:115], v19 offset:1024
    v_mfma_f32_16x16x32_bf16 v[144:147], v[32:35], v[72:75], v[144:147]
    ds_read_b128 v[80:83], v18 offset:0
    v_mfma_f32_16x16x32_bf16 v[152:155], v[32:35], v[76:79], v[152:155]
    ds_read_b128 v[84:87], v18 offset:2048
    v_mfma_f32_16x16x32_bf16 v[132:135], v[36:39], v[64:67], v[132:135]
    ds_read_b64_tr_b16 v[116:117], v20 offset:0
    v_mfma_f32_16x16x32_bf16 v[140:143], v[36:39], v[68:71], v[140:143]
    ds_read_b64_tr_b16 v[118:119], v20 offset:1024
    v_mfma_f32_16x16x32_bf16 v[148:151], v[36:39], v[72:75], v[148:151]
    ds_read_b128 v[88:91], v18 offset:4096
    v_mfma_f32_16x16x32_bf16 v[156:159], v[36:39], v[76:79], v[156:159]
    ds_read_b128 v[92:95], v18 offset:6144
    v_mfma_f32_16x16x32_bf16 v[160:163], v[40:43], v[64:67], v[160:163]
    ds_read_b64_tr_b16 v[120:121], v21 offset:0
    v_mfma_f32_16x16x32_bf16 v[168:171], v[40:43], v[68:71], v[168:171]
    ds_read_b64_tr_b16 v[122:123], v21 offset:1024
    v_mfma_f32_16x16x32_bf16 v[176:179], v[40:43], v[72:75], v[176:179]
    ds_read_b128 v[96:99], v18 offset:8192
    v_mfma_f32_16x16x32_bf16 v[184:187], v[40:43], v[76:79], v[184:187]
    ds_read_b128 v[100:103], v18 offset:10240
    v_mfma_f32_16x16x32_bf16 v[164:167], v[44:47], v[64:67], v[164:167]
    ds_read_b64_tr_b16 v[124:125], v22 offset:0
    s_waitcnt vmcnt(2)
    s_mov_b64 exec, 0xffff
    buffer_store_dwordx4 v[24:27], v4, s[20:23], s53 offen offset:2048 sc1
    s_mov_b64 exec, -1
    v_mfma_f32_16x16x32_bf16 v[172:175], v[44:47], v[68:71], v[172:175]
    ds_read_b64_tr_b16 v[126:127], v22 offset:1024
    v_mfma_f32_16x16x32_bf16 v[180:183], v[44:47], v[72:75], v[180:183]
    ds_read_b128 v[104:107], v18 offset:12288
    v_mfma_f32_16x16x32_bf16 v[188:191], v[44:47], v[76:79], v[188:191]
    ds_read_b128 v[108:111], v18 offset:14336
    v_mfma_f32_16x16x32_bf16 v[192:195], v[48:51], v[64:67], v[192:195]
    v_mfma_f32_16x16x32_bf16 v[200:203], v[48:51], v[68:71], v[200:203]
    v_mfma_f32_16x16x32_bf16 v[208:211], v[48:51], v[72:75], v[208:211]
    v_mfma_f32_16x16x32_bf16 v[216:219], v[48:51], v[76:79], v[216:219]
    v_mfma_f32_16x16x32_bf16 v[196:199], v[52:55], v[64:67], v[196:199]
    v_mfma_f32_16x16x32_bf16 v[204:207], v[52:55], v[68:71], v[204:207]
    v_mfma_f32_16x16x32_bf16 v[212:215], v[52:55], v[72:75], v[212:215]
    v_mfma_f32_16x16x32_bf16 v[220:223], v[52:55], v[76:79], v[220:223]
    v_mfma_f32_16x16x32_bf16 v[224:227], v[56:59], v[64:67], v[224:227]
    v_mfma_f32_16x16x32_bf16 v[232:235], v[56:59], v[68:71], v[232:235]
    v_mfma_f32_16x16x32_bf16 v[240:243], v[56:59], v[72:75], v[240:243]
    v_mfma_f32_16x16x32_bf16 v[248:251], v[56:59], v[76:79], v[248:251]
    v_mfma_f32_16x16x32_bf16 v[228:231], v[60:63], v[64:67], v[228:231]
    v_mfma_f32_16x16x32_bf16 v[236:239], v[60:63], v[68:71], v[236:239]
    v_add_u32 v18, 65536, v13
    v_add_u32 v19, 114688, v14
    v_mfma_f32_16x16x32_bf16 v[244:247], v[60:63], v[72:75], v[244:247]
    v_add_u32 v20, 114688, v15
    v_add_u32 v21, 114688, v16
    v_mfma_f32_16x16x32_bf16 v[252:255], v[60:63], v[76:79], v[252:255]
    v_add_u32 v22, 114688, v17
    s_waitcnt lgkmcnt(0)
    s_barrier
    v_mfma_f32_16x16x32_bf16 v[128:131], v[80:83], v[112:115], v[128:131]
    ds_read_b64_tr_b16 v[64:65], v19 offset:0
    v_lshrrev_b32 v5, 3, v1
    v_mul_u32_u24 v5, 1152, v5
    v_and_b32 v6, 7, v1
    v_xor_b32 v6, v6, v3
    v_mfma_f32_16x16x32_bf16 v[136:139], v[80:83], v[116:119], v[136:139]
    ds_read_b64_tr_b16 v[66:67], v19 offset:1024
    v_mfma_f32_16x16x32_bf16 v[144:147], v[80:83], v[120:123], v[144:147]
    ds_read_b128 v[32:35], v18 offset:0
    v_lshl_add_u32 v11, v6, 4, v5
    v_xor_b32 v6, 4, v6
    v_lshl_add_u32 v24, v6, 4, v5
    v_add_u32 v24, 9216, v24
    v_mfma_f32_16x16x32_bf16 v[152:155], v[80:83], v[124:127], v[152:155]
    ds_read_b128 v[36:39], v18 offset:2048
    v_mfma_f32_16x16x32_bf16 v[132:135], v[84:87], v[112:115], v[132:135]
    ds_read_b64_tr_b16 v[68:69], v20 offset:0
    s_lshl_b32 s32, s7, 2
    s_add_u32 s32, s32, s40
    s_mul_i32 s37, s32, 36864
    s_mul_i32 s44, s6, 72
    v_mfma_f32_16x16x32_bf16 v[140:143], v[84:87], v[116:119], v[140:143]
    ds_read_b64_tr_b16 v[70:71], v20 offset:1024
    v_mfma_f32_16x16x32_bf16 v[148:151], v[84:87], v[120:123], v[148:151]
    ds_read_b128 v[40:43], v18 offset:4096
    s_and_b32 s44, s44, 15
    s_mul_i32 s38, s6, 147456
    s_add_u32 s38, s38, s43
    s_add_u32 s38, s38, 69206016
    v_mfma_f32_16x16x32_bf16 v[156:159], v[84:87], v[124:127], v[156:159]
    ds_read_b128 v[44:47], v18 offset:6144
    v_mfma_f32_16x16x32_bf16 v[160:163], v[88:91], v[112:115], v[160:163]
    ds_read_b64_tr_b16 v[72:73], v21 offset:0
    v_mfma_f32_16x16x32_bf16 v[168:171], v[88:91], v[116:119], v[168:171]
    ds_read_b64_tr_b16 v[74:75], v21 offset:1024
    s_sub_u32 s32, 15, s5
    s_lshl_b32 s32, s32, 7
    s_lshl_b32 s33, s40, 5
    s_add_u32 s59, s32, s33
    v_mfma_f32_16x16x32_bf16 v[176:179], v[88:91], v[120:123], v[176:179]
    ds_read_b128 v[48:51], v18 offset:8192
    v_mfma_f32_16x16x32_bf16 v[184:187], v[88:91], v[124:127], v[184:187]
    ds_read_b128 v[52:55], v18 offset:10240
    s_lshl_b32 s32, s5, 7
    s_add_u32 s32, s32, s33
    s_mul_i32 s90, s32, 1152
    s_mul_i32 s91, s59, 1152
    v_mfma_f32_16x16x32_bf16 v[164:167], v[92:95], v[112:115], v[164:167]
    ds_read_b64_tr_b16 v[76:77], v22 offset:0
    v_mfma_f32_16x16x32_bf16 v[172:175], v[92:95], v[116:119], v[172:175]
    ds_read_b64_tr_b16 v[78:79], v22 offset:1024
    s_cmp_eq_u32 s45, 0
    s_cselect_b32 s58, s32, s59
    v_mfma_f32_16x16x32_bf16 v[180:183], v[92:95], v[120:123], v[180:183]
    ds_read_b128 v[56:59], v18 offset:12288
    v_mfma_f32_16x16x32_bf16 v[188:191], v[92:95], v[124:127], v[188:191]
    ds_read_b128 v[60:63], v18 offset:14336
    v_mfma_f32_16x16x32_bf16 v[192:195], v[96:99], v[112:115], v[192:195]
    v_mfma_f32_16x16x32_bf16 v[200:203], v[96:99], v[116:119], v[200:203]
    v_mfma_f32_16x16x32_bf16 v[208:211], v[96:99], v[120:123], v[208:211]
    v_mfma_f32_16x16x32_bf16 v[216:219], v[96:99], v[124:127], v[216:219]
    v_mfma_f32_16x16x32_bf16 v[196:199], v[100:103], v[112:115], v[196:199]
    v_mfma_f32_16x16x32_bf16 v[204:207], v[100:103], v[116:119], v[204:207]
    v_mfma_f32_16x16x32_bf16 v[212:215], v[100:103], v[120:123], v[212:215]
    v_mfma_f32_16x16x32_bf16 v[220:223], v[100:103], v[124:127], v[220:223]
    v_mfma_f32_16x16x32_bf16 v[224:227], v[104:107], v[112:115], v[224:227]
    v_mfma_f32_16x16x32_bf16 v[232:235], v[104:107], v[116:119], v[232:235]
    v_mfma_f32_16x16x32_bf16 v[240:243], v[104:107], v[120:123], v[240:243]
    v_mfma_f32_16x16x32_bf16 v[248:251], v[104:107], v[124:127], v[248:251]
    v_mfma_f32_16x16x32_bf16 v[228:231], v[108:111], v[112:115], v[228:231]
    v_mfma_f32_16x16x32_bf16 v[236:239], v[108:111], v[116:119], v[236:239]
    v_add_u32 v18, 65536, v30
    v_add_u32 v19, 131072, v14
    v_mfma_f32_16x16x32_bf16 v[244:247], v[108:111], v[120:123], v[244:247]
    v_add_u32 v20, 131072, v15
    v_add_u32 v21, 131072, v16
    v_mfma_f32_16x16x32_bf16 v[252:255], v[108:111], v[124:127], v[252:255]
    v_add_u32 v22, 131072, v17
    s_waitcnt vmcnt(0) lgkmcnt(0)
    s_barrier
    v_mfma_f32_16x16x32_bf16 v[128:131], v[32:35], v[64:67], v[128:131]
    ds_read_b64_tr_b16 v[112:113], v19 offset:0
    v_mfma_f32_16x16x32_bf16 v[136:139], v[32:35], v[68:71], v[136:139]
    ds_read_b64_tr_b16 v[114:115], v19 offset:1024
    v_mfma_f32_16x16x32_bf16 v[144:147], v[32:35], v[72:75], v[144:147]
    ds_read_b128 v[80:83], v18 offset:0
    v_mfma_f32_16x16x32_bf16 v[152:155], v[32:35], v[76:79], v[152:155]
    ds_read_b128 v[84:87], v18 offset:2048
    v_mfma_f32_16x16x32_bf16 v[132:135], v[36:39], v[64:67], v[132:135]
    ds_read_b64_tr_b16 v[116:117], v20 offset:0
    v_mfma_f32_16x16x32_bf16 v[140:143], v[36:39], v[68:71], v[140:143]
    ds_read_b64_tr_b16 v[118:119], v20 offset:1024
    v_mfma_f32_16x16x32_bf16 v[148:151], v[36:39], v[72:75], v[148:151]
    ds_read_b128 v[88:91], v18 offset:4096
    v_mfma_f32_16x16x32_bf16 v[156:159], v[36:39], v[76:79], v[156:159]
    ds_read_b128 v[92:95], v18 offset:6144
    v_mfma_f32_16x16x32_bf16 v[160:163], v[40:43], v[64:67], v[160:163]
    ds_read_b64_tr_b16 v[120:121], v21 offset:0
    v_mfma_f32_16x16x32_bf16 v[168:171], v[40:43], v[68:71], v[168:171]
    ds_read_b64_tr_b16 v[122:123], v21 offset:1024
    v_mfma_f32_16x16x32_bf16 v[176:179], v[40:43], v[72:75], v[176:179]
    ds_read_b128 v[96:99], v18 offset:8192
    v_mfma_f32_16x16x32_bf16 v[184:187], v[40:43], v[76:79], v[184:187]
    ds_read_b128 v[100:103], v18 offset:10240
    v_mfma_f32_16x16x32_bf16 v[164:167], v[44:47], v[64:67], v[164:167]
    ds_read_b64_tr_b16 v[124:125], v22 offset:0
    s_cmp_lg_u32 s3, 6
    s_cbranch_scc1 kf_nof0
    s_lshl_b32 s32, s2, 7
    s_add_u32 s32, s32, 66846720
    v_mov_b32 v27, s32
    v_mov_b32 v26, s41
    s_mov_b64 exec, 1
    buffer_store_dword v26, v27, s[20:23], 0 offen sc1
    s_mov_b64 exec, -1
    s_and_b32 s32, s2, 0xc0
    v_add_u32 v31, s32, v1
    v_lshlrev_b32 v12, 7, v31
    v_add_u32 v12, 66846720, v12
kf_nof0:
    v_mfma_f32_16x16x32_bf16 v[172:175], v[44:47], v[68:71], v[172:175]
    ds_read_b64_tr_b16 v[126:127], v22 offset:1024
    v_mfma_f32_16x16x32_bf16 v[180:183], v[44:47], v[72:75], v[180:183]
    ds_read_b128 v[104:107], v18 offset:12288
    v_mfma_f32_16x16x32_bf16 v[188:191], v[44:47], v[76:79], v[188:191]
    ds_read_b128 v[108:111], v18 offset:14336
    v_mfma_f32_16x16x32_bf16 v[192:195], v[48:51], v[64:67], v[192:195]
    v_mfma_f32_16x16x32_bf16 v[200:203], v[48:51], v[68:71], v[200:203]
    v_mfma_f32_16x16x32_bf16 v[208:211], v[48:51], v[72:75], v[208:211]
    v_mfma_f32_16x16x32_bf16 v[216:219], v[48:51], v[76:79], v[216:219]
    v_mfma_f32_16x16x32_bf16 v[196:199], v[52:55], v[64:67], v[196:199]
    s_mov_b32 s24, s64
    s_and_b32 s25, s65, 0xffff
    s_mov_b32 s26, 2359296
    s_mov_b32 s27, 0x20000
    s_mul_i32 s50, s61, 18432
    v_min_u32 v29, 31, v1
    v_lshlrev_b32 v29, 7, v29
    buffer_load_dword v28, v29, s[24:27], s50 offen
    s_add_u32 s50, s50, 4096
    v_mfma_f32_16x16x32_bf16 v[204:207], v[52:55], v[68:71], v[204:207]
    v_mfma_f32_16x16x32_bf16 v[212:215], v[52:55], v[72:75], v[212:215]
    v_mfma_f32_16x16x32_bf16 v[220:223], v[52:55], v[76:79], v[220:223]
    v_mfma_f32_16x16x32_bf16 v[224:227], v[56:59], v[64:67], v[224:227]
    v_mfma_f32_16x16x32_bf16 v[232:235], v[56:59], v[68:71], v[232:235]
    v_mfma_f32_16x16x32_bf16 v[240:243], v[56:59], v[72:75], v[240:243]
    v_mfma_f32_16x16x32_bf16 v[248:251], v[56:59], v[76:79], v[248:251]
    v_mfma_f32_16x16x32_bf16 v[228:231], v[60:63], v[64:67], v[228:231]
    v_mfma_f32_16x16x32_bf16 v[236:239], v[60:63], v[68:71], v[236:239]
    v_add_u32 v18, 0, v13
    v_add_u32 v19, 147456, v14
    v_mfma_f32_16x16x32_bf16 v[244:247], v[60:63], v[72:75], v[244:247]
    v_add_u32 v20, 147456, v15
    v_add_u32 v21, 147456, v16
    v_mfma_f32_16x16x32_bf16 v[252:255], v[60:63], v[76:79], v[252:255]
    v_add_u32 v22, 147456, v17
    s_waitcnt lgkmcnt(0)
    s_barrier
    v_mfma_f32_16x16x32_bf16 v[128:131], v[80:83], v[112:115], v[128:131]
    ds_read_b64_tr_b16 v[64:65], v19 offset:0
    v_mfma_f32_16x16x32_bf16 v[136:139], v[80:83], v[116:119], v[136:139]
    ds_read_b64_tr_b16 v[66:67], v19 offset:1024
    v_mfma_f32_16x16x32_bf16 v[144:147], v[80:83], v[120:123], v[144:147]
    ds_read_b128 v[32:35], v18 offset:0
    v_mfma_f32_16x16x32_bf16 v[152:155], v[80:83], v[124:127], v[152:155]
    ds_read_b128 v[36:39], v18 offset:2048
    v_mfma_f32_16x16x32_bf16 v[132:135], v[84:87], v[112:115], v[132:135]
    ds_read_b64_tr_b16 v[68:69], v20 offset:0
    v_mfma_f32_16x16x32_bf16 v[140:143], v[84:87], v[116:119], v[140:143]
    ds_read_b64_tr_b16 v[70:71], v20 offset:1024
    v_mfma_f32_16x16x32_bf16 v[148:151], v[84:87], v[120:123], v[148:151]
    ds_read_b128 v[40:43], v18 offset:4096
    v_mfma_f32_16x16x32_bf16 v[156:159], v[84:87], v[124:127], v[156:159]
    ds_read_b128 v[44:47], v18 offset:6144
    v_mfma_f32_16x16x32_bf16 v[160:163], v[88:91], v[112:115], v[160:163]
    ds_read_b64_tr_b16 v[72:73], v21 offset:0
    v_mfma_f32_16x16x32_bf16 v[168:171], v[88:91], v[116:119], v[168:171]
    ds_read_b64_tr_b16 v[74:75], v21 offset:1024
    v_mfma_f32_16x16x32_bf16 v[176:179], v[88:91], v[120:123], v[176:179]
    ds_read_b128 v[48:51], v18 offset:8192
    v_mfma_f32_16x16x32_bf16 v[184:187], v[88:91], v[124:127], v[184:187]
    ds_read_b128 v[52:55], v18 offset:10240
    v_mfma_f32_16x16x32_bf16 v[164:167], v[92:95], v[112:115], v[164:167]
    ds_read_b64_tr_b16 v[76:77], v22 offset:0
    buffer_load_dword v28, v29, s[24:27], s50 offen
    s_add_u32 s50, s50, 4096
    v_mfma_f32_16x16x32_bf16 v[172:175], v[92:95], v[116:119], v[172:175]
    ds_read_b64_tr_b16 v[78:79], v22 offset:1024
    v_mfma_f32_16x16x32_bf16 v[180:183], v[92:95], v[120:123], v[180:183]
    ds_read_b128 v[56:59], v18 offset:12288
    v_mfma_f32_16x16x32_bf16 v[188:191], v[92:95], v[124:127], v[188:191]
    ds_read_b128 v[60:63], v18 offset:14336
    v_mfma_f32_16x16x32_bf16 v[192:195], v[96:99], v[112:115], v[192:195]
    v_mfma_f32_16x16x32_bf16 v[200:203], v[96:99], v[116:119], v[200:203]
    v_mfma_f32_16x16x32_bf16 v[208:211], v[96:99], v[120:123], v[208:211]
    v_mfma_f32_16x16x32_bf16 v[216:219], v[96:99], v[124:127], v[216:219]
    v_mfma_f32_16x16x32_bf16 v[196:199], v[100:103], v[112:115], v[196:199]
    v_mfma_f32_16x16x32_bf16 v[204:207], v[100:103], v[116:119], v[204:207]
    v_mfma_f32_16x16x32_bf16 v[212:215], v[100:103], v[120:123], v[212:215]
    v_mfma_f32_16x16x32_bf16 v[220:223], v[100:103], v[124:127], v[220:223]
    v_mfma_f32_16x16x32_bf16 v[224:227], v[104:107], v[112:115], v[224:227]
    v_mfma_f32_16x16x32_bf16 v[232:235], v[104:107], v[116:119], v[232:235]
    v_mfma_f32_16x16x32_bf16 v[240:243], v[104:107], v[120:123], v[240:243]
    v_mfma_f32_16x16x32_bf16 v[248:251], v[104:107], v[124:127], v[248:251]
    v_mfma_f32_16x16x32_bf16 v[228:231], v[108:111], v[112:115], v[228:231]
    v_mfma_f32_16x16x32_bf16 v[236:239], v[108:111], v[116:119], v[236:239]
    v_add_u32 v18, 0, v30
    v_add_u32 v19, 98304, v14
    v_mfma_f32_16x16x32_bf16 v[244:247], v[108:111], v[120:123], v[244:247]
    v_add_u32 v20, 98304, v15
    v_add_u32 v21, 98304, v16
    v_mfma_f32_16x16x32_bf16 v[252:255], v[108:111], v[124:127], v[252:255]
    v_add_u32 v22, 98304, v17
    s_waitcnt lgkmcnt(0)
    s_barrier
    v_mfma_f32_16x16x32_bf16 v[128:131], v[32:35], v[64:67], v[128:131]
    ds_read_b64_tr_b16 v[112:113], v19 offset:0
    v_mfma_f32_16x16x32_bf16 v[136:139], v[32:35], v[68:71], v[136:139]
    ds_read_b64_tr_b16 v[114:115], v19 offset:1024
    v_mfma_f32_16x16x32_bf16 v[144:147], v[32:35], v[72:75], v[144:147]
    ds_read_b128 v[80:83], v18 offset:0
    v_mfma_f32_16x16x32_bf16 v[152:155], v[32:35], v[76:79], v[152:155]
    ds_read_b128 v[84:87], v18 offset:2048
    v_mfma_f32_16x16x32_bf16 v[132:135], v[36:39], v[64:67], v[132:135]
    ds_read_b64_tr_b16 v[116:117], v20 offset:0
    v_mfma_f32_16x16x32_bf16 v[140:143], v[36:39], v[68:71], v[140:143]
    ds_read_b64_tr_b16 v[118:119], v20 offset:1024
    v_mfma_f32_16x16x32_bf16 v[148:151], v[36:39], v[72:75], v[148:151]
    ds_read_b128 v[88:91], v18 offset:4096
    v_mfma_f32_16x16x32_bf16 v[156:159], v[36:39], v[76:79], v[156:159]
    ds_read_b128 v[92:95], v18 offset:6144
    v_mfma_f32_16x16x32_bf16 v[160:163], v[40:43], v[64:67], v[160:163]
    ds_read_b64_tr_b16 v[120:121], v21 offset:0
    v_mfma_f32_16x16x32_bf16 v[168:171], v[40:43], v[68:71], v[168:171]
    ds_read_b64_tr_b16 v[122:123], v21 offset:1024
    v_mfma_f32_16x16x32_bf16 v[176:179], v[40:43], v[72:75], v[176:179]
    ds_read_b128 v[96:99], v18 offset:8192
    v_mfma_f32_16x16x32_bf16 v[184:187], v[40:43], v[76:79], v[184:187]
    ds_read_b128 v[100:103], v18 offset:10240
    v_mfma_f32_16x16x32_bf16 v[164:167], v[44:47], v[64:67], v[164:167]
    ds_read_b64_tr_b16 v[124:125], v22 offset:0
    buffer_load_dword v28, v29, s[24:27], s50 offen
    s_add_u32 s50, s50, 4096
    v_mfma_f32_16x16x32_bf16 v[172:175], v[44:47], v[68:71], v[172:175]
    ds_read_b64_tr_b16 v[126:127], v22 offset:1024
    v_mfma_f32_16x16x32_bf16 v[180:183], v[44:47], v[72:75], v[180:183]
    ds_read_b128 v[104:107], v18 offset:12288
    v_mfma_f32_16x16x32_bf16 v[188:191], v[44:47], v[76:79], v[188:191]
    ds_read_b128 v[108:111], v18 offset:14336
    v_mfma_f32_16x16x32_bf16 v[192:195], v[48:51], v[64:67], v[192:195]
    v_mfma_f32_16x16x32_bf16 v[200:203], v[48:51], v[68:71], v[200:203]
    v_mfma_f32_16x16x32_bf16 v[208:211], v[48:51], v[72:75], v[208:211]
    v_mfma_f32_16x16x32_bf16 v[216:219], v[48:51], v[76:79], v[216:219]
    v_mfma_f32_16x16x32_bf16 v[196:199], v[52:55], v[64:67], v[196:199]
    v_mfma_f32_16x16x32_bf16 v[204:207], v[52:55], v[68:71], v[204:207]
    v_mfma_f32_16x16x32_bf16 v[212:215], v[52:55], v[72:75], v[212:215]
    v_mfma_f32_16x16x32_bf16 v[220:223], v[52:55], v[76:79], v[220:223]
    v_mfma_f32_16x16x32_bf16 v[224:227], v[56:59], v[64:67], v[224:227]
    v_mfma_f32_16x16x32_bf16 v[232:235], v[56:59], v[68:71], v[232:235]
    v_mfma_f32_16x16x32_bf16 v[240:243], v[56:59], v[72:75], v[240:243]
    v_mfma_f32_16x16x32_bf16 v[248:251], v[56:59], v[76:79], v[248:251]
    v_mfma_f32_16x16x32_bf16 v[228:231], v[60:63], v[64:67], v[228:231]
    v_mfma_f32_16x16x32_bf16 v[236:239], v[60:63], v[68:71], v[236:239]
    v_add_u32 v18, 32768, v13
    v_add_u32 v19, 114688, v14
    v_mfma_f32_16x16x32_bf16 v[244:247], v[60:63], v[72:75], v[244:247]
    v_add_u32 v20, 114688, v15
    v_add_u32 v21, 114688, v16
    v_mfma_f32_16x16x32_bf16 v[252:255], v[60:63], v[76:79], v[252:255]
    v_add_u32 v22, 114688, v17
    s_waitcnt lgkmcnt(0)
    s_barrier
    v_mfma_f32_16x16x32_bf16 v[128:131], v[80:83], v[112:115], v[128:131]
    ds_read_b64_tr_b16 v[64:65], v19 offset:0
    v_mfma_f32_16x16x32_bf16 v[136:139], v[80:83], v[116:119], v[136:139]
    ds_read_b64_tr_b16 v[66:67], v19 offset:1024
    v_mfma_f32_16x16x32_bf16 v[144:147], v[80:83], v[120:123], v[144:147]
    ds_read_b128 v[32:35], v18 offset:0
    v_mfma_f32_16x16x32_bf16 v[152:155], v[80:83], v[124:127], v[152:155]
    ds_read_b128 v[36:39], v18 offset:2048
    v_mfma_f32_16x16x32_bf16 v[132:135], v[84:87], v[112:115], v[132:135]
    ds_read_b64_tr_b16 v[68:69], v20 offset:0
    v_mfma_f32_16x16x32_bf16 v[140:143], v[84:87], v[116:119], v[140:143]
    ds_read_b64_tr_b16 v[70:71], v20 offset:1024
    v_mfma_f32_16x16x32_bf16 v[148:151], v[84:87], v[120:123], v[148:151]
    ds_read_b128 v[40:43], v18 offset:4096
    v_mfma_f32_16x16x32_bf16 v[156:159], v[84:87], v[124:127], v[156:159]
    ds_read_b128 v[44:47], v18 offset:6144
    v_mfma_f32_16x16x32_bf16 v[160:163], v[88:91], v[112:115], v[160:163]
    ds_read_b64_tr_b16 v[72:73], v21 offset:0
    v_mfma_f32_16x16x32_bf16 v[168:171], v[88:91], v[116:119], v[168:171]
    ds_read_b64_tr_b16 v[74:75], v21 offset:1024
    v_mfma_f32_16x16x32_bf16 v[176:179], v[88:91], v[120:123], v[176:179]
    ds_read_b128 v[48:51], v18 offset:8192
    v_mfma_f32_16x16x32_bf16 v[184:187], v[88:91], v[124:127], v[184:187]
    ds_read_b128 v[52:55], v18 offset:10240
    v_mfma_f32_16x16x32_bf16 v[164:167], v[92:95], v[112:115], v[164:167]
    ds_read_b64_tr_b16 v[76:77], v22 offset:0
    s_cmp_lg_u32 s3, 6
    s_cbranch_scc1 kf_np00
    buffer_load_ubyte v26, v31, s[16:19], 0 offen sc0 sc1
    buffer_load_dword v9, v12, s[20:23], 0 offen sc1
kf_np00:
    v_mfma_f32_16x16x32_bf16 v[172:175], v[92:95], v[116:119], v[172:175]
    ds_read_b64_tr_b16 v[78:79], v22 offset:1024
    v_mfma_f32_16x16x32_bf16 v[180:183], v[92:95], v[120:123], v[180:183]
    ds_read_b128 v[56:59], v18 offset:12288
    v_mfma_f32_16x16x32_bf16 v[188:191], v[92:95], v[124:127], v[188:191]
    ds_read_b128 v[60:63], v18 offset:14336
    v_mfma_f32_16x16x32_bf16 v[192:195], v[96:99], v[112:115], v[192:195]
    v_mfma_f32_16x16x32_bf16 v[200:203], v[96:99], v[116:119], v[200:203]
    v_mfma_f32_16x16x32_bf16 v[208:211], v[96:99], v[120:123], v[208:211]
    v_mfma_f32_16x16x32_bf16 v[216:219], v[96:99], v[124:127], v[216:219]
    v_mfma_f32_16x16x32_bf16 v[196:199], v[100:103], v[112:115], v[196:199]
    v_mfma_f32_16x16x32_bf16 v[204:207], v[100:103], v[116:119], v[204:207]
    v_mfma_f32_16x16x32_bf16 v[212:215], v[100:103], v[120:123], v[212:215]
    v_mfma_f32_16x16x32_bf16 v[220:223], v[100:103], v[124:127], v[220:223]
    v_mfma_f32_16x16x32_bf16 v[224:227], v[104:107], v[112:115], v[224:227]
    v_mfma_f32_16x16x32_bf16 v[232:235], v[104:107], v[116:119], v[232:235]
    v_mfma_f32_16x16x32_bf16 v[240:243], v[104:107], v[120:123], v[240:243]
    v_mfma_f32_16x16x32_bf16 v[248:251], v[104:107], v[124:127], v[248:251]
    v_mfma_f32_16x16x32_bf16 v[228:231], v[108:111], v[112:115], v[228:231]
    v_mfma_f32_16x16x32_bf16 v[236:239], v[108:111], v[116:119], v[236:239]
    v_add_u32 v18, 32768, v30
    v_add_u32 v19, 131072, v14
    v_mfma_f32_16x16x32_bf16 v[244:247], v[108:111], v[120:123], v[244:247]
    v_add_u32 v20, 131072, v15
    v_add_u32 v21, 131072, v16
    v_mfma_f32_16x16x32_bf16 v[252:255], v[108:111], v[124:127], v[252:255]
    v_add_u32 v22, 131072, v17
    s_waitcnt lgkmcnt(0)
    s_barrier
    v_mfma_f32_16x16x32_bf16 v[128:131], v[32:35], v[64:67], v[128:131]
    ds_read_b64_tr_b16 v[112:113], v19 offset:0
    v_mfma_f32_16x16x32_bf16 v[136:139], v[32:35], v[68:71], v[136:139]
    ds_read_b64_tr_b16 v[114:115], v19 offset:1024
    v_mfma_f32_16x16x32_bf16 v[144:147], v[32:35], v[72:75], v[144:147]
    ds_read_b128 v[80:83], v18 offset:0
    v_mfma_f32_16x16x32_bf16 v[152:155], v[32:35], v[76:79], v[152:155]
    ds_read_b128 v[84:87], v18 offset:2048
    v_mfma_f32_16x16x32_bf16 v[132:135], v[36:39], v[64:67], v[132:135]
    ds_read_b64_tr_b16 v[116:117], v20 offset:0
    v_mfma_f32_16x16x32_bf16 v[140:143], v[36:39], v[68:71], v[140:143]
    ds_read_b64_tr_b16 v[118:119], v20 offset:1024
    v_mfma_f32_16x16x32_bf16 v[148:151], v[36:39], v[72:75], v[148:151]
    ds_read_b128 v[88:91], v18 offset:4096
    v_mfma_f32_16x16x32_bf16 v[156:159], v[36:39], v[76:79], v[156:159]
    ds_read_b128 v[92:95], v18 offset:6144
    v_mfma_f32_16x16x32_bf16 v[160:163], v[40:43], v[64:67], v[160:163]
    ds_read_b64_tr_b16 v[120:121], v21 offset:0
    v_mfma_f32_16x16x32_bf16 v[168:171], v[40:43], v[68:71], v[168:171]
    ds_read_b64_tr_b16 v[122:123], v21 offset:1024
    v_mfma_f32_16x16x32_bf16 v[176:179], v[40:43], v[72:75], v[176:179]
    ds_read_b128 v[96:99], v18 offset:8192
    v_mfma_f32_16x16x32_bf16 v[184:187], v[40:43], v[76:79], v[184:187]
    ds_read_b128 v[100:103], v18 offset:10240
    v_mfma_f32_16x16x32_bf16 v[164:167], v[44:47], v[64:67], v[164:167]
    ds_read_b64_tr_b16 v[124:125], v22 offset:0
    s_cmp_lg_u32 s3, 6
    s_cbranch_scc1 kf_np01
    s_mov_b32 s33, 0
kf_poll0:
    s_waitcnt vmcnt(0)
    v_and_b32 v9, 0xfffffeff, v9
    v_cmp_ne_u32 vcc, v26, v9
    v_cmp_eq_u32 s[52:53], 0, v26
    s_add_u32 s33, s33, 1
    s_nop 1
    s_or_b64 vcc, vcc, s[52:53]
    s_cbranch_vccz kf_np01
    s_cmp_ge_u32 s33, 400000
    s_cbranch_scc1 kf_np01
    s_sleep 1
    buffer_load_ubyte v26, v31, s[16:19], 0 offen sc0 sc1
    buffer_load_dword v9, v12, s[20:23], 0 offen sc1
    s_branch kf_poll0
kf_np01:
    v_mfma_f32_16x16x32_bf16 v[172:175], v[44:47], v[68:71], v[172:175]
    ds_read_b64_tr_b16 v[126:127], v22 offset:1024
    v_mfma_f32_16x16x32_bf16 v[180:183], v[44:47], v[72:75], v[180:183]
    ds_read_b128 v[104:107], v18 offset:12288
    v_mfma_f32_16x16x32_bf16 v[188:191], v[44:47], v[76:79], v[188:191]
    ds_read_b128 v[108:111], v18 offset:14336
    v_mfma_f32_16x16x32_bf16 v[192:195], v[48:51], v[64:67], v[192:195]
    v_mfma_f32_16x16x32_bf16 v[200:203], v[48:51], v[68:71], v[200:203]
    v_mfma_f32_16x16x32_bf16 v[208:211], v[48:51], v[72:75], v[208:211]
    v_mfma_f32_16x16x32_bf16 v[216:219], v[48:51], v[76:79], v[216:219]
    v_mfma_f32_16x16x32_bf16 v[196:199], v[52:55], v[64:67], v[196:199]
    buffer_load_dword v28, v29, s[24:27], s50 offen
    s_add_u32 s50, s50, 4096
    v_mfma_f32_16x16x32_bf16 v[204:207], v[52:55], v[68:71], v[204:207]
    v_mfma_f32_16x16x32_bf16 v[212:215], v[52:55], v[72:75], v[212:215]
    v_mfma_f32_16x16x32_bf16 v[220:223], v[52:55], v[76:79], v[220:223]
    v_mfma_f32_16x16x32_bf16 v[224:227], v[56:59], v[64:67], v[224:227]
    v_mfma_f32_16x16x32_bf16 v[232:235], v[56:59], v[68:71], v[232:235]
    v_mfma_f32_16x16x32_bf16 v[240:243], v[56:59], v[72:75], v[240:243]
    v_mfma_f32_16x16x32_bf16 v[248:251], v[56:59], v[76:79], v[248:251]
    v_mfma_f32_16x16x32_bf16 v[228:231], v[60:63], v[64:67], v[228:231]
    v_mfma_f32_16x16x32_bf16 v[236:239], v[60:63], v[68:71], v[236:239]
    v_add_u32 v18, 65536, v13
    v_add_u32 v19, 147456, v14
    v_mfma_f32_16x16x32_bf16 v[244:247], v[60:63], v[72:75], v[244:247]
    v_add_u32 v20, 147456, v15
    v_add_u32 v21, 147456, v16
    v_mfma_f32_16x16x32_bf16 v[252:255], v[60:63], v[76:79], v[252:255]
    v_add_u32 v22, 147456, v17
    s_waitcnt lgkmcnt(0)
    s_barrier
    v_mfma_f32_16x16x32_bf16 v[128:131], v[80:83], v[112:115], v[128:131]
    ds_read_b64_tr_b16 v[64:65], v19 offset:0
    v_mfma_f32_16x16x32_bf16 v[136:139], v[80:83], v[116:119], v[136:139]
    ds_read_b64_tr_b16 v[66:67], v19 offset:1024
    v_mfma_f32_16x16x32_bf16 v[144:147], v[80:83], v[120:123], v[144:147]
    ds_read_b128 v[32:35], v18 offset:0
    v_mfma_f32_16x16x32_bf16 v[152:155], v[80:83], v[124:127], v[152:155]
    ds_read_b128 v[36:39], v18 offset:2048
    v_mfma_f32_16x16x32_bf16 v[132:135], v[84:87], v[112:115], v[132:135]
    ds_read_b64_tr_b16 v[68:69], v20 offset:0
    v_mfma_f32_16x16x32_bf16 v[140:143], v[84:87], v[116:119], v[140:143]
    ds_read_b64_tr_b16 v[70:71], v20 offset:1024
    v_mfma_f32_16x16x32_bf16 v[148:151], v[84:87], v[120:123], v[148:151]
    ds_read_b128 v[40:43], v18 offset:4096
    v_mfma_f32_16x16x32_bf16 v[156:159], v[84:87], v[124:127], v[156:159]
    ds_read_b128 v[44:47], v18 offset:6144
    v_mfma_f32_16x16x32_bf16 v[160:163], v[88:91], v[112:115], v[160:163]
    ds_read_b64_tr_b16 v[72:73], v21 offset:0
    v_mfma_f32_16x16x32_bf16 v[168:171], v[88:91], v[116:119], v[168:171]
    ds_read_b64_tr_b16 v[74:75], v21 offset:1024
    v_mfma_f32_16x16x32_bf16 v[176:179], v[88:91], v[120:123], v[176:179]
    ds_read_b128 v[48:51], v18 offset:8192
    v_mfma_f32_16x16x32_bf16 v[184:187], v[88:91], v[124:127], v[184:187]
    ds_read_b128 v[52:55], v18 offset:10240
    v_mfma_f32_16x16x32_bf16 v[164:167], v[92:95], v[112:115], v[164:167]
    ds_read_b64_tr_b16 v[76:77], v22 offset:0
    s_mov_b32 s8, s76
    s_and_b32 s9, s77, 0xffff
    s_mov_b32 s10, 2359296
    s_mov_b32 s11, 0x20000
    v_mfma_f32_16x16x32_bf16 v[172:175], v[92:95], v[116:119], v[172:175]
    ds_read_b64_tr_b16 v[78:79], v22 offset:1024
    v_mfma_f32_16x16x32_bf16 v[180:183], v[92:95], v[120:123], v[180:183]
    ds_read_b128 v[56:59], v18 offset:12288
    v_mfma_f32_16x16x32_bf16 v[188:191], v[92:95], v[124:127], v[188:191]
    ds_read_b128 v[60:63], v18 offset:14336
    v_mfma_f32_16x16x32_bf16 v[192:195], v[96:99], v[112:115], v[192:195]
    v_mfma_f32_16x16x32_bf16 v[200:203], v[96:99], v[116:119], v[200:203]
    v_mfma_f32_16x16x32_bf16 v[208:211], v[96:99], v[120:123], v[208:211]
    v_mfma_f32_16x16x32_bf16 v[216:219], v[96:99], v[124:127], v[216:219]
    v_mfma_f32_16x16x32_bf16 v[196:199], v[100:103], v[112:115], v[196:199]
    s_and_b32 s32, s7, 3
    s_lshl_b32 s32, s32, 2
    s_add_u32 s32, s32, s40
    s_mul_i32 s32, s32, 6144
    s_mul_i32 s33, s6, 147456
    s_add_u32 s32, s32, s33
    s_add_u32 s32, s32, 69255168
    v_min_u32 v5, 47, v1
    v_lshlrev_b32 v5, 7, v5
    buffer_load_dword v28, v5, s[20:23], s32 offen sc1
    v_mfma_f32_16x16x32_bf16 v[204:207], v[100:103], v[116:119], v[204:207]
    v_mfma_f32_16x16x32_bf16 v[212:215], v[100:103], v[120:123], v[212:215]
    v_mfma_f32_16x16x32_bf16 v[220:223], v[100:103], v[124:127], v[220:223]
    v_mfma_f32_16x16x32_bf16 v[224:227], v[104:107], v[112:115], v[224:227]
    v_mfma_f32_16x16x32_bf16 v[232:235], v[104:107], v[116:119], v[232:235]
    v_mfma_f32_16x16x32_bf16 v[240:243], v[104:107], v[120:123], v[240:243]
    v_mfma_f32_16x16x32_bf16 v[248:251], v[104:107], v[124:127], v[248:251]
    v_mfma_f32_16x16x32_bf16 v[228:231], v[108:111], v[112:115], v[228:231]
    v_mfma_f32_16x16x32_bf16 v[236:239], v[108:111], v[116:119], v[236:239]
    v_add_u32 v18, 65536, v30
    v_add_u32 v19, 98304, v14
    v_mfma_f32_16x16x32_bf16 v[244:247], v[108:111], v[120:123], v[244:247]
    v_add_u32 v20, 98304, v15
    v_add_u32 v21, 98304, v16
    v_mfma_f32_16x16x32_bf16 v[252:255], v[108:111], v[124:127], v[252:255]
    v_add_u32 v22, 98304, v17
    s_waitcnt lgkmcnt(0)
    s_barrier
    v_mfma_f32_16x16x32_bf16 v[128:131], v[32:35], v[64:67], v[128:131]
    ds_read_b64_tr_b16 v[112:113], v19 offset:0
    v_mfma_f32_16x16x32_bf16 v[136:139], v[32:35], v[68:71], v[136:139]
    ds_read_b64_tr_b16 v[114:115], v19 offset:1024
    v_mfma_f32_16x16x32_bf16 v[144:147], v[32:35], v[72:75], v[144:147]
    ds_read_b128 v[80:83], v18 offset:0
    v_mfma_f32_16x16x32_bf16 v[152:155], v[32:35], v[76:79], v[152:155]
    ds_read_b128 v[84:87], v18 offset:2048
    v_mfma_f32_16x16x32_bf16 v[132:135], v[36:39], v[64:67], v[132:135]
    ds_read_b64_tr_b16 v[116:117], v20 offset:0
    v_mfma_f32_16x16x32_bf16 v[140:143], v[36:39], v[68:71], v[140:143]
    ds_read_b64_tr_b16 v[118:119], v20 offset:1024
    v_mfma_f32_16x16x32_bf16 v[148:151], v[36:39], v[72:75], v[148:151]
    ds_read_b128 v[88:91], v18 offset:4096
    v_mfma_f32_16x16x32_bf16 v[156:159], v[36:39], v[76:79], v[156:159]
    ds_read_b128 v[92:95], v18 offset:6144
    v_mfma_f32_16x16x32_bf16 v[160:163], v[40:43], v[64:67], v[160:163]
    ds_read_b64_tr_b16 v[120:121], v21 offset:0
    v_mfma_f32_16x16x32_bf16 v[168:171], v[40:43], v[68:71], v[168:171]
    ds_read_b64_tr_b16 v[122:123], v21 offset:1024
    v_mfma_f32_16x16x32_bf16 v[176:179], v[40:43], v[72:75], v[176:179]
    ds_read_b128 v[96:99], v18 offset:8192
    v_mfma_f32_16x16x32_bf16 v[184:187], v[40:43], v[76:79], v[184:187]
    ds_read_b128 v[100:103], v18 offset:10240
    v_mfma_f32_16x16x32_bf16 v[164:167], v[44:47], v[64:67], v[164:167]
    ds_read_b64_tr_b16 v[124:125], v22 offset:0
    v_min_u32 v29, 15, v1
    v_lshlrev_b32 v29, 7, v29
    buffer_load_dword v28, v29, s[24:27], s50 offen
    s_add_u32 s50, s50, 4096
    v_mfma_f32_16x16x32_bf16 v[172:175], v[44:47], v[68:71], v[172:175]
    ds_read_b64_tr_b16 v[126:127], v22 offset:1024
    v_mfma_f32_16x16x32_bf16 v[180:183], v[44:47], v[72:75], v[180:183]
    ds_read_b128 v[104:107], v18 offset:12288
    v_mfma_f32_16x16x32_bf16 v[188:191], v[44:47], v[76:79], v[188:191]
    ds_read_b128 v[108:111], v18 offset:14336
    v_mfma_f32_16x16x32_bf16 v[192:195], v[48:51], v[64:67], v[192:195]
    v_mfma_f32_16x16x32_bf16 v[200:203], v[48:51], v[68:71], v[200:203]
    v_mfma_f32_16x16x32_bf16 v[208:211], v[48:51], v[72:75], v[208:211]
    v_mfma_f32_16x16x32_bf16 v[216:219], v[48:51], v[76:79], v[216:219]
    v_mfma_f32_16x16x32_bf16 v[196:199], v[52:55], v[64:67], v[196:199]
    v_mfma_f32_16x16x32_bf16 v[204:207], v[52:55], v[68:71], v[204:207]
    v_mfma_f32_16x16x32_bf16 v[212:215], v[52:55], v[72:75], v[212:215]
    v_mfma_f32_16x16x32_bf16 v[220:223], v[52:55], v[76:79], v[220:223]
    v_mfma_f32_16x16x32_bf16 v[224:227], v[56:59], v[64:67], v[224:227]
    v_mfma_f32_16x16x32_bf16 v[232:235], v[56:59], v[68:71], v[232:235]
    v_mfma_f32_16x16x32_bf16 v[240:243], v[56:59], v[72:75], v[240:243]
    v_mfma_f32_16x16x32_bf16 v[248:251], v[56:59], v[76:79], v[248:251]
    v_mfma_f32_16x16x32_bf16 v[228:231], v[60:63], v[64:67], v[228:231]
    v_mfma_f32_16x16x32_bf16 v[236:239], v[60:63], v[68:71], v[236:239]
    v_add_u32 v18, 0, v13
    v_add_u32 v19, 114688, v14
    v_mfma_f32_16x16x32_bf16 v[244:247], v[60:63], v[72:75], v[244:247]
    v_add_u32 v20, 114688, v15
    v_add_u32 v21, 114688, v16
    v_mfma_f32_16x16x32_bf16 v[252:255], v[60:63], v[76:79], v[252:255]
    v_add_u32 v22, 114688, v17
    s_waitcnt lgkmcnt(0)
    s_barrier
    v_mfma_f32_16x16x32_bf16 v[128:131], v[80:83], v[112:115], v[128:131]
    ds_read_b64_tr_b16 v[64:65], v19 offset:0
    v_mfma_f32_16x16x32_bf16 v[136:139], v[80:83], v[116:119], v[136:139]
    ds_read_b64_tr_b16 v[66:67], v19 offset:1024
    v_mfma_f32_16x16x32_bf16 v[144:147], v[80:83], v[120:123], v[144:147]
    ds_read_b128 v[32:35], v18 offset:0
    v_mfma_f32_16x16x32_bf16 v[152:155], v[80:83], v[124:127], v[152:155]
    ds_read_b128 v[36:39], v18 offset:2048
    v_mfma_f32_16x16x32_bf16 v[132:135], v[84:87], v[112:115], v[132:135]
    ds_read_b64_tr_b16 v[68:69], v20 offset:0
    v_mfma_f32_16x16x32_bf16 v[140:143], v[84:87], v[116:119], v[140:143]
    ds_read_b64_tr_b16 v[70:71], v20 offset:1024
    v_mfma_f32_16x16x32_bf16 v[148:151], v[84:87], v[120:123], v[148:151]
    ds_read_b128 v[40:43], v18 offset:4096
    v_mfma_f32_16x16x32_bf16 v[156:159], v[84:87], v[124:127], v[156:159]
    ds_read_b128 v[44:47], v18 offset:6144
    v_mfma_f32_16x16x32_bf16 v[160:163], v[88:91], v[112:115], v[160:163]
    ds_read_b64_tr_b16 v[72:73], v21 offset:0
    v_mfma_f32_16x16x32_bf16 v[168:171], v[88:91], v[116:119], v[168:171]
    ds_read_b64_tr_b16 v[74:75], v21 offset:1024
    v_mfma_f32_16x16x32_bf16 v[176:179], v[88:91], v[120:123], v[176:179]
    ds_read_b128 v[48:51], v18 offset:8192
    v_mfma_f32_16x16x32_bf16 v[184:187], v[88:91], v[124:127], v[184:187]
    ds_read_b128 v[52:55], v18 offset:10240
    v_mfma_f32_16x16x32_bf16 v[164:167], v[92:95], v[112:115], v[164:167]
    ds_read_b64_tr_b16 v[76:77], v22 offset:0
    v_mfma_f32_16x16x32_bf16 v[172:175], v[92:95], v[116:119], v[172:175]
    ds_read_b64_tr_b16 v[78:79], v22 offset:1024
    v_mfma_f32_16x16x32_bf16 v[180:183], v[92:95], v[120:123], v[180:183]
    ds_read_b128 v[56:59], v18 offset:12288
    v_mfma_f32_16x16x32_bf16 v[188:191], v[92:95], v[124:127], v[188:191]
    ds_read_b128 v[60:63], v18 offset:14336
    v_mfma_f32_16x16x32_bf16 v[192:195], v[96:99], v[112:115], v[192:195]
    v_mfma_f32_16x16x32_bf16 v[200:203], v[96:99], v[116:119], v[200:203]
    v_mfma_f32_16x16x32_bf16 v[208:211], v[96:99], v[120:123], v[208:211]
    v_mfma_f32_16x16x32_bf16 v[216:219], v[96:99], v[124:127], v[216:219]
    v_mfma_f32_16x16x32_bf16 v[196:199], v[100:103], v[112:115], v[196:199]
    v_mfma_f32_16x16x32_bf16 v[204:207], v[100:103], v[116:119], v[204:207]
    v_mfma_f32_16x16x32_bf16 v[212:215], v[100:103], v[120:123], v[212:215]
    v_mfma_f32_16x16x32_bf16 v[220:223], v[100:103], v[124:127], v[220:223]
    v_mfma_f32_16x16x32_bf16 v[224:227], v[104:107], v[112:115], v[224:227]
    v_mfma_f32_16x16x32_bf16 v[232:235], v[104:107], v[116:119], v[232:235]
    v_mfma_f32_16x16x32_bf16 v[240:243], v[104:107], v[120:123], v[240:243]
    v_mfma_f32_16x16x32_bf16 v[248:251], v[104:107], v[124:127], v[248:251]
    v_mfma_f32_16x16x32_bf16 v[228:231], v[108:111], v[112:115], v[228:231]
    v_mfma_f32_16x16x32_bf16 v[236:239], v[108:111], v[116:119], v[236:239]
    v_add_u32 v18, 0, v30
    v_add_u32 v19, 131072, v14
    v_mfma_f32_16x16x32_bf16 v[244:247], v[108:111], v[120:123], v[244:247]
    v_add_u32 v20, 131072, v15
    v_add_u32 v21, 131072, v16
    v_mfma_f32_16x16x32_bf16 v[252:255], v[108:111], v[124:127], v[252:255]
    v_add_u32 v22, 131072, v17
    s_waitcnt lgkmcnt(0)
    s_barrier
    v_mfma_f32_16x16x32_bf16 v[128:131], v[32:35], v[64:67], v[128:131]
    ds_read_b64_tr_b16 v[112:113], v19 offset:0
    v_mfma_f32_16x16x32_bf16 v[136:139], v[32:35], v[68:71], v[136:139]
    ds_read_b64_tr_b16 v[114:115], v19 offset:1024
    v_mfma_f32_16x16x32_bf16 v[144:147], v[32:35], v[72:75], v[144:147]
    ds_read_b128 v[80:83], v18 offset:0
    v_mfma_f32_16x16x32_bf16 v[152:155], v[32:35], v[76:79], v[152:155]
    ds_read_b128 v[84:87], v18 offset:2048
    v_mfma_f32_16x16x32_bf16 v[132:135], v[36:39], v[64:67], v[132:135]
    ds_read_b64_tr_b16 v[116:117], v20 offset:0
    v_mfma_f32_16x16x32_bf16 v[140:143], v[36:39], v[68:71], v[140:143]
    ds_read_b64_tr_b16 v[118:119], v20 offset:1024
    v_mfma_f32_16x16x32_bf16 v[148:151], v[36:39], v[72:75], v[148:151]
    ds_read_b128 v[88:91], v18 offset:4096
    v_mfma_f32_16x16x32_bf16 v[156:159], v[36:39], v[76:79], v[156:159]
    ds_read_b128 v[92:95], v18 offset:6144
    v_mfma_f32_16x16x32_bf16 v[160:163], v[40:43], v[64:67], v[160:163]
    ds_read_b64_tr_b16 v[120:121], v21 offset:0
    v_mfma_f32_16x16x32_bf16 v[168:171], v[40:43], v[68:71], v[168:171]
    ds_read_b64_tr_b16 v[122:123], v21 offset:1024
    v_mfma_f32_16x16x32_bf16 v[176:179], v[40:43], v[72:75], v[176:179]
    ds_read_b128 v[96:99], v18 offset:8192
    v_mfma_f32_16x16x32_bf16 v[184:187], v[40:43], v[76:79], v[184:187]
    ds_read_b128 v[100:103], v18 offset:10240
    v_mfma_f32_16x16x32_bf16 v[164:167], v[44:47], v[64:67], v[164:167]
    ds_read_b64_tr_b16 v[124:125], v22 offset:0
    v_mfma_f32_16x16x32_bf16 v[172:175], v[44:47], v[68:71], v[172:175]
    ds_read_b64_tr_b16 v[126:127], v22 offset:1024
    v_mfma_f32_16x16x32_bf16 v[180:183], v[44:47], v[72:75], v[180:183]
    ds_read_b128 v[104:107], v18 offset:12288
    v_mfma_f32_16x16x32_bf16 v[188:191], v[44:47], v[76:79], v[188:191]
    ds_read_b128 v[108:111], v18 offset:14336
    v_mfma_f32_16x16x32_bf16 v[192:195], v[48:51], v[64:67], v[192:195]
    v_mfma_f32_16x16x32_bf16 v[200:203], v[48:51], v[68:71], v[200:203]
    v_mfma_f32_16x16x32_bf16 v[208:211], v[48:51], v[72:75], v[208:211]
    v_mfma_f32_16x16x32_bf16 v[216:219], v[48:51], v[76:79], v[216:219]
    v_mfma_f32_16x16x32_bf16 v[196:199], v[52:55], v[64:67], v[196:199]
    v_mfma_f32_16x16x32_bf16 v[204:207], v[52:55], v[68:71], v[204:207]
    v_mfma_f32_16x16x32_bf16 v[212:215], v[52:55], v[72:75], v[212:215]
    v_mfma_f32_16x16x32_bf16 v[220:223], v[52:55], v[76:79], v[220:223]
    v_mfma_f32_16x16x32_bf16 v[224:227], v[56:59], v[64:67], v[224:227]
    v_mfma_f32_16x16x32_bf16 v[232:235], v[56:59], v[68:71], v[232:235]
    v_mfma_f32_16x16x32_bf16 v[240:243], v[56:59], v[72:75], v[240:243]
    v_mfma_f32_16x16x32_bf16 v[248:251], v[56:59], v[76:79], v[248:251]
    v_mfma_f32_16x16x32_bf16 v[228:231], v[60:63], v[64:67], v[228:231]
    v_mfma_f32_16x16x32_bf16 v[236:239], v[60:63], v[68:71], v[236:239]
    v_mfma_f32_16x16x32_bf16 v[244:247], v[60:63], v[72:75], v[244:247]
    v_mfma_f32_16x16x32_bf16 v[252:255], v[60:63], v[76:79], v[252:255]
    s_waitcnt lgkmcnt(0)
    v_mfma_f32_16x16x32_bf16 v[128:131], v[80:83], v[112:115], v[128:131]
    v_mfma_f32_16x16x32_bf16 v[136:139], v[80:83], v[116:119], v[136:139]
    v_mfma_f32_16x16x32_bf16 v[144:147], v[80:83], v[120:123], v[144:147]
    v_mfma_f32_16x16x32_bf16 v[152:155], v[80:83], v[124:127], v[152:155]
    v_mfma_f32_16x16x32_bf16 v[132:135], v[84:87], v[112:115], v[132:135]
    v_mfma_f32_16x16x32_bf16 v[140:143], v[84:87], v[116:119], v[140:143]
    v_mfma_f32_16x16x32_bf16 v[148:151], v[84:87], v[120:123], v[148:151]
    v_mfma_f32_16x16x32_bf16 v[156:159], v[84:87], v[124:127], v[156:159]
    v_mfma_f32_16x16x32_bf16 v[160:163], v[88:91], v[112:115], v[160:163]
    v_mfma_f32_16x16x32_bf16 v[168:171], v[88:91], v[116:119], v[168:171]
    v_mfma_f32_16x16x32_bf16 v[176:179], v[88:91], v[120:123], v[176:179]
    v_mfma_f32_16x16x32_bf16 v[184:187], v[88:91], v[124:127], v[184:187]
    v_mfma_f32_16x16x32_bf16 v[164:167], v[92:95], v[112:115], v[164:167]
    v_mfma_f32_16x16x32_bf16 v[172:175], v[92:95], v[116:119], v[172:175]
    v_mfma_f32_16x16x32_bf16 v[180:183], v[92:95], v[120:123], v[180:183]
    v_mfma_f32_16x16x32_bf16 v[188:191], v[92:95], v[124:127], v[188:191]
    v_mfma_f32_16x16x32_bf16 v[192:195], v[96:99], v[112:115], v[192:195]
    v_mfma_f32_16x16x32_bf16 v[200:203], v[96:99], v[116:119], v[200:203]
    v_mfma_f32_16x16x32_bf16 v[208:211], v[96:99], v[120:123], v[208:211]
    v_mfma_f32_16x16x32_bf16 v[216:219], v[96:99], v[124:127], v[216:219]
    v_mfma_f32_16x16x32_bf16 v[196:199], v[100:103], v[112:115], v[196:199]
    v_mfma_f32_16x16x32_bf16 v[204:207], v[100:103], v[116:119], v[204:207]
    v_mfma_f32_16x16x32_bf16 v[212:215], v[100:103], v[120:123], v[212:215]
    v_mfma_f32_16x16x32_bf16 v[220:223], v[100:103], v[124:127], v[220:223]
    v_mfma_f32_16x16x32_bf16 v[224:227], v[104:107], v[112:115], v[224:227]
    v_mfma_f32_16x16x32_bf16 v[232:235], v[104:107], v[116:119], v[232:235]
    v_mfma_f32_16x16x32_bf16 v[240:243], v[104:107], v[120:123], v[240:243]
    v_mfma_f32_16x16x32_bf16 v[248:251], v[104:107], v[124:127], v[248:251]
    v_mfma_f32_16x16x32_bf16 v[228:231], v[108:111], v[112:115], v[228:231]
    v_mfma_f32_16x16x32_bf16 v[236:239], v[108:111], v[116:119], v[236:239]
    v_mfma_f32_16x16x32_bf16 v[244:247], v[108:111], v[120:123], v[244:247]
    v_mfma_f32_16x16x32_bf16 v[252:255], v[108:111], v[124:127], v[252:255]
kf_kvdone:
    s_lshl_b32 s32, s46, 6
    v_add_u32 v5, s32, v2
    v_lshlrev_b32 v5, 7, v5
    v_lshrrev_b32 v6, 1, v2
    v_or_b32 v7, 0, v3
    v_xor_b32 v6, v6, v7
    v_lshl_add_u32 v14, v6, 4, v5
    s_lshl_b32 s32, s46, 6
    v_add_u32 v5, s32, v2
    v_lshlrev_b32 v5, 7, v5
    v_lshrrev_b32 v6, 1, v2
    v_or_b32 v7, 4, v3
    v_xor_b32 v6, v6, v7
    v_lshl_add_u32 v15, v6, 4, v5
    v_lshrrev_b32 v5, 2, v2
    v_lshl_add_u32 v8, v3, 3, v5
    v_lshlrev_b32 v8, 8, v8
    v_and_b32 v7, 1, v3
    v_lshl_or_b32 v7, v7, 2, v5
    v_and_b32 v5, 3, v2
    v_lshl_add_u32 v8, v5, 3, v8
    s_and_b32 s32, s3, 6
    s_add_u32 s32, s32, 0
    v_xor_b32 v5, s32, v7
    v_lshl_add_u32 v16, v5, 5, v8
    s_and_b32 s32, s3, 6
    s_add_u32 s32, s32, 1
    v_xor_b32 v5, s32, v7
    v_lshl_add_u32 v17, v5, 5, v8
    s_lshl_b32 s32, s4, 6
    s_lshl_b32 s33, s5, 3
    s_add_u32 s32, s32, s33
    s_lshl_b32 s33, s46, 2
    s_add_u32 s32, s32, s33
    s_lshl_b32 s32, s32, 13
    s_lshl_b32 s33, s47, 11
    s_lshl_b32 s33, s33, s45
    s_add_u32 s32, s32, s33
    s_lshl_b32 s33, s45, 24
    s_add_u32 s55, s32, s33
    s_lshr_b32 s33, 4096, s45
    s_add_u32 s56, s55, s33
    s_mov_b32 s48, 0x3e0293ee
    s_mov_b32 s49, 0x16801680
    s_mov_b32 s24, s80
    s_and_b32 s25, s81, 0xffff
    s_mov_b32 s26, 20736
    s_mov_b32 s27, 0x20000
    v_and_b32 v80, 31, v1
    v_lshrrev_b32 v81, 5, v1
    s_cmp_ge_u32 s3, 3
    s_cselect_b32 s32, 1, 0
    s_mul_i32 s33, s32, 3
    s_sub_u32 s33, s3, s33
    v_bfe_u32 v5, v80, 2, 1
    v_lshrrev_b32 v6, 3, v80
    v_and_b32 v7, 3, v80
    v_lshl_add_u32 v6, v6, 2, v7
    s_lshl_b32 s32, s32, 4
    v_add_u32 v6, s32, v6
    s_lshl_b32 s33, s33, 4
    s_lshr_b32 s34, s44, 1
    s_sub_u32 s33, s33, s34
    v_lshlrev_b32 v7, 3, v81
    v_add_u32 v7, s33, v7
    v_mul_u32_u24 v8, 18, v5
    v_sub_u32 v7, v7, v8
    v_cmp_gt_u32 vcc, 18, v6
    v_mov_b32 v8, 1000
    s_nop 0
    v_cndmask_b32 v7, v8, v7, vcc
    s_lshl_b32 s32, s6, 1
    v_add_u32 v5, s32, v5
    v_mul_u32_u24 v5, 648, v5
    v_lshl_add_u32 v5, v6, 1, v5
    v_mov_b32 v8, 0x7fffff00
    v_add_u32 v6, 0, v7
    v_cmp_gt_u32 vcc, 18, v6
    v_mad_u32_u24 v84, v6, 36, v5
    s_nop 0
    v_cndmask_b32 v84, v8, v84, vcc
    v_add_u32 v6, 1, v7
    v_cmp_gt_u32 vcc, 18, v6
    v_mad_u32_u24 v85, v6, 36, v5
    s_nop 0
    v_cndmask_b32 v85, v8, v85, vcc
    v_add_u32 v6, 2, v7
    v_cmp_gt_u32 vcc, 18, v6
    v_mad_u32_u24 v86, v6, 36, v5
    s_nop 0
    v_cndmask_b32 v86, v8, v86, vcc
    v_add_u32 v6, 3, v7
    v_cmp_gt_u32 vcc, 18, v6
    v_mad_u32_u24 v87, v6, 36, v5
    s_nop 0
    v_cndmask_b32 v87, v8, v87, vcc
    v_add_u32 v6, 4, v7
    v_cmp_gt_u32 vcc, 18, v6
    v_mad_u32_u24 v88, v6, 36, v5
    s_nop 0
    v_cndmask_b32 v88, v8, v88, vcc
    v_add_u32 v6, 5, v7
    v_cmp_gt_u32 vcc, 18, v6
    v_mad_u32_u24 v89, v6, 36, v5
    s_nop 0
    v_cndmask_b32 v89, v8, v89, vcc
    v_add_u32 v6, 6, v7
    v_cmp_gt_u32 vcc, 18, v6
    v_mad_u32_u24 v90, v6, 36, v5
    s_nop 0
    v_cndmask_b32 v90, v8, v90, vcc
    v_add_u32 v6, 7, v7
    v_cmp_gt_u32 vcc, 18, v6
    v_mad_u32_u24 v91, v6, 36, v5
    s_nop 0
    v_cndmask_b32 v91, v8, v91, vcc
    buffer_load_ushort v84, v84, s[24:27], 0 offen
    buffer_load_ushort v85, v85, s[24:27], 0 offen
    buffer_load_ushort v86, v86, s[24:27], 0 offen
    buffer_load_ushort v87, v87, s[24:27], 0 offen
    buffer_load_ushort v88, v88, s[24:27], 0 offen
    buffer_load_ushort v89, v89, s[24:27], 0 offen
    buffer_load_ushort v90, v90, s[24:27], 0 offen
    buffer_load_ushort v91, v91, s[24:27], 0 offen
    v_mov_b64 v[96:97], 0
    v_mov_b64 v[98:99], 0
    v_mov_b64 v[100:101], 0
    v_mov_b64 v[102:103], 0
    v_mov_b64 v[104:105], 0
    v_mov_b64 v[106:107], 0
    v_mov_b64 v[108:109], 0
    v_mov_b64 v[110:111], 0
    v_mov_b64 v[112:113], 0
    v_mov_b64 v[114:115], 0
    v_mov_b64 v[116:117], 0
    v_mov_b64 v[118:119], 0
    v_mov_b64 v[120:121], 0
    v_mov_b64 v[122:123], 0
    v_mov_b64 v[124:125], 0
    v_mov_b64 v[126:127], 0
    v_add_u32 v19, 32768, v14
    v_add_u32 v20, 32768, v15
    v_add_u32 v21, 147456, v16
    v_add_u32 v22, 147456, v17
    s_cmp_eq_u32 s45, 1
    s_cbranch_scc1 kf_b1
kf_b0:
    s_waitcnt vmcnt(28) lgkmcnt(0)
    s_barrier
    ds_read_b64_tr_b16 v[48:49], v21 offset:0
    ds_read_b64_tr_b16 v[50:51], v21 offset:1024
    v_mul_f32 v248, s48, v248
    v_mul_f32 v249, s48, v249
    v_mul_f32 v250, s48, v250
    ds_read_b128 v[32:35], v19 offset:0
    ds_read_b128 v[36:39], v19 offset:2048
    v_mul_f32 v251, s48, v251
    v_mul_f32 v252, s48, v252
    v_mul_f32 v253, s48, v253
    ds_read_b64_tr_b16 v[52:53], v22 offset:0
    ds_read_b64_tr_b16 v[54:55], v22 offset:1024
    v_mul_f32 v254, s48, v254
    v_mul_f32 v255, s48, v255
    v_cvt_pk_bf16_f32 v255, v254, v255
    ds_read_b128 v[40:43], v19 offset:4096
    ds_read_b128 v[44:47], v19 offset:6144
    v_cvt_pk_bf16_f32 v254, v252, v253
    v_cvt_pk_bf16_f32 v253, v250, v251
    v_cvt_pk_bf16_f32 v252, v248, v249
    v_mul_f32 v240, s48, v240
    v_mul_f32 v241, s48, v241
    v_mul_f32 v242, s48, v242
    v_mul_f32 v243, s48, v243
    v_mul_f32 v244, s48, v244
    v_mul_f32 v245, s48, v245
    v_mul_f32 v246, s48, v246
    v_mul_f32 v247, s48, v247
    v_cvt_pk_bf16_f32 v251, v246, v247
    v_cvt_pk_bf16_f32 v250, v244, v245
    v_cvt_pk_bf16_f32 v249, v242, v243
    v_cvt_pk_bf16_f32 v248, v240, v241
    s_waitcnt lgkmcnt(0)
    v_mfma_f32_16x16x32_bf16 v[96:99], v[48:51], v[32:35], v[96:99]
    ds_read_b64_tr_b16 v[72:73], v21 offset:8192
    ds_read_b64_tr_b16 v[74:75], v21 offset:9216
    v_mul_f32 v232, s48, v232
    v_mul_f32 v233, s48, v233
    v_mul_f32 v234, s48, v234
    v_mfma_f32_16x16x32_bf16 v[100:103], v[52:55], v[32:35], v[100:103]
    ds_read_b128 v[56:59], v20 offset:0
    ds_read_b128 v[60:63], v20 offset:2048
    v_mul_f32 v235, s48, v235
    v_mul_f32 v236, s48, v236
    v_mul_f32 v237, s48, v237
    v_mfma_f32_16x16x32_bf16 v[104:107], v[48:51], v[36:39], v[104:107]
    ds_read_b64_tr_b16 v[76:77], v22 offset:8192
    ds_read_b64_tr_b16 v[78:79], v22 offset:9216
    v_mul_f32 v238, s48, v238
    v_mul_f32 v239, s48, v239
    v_cvt_pk_bf16_f32 v247, v238, v239
    v_mfma_f32_16x16x32_bf16 v[108:111], v[52:55], v[36:39], v[108:111]
    ds_read_b128 v[64:67], v20 offset:4096
    ds_read_b128 v[68:71], v20 offset:6144
    v_cvt_pk_bf16_f32 v246, v236, v237
    v_cvt_pk_bf16_f32 v245, v234, v235
    v_cvt_pk_bf16_f32 v244, v232, v233
    v_mfma_f32_16x16x32_bf16 v[112:115], v[48:51], v[40:43], v[112:115]
    v_mul_f32 v224, s48, v224
    v_mul_f32 v225, s48, v225
    v_mul_f32 v226, s48, v226
    v_mfma_f32_16x16x32_bf16 v[116:119], v[52:55], v[40:43], v[116:119]
    v_mul_f32 v227, s48, v227
    v_mul_f32 v228, s48, v228
    v_mul_f32 v229, s48, v229
    v_mfma_f32_16x16x32_bf16 v[120:123], v[48:51], v[44:47], v[120:123]
    v_mul_f32 v230, s48, v230
    v_mul_f32 v231, s48, v231
    v_cvt_pk_bf16_f32 v243, v230, v231
    v_mfma_f32_16x16x32_bf16 v[124:127], v[52:55], v[44:47], v[124:127]
    v_cvt_pk_bf16_f32 v242, v228, v229
    v_cvt_pk_bf16_f32 v241, v226, v227
    v_cvt_pk_bf16_f32 v240, v224, v225
    v_add_u32 v19, 49152, v14
    v_add_u32 v20, 49152, v15
    v_add_u32 v21, 98304, v16
    v_add_u32 v22, 98304, v17
    s_waitcnt vmcnt(20) lgkmcnt(0)
    s_barrier
    v_mfma_f32_16x16x32_bf16 v[96:99], v[72:75], v[56:59], v[96:99]
    ds_read_b64_tr_b16 v[48:49], v21 offset:0
    ds_read_b64_tr_b16 v[50:51], v21 offset:1024
    v_mul_f32 v216, s48, v216
    v_mul_f32 v217, s48, v217
    v_mul_f32 v218, s48, v218
    v_mfma_f32_16x16x32_bf16 v[100:103], v[76:79], v[56:59], v[100:103]
    ds_read_b128 v[32:35], v19 offset:0
    ds_read_b128 v[36:39], v19 offset:2048
    v_mul_f32 v219, s48, v219
    v_mul_f32 v220, s48, v220
    v_mul_f32 v221, s48, v221
    v_mfma_f32_16x16x32_bf16 v[104:107], v[72:75], v[60:63], v[104:107]
    ds_read_b64_tr_b16 v[52:53], v22 offset:0
    ds_read_b64_tr_b16 v[54:55], v22 offset:1024
    v_mul_f32 v222, s48, v222
    v_mul_f32 v223, s48, v223
    v_cvt_pk_bf16_f32 v239, v222, v223
    s_add_u32 s50, s56, 24576
    buffer_store_dwordx4 v[252:255], v4, s[20:23], s50 offen offset:1024 sc1
    v_mfma_f32_16x16x32_bf16 v[108:111], v[76:79], v[60:63], v[108:111]
    ds_read_b128 v[40:43], v19 offset:4096
    ds_read_b128 v[44:47], v19 offset:6144
    v_cvt_pk_bf16_f32 v238, v220, v221
    v_cvt_pk_bf16_f32 v237, v218, v219
    v_cvt_pk_bf16_f32 v236, v216, v217
    v_mfma_f32_16x16x32_bf16 v[112:115], v[72:75], v[64:67], v[112:115]
    v_mul_f32 v208, s48, v208
    v_mul_f32 v209, s48, v209
    v_mul_f32 v210, s48, v210
    v_mfma_f32_16x16x32_bf16 v[116:119], v[76:79], v[64:67], v[116:119]
    v_mul_f32 v211, s48, v211
    v_mul_f32 v212, s48, v212
    v_mul_f32 v213, s48, v213
    v_mfma_f32_16x16x32_bf16 v[120:123], v[72:75], v[68:71], v[120:123]
    v_mul_f32 v214, s48, v214
    v_mul_f32 v215, s48, v215
    v_cvt_pk_bf16_f32 v235, v214, v215
    v_mfma_f32_16x16x32_bf16 v[124:127], v[76:79], v[68:71], v[124:127]
    v_cvt_pk_bf16_f32 v234, v212, v213
    v_cvt_pk_bf16_f32 v233, v210, v211
    v_cvt_pk_bf16_f32 v232, v208, v209
    s_waitcnt lgkmcnt(0)
    v_mfma_f32_16x16x32_bf16 v[96:99], v[48:51], v[32:35], v[96:99]
    ds_read_b64_tr_b16 v[72:73], v21 offset:8192
    ds_read_b64_tr_b16 v[74:75], v21 offset:9216
    v_mul_f32 v200, s48, v200
    v_mul_f32 v201, s48, v201
    v_mul_f32 v202, s48, v202
    v_mfma_f32_16x16x32_bf16 v[100:103], v[52:55], v[32:35], v[100:103]
    ds_read_b128 v[56:59], v20 offset:0
    ds_read_b128 v[60:63], v20 offset:2048
    v_mul_f32 v203, s48, v203
    v_mul_f32 v204, s48, v204
    v_mul_f32 v205, s48, v205
    v_mfma_f32_16x16x32_bf16 v[104:107], v[48:51], v[36:39], v[104:107]
    ds_read_b64_tr_b16 v[76:77], v22 offset:8192
    ds_read_b64_tr_b16 v[78:79], v22 offset:9216
    v_mul_f32 v206, s48, v206
    v_mul_f32 v207, s48, v207
    v_cvt_pk_bf16_f32 v231, v206, v207
    s_add_u32 s50, s56, 24576
    buffer_store_dwordx4 v[248:251], v4, s[20:23], s50 offen offset:0 sc1
    v_mfma_f32_16x16x32_bf16 v[108:111], v[52:55], v[36:39], v[108:111]
    ds_read_b128 v[64:67], v20 offset:4096
    ds_read_b128 v[68:71], v20 offset:6144
    v_cvt_pk_bf16_f32 v230, v204, v205
    v_cvt_pk_bf16_f32 v229, v202, v203
    v_cvt_pk_bf16_f32 v228, v200, v201
    v_mfma_f32_16x16x32_bf16 v[112:115], v[48:51], v[40:43], v[112:115]
    v_mul_f32 v192, s48, v192
    v_mul_f32 v193, s48, v193
    v_mul_f32 v194, s48, v194
    v_mfma_f32_16x16x32_bf16 v[116:119], v[52:55], v[40:43], v[116:119]
    v_mul_f32 v195, s48, v195
    v_mul_f32 v196, s48, v196
    v_mul_f32 v197, s48, v197
    v_mfma_f32_16x16x32_bf16 v[120:123], v[48:51], v[44:47], v[120:123]
    v_mul_f32 v198, s48, v198
    v_mul_f32 v199, s48, v199
    v_cvt_pk_bf16_f32 v227, v198, v199
    v_mfma_f32_16x16x32_bf16 v[124:127], v[52:55], v[44:47], v[124:127]
    v_cvt_pk_bf16_f32 v226, v196, v197
    v_cvt_pk_bf16_f32 v225, v194, v195
    v_cvt_pk_bf16_f32 v224, v192, v193
    v_add_u32 v19, 65536, v14
    v_add_u32 v20, 65536, v15
    v_add_u32 v21, 114688, v16
    v_add_u32 v22, 114688, v17
    s_waitcnt vmcnt(14) lgkmcnt(0)
    s_barrier
    v_mfma_f32_16x16x32_bf16 v[96:99], v[72:75], v[56:59], v[96:99]
    ds_read_b64_tr_b16 v[48:49], v21 offset:0
    ds_read_b64_tr_b16 v[50:51], v21 offset:1024
    v_mul_f32 v184, s48, v184
    v_mul_f32 v185, s48, v185
    v_mul_f32 v186, s48, v186
    v_mfma_f32_16x16x32_bf16 v[100:103], v[76:79], v[56:59], v[100:103]
    ds_read_b128 v[32:35], v19 offset:0
    ds_read_b128 v[36:39], v19 offset:2048
    v_mul_f32 v187, s48, v187
    v_mul_f32 v188, s48, v188
    v_mul_f32 v189, s48, v189
    v_mfma_f32_16x16x32_bf16 v[104:107], v[72:75], v[60:63], v[104:107]
    ds_read_b64_tr_b16 v[52:53], v22 offset:0
    ds_read_b64_tr_b16 v[54:55], v22 offset:1024
    v_mul_f32 v190, s48, v190
    v_mul_f32 v191, s48, v191
    v_cvt_pk_bf16_f32 v223, v190, v191
    s_add_u32 s50, s55, 24576
    buffer_store_dwordx4 v[244:247], v4, s[20:23], s50 offen offset:1024 sc1
    v_mfma_f32_16x16x32_bf16 v[108:111], v[76:79], v[60:63], v[108:111]
    ds_read_b128 v[40:43], v19 offset:4096
    ds_read_b128 v[44:47], v19 offset:6144
    v_cvt_pk_bf16_f32 v222, v188, v189
    v_cvt_pk_bf16_f32 v221, v186, v187
    v_cvt_pk_bf16_f32 v220, v184, v185
    v_mfma_f32_16x16x32_bf16 v[112:115], v[72:75], v[64:67], v[112:115]
    v_mul_f32 v176, s48, v176
    v_mul_f32 v177, s48, v177
    v_mul_f32 v178, s48, v178
    v_mfma_f32_16x16x32_bf16 v[116:119], v[76:79], v[64:67], v[116:119]
    v_mul_f32 v179, s48, v179
    v_mul_f32 v180, s48, v180
    v_mul_f32 v181, s48, v181
    v_mfma_f32_16x16x32_bf16 v[120:123], v[72:75], v[68:71], v[120:123]
    v_mul_f32 v182, s48, v182
    v_mul_f32 v183, s48, v183
    v_cvt_pk_bf16_f32 v219, v182, v183
    v_mfma_f32_16x16x32_bf16 v[124:127], v[76:79], v[68:71], v[124:127]
    v_cvt_pk_bf16_f32 v218, v180, v181
    v_cvt_pk_bf16_f32 v217, v178, v179
    v_cvt_pk_bf16_f32 v216, v176, v177
    s_waitcnt lgkmcnt(0)
    v_mfma_f32_16x16x32_bf16 v[96:99], v[48:51], v[32:35], v[96:99]
    ds_read_b64_tr_b16 v[72:73], v21 offset:8192
    ds_read_b64_tr_b16 v[74:75], v21 offset:9216
    v_mul_f32 v168, s48, v168
    v_mul_f32 v169, s48, v169
    v_mul_f32 v170, s48, v170
    v_mfma_f32_16x16x32_bf16 v[100:103], v[52:55], v[32:35], v[100:103]
    ds_read_b128 v[56:59], v20 offset:0
    ds_read_b128 v[60:63], v20 offset:2048
    v_mul_f32 v171, s48, v171
    v_mul_f32 v172, s48, v172
    v_mul_f32 v173, s48, v173
    v_mfma_f32_16x16x32_bf16 v[104:107], v[48:51], v[36:39], v[104:107]
    ds_read_b64_tr_b16 v[76:77], v22 offset:8192
    ds_read_b64_tr_b16 v[78:79], v22 offset:9216
    v_mul_f32 v174, s48, v174
    v_mul_f32 v175, s48, v175
    v_cvt_pk_bf16_f32 v215, v174, v175
    s_add_u32 s50, s55, 24576
    buffer_store_dwordx4 v[240:243], v4, s[20:23], s50 offen offset:0 sc1
    v_mfma_f32_16x16x32_bf16 v[108:111], v[52:55], v[36:39], v[108:111]
    ds_read_b128 v[64:67], v20 offset:4096
    ds_read_b128 v[68:71], v20 offset:6144
    v_cvt_pk_bf16_f32 v214, v172, v173
    v_cvt_pk_bf16_f32 v213, v170, v171
    v_cvt_pk_bf16_f32 v212, v168, v169
    v_mfma_f32_16x16x32_bf16 v[112:115], v[48:51], v[40:43], v[112:115]
    v_mul_f32 v160, s48, v160
    v_mul_f32 v161, s48, v161
    v_mul_f32 v162, s48, v162
    v_mfma_f32_16x16x32_bf16 v[116:119], v[52:55], v[40:43], v[116:119]
    v_mul_f32 v163, s48, v163
    v_mul_f32 v164, s48, v164
    v_mul_f32 v165, s48, v165
    v_mfma_f32_16x16x32_bf16 v[120:123], v[48:51], v[44:47], v[120:123]
    v_mul_f32 v166, s48, v166
    v_mul_f32 v167, s48, v167
    v_cvt_pk_bf16_f32 v211, v166, v167
    v_mfma_f32_16x16x32_bf16 v[124:127], v[52:55], v[44:47], v[124:127]
    v_cvt_pk_bf16_f32 v210, v164, v165
    v_cvt_pk_bf16_f32 v209, v162, v163
    v_cvt_pk_bf16_f32 v208, v160, v161
    v_add_u32 v19, 81920, v14
    v_add_u32 v20, 81920, v15
    v_add_u32 v21, 131072, v16
    v_add_u32 v22, 131072, v17
    s_waitcnt vmcnt(12) lgkmcnt(0)
    s_barrier
    v_mfma_f32_16x16x32_bf16 v[96:99], v[72:75], v[56:59], v[96:99]
    ds_read_b64_tr_b16 v[48:49], v21 offset:0
    ds_read_b64_tr_b16 v[50:51], v21 offset:1024
    v_mul_f32 v152, s48, v152
    v_mul_f32 v153, s48, v153
    v_mul_f32 v154, s48, v154
    v_mfma_f32_16x16x32_bf16 v[100:103], v[76:79], v[56:59], v[100:103]
    ds_read_b128 v[32:35], v19 offset:0
    ds_read_b128 v[36:39], v19 offset:2048
    v_mul_f32 v155, s48, v155
    v_mul_f32 v156, s48, v156
    v_mul_f32 v157, s48, v157
    v_mfma_f32_16x16x32_bf16 v[104:107], v[72:75], v[60:63], v[104:107]
    ds_read_b64_tr_b16 v[52:53], v22 offset:0
    ds_read_b64_tr_b16 v[54:55], v22 offset:1024
    v_mul_f32 v158, s48, v158
    v_mul_f32 v159, s48, v159
    v_cvt_pk_bf16_f32 v207, v158, v159
    s_add_u32 s50, s56, 16384
    buffer_store_dwordx4 v[236:239], v4, s[20:23], s50 offen offset:1024 sc1
    v_mfma_f32_16x16x32_bf16 v[108:111], v[76:79], v[60:63], v[108:111]
    ds_read_b128 v[40:43], v19 offset:4096
    ds_read_b128 v[44:47], v19 offset:6144
    v_cvt_pk_bf16_f32 v206, v156, v157
    v_cvt_pk_bf16_f32 v205, v154, v155
    v_cvt_pk_bf16_f32 v204, v152, v153
    v_mfma_f32_16x16x32_bf16 v[112:115], v[72:75], v[64:67], v[112:115]
    v_mul_f32 v144, s48, v144
    v_mul_f32 v145, s48, v145
    v_mul_f32 v146, s48, v146
    v_mfma_f32_16x16x32_bf16 v[116:119], v[76:79], v[64:67], v[116:119]
    v_mul_f32 v147, s48, v147
    v_mul_f32 v148, s48, v148
    v_mul_f32 v149, s48, v149
    v_mfma_f32_16x16x32_bf16 v[120:123], v[72:75], v[68:71], v[120:123]
    v_mul_f32 v150, s48, v150
    v_mul_f32 v151, s48, v151
    v_cvt_pk_bf16_f32 v203, v150, v151
    v_mfma_f32_16x16x32_bf16 v[124:127], v[76:79], v[68:71], v[124:127]
    v_cvt_pk_bf16_f32 v202, v148, v149
    v_cvt_pk_bf16_f32 v201, v146, v147
    v_cvt_pk_bf16_f32 v200, v144, v145
    s_waitcnt lgkmcnt(0)
    v_mfma_f32_16x16x32_bf16 v[96:99], v[48:51], v[32:35], v[96:99]
    ds_read_b64_tr_b16 v[72:73], v21 offset:8192
    ds_read_b64_tr_b16 v[74:75], v21 offset:9216
    v_mul_f32 v136, s48, v136
    v_mul_f32 v137, s48, v137
    v_mul_f32 v138, s48, v138
    v_mfma_f32_16x16x32_bf16 v[100:103], v[52:55], v[32:35], v[100:103]
    ds_read_b128 v[56:59], v20 offset:0
    ds_read_b128 v[60:63], v20 offset:2048
    v_mul_f32 v139, s48, v139
    v_mul_f32 v140, s48, v140
    v_mul_f32 v141, s48, v141
    v_mfma_f32_16x16x32_bf16 v[104:107], v[48:51], v[36:39], v[104:107]
    ds_read_b64_tr_b16 v[76:77], v22 offset:8192
    ds_read_b64_tr_b16 v[78:79], v22 offset:9216
    v_mul_f32 v142, s48, v142
    v_mul_f32 v143, s48, v143
    v_cvt_pk_bf16_f32 v199, v142, v143
    s_add_u32 s50, s56, 16384
    buffer_store_dwordx4 v[232:235], v4, s[20:23], s50 offen offset:0 sc1
    v_mfma_f32_16x16x32_bf16 v[108:111], v[52:55], v[36:39], v[108:111]
    ds_read_b128 v[64:67], v20 offset:4096
    ds_read_b128 v[68:71], v20 offset:6144
    v_cvt_pk_bf16_f32 v198, v140, v141
    v_cvt_pk_bf16_f32 v197, v138, v139
    v_cvt_pk_bf16_f32 v196, v136, v137
    v_mfma_f32_16x16x32_bf16 v[112:115], v[48:51], v[40:43], v[112:115]
    v_mul_f32 v128, s48, v128
    v_mul_f32 v129, s48, v129
    v_mul_f32 v130, s48, v130
    v_mfma_f32_16x16x32_bf16 v[116:119], v[52:55], v[40:43], v[116:119]
    v_mul_f32 v131, s48, v131
    v_mul_f32 v132, s48, v132
    v_mul_f32 v133, s48, v133
    v_mfma_f32_16x16x32_bf16 v[120:123], v[48:51], v[44:47], v[120:123]
    v_mul_f32 v134, s48, v134
    v_mul_f32 v135, s48, v135
    v_cvt_pk_bf16_f32 v195, v134, v135
    v_mfma_f32_16x16x32_bf16 v[124:127], v[52:55], v[44:47], v[124:127]
    v_cvt_pk_bf16_f32 v194, v132, v133
    v_cvt_pk_bf16_f32 v193, v130, v131
    v_cvt_pk_bf16_f32 v192, v128, v129
    v_add_u32 v19, 0, v14
    v_add_u32 v20, 0, v15
    v_add_u32 v21, 147456, v16
    v_add_u32 v22, 147456, v17
    s_waitcnt lgkmcnt(0)
    s_barrier
    v_mfma_f32_16x16x32_bf16 v[96:99], v[72:75], v[56:59], v[96:99]
    ds_read_b64_tr_b16 v[48:49], v21 offset:0
    ds_read_b64_tr_b16 v[50:51], v21 offset:1024
    v_mfma_f32_16x16x32_bf16 v[100:103], v[76:79], v[56:59], v[100:103]
    ds_read_b128 v[32:35], v19 offset:0
    ds_read_b128 v[36:39], v19 offset:2048
    v_mfma_f32_16x16x32_bf16 v[104:107], v[72:75], v[60:63], v[104:107]
    ds_read_b64_tr_b16 v[52:53], v22 offset:0
    ds_read_b64_tr_b16 v[54:55], v22 offset:1024
    s_add_u32 s50, s55, 16384
    buffer_store_dwordx4 v[228:231], v4, s[20:23], s50 offen offset:1024 sc1
    v_mfma_f32_16x16x32_bf16 v[108:111], v[76:79], v[60:63], v[108:111]
    ds_read_b128 v[40:43], v19 offset:4096
    ds_read_b128 v[44:47], v19 offset:6144
    v_mfma_f32_16x16x32_bf16 v[112:115], v[72:75], v[64:67], v[112:115]
    v_mfma_f32_16x16x32_bf16 v[116:119], v[76:79], v[64:67], v[116:119]
    v_mfma_f32_16x16x32_bf16 v[120:123], v[72:75], v[68:71], v[120:123]
    v_mfma_f32_16x16x32_bf16 v[124:127], v[76:79], v[68:71], v[124:127]
    s_waitcnt lgkmcnt(0)
    v_mfma_f32_16x16x32_bf16 v[96:99], v[48:51], v[32:35], v[96:99]
    ds_read_b64_tr_b16 v[72:73], v21 offset:8192
    ds_read_b64_tr_b16 v[74:75], v21 offset:9216
    v_mfma_f32_16x16x32_bf16 v[100:103], v[52:55], v[32:35], v[100:103]
    ds_read_b128 v[56:59], v20 offset:0
    ds_read_b128 v[60:63], v20 offset:2048
    v_mfma_f32_16x16x32_bf16 v[104:107], v[48:51], v[36:39], v[104:107]
    ds_read_b64_tr_b16 v[76:77], v22 offset:8192
    ds_read_b64_tr_b16 v[78:79], v22 offset:9216
    s_add_u32 s50, s55, 16384
    buffer_store_dwordx4 v[224:227], v4, s[20:23], s50 offen offset:0 sc1
    v_mfma_f32_16x16x32_bf16 v[108:111], v[52:55], v[36:39], v[108:111]
    ds_read_b128 v[64:67], v20 offset:4096
    ds_read_b128 v[68:71], v20 offset:6144
    v_mfma_f32_16x16x32_bf16 v[112:115], v[48:51], v[40:43], v[112:115]
    v_mfma_f32_16x16x32_bf16 v[116:119], v[52:55], v[40:43], v[116:119]
    v_mfma_f32_16x16x32_bf16 v[120:123], v[48:51], v[44:47], v[120:123]
    v_mfma_f32_16x16x32_bf16 v[124:127], v[52:55], v[44:47], v[124:127]
    v_add_u32 v19, 16384, v14
    v_add_u32 v20, 16384, v15
    v_add_u32 v21, 98304, v16
    v_add_u32 v22, 98304, v17
    s_waitcnt lgkmcnt(0)
    s_barrier
    v_mfma_f32_16x16x32_bf16 v[96:99], v[72:75], v[56:59], v[96:99]
    ds_read_b64_tr_b16 v[48:49], v21 offset:0
    ds_read_b64_tr_b16 v[50:51], v21 offset:1024
    v_mfma_f32_16x16x32_bf16 v[100:103], v[76:79], v[56:59], v[100:103]
    ds_read_b128 v[32:35], v19 offset:0
    ds_read_b128 v[36:39], v19 offset:2048
    v_mfma_f32_16x16x32_bf16 v[104:107], v[72:75], v[60:63], v[104:107]
    ds_read_b64_tr_b16 v[52:53], v22 offset:0
    ds_read_b64_tr_b16 v[54:55], v22 offset:1024
    s_add_u32 s50, s56, 8192
    buffer_store_dwordx4 v[220:223], v4, s[20:23], s50 offen offset:1024 sc1
    v_mfma_f32_16x16x32_bf16 v[108:111], v[76:79], v[60:63], v[108:111]
    ds_read_b128 v[40:43], v19 offset:4096
    ds_read_b128 v[44:47], v19 offset:6144
    v_mfma_f32_16x16x32_bf16 v[112:115], v[72:75], v[64:67], v[112:115]
    v_mfma_f32_16x16x32_bf16 v[116:119], v[76:79], v[64:67], v[116:119]
    v_mfma_f32_16x16x32_bf16 v[120:123], v[72:75], v[68:71], v[120:123]
    v_mfma_f32_16x16x32_bf16 v[124:127], v[76:79], v[68:71], v[124:127]
    s_waitcnt lgkmcnt(0)
    v_mfma_f32_16x16x32_bf16 v[96:99], v[48:51], v[32:35], v[96:99]
    ds_read_b64_tr_b16 v[72:73], v21 offset:8192
    ds_read_b64_tr_b16 v[74:75], v21 offset:9216
    v_mfma_f32_16x16x32_bf16 v[100:103], v[52:55], v[32:35], v[100:103]
    ds_read_b128 v[56:59], v20 offset:0
    ds_read_b128 v[60:63], v20 offset:2048
    v_mfma_f32_16x16x32_bf16 v[104:107], v[48:51], v[36:39], v[104:107]
    ds_read_b64_tr_b16 v[76:77], v22 offset:8192
    ds_read_b64_tr_b16 v[78:79], v22 offset:9216
    s_add_u32 s50, s56, 8192
    buffer_store_dwordx4 v[216:219], v4, s[20:23], s50 offen offset:0 sc1
    v_mfma_f32_16x16x32_bf16 v[108:111], v[52:55], v[36:39], v[108:111]
    ds_read_b128 v[64:67], v20 offset:4096
    ds_read_b128 v[68:71], v20 offset:6144
    v_mfma_f32_16x16x32_bf16 v[112:115], v[48:51], v[40:43], v[112:115]
    v_mfma_f32_16x16x32_bf16 v[116:119], v[52:55], v[40:43], v[116:119]
    v_mfma_f32_16x16x32_bf16 v[120:123], v[48:51], v[44:47], v[120:123]
    v_mfma_f32_16x16x32_bf16 v[124:127], v[52:55], v[44:47], v[124:127]
    v_add_u32 v19, 32768, v14
    v_add_u32 v20, 32768, v15
    v_add_u32 v21, 114688, v16
    v_add_u32 v22, 114688, v17
    s_waitcnt lgkmcnt(0)
    s_barrier
    v_mfma_f32_16x16x32_bf16 v[96:99], v[72:75], v[56:59], v[96:99]
    ds_read_b64_tr_b16 v[48:49], v21 offset:0
    ds_read_b64_tr_b16 v[50:51], v21 offset:1024
    v_mfma_f32_16x16x32_bf16 v[100:103], v[76:79], v[56:59], v[100:103]
    ds_read_b128 v[32:35], v19 offset:0
    ds_read_b128 v[36:39], v19 offset:2048
    v_mfma_f32_16x16x32_bf16 v[104:107], v[72:75], v[60:63], v[104:107]
    ds_read_b64_tr_b16 v[52:53], v22 offset:0
    ds_read_b64_tr_b16 v[54:55], v22 offset:1024
    s_mov_b32 s8, s64
    s_and_b32 s9, s65, 0xffff
    s_mov_b32 s10, 2359296
    s_mov_b32 s11, 0x20000
    s_mov_b32 s12, s68
    s_and_b32 s13, s69, 0xffff
    s_mov_b32 s14, 4718592
    s_mov_b32 s15, 0x20000
    v_mfma_f32_16x16x32_bf16 v[108:111], v[76:79], v[60:63], v[108:111]
    ds_read_b128 v[40:43], v19 offset:4096
    ds_read_b128 v[44:47], v19 offset:6144
    v_mfma_f32_16x16x32_bf16 v[112:115], v[72:75], v[64:67], v[112:115]
    v_mfma_f32_16x16x32_bf16 v[116:119], v[76:79], v[64:67], v[116:119]
    v_mfma_f32_16x16x32_bf16 v[120:123], v[72:75], v[68:71], v[120:123]
    v_mfma_f32_16x16x32_bf16 v[124:127], v[76:79], v[68:71], v[124:127]
    s_waitcnt lgkmcnt(0)
    v_mfma_f32_16x16x32_bf16 v[96:99], v[48:51], v[32:35], v[96:99]
    ds_read_b64_tr_b16 v[72:73], v21 offset:8192
    ds_read_b64_tr_b16 v[74:75], v21 offset:9216
    v_mfma_f32_16x16x32_bf16 v[100:103], v[52:55], v[32:35], v[100:103]
    ds_read_b128 v[56:59], v20 offset:0
    ds_read_b128 v[60:63], v20 offset:2048
    v_mfma_f32_16x16x32_bf16 v[104:107], v[48:51], v[36:39], v[104:107]
    ds_read_b64_tr_b16 v[76:77], v22 offset:8192
    ds_read_b64_tr_b16 v[78:79], v22 offset:9216
    s_add_u32 s50, s55, 8192
    buffer_store_dwordx4 v[212:215], v4, s[20:23], s50 offen offset:1024 sc1
    v_mfma_f32_16x16x32_bf16 v[108:111], v[52:55], v[36:39], v[108:111]
    ds_read_b128 v[64:67], v20 offset:4096
    ds_read_b128 v[68:71], v20 offset:6144
    v_mfma_f32_16x16x32_bf16 v[112:115], v[48:51], v[40:43], v[112:115]
    v_mfma_f32_16x16x32_bf16 v[116:119], v[52:55], v[40:43], v[116:119]
    v_mfma_f32_16x16x32_bf16 v[120:123], v[48:51], v[44:47], v[120:123]
    v_mfma_f32_16x16x32_bf16 v[124:127], v[52:55], v[44:47], v[124:127]
    v_add_u32 v19, 49152, v14
    v_add_u32 v20, 49152, v15
    v_add_u32 v21, 131072, v16
    v_add_u32 v22, 131072, v17
    s_waitcnt lgkmcnt(0)
    s_barrier
    v_mfma_f32_16x16x32_bf16 v[96:99], v[72:75], v[56:59], v[96:99]
    ds_read_b64_tr_b16 v[48:49], v21 offset:0
    ds_read_b64_tr_b16 v[50:51], v21 offset:1024
    v_mfma_f32_16x16x32_bf16 v[100:103], v[76:79], v[56:59], v[100:103]
    ds_read_b128 v[32:35], v19 offset:0
    ds_read_b128 v[36:39], v19 offset:2048
    v_mfma_f32_16x16x32_bf16 v[104:107], v[72:75], v[60:63], v[104:107]
    ds_read_b64_tr_b16 v[52:53], v22 offset:0
    ds_read_b64_tr_b16 v[54:55], v22 offset:1024
    s_add_u32 s50, s55, 8192
    buffer_store_dwordx4 v[208:211], v4, s[20:23], s50 offen offset:0 sc1
    v_mfma_f32_16x16x32_bf16 v[108:111], v[76:79], v[60:63], v[108:111]
    ds_read_b128 v[40:43], v19 offset:4096
    ds_read_b128 v[44:47], v19 offset:6144
    v_mfma_f32_16x16x32_bf16 v[112:115], v[72:75], v[64:67], v[112:115]
    v_mfma_f32_16x16x32_bf16 v[116:119], v[76:79], v[64:67], v[116:119]
    v_mfma_f32_16x16x32_bf16 v[120:123], v[72:75], v[68:71], v[120:123]
    v_mfma_f32_16x16x32_bf16 v[124:127], v[76:79], v[68:71], v[124:127]
    s_waitcnt lgkmcnt(0)
    v_mfma_f32_16x16x32_bf16 v[96:99], v[48:51], v[32:35], v[96:99]
    ds_read_b64_tr_b16 v[72:73], v21 offset:8192
    ds_read_b64_tr_b16 v[74:75], v21 offset:9216
    v_mfma_f32_16x16x32_bf16 v[100:103], v[52:55], v[32:35], v[100:103]
    ds_read_b128 v[56:59], v20 offset:0
    ds_read_b128 v[60:63], v20 offset:2048
    v_mfma_f32_16x16x32_bf16 v[104:107], v[48:51], v[36:39], v[104:107]
    ds_read_b64_tr_b16 v[76:77], v22 offset:8192
    ds_read_b64_tr_b16 v[78:79], v22 offset:9216
    v_mfma_f32_16x16x32_bf16 v[108:111], v[52:55], v[36:39], v[108:111]
    ds_read_b128 v[64:67], v20 offset:4096
    ds_read_b128 v[68:71], v20 offset:6144
    v_mfma_f32_16x16x32_bf16 v[112:115], v[48:51], v[40:43], v[112:115]
    v_mfma_f32_16x16x32_bf16 v[116:119], v[52:55], v[40:43], v[116:119]
    v_mfma_f32_16x16x32_bf16 v[120:123], v[48:51], v[44:47], v[120:123]
    v_mfma_f32_16x16x32_bf16 v[124:127], v[52:55], v[44:47], v[124:127]
    v_add_u32 v19, 65536, v14
    v_add_u32 v20, 65536, v15
    v_add_u32 v21, 147456, v16
    v_add_u32 v22, 147456, v17
    s_waitcnt lgkmcnt(0)
    s_barrier
    v_mfma_f32_16x16x32_bf16 v[96:99], v[72:75], v[56:59], v[96:99]
    ds_read_b64_tr_b16 v[48:49], v21 offset:0
    ds_read_b64_tr_b16 v[50:51], v21 offset:1024
    v_mfma_f32_16x16x32_bf16 v[100:103], v[76:79], v[56:59], v[100:103]
    ds_read_b128 v[32:35], v19 offset:0
    ds_read_b128 v[36:39], v19 offset:2048
    v_mfma_f32_16x16x32_bf16 v[104:107], v[72:75], v[60:63], v[104:107]
    ds_read_b64_tr_b16 v[52:53], v22 offset:0
    ds_read_b64_tr_b16 v[54:55], v22 offset:1024
    s_add_u32 s50, s56, 0
    buffer_store_dwordx4 v[204:207], v4, s[20:23], s50 offen offset:1024 sc1
    v_mfma_f32_16x16x32_bf16 v[108:111], v[76:79], v[60:63], v[108:111]
    ds_read_b128 v[40:43], v19 offset:4096
    ds_read_b128 v[44:47], v19 offset:6144
    v_mfma_f32_16x16x32_bf16 v[112:115], v[72:75], v[64:67], v[112:115]
    v_mfma_f32_16x16x32_bf16 v[116:119], v[76:79], v[64:67], v[116:119]
    v_mfma_f32_16x16x32_bf16 v[120:123], v[72:75], v[68:71], v[120:123]
    v_mfma_f32_16x16x32_bf16 v[124:127], v[76:79], v[68:71], v[124:127]
    s_waitcnt lgkmcnt(0)
    v_mfma_f32_16x16x32_bf16 v[96:99], v[48:51], v[32:35], v[96:99]
    ds_read_b64_tr_b16 v[72:73], v21 offset:8192
    ds_read_b64_tr_b16 v[74:75], v21 offset:9216
    v_mfma_f32_16x16x32_bf16 v[100:103], v[52:55], v[32:35], v[100:103]
    ds_read_b128 v[56:59], v20 offset:0
    ds_read_b128 v[60:63], v20 offset:2048
    v_mfma_f32_16x16x32_bf16 v[104:107], v[48:51], v[36:39], v[104:107]
    ds_read_b64_tr_b16 v[76:77], v22 offset:8192
    ds_read_b64_tr_b16 v[78:79], v22 offset:9216
    v_mfma_f32_16x16x32_bf16 v[108:111], v[52:55], v[36:39], v[108:111]
    ds_read_b128 v[64:67], v20 offset:4096
    ds_read_b128 v[68:71], v20 offset:6144
    v_mfma_f32_16x16x32_bf16 v[112:115], v[48:51], v[40:43], v[112:115]
    v_mfma_f32_16x16x32_bf16 v[116:119], v[52:55], v[40:43], v[116:119]
    v_mfma_f32_16x16x32_bf16 v[120:123], v[48:51], v[44:47], v[120:123]
    v_mfma_f32_16x16x32_bf16 v[124:127], v[52:55], v[44:47], v[124:127]
    v_add_u32 v19, 81920, v14
    v_add_u32 v20, 81920, v15
    v_add_u32 v21, 98304, v16
    v_add_u32 v22, 98304, v17
    s_waitcnt vmcnt(13) lgkmcnt(0)
    s_branch kf_bgd
kf_b1:
    s_waitcnt lgkmcnt(0)
    s_barrier
    ds_read_b64_tr_b16 v[48:49], v21 offset:0
    ds_read_b64_tr_b16 v[50:51], v21 offset:1024
    v_cvt_pk_bf16_f32 v255, v254, v255
    v_cvt_pk_bf16_f32 v254, v252, v253
    ds_read_b128 v[32:35], v19 offset:0
    ds_read_b128 v[36:39], v19 offset:2048
    v_cvt_pk_bf16_f32 v253, v250, v251
    v_cvt_pk_bf16_f32 v252, v248, v249
    ds_read_b64_tr_b16 v[52:53], v22 offset:0
    ds_read_b64_tr_b16 v[54:55], v22 offset:1024
    v_add_u32 v252, s49, v252
    v_add_u32 v253, s49, v253
    s_add_u32 m0, s43, 131072
    s_add_u32 s39, s38, 49152
    buffer_load_dwordx4 v4, s[20:23], s39 offen sc1 lds
    ds_read_b128 v[40:43], v19 offset:4096
    ds_read_b128 v[44:47], v19 offset:6144
    v_add_u32 v254, s49, v254
    v_add_u32 v255, s49, v255
    s_add_u32 m0, s43, 135168
    s_add_u32 s39, s38, 53248
    buffer_load_dwordx4 v4, s[20:23], s39 offen sc1 lds
    v_cvt_pk_bf16_f32 v251, v246, v247
    v_cvt_pk_bf16_f32 v250, v244, v245
    v_cvt_pk_bf16_f32 v249, v242, v243
    v_cvt_pk_bf16_f32 v248, v240, v241
    s_add_u32 m0, s43, 139264
    s_add_u32 s39, s38, 57344
    buffer_load_dwordx4 v4, s[20:23], s39 offen sc1 lds
    v_add_u32 v248, s49, v248
    v_add_u32 v249, s49, v249
    s_add_u32 m0, s43, 143360
    s_add_u32 s39, s38, 61440
    buffer_load_dwordx4 v4, s[20:23], s39 offen sc1 lds
    v_add_u32 v250, s49, v250
    v_add_u32 v251, s49, v251
    s_waitcnt lgkmcnt(0)
    v_mfma_f32_16x16x32_bf16 v[96:99], v[48:51], v[32:35], v[96:99]
    ds_read_b64_tr_b16 v[72:73], v21 offset:8192
    ds_read_b64_tr_b16 v[74:75], v21 offset:9216
    v_cvt_pk_bf16_f32 v247, v238, v239
    v_cvt_pk_bf16_f32 v246, v236, v237
    v_mfma_f32_16x16x32_bf16 v[100:103], v[52:55], v[32:35], v[100:103]
    ds_read_b128 v[56:59], v20 offset:0
    ds_read_b128 v[60:63], v20 offset:2048
    v_cvt_pk_bf16_f32 v245, v234, v235
    v_cvt_pk_bf16_f32 v244, v232, v233
    v_mfma_f32_16x16x32_bf16 v[104:107], v[48:51], v[36:39], v[104:107]
    ds_read_b64_tr_b16 v[76:77], v22 offset:8192
    ds_read_b64_tr_b16 v[78:79], v22 offset:9216
    v_add_u32 v244, s49, v244
    v_add_u32 v245, s49, v245
    s_add_u32 m0, s92, 0
    s_add_u32 s39, s37, 512
    buffer_load_dwordx4 v11, s[8:11], s39 offen lds
    v_mfma_f32_16x16x32_bf16 v[108:111], v[52:55], v[36:39], v[108:111]
    ds_read_b128 v[64:67], v20 offset:4096
    ds_read_b128 v[68:71], v20 offset:6144
    v_add_u32 v246, s49, v246
    v_add_u32 v247, s49, v247
    s_add_u32 m0, s92, 1024
    s_add_u32 s39, s37, 512
    buffer_load_dwordx4 v24, s[8:11], s39 offen lds
    v_mfma_f32_16x16x32_bf16 v[112:115], v[48:51], v[40:43], v[112:115]
    v_cvt_pk_bf16_f32 v243, v230, v231
    v_cvt_pk_bf16_f32 v242, v228, v229
    v_mfma_f32_16x16x32_bf16 v[116:119], v[52:55], v[40:43], v[116:119]
    v_cvt_pk_bf16_f32 v241, v226, v227
    v_cvt_pk_bf16_f32 v240, v224, v225
    s_add_u32 m0, s92, 2048
    s_add_u32 s39, s37, 18944
    buffer_load_dwordx4 v11, s[8:11], s39 offen lds
    v_mfma_f32_16x16x32_bf16 v[120:123], v[48:51], v[44:47], v[120:123]
    v_add_u32 v240, s49, v240
    v_add_u32 v241, s49, v241
    s_add_u32 m0, s92, 3072
    s_add_u32 s39, s37, 18944
    buffer_load_dwordx4 v24, s[8:11], s39 offen lds
    v_mfma_f32_16x16x32_bf16 v[124:127], v[52:55], v[44:47], v[124:127]
    v_add_u32 v242, s49, v242
    v_add_u32 v243, s49, v243
    v_add_u32 v19, 49152, v14
    v_add_u32 v20, 49152, v15
    v_add_u32 v21, 98304, v16
    v_add_u32 v22, 98304, v17
    s_waitcnt lgkmcnt(0)
    s_barrier
    v_mfma_f32_16x16x32_bf16 v[96:99], v[72:75], v[56:59], v[96:99]
    ds_read_b64_tr_b16 v[48:49], v21 offset:0
    ds_read_b64_tr_b16 v[50:51], v21 offset:1024
    v_cvt_pk_bf16_f32 v239, v222, v223
    v_cvt_pk_bf16_f32 v238, v220, v221
    v_mfma_f32_16x16x32_bf16 v[100:103], v[76:79], v[56:59], v[100:103]
    ds_read_b128 v[32:35], v19 offset:0
    ds_read_b128 v[36:39], v19 offset:2048
    v_cvt_pk_bf16_f32 v237, v218, v219
    v_cvt_pk_bf16_f32 v236, v216, v217
    v_mfma_f32_16x16x32_bf16 v[104:107], v[72:75], v[60:63], v[104:107]
    ds_read_b64_tr_b16 v[52:53], v22 offset:0
    ds_read_b64_tr_b16 v[54:55], v22 offset:1024
    v_add_u32 v236, s49, v236
    v_add_u32 v237, s49, v237
    s_add_u32 m0, s43, 147456
    s_add_u32 s39, s38, 65536
    buffer_load_dwordx4 v4, s[20:23], s39 offen sc1 lds
    v_mfma_f32_16x16x32_bf16 v[108:111], v[76:79], v[60:63], v[108:111]
    ds_read_b128 v[40:43], v19 offset:4096
    ds_read_b128 v[44:47], v19 offset:6144
    v_add_u32 v238, s49, v238
    v_add_u32 v239, s49, v239
    s_add_u32 m0, s43, 151552
    s_add_u32 s39, s38, 69632
    buffer_load_dwordx4 v4, s[20:23], s39 offen sc1 lds
    v_mfma_f32_16x16x32_bf16 v[112:115], v[72:75], v[64:67], v[112:115]
    v_cvt_pk_bf16_f32 v235, v214, v215
    v_cvt_pk_bf16_f32 v234, v212, v213
    v_mfma_f32_16x16x32_bf16 v[116:119], v[76:79], v[64:67], v[116:119]
    v_cvt_pk_bf16_f32 v233, v210, v211
    v_cvt_pk_bf16_f32 v232, v208, v209
    s_add_u32 m0, s43, 155648
    s_add_u32 s39, s38, 73728
    buffer_load_dwordx4 v4, s[20:23], s39 offen sc1 lds
    v_mfma_f32_16x16x32_bf16 v[120:123], v[72:75], v[68:71], v[120:123]
    v_add_u32 v232, s49, v232
    v_add_u32 v233, s49, v233
    s_add_u32 m0, s43, 159744
    s_add_u32 s39, s38, 77824
    buffer_load_dwordx4 v4, s[20:23], s39 offen sc1 lds
    v_mfma_f32_16x16x32_bf16 v[124:127], v[76:79], v[68:71], v[124:127]
    v_add_u32 v234, s49, v234
    v_add_u32 v235, s49, v235
    s_waitcnt lgkmcnt(0)
    v_mfma_f32_16x16x32_bf16 v[96:99], v[48:51], v[32:35], v[96:99]
    ds_read_b64_tr_b16 v[72:73], v21 offset:8192
    ds_read_b64_tr_b16 v[74:75], v21 offset:9216
    v_cvt_pk_bf16_f32 v231, v206, v207
    v_cvt_pk_bf16_f32 v230, v204, v205
    v_mfma_f32_16x16x32_bf16 v[100:103], v[52:55], v[32:35], v[100:103]
    ds_read_b128 v[56:59], v20 offset:0
    ds_read_b128 v[60:63], v20 offset:2048
    v_cvt_pk_bf16_f32 v229, v202, v203
    v_cvt_pk_bf16_f32 v228, v200, v201
    v_mfma_f32_16x16x32_bf16 v[104:107], v[48:51], v[36:39], v[104:107]
    ds_read_b64_tr_b16 v[76:77], v22 offset:8192
    ds_read_b64_tr_b16 v[78:79], v22 offset:9216
    v_add_u32 v228, s49, v228
    v_add_u32 v229, s49, v229
    s_add_u32 m0, s92, 16384
    s_add_u32 s39, s37, 640
    buffer_load_dwordx4 v11, s[8:11], s39 offen lds
    v_mfma_f32_16x16x32_bf16 v[108:111], v[52:55], v[36:39], v[108:111]
    ds_read_b128 v[64:67], v20 offset:4096
    ds_read_b128 v[68:71], v20 offset:6144
    v_add_u32 v230, s49, v230
    v_add_u32 v231, s49, v231
    s_add_u32 m0, s92, 17408
    s_add_u32 s39, s37, 640
    buffer_load_dwordx4 v24, s[8:11], s39 offen lds
    v_mfma_f32_16x16x32_bf16 v[112:115], v[48:51], v[40:43], v[112:115]
    v_cvt_pk_bf16_f32 v227, v198, v199
    v_cvt_pk_bf16_f32 v226, v196, v197
    v_mfma_f32_16x16x32_bf16 v[116:119], v[52:55], v[40:43], v[116:119]
    v_cvt_pk_bf16_f32 v225, v194, v195
    v_cvt_pk_bf16_f32 v224, v192, v193
    s_add_u32 m0, s92, 18432
    s_add_u32 s39, s37, 19072
    buffer_load_dwordx4 v11, s[8:11], s39 offen lds
    v_mfma_f32_16x16x32_bf16 v[120:123], v[48:51], v[44:47], v[120:123]
    v_add_u32 v224, s49, v224
    v_add_u32 v225, s49, v225
    s_add_u32 m0, s92, 19456
    s_add_u32 s39, s37, 19072
    buffer_load_dwordx4 v24, s[8:11], s39 offen lds
    v_mfma_f32_16x16x32_bf16 v[124:127], v[52:55], v[44:47], v[124:127]
    v_add_u32 v226, s49, v226
    v_add_u32 v227, s49, v227
    v_add_u32 v19, 65536, v14
    v_add_u32 v20, 65536, v15
    v_add_u32 v21, 114688, v16
    v_add_u32 v22, 114688, v17
    s_waitcnt lgkmcnt(0)
    s_barrier
    v_mfma_f32_16x16x32_bf16 v[96:99], v[72:75], v[56:59], v[96:99]
    ds_read_b64_tr_b16 v[48:49], v21 offset:0
    ds_read_b64_tr_b16 v[50:51], v21 offset:1024
    v_cvt_pk_bf16_f32 v223, v190, v191
    v_cvt_pk_bf16_f32 v222, v188, v189
    v_mfma_f32_16x16x32_bf16 v[100:103], v[76:79], v[56:59], v[100:103]
    ds_read_b128 v[32:35], v19 offset:0
    ds_read_b128 v[36:39], v19 offset:2048
    v_cvt_pk_bf16_f32 v221, v186, v187
    v_cvt_pk_bf16_f32 v220, v184, v185
    v_mfma_f32_16x16x32_bf16 v[104:107], v[72:75], v[60:63], v[104:107]
    ds_read_b64_tr_b16 v[52:53], v22 offset:0
    ds_read_b64_tr_b16 v[54:55], v22 offset:1024
    v_add_u32 v220, s49, v220
    v_add_u32 v221, s49, v221
    s_add_u32 m0, s43, 98304
    s_add_u32 s39, s38, 81920
    buffer_load_dwordx4 v4, s[20:23], s39 offen sc1 lds
    v_mfma_f32_16x16x32_bf16 v[108:111], v[76:79], v[60:63], v[108:111]
    ds_read_b128 v[40:43], v19 offset:4096
    ds_read_b128 v[44:47], v19 offset:6144
    v_add_u32 v222, s49, v222
    v_add_u32 v223, s49, v223
    s_add_u32 m0, s43, 102400
    s_add_u32 s39, s38, 86016
    buffer_load_dwordx4 v4, s[20:23], s39 offen sc1 lds
    v_mfma_f32_16x16x32_bf16 v[112:115], v[72:75], v[64:67], v[112:115]
    v_cvt_pk_bf16_f32 v219, v182, v183
    v_cvt_pk_bf16_f32 v218, v180, v181
    v_mfma_f32_16x16x32_bf16 v[116:119], v[76:79], v[64:67], v[116:119]
    v_cvt_pk_bf16_f32 v217, v178, v179
    v_cvt_pk_bf16_f32 v216, v176, v177
    s_add_u32 m0, s43, 106496
    s_add_u32 s39, s38, 90112
    buffer_load_dwordx4 v4, s[20:23], s39 offen sc1 lds
    v_mfma_f32_16x16x32_bf16 v[120:123], v[72:75], v[68:71], v[120:123]
    v_add_u32 v216, s49, v216
    v_add_u32 v217, s49, v217
    s_add_u32 m0, s43, 110592
    s_add_u32 s39, s38, 94208
    buffer_load_dwordx4 v4, s[20:23], s39 offen sc1 lds
    v_mfma_f32_16x16x32_bf16 v[124:127], v[76:79], v[68:71], v[124:127]
    v_add_u32 v218, s49, v218
    v_add_u32 v219, s49, v219
    s_waitcnt lgkmcnt(0)
    v_mfma_f32_16x16x32_bf16 v[96:99], v[48:51], v[32:35], v[96:99]
    ds_read_b64_tr_b16 v[72:73], v21 offset:8192
    ds_read_b64_tr_b16 v[74:75], v21 offset:9216
    v_cvt_pk_bf16_f32 v215, v174, v175
    v_cvt_pk_bf16_f32 v214, v172, v173
    v_mfma_f32_16x16x32_bf16 v[100:103], v[52:55], v[32:35], v[100:103]
    ds_read_b128 v[56:59], v20 offset:0
    ds_read_b128 v[60:63], v20 offset:2048
    v_cvt_pk_bf16_f32 v213, v170, v171
    v_cvt_pk_bf16_f32 v212, v168, v169
    v_mfma_f32_16x16x32_bf16 v[104:107], v[48:51], v[36:39], v[104:107]
    ds_read_b64_tr_b16 v[76:77], v22 offset:8192
    ds_read_b64_tr_b16 v[78:79], v22 offset:9216
    v_add_u32 v212, s49, v212
    v_add_u32 v213, s49, v213
    s_add_u32 m0, s92, 32768
    s_add_u32 s39, s37, 768
    buffer_load_dwordx4 v11, s[8:11], s39 offen lds
    v_mfma_f32_16x16x32_bf16 v[108:111], v[52:55], v[36:39], v[108:111]
    ds_read_b128 v[64:67], v20 offset:4096
    ds_read_b128 v[68:71], v20 offset:6144
    v_add_u32 v214, s49, v214
    v_add_u32 v215, s49, v215
    s_add_u32 m0, s92, 33792
    s_add_u32 s39, s37, 768
    buffer_load_dwordx4 v24, s[8:11], s39 offen lds
    v_mfma_f32_16x16x32_bf16 v[112:115], v[48:51], v[40:43], v[112:115]
    v_cvt_pk_bf16_f32 v211, v166, v167
    v_cvt_pk_bf16_f32 v210, v164, v165
    v_mfma_f32_16x16x32_bf16 v[116:119], v[52:55], v[40:43], v[116:119]
    v_cvt_pk_bf16_f32 v209, v162, v163
    v_cvt_pk_bf16_f32 v208, v160, v161
    s_add_u32 m0, s92, 34816
    s_add_u32 s39, s37, 19200
    buffer_load_dwordx4 v11, s[8:11], s39 offen lds
    v_mfma_f32_16x16x32_bf16 v[120:123], v[48:51], v[44:47], v[120:123]
    v_add_u32 v208, s49, v208
    v_add_u32 v209, s49, v209
    s_add_u32 m0, s92, 35840
    s_add_u32 s39, s37, 19200
    buffer_load_dwordx4 v24, s[8:11], s39 offen lds
    v_mfma_f32_16x16x32_bf16 v[124:127], v[52:55], v[44:47], v[124:127]
    v_add_u32 v210, s49, v210
    v_add_u32 v211, s49, v211
    v_add_u32 v19, 81920, v14
    v_add_u32 v20, 81920, v15
    v_add_u32 v21, 131072, v16
    v_add_u32 v22, 131072, v17
    s_waitcnt vmcnt(20) lgkmcnt(0)
    s_barrier
    v_mfma_f32_16x16x32_bf16 v[96:99], v[72:75], v[56:59], v[96:99]
    ds_read_b64_tr_b16 v[48:49], v21 offset:0
    ds_read_b64_tr_b16 v[50:51], v21 offset:1024
    v_cvt_pk_bf16_f32 v207, v158, v159
    v_cvt_pk_bf16_f32 v206, v156, v157
    v_mfma_f32_16x16x32_bf16 v[100:103], v[76:79], v[56:59], v[100:103]
    ds_read_b128 v[32:35], v19 offset:0
    ds_read_b128 v[36:39], v19 offset:2048
    v_cvt_pk_bf16_f32 v205, v154, v155
    v_cvt_pk_bf16_f32 v204, v152, v153
    v_mfma_f32_16x16x32_bf16 v[104:107], v[72:75], v[60:63], v[104:107]
    ds_read_b64_tr_b16 v[52:53], v22 offset:0
    ds_read_b64_tr_b16 v[54:55], v22 offset:1024
    v_add_u32 v204, s49, v204
    v_add_u32 v205, s49, v205
    s_add_u32 m0, s43, 114688
    s_add_u32 s39, s38, 98304
    buffer_load_dwordx4 v4, s[20:23], s39 offen sc1 lds
    v_mfma_f32_16x16x32_bf16 v[108:111], v[76:79], v[60:63], v[108:111]
    ds_read_b128 v[40:43], v19 offset:4096
    ds_read_b128 v[44:47], v19 offset:6144
    v_add_u32 v206, s49, v206
    v_add_u32 v207, s49, v207
    s_add_u32 m0, s43, 118784
    s_add_u32 s39, s38, 102400
    buffer_load_dwordx4 v4, s[20:23], s39 offen sc1 lds
    v_mfma_f32_16x16x32_bf16 v[112:115], v[72:75], v[64:67], v[112:115]
    v_cvt_pk_bf16_f32 v203, v150, v151
    v_cvt_pk_bf16_f32 v202, v148, v149
    v_mfma_f32_16x16x32_bf16 v[116:119], v[76:79], v[64:67], v[116:119]
    v_cvt_pk_bf16_f32 v201, v146, v147
    v_cvt_pk_bf16_f32 v200, v144, v145
    s_add_u32 m0, s43, 122880
    s_add_u32 s39, s38, 106496
    buffer_load_dwordx4 v4, s[20:23], s39 offen sc1 lds
    v_mfma_f32_16x16x32_bf16 v[120:123], v[72:75], v[68:71], v[120:123]
    v_add_u32 v200, s49, v200
    v_add_u32 v201, s49, v201
    s_add_u32 m0, s43, 126976
    s_add_u32 s39, s38, 110592
    buffer_load_dwordx4 v4, s[20:23], s39 offen sc1 lds
    v_mfma_f32_16x16x32_bf16 v[124:127], v[76:79], v[68:71], v[124:127]
    v_add_u32 v202, s49, v202
    v_add_u32 v203, s49, v203
    s_waitcnt lgkmcnt(0)
    v_mfma_f32_16x16x32_bf16 v[96:99], v[48:51], v[32:35], v[96:99]
    ds_read_b64_tr_b16 v[72:73], v21 offset:8192
    ds_read_b64_tr_b16 v[74:75], v21 offset:9216
    v_cvt_pk_bf16_f32 v199, v142, v143
    v_cvt_pk_bf16_f32 v198, v140, v141
    v_mfma_f32_16x16x32_bf16 v[100:103], v[52:55], v[32:35], v[100:103]
    ds_read_b128 v[56:59], v20 offset:0
    ds_read_b128 v[60:63], v20 offset:2048
    v_cvt_pk_bf16_f32 v197, v138, v139
    v_cvt_pk_bf16_f32 v196, v136, v137
    v_mfma_f32_16x16x32_bf16 v[104:107], v[48:51], v[36:39], v[104:107]
    ds_read_b64_tr_b16 v[76:77], v22 offset:8192
    ds_read_b64_tr_b16 v[78:79], v22 offset:9216
    v_add_u32 v196, s49, v196
    v_add_u32 v197, s49, v197
    s_add_u32 m0, s92, 49152
    s_add_u32 s39, s37, 896
    buffer_load_dwordx4 v11, s[8:11], s39 offen lds
    v_mfma_f32_16x16x32_bf16 v[108:111], v[52:55], v[36:39], v[108:111]
    ds_read_b128 v[64:67], v20 offset:4096
    ds_read_b128 v[68:71], v20 offset:6144
    v_add_u32 v198, s49, v198
    v_add_u32 v199, s49, v199
    s_add_u32 m0, s92, 50176
    s_add_u32 s39, s37, 896
    buffer_load_dwordx4 v24, s[8:11], s39 offen lds
    v_mfma_f32_16x16x32_bf16 v[112:115], v[48:51], v[40:43], v[112:115]
    v_cvt_pk_bf16_f32 v195, v134, v135
    v_cvt_pk_bf16_f32 v194, v132, v133
    v_mfma_f32_16x16x32_bf16 v[116:119], v[52:55], v[40:43], v[116:119]
    v_cvt_pk_bf16_f32 v193, v130, v131
    v_cvt_pk_bf16_f32 v192, v128, v129
    s_add_u32 m0, s92, 51200
    s_add_u32 s39, s37, 19328
    buffer_load_dwordx4 v11, s[8:11], s39 offen lds
    v_mfma_f32_16x16x32_bf16 v[120:123], v[48:51], v[44:47], v[120:123]
    v_add_u32 v192, s49, v192
    v_add_u32 v193, s49, v193
    s_add_u32 m0, s92, 52224
    s_add_u32 s39, s37, 19328
    buffer_load_dwordx4 v24, s[8:11], s39 offen lds
    v_mfma_f32_16x16x32_bf16 v[124:127], v[52:55], v[44:47], v[124:127]
    v_add_u32 v194, s49, v194
    v_add_u32 v195, s49, v195
    v_add_u32 v19, 0, v14
    v_add_u32 v20, 0, v15
    v_add_u32 v21, 147456, v16
    v_add_u32 v22, 147456, v17
    s_waitcnt vmcnt(20) lgkmcnt(0)
    s_barrier
    v_mfma_f32_16x16x32_bf16 v[96:99], v[72:75], v[56:59], v[96:99]
    ds_read_b64_tr_b16 v[48:49], v21 offset:0
    ds_read_b64_tr_b16 v[50:51], v21 offset:1024
    v_mfma_f32_16x16x32_bf16 v[100:103], v[76:79], v[56:59], v[100:103]
    ds_read_b128 v[32:35], v19 offset:0
    ds_read_b128 v[36:39], v19 offset:2048
    v_mfma_f32_16x16x32_bf16 v[104:107], v[72:75], v[60:63], v[104:107]
    ds_read_b64_tr_b16 v[52:53], v22 offset:0
    ds_read_b64_tr_b16 v[54:55], v22 offset:1024
    s_add_u32 m0, s43, 131072
    s_add_u32 s39, s38, 114688
    buffer_load_dwordx4 v4, s[20:23], s39 offen sc1 lds
    v_mfma_f32_16x16x32_bf16 v[108:111], v[76:79], v[60:63], v[108:111]
    ds_read_b128 v[40:43], v19 offset:4096
    ds_read_b128 v[44:47], v19 offset:6144
    s_add_u32 m0, s43, 135168
    s_add_u32 s39, s38, 118784
    buffer_load_dwordx4 v4, s[20:23], s39 offen sc1 lds
    v_mfma_f32_16x16x32_bf16 v[112:115], v[72:75], v[64:67], v[112:115]
    v_mfma_f32_16x16x32_bf16 v[116:119], v[76:79], v[64:67], v[116:119]
    s_add_u32 m0, s43, 139264
    s_add_u32 s39, s38, 122880
    buffer_load_dwordx4 v4, s[20:23], s39 offen sc1 lds
    v_mfma_f32_16x16x32_bf16 v[120:123], v[72:75], v[68:71], v[120:123]
    s_add_u32 m0, s43, 143360
    s_add_u32 s39, s38, 126976
    buffer_load_dwordx4 v4, s[20:23], s39 offen sc1 lds
    v_mfma_f32_16x16x32_bf16 v[124:127], v[76:79], v[68:71], v[124:127]
    s_waitcnt lgkmcnt(0)
    v_mfma_f32_16x16x32_bf16 v[96:99], v[48:51], v[32:35], v[96:99]
    ds_read_b64_tr_b16 v[72:73], v21 offset:8192
    ds_read_b64_tr_b16 v[74:75], v21 offset:9216
    v_mfma_f32_16x16x32_bf16 v[100:103], v[52:55], v[32:35], v[100:103]
    ds_read_b128 v[56:59], v20 offset:0
    ds_read_b128 v[60:63], v20 offset:2048
    v_mfma_f32_16x16x32_bf16 v[104:107], v[48:51], v[36:39], v[104:107]
    ds_read_b64_tr_b16 v[76:77], v22 offset:8192
    ds_read_b64_tr_b16 v[78:79], v22 offset:9216
    s_add_u32 m0, s92, 65536
    s_add_u32 s39, s37, 1024
    buffer_load_dwordx4 v11, s[8:11], s39 offen lds
    v_mfma_f32_16x16x32_bf16 v[108:111], v[52:55], v[36:39], v[108:111]
    ds_read_b128 v[64:67], v20 offset:4096
    ds_read_b128 v[68:71], v20 offset:6144
    s_add_u32 m0, s92, 66560
    s_add_u32 s39, s37, 1024
    buffer_load_dwordx4 v24, s[8:11], s39 offen lds
    v_mfma_f32_16x16x32_bf16 v[112:115], v[48:51], v[40:43], v[112:115]
    v_mfma_f32_16x16x32_bf16 v[116:119], v[52:55], v[40:43], v[116:119]
    s_add_u32 m0, s92, 67584
    s_add_u32 s39, s37, 19456
    buffer_load_dwordx4 v11, s[8:11], s39 offen lds
    v_mfma_f32_16x16x32_bf16 v[120:123], v[48:51], v[44:47], v[120:123]
    s_add_u32 m0, s92, 68608
    s_add_u32 s39, s37, 19456
    buffer_load_dwordx4 v24, s[8:11], s39 offen lds
    v_mfma_f32_16x16x32_bf16 v[124:127], v[52:55], v[44:47], v[124:127]
    v_add_u32 v19, 16384, v14
    v_add_u32 v20, 16384, v15
    v_add_u32 v21, 98304, v16
    v_add_u32 v22, 98304, v17
    s_waitcnt vmcnt(20) lgkmcnt(0)
    s_barrier
    v_mfma_f32_16x16x32_bf16 v[96:99], v[72:75], v[56:59], v[96:99]
    ds_read_b64_tr_b16 v[48:49], v21 offset:0
    ds_read_b64_tr_b16 v[50:51], v21 offset:1024
    v_mfma_f32_16x16x32_bf16 v[100:103], v[76:79], v[56:59], v[100:103]
    ds_read_b128 v[32:35], v19 offset:0
    ds_read_b128 v[36:39], v19 offset:2048
    v_mfma_f32_16x16x32_bf16 v[104:107], v[72:75], v[60:63], v[104:107]
    ds_read_b64_tr_b16 v[52:53], v22 offset:0
    ds_read_b64_tr_b16 v[54:55], v22 offset:1024
    s_add_u32 m0, s43, 147456
    s_add_u32 s39, s38, 131072
    buffer_load_dwordx4 v4, s[20:23], s39 offen sc1 lds
    v_mfma_f32_16x16x32_bf16 v[108:111], v[76:79], v[60:63], v[108:111]
    ds_read_b128 v[40:43], v19 offset:4096
    ds_read_b128 v[44:47], v19 offset:6144
    v_mfma_f32_16x16x32_bf16 v[112:115], v[72:75], v[64:67], v[112:115]
    v_mfma_f32_16x16x32_bf16 v[116:119], v[76:79], v[64:67], v[116:119]
    s_add_u32 m0, s43, 151552
    s_add_u32 s39, s38, 135168
    buffer_load_dwordx4 v4, s[20:23], s39 offen sc1 lds
    v_mfma_f32_16x16x32_bf16 v[120:123], v[72:75], v[68:71], v[120:123]
    v_mfma_f32_16x16x32_bf16 v[124:127], v[76:79], v[68:71], v[124:127]
    s_waitcnt lgkmcnt(0)
    v_mfma_f32_16x16x32_bf16 v[96:99], v[48:51], v[32:35], v[96:99]
    ds_read_b64_tr_b16 v[72:73], v21 offset:8192
    ds_read_b64_tr_b16 v[74:75], v21 offset:9216
    v_mfma_f32_16x16x32_bf16 v[100:103], v[52:55], v[32:35], v[100:103]
    ds_read_b128 v[56:59], v20 offset:0
    ds_read_b128 v[60:63], v20 offset:2048
    v_mfma_f32_16x16x32_bf16 v[104:107], v[48:51], v[36:39], v[104:107]
    ds_read_b64_tr_b16 v[76:77], v22 offset:8192
    ds_read_b64_tr_b16 v[78:79], v22 offset:9216
    s_add_u32 m0, s43, 155648
    s_add_u32 s39, s38, 139264
    buffer_load_dwordx4 v4, s[20:23], s39 offen sc1 lds
    v_mfma_f32_16x16x32_bf16 v[108:111], v[52:55], v[36:39], v[108:111]
    ds_read_b128 v[64:67], v20 offset:4096
    ds_read_b128 v[68:71], v20 offset:6144
    v_mfma_f32_16x16x32_bf16 v[112:115], v[48:51], v[40:43], v[112:115]
    v_mfma_f32_16x16x32_bf16 v[116:119], v[52:55], v[40:43], v[116:119]
    s_add_u32 m0, s43, 159744
    s_add_u32 s39, s38, 143360
    buffer_load_dwordx4 v4, s[20:23], s39 offen sc1 lds
    v_mfma_f32_16x16x32_bf16 v[120:123], v[48:51], v[44:47], v[120:123]
    v_mfma_f32_16x16x32_bf16 v[124:127], v[52:55], v[44:47], v[124:127]
    v_add_u32 v19, 32768, v14
    v_add_u32 v20, 32768, v15
    v_add_u32 v21, 114688, v16
    v_add_u32 v22, 114688, v17
    s_waitcnt vmcnt(16) lgkmcnt(0)
    s_barrier
    v_mfma_f32_16x16x32_bf16 v[96:99], v[72:75], v[56:59], v[96:99]
    ds_read_b64_tr_b16 v[48:49], v21 offset:0
    ds_read_b64_tr_b16 v[50:51], v21 offset:1024
    v_mfma_f32_16x16x32_bf16 v[100:103], v[76:79], v[56:59], v[100:103]
    ds_read_b128 v[32:35], v19 offset:0
    ds_read_b128 v[36:39], v19 offset:2048
    v_mfma_f32_16x16x32_bf16 v[104:107], v[72:75], v[60:63], v[104:107]
    ds_read_b64_tr_b16 v[52:53], v22 offset:0
    ds_read_b64_tr_b16 v[54:55], v22 offset:1024
    s_mov_b32 s8, s64
    s_and_b32 s9, s65, 0xffff
    s_mov_b32 s10, 2359296
    s_mov_b32 s11, 0x20000
    s_mov_b32 s12, s68
    s_and_b32 s13, s69, 0xffff
    s_mov_b32 s14, 4718592
    s_mov_b32 s15, 0x20000
    v_mfma_f32_16x16x32_bf16 v[108:111], v[76:79], v[60:63], v[108:111]
    ds_read_b128 v[40:43], v19 offset:4096
    ds_read_b128 v[44:47], v19 offset:6144
    s_add_u32 m0, s43, 98304
    s_add_u32 s39, s36, 0
    buffer_load_dwordx4 v10, s[12:15], s39 offen lds
    v_mfma_f32_16x16x32_bf16 v[112:115], v[72:75], v[64:67], v[112:115]
    s_add_u32 m0, s43, 102400
    s_add_u32 s39, s36, 131072
    buffer_load_dwordx4 v10, s[12:15], s39 offen lds
    v_mfma_f32_16x16x32_bf16 v[116:119], v[76:79], v[64:67], v[116:119]
    s_add_u32 m0, s43, 106496
    s_add_u32 s39, s36, 262144
    buffer_load_dwordx4 v10, s[12:15], s39 offen lds
    v_mfma_f32_16x16x32_bf16 v[120:123], v[72:75], v[68:71], v[120:123]
    s_add_u32 m0, s43, 110592
    s_add_u32 s39, s36, 393216
    buffer_load_dwordx4 v10, s[12:15], s39 offen lds
    v_mfma_f32_16x16x32_bf16 v[124:127], v[76:79], v[68:71], v[124:127]
    s_waitcnt lgkmcnt(0)
    v_mfma_f32_16x16x32_bf16 v[96:99], v[48:51], v[32:35], v[96:99]
    ds_read_b64_tr_b16 v[72:73], v21 offset:8192
    ds_read_b64_tr_b16 v[74:75], v21 offset:9216
    v_mfma_f32_16x16x32_bf16 v[100:103], v[52:55], v[32:35], v[100:103]
    ds_read_b128 v[56:59], v20 offset:0
    ds_read_b128 v[60:63], v20 offset:2048
    v_mfma_f32_16x16x32_bf16 v[104:107], v[48:51], v[36:39], v[104:107]
    ds_read_b64_tr_b16 v[76:77], v22 offset:8192
    ds_read_b64_tr_b16 v[78:79], v22 offset:9216
    s_add_u32 m0, s92, 0
    s_add_u32 s39, s90, 0
    buffer_load_dwordx4 v11, s[8:11], s39 offen lds
    v_mfma_f32_16x16x32_bf16 v[108:111], v[52:55], v[36:39], v[108:111]
    ds_read_b128 v[64:67], v20 offset:4096
    ds_read_b128 v[68:71], v20 offset:6144
    s_add_u32 m0, s92, 1024
    s_add_u32 s39, s90, 0
    buffer_load_dwordx4 v24, s[8:11], s39 offen lds
    v_mfma_f32_16x16x32_bf16 v[112:115], v[48:51], v[40:43], v[112:115]
    v_mfma_f32_16x16x32_bf16 v[116:119], v[52:55], v[40:43], v[116:119]
    s_add_u32 m0, s92, 2048
    s_add_u32 s39, s90, 18432
    buffer_load_dwordx4 v11, s[8:11], s39 offen lds
    v_mfma_f32_16x16x32_bf16 v[120:123], v[48:51], v[44:47], v[120:123]
    s_add_u32 m0, s92, 3072
    s_add_u32 s39, s90, 18432
    buffer_load_dwordx4 v24, s[8:11], s39 offen lds
    v_mfma_f32_16x16x32_bf16 v[124:127], v[52:55], v[44:47], v[124:127]
    v_add_u32 v19, 49152, v14
    v_add_u32 v20, 49152, v15
    v_add_u32 v21, 131072, v16
    v_add_u32 v22, 131072, v17
    s_waitcnt vmcnt(16) lgkmcnt(0)
    s_barrier
    v_mfma_f32_16x16x32_bf16 v[96:99], v[72:75], v[56:59], v[96:99]
    ds_read_b64_tr_b16 v[48:49], v21 offset:0
    ds_read_b64_tr_b16 v[50:51], v21 offset:1024
    v_mfma_f32_16x16x32_bf16 v[100:103], v[76:79], v[56:59], v[100:103]
    ds_read_b128 v[32:35], v19 offset:0
    ds_read_b128 v[36:39], v19 offset:2048
    v_mfma_f32_16x16x32_bf16 v[104:107], v[72:75], v[60:63], v[104:107]
    ds_read_b64_tr_b16 v[52:53], v22 offset:0
    ds_read_b64_tr_b16 v[54:55], v22 offset:1024
    s_add_u32 m0, s92, 16384
    s_add_u32 s39, s91, 0
    buffer_load_dwordx4 v11, s[8:11], s39 offen lds
    v_mfma_f32_16x16x32_bf16 v[108:111], v[76:79], v[60:63], v[108:111]
    ds_read_b128 v[40:43], v19 offset:4096
    ds_read_b128 v[44:47], v19 offset:6144
    v_mfma_f32_16x16x32_bf16 v[112:115], v[72:75], v[64:67], v[112:115]
    v_mfma_f32_16x16x32_bf16 v[116:119], v[76:79], v[64:67], v[116:119]
    s_add_u32 m0, s92, 17408
    s_add_u32 s39, s91, 0
    buffer_load_dwordx4 v24, s[8:11], s39 offen lds
    v_mfma_f32_16x16x32_bf16 v[120:123], v[72:75], v[68:71], v[120:123]
    v_mfma_f32_16x16x32_bf16 v[124:127], v[76:79], v[68:71], v[124:127]
    s_waitcnt lgkmcnt(0)
    v_mfma_f32_16x16x32_bf16 v[96:99], v[48:51], v[32:35], v[96:99]
    ds_read_b64_tr_b16 v[72:73], v21 offset:8192
    ds_read_b64_tr_b16 v[74:75], v21 offset:9216
    v_mfma_f32_16x16x32_bf16 v[100:103], v[52:55], v[32:35], v[100:103]
    ds_read_b128 v[56:59], v20 offset:0
    ds_read_b128 v[60:63], v20 offset:2048
    v_mfma_f32_16x16x32_bf16 v[104:107], v[48:51], v[36:39], v[104:107]
    ds_read_b64_tr_b16 v[76:77], v22 offset:8192
    ds_read_b64_tr_b16 v[78:79], v22 offset:9216
    s_add_u32 m0, s92, 18432
    s_add_u32 s39, s91, 18432
    buffer_load_dwordx4 v11, s[8:11], s39 offen lds
    v_mfma_f32_16x16x32_bf16 v[108:111], v[52:55], v[36:39], v[108:111]
    ds_read_b128 v[64:67], v20 offset:4096
    ds_read_b128 v[68:71], v20 offset:6144
    v_mfma_f32_16x16x32_bf16 v[112:115], v[48:51], v[40:43], v[112:115]
    v_mfma_f32_16x16x32_bf16 v[116:119], v[52:55], v[40:43], v[116:119]
    s_add_u32 m0, s92, 19456
    s_add_u32 s39, s91, 18432
    buffer_load_dwordx4 v24, s[8:11], s39 offen lds
    v_mfma_f32_16x16x32_bf16 v[120:123], v[48:51], v[44:47], v[120:123]
    v_mfma_f32_16x16x32_bf16 v[124:127], v[52:55], v[44:47], v[124:127]
    v_add_u32 v19, 65536, v14
    v_add_u32 v20, 65536, v15
    v_add_u32 v21, 147456, v16
    v_add_u32 v22, 147456, v17
    s_waitcnt vmcnt(12) lgkmcnt(0)
    s_barrier
    v_mfma_f32_16x16x32_bf16 v[96:99], v[72:75], v[56:59], v[96:99]
    ds_read_b64_tr_b16 v[48:49], v21 offset:0
    ds_read_b64_tr_b16 v[50:51], v21 offset:1024
    v_mfma_f32_16x16x32_bf16 v[100:103], v[76:79], v[56:59], v[100:103]
    ds_read_b128 v[32:35], v19 offset:0
    ds_read_b128 v[36:39], v19 offset:2048
    v_mfma_f32_16x16x32_bf16 v[104:107], v[72:75], v[60:63], v[104:107]
    ds_read_b64_tr_b16 v[52:53], v22 offset:0
    ds_read_b64_tr_b16 v[54:55], v22 offset:1024
    s_add_u32 m0, s92, 32768
    s_add_u32 s39, s90, 128
    buffer_load_dwordx4 v11, s[8:11], s39 offen lds
    v_mfma_f32_16x16x32_bf16 v[108:111], v[76:79], v[60:63], v[108:111]
    ds_read_b128 v[40:43], v19 offset:4096
    ds_read_b128 v[44:47], v19 offset:6144
    s_add_u32 m0, s92, 33792
    s_add_u32 s39, s90, 128
    buffer_load_dwordx4 v24, s[8:11], s39 offen lds
    v_mfma_f32_16x16x32_bf16 v[112:115], v[72:75], v[64:67], v[112:115]
    s_add_u32 m0, s92, 34816
    s_add_u32 s39, s90, 18560
    buffer_load_dwordx4 v11, s[8:11], s39 offen lds
    v_mfma_f32_16x16x32_bf16 v[116:119], v[76:79], v[64:67], v[116:119]
    s_add_u32 m0, s92, 35840
    s_add_u32 s39, s90, 18560
    buffer_load_dwordx4 v24, s[8:11], s39 offen lds
    v_mfma_f32_16x16x32_bf16 v[120:123], v[72:75], v[68:71], v[120:123]
    s_add_u32 m0, s92, 49152
    s_add_u32 s39, s91, 128
    buffer_load_dwordx4 v11, s[8:11], s39 offen lds
    v_mfma_f32_16x16x32_bf16 v[124:127], v[76:79], v[68:71], v[124:127]
    s_waitcnt lgkmcnt(0)
    v_mfma_f32_16x16x32_bf16 v[96:99], v[48:51], v[32:35], v[96:99]
    ds_read_b64_tr_b16 v[72:73], v21 offset:8192
    ds_read_b64_tr_b16 v[74:75], v21 offset:9216
    v_mfma_f32_16x16x32_bf16 v[100:103], v[52:55], v[32:35], v[100:103]
    ds_read_b128 v[56:59], v20 offset:0
    ds_read_b128 v[60:63], v20 offset:2048
    v_mfma_f32_16x16x32_bf16 v[104:107], v[48:51], v[36:39], v[104:107]
    ds_read_b64_tr_b16 v[76:77], v22 offset:8192
    ds_read_b64_tr_b16 v[78:79], v22 offset:9216
    s_add_u32 m0, s92, 50176
    s_add_u32 s39, s91, 128
    buffer_load_dwordx4 v24, s[8:11], s39 offen lds
    v_mfma_f32_16x16x32_bf16 v[108:111], v[52:55], v[36:39], v[108:111]
    ds_read_b128 v[64:67], v20 offset:4096
    ds_read_b128 v[68:71], v20 offset:6144
    s_add_u32 m0, s92, 51200
    s_add_u32 s39, s91, 18560
    buffer_load_dwordx4 v11, s[8:11], s39 offen lds
    v_mfma_f32_16x16x32_bf16 v[112:115], v[48:51], v[40:43], v[112:115]
    s_add_u32 m0, s92, 52224
    s_add_u32 s39, s91, 18560
    buffer_load_dwordx4 v24, s[8:11], s39 offen lds
    v_mfma_f32_16x16x32_bf16 v[116:119], v[52:55], v[40:43], v[116:119]
    s_add_u32 s50, s56, 24576
    buffer_store_dwordx4 v[252:255], v4, s[20:23], s50 offen offset:1024 sc1
    v_mfma_f32_16x16x32_bf16 v[120:123], v[48:51], v[44:47], v[120:123]
    s_add_u32 s50, s56, 24576
    buffer_store_dwordx4 v[248:251], v4, s[20:23], s50 offen offset:0 sc1
    v_mfma_f32_16x16x32_bf16 v[124:127], v[52:55], v[44:47], v[124:127]
    v_add_u32 v19, 81920, v14
    v_add_u32 v20, 81920, v15
    v_add_u32 v21, 98304, v16
    v_add_u32 v22, 98304, v17
    s_waitcnt vmcnt(63) lgkmcnt(0)
kf_bgd:
    v_mfma_f32_16x16x32_bf16 v[96:99], v[72:75], v[56:59], v[96:99]
    v_mfma_f32_16x16x32_bf16 v[100:103], v[76:79], v[56:59], v[100:103]
    v_mfma_f32_16x16x32_bf16 v[104:107], v[72:75], v[60:63], v[104:107]
    v_mfma_f32_16x16x32_bf16 v[108:111], v[76:79], v[60:63], v[108:111]
    v_mfma_f32_16x16x32_bf16 v[112:115], v[72:75], v[64:67], v[112:115]
    v_mfma_f32_16x16x32_bf16 v[116:119], v[76:79], v[64:67], v[116:119]
    v_mfma_f32_16x16x32_bf16 v[120:123], v[72:75], v[68:71], v[120:123]
    v_mfma_f32_16x16x32_bf16 v[124:127], v[76:79], v[68:71], v[124:127]
    s_lshl_b32 s32, s46, 6
    v_add_u32 v5, s32, v2
    v_mul_u32_u24 v5, 272, v5
    v_lshl_add_u32 v5, v3, 3, v5
    s_lshr_b32 s32, s3, 1
    s_lshl_b32 s33, s32, 6
    s_add_u32 s33, s33, 114688
    v_add_u32 v5, s33, v5
    v_lshl_or_b32 v92, v85, 16, v84
    v_lshl_or_b32 v93, v87, 16, v86
    v_lshl_or_b32 v94, v89, 16, v88
    v_lshl_or_b32 v95, v91, 16, v90
    s_barrier
    s_cmp_eq_u32 s45, 0
    s_cbranch_scc1 kf_nop2
    s_add_u32 m0, s92, 65536
    s_add_u32 s39, s90, 256
    buffer_load_dwordx4 v11, s[8:11], s39 offen lds
    s_add_u32 m0, s92, 66560
    s_add_u32 s39, s90, 256
    buffer_load_dwordx4 v24, s[8:11], s39 offen lds
    s_add_u32 m0, s92, 67584
    s_add_u32 s39, s90, 18688
    buffer_load_dwordx4 v11, s[8:11], s39 offen lds
    s_add_u32 m0, s92, 68608
    s_add_u32 s39, s90, 18688
    buffer_load_dwordx4 v24, s[8:11], s39 offen lds
    s_add_u32 m0, s92, 81920
    s_add_u32 s39, s91, 256
    buffer_load_dwordx4 v11, s[8:11], s39 offen lds
    s_add_u32 m0, s92, 82944
    s_add_u32 s39, s91, 256
    buffer_load_dwordx4 v24, s[8:11], s39 offen lds
    s_add_u32 m0, s92, 83968
    s_add_u32 s39, s91, 18688
    buffer_load_dwordx4 v11, s[8:11], s39 offen lds
    s_add_u32 m0, s92, 84992
    s_add_u32 s39, s91, 18688
    buffer_load_dwordx4 v24, s[8:11], s39 offen lds
kf_nop2:
    s_cmp_eq_u32 s45, 1
    s_cbranch_scc1 kf_sba
    s_add_u32 s50, s56, 0
    buffer_store_dwordx4 v[200:203], v4, s[20:23], s50 offen offset:0 sc1
    s_add_u32 s50, s55, 0
    buffer_store_dwordx4 v[196:199], v4, s[20:23], s50 offen offset:1024 sc1
    s_branch kf_sea
kf_sba:
    s_add_u32 s50, s55, 24576
    buffer_store_dwordx4 v[244:247], v4, s[20:23], s50 offen offset:1024 sc1
    s_add_u32 s50, s55, 24576
    buffer_store_dwordx4 v[240:243], v4, s[20:23], s50 offen offset:0 sc1
kf_sea:
    v_cvt_pk_bf16_f32 v32, v96, v97
    v_cvt_pk_bf16_f32 v33, v98, v99
    ds_write_b64 v5, v[32:33] offset:0
    v_cvt_pk_bf16_f32 v34, v100, v101
    v_cvt_pk_bf16_f32 v35, v102, v103
    ds_write_b64 v5, v[34:35] offset:32
    v_cvt_pk_bf16_f32 v36, v104, v105
    v_cvt_pk_bf16_f32 v37, v106, v107
    ds_write_b64 v5, v[36:37] offset:4352
    v_cvt_pk_bf16_f32 v38, v108, v109
    v_cvt_pk_bf16_f32 v39, v110, v111
    ds_write_b64 v5, v[38:39] offset:4384
    v_cvt_pk_bf16_f32 v40, v112, v113
    v_cvt_pk_bf16_f32 v41, v114, v115
    ds_write_b64 v5, v[40:41] offset:8704
    v_cvt_pk_bf16_f32 v42, v116, v117
    v_cvt_pk_bf16_f32 v43, v118, v119
    ds_write_b64 v5, v[42:43] offset:8736
    v_cvt_pk_bf16_f32 v44, v120, v121
    v_cvt_pk_bf16_f32 v45, v122, v123
    ds_write_b64 v5, v[44:45] offset:13056
    v_cvt_pk_bf16_f32 v46, v124, v125
    v_cvt_pk_bf16_f32 v47, v126, v127
    ds_write_b64 v5, v[46:47] offset:13088
    s_cmp_lt_u32 s32, 2
    s_cbranch_scc1 kf_noones
    s_cmp_eq_u32 s32, 2
    s_cselect_b32 s33, 0, 74
    s_add_u32 s33, s33, s44
    s_add_u32 s33, s33, 114846
    s_lshl_b32 s34, s46, 6
    v_add_u32 v6, s34, v1
    v_mul_u32_u24 v6, 272, v6
    v_add_u32 v6, s33, v6
    v_mov_b32 v7, 0x3f80
    ds_write_b16 v6, v7 offset:0
kf_noones:
    v_add_u32 v82, 114688, v4
    s_cmp_ge_u32 s3, 6
    s_cbranch_scc1 kf_nowimg
    v_add_u32 v6, s60, v82
    ds_write_b128 v6, v[92:95] offset:34816
kf_nowimg:
    s_and_b32 s32, s3, 3
    s_lshl_b32 s32, s32, 5
    v_add_u32 v5, s32, v80
    v_mul_u32_u24 v6, 272, v5
    v_lshl_add_u32 v6, v81, 4, v6
    s_mul_i32 s33, s45, 80
    s_add_u32 s33, s33, 114688
    v_add_u32 v6, s33, v6
    s_waitcnt lgkmcnt(0)
    s_barrier
    ds_read_b128 v[56:59], v6 offset:0
    ds_read_b128 v[60:63], v6 offset:32
    ds_read_b128 v[64:67], v6 offset:64
    ds_read_b128 v[32:35], v82 offset:34816
    ds_read_b128 v[36:39], v82 offset:35840
    ds_read_b128 v[40:43], v82 offset:36864
    ds_read_b128 v[44:47], v82 offset:37888
    ds_read_b128 v[48:51], v82 offset:38912
    ds_read_b128 v[52:55], v82 offset:39936
    s_waitcnt lgkmcnt(0)
    s_barrier
    v_mfma_f32_32x32x16_bf16 v[160:175], v[32:35], v[56:59], 0
    v_mfma_f32_32x32x16_bf16 v[160:175], v[36:39], v[60:63], v[160:175]
    v_mfma_f32_32x32x16_bf16 v[160:175], v[40:43], v[64:67], v[160:175]
    v_mfma_f32_32x32x16_bf16 v[176:191], v[44:47], v[56:59], 0
    v_mfma_f32_32x32x16_bf16 v[176:191], v[48:51], v[60:63], v[176:191]
    v_mfma_f32_32x32x16_bf16 v[176:191], v[52:55], v[64:67], v[176:191]
    s_cmp_eq_u32 s45, 1
    s_cbranch_scc1 kf_sbb
    s_add_u32 s50, s55, 0
    buffer_store_dwordx4 v[192:195], v4, s[20:23], s50 offen offset:0 sc1
    s_branch kf_seb
kf_sbb:
    s_add_u32 s50, s56, 16384
    buffer_store_dwordx4 v[236:239], v4, s[20:23], s50 offen offset:1024 sc1
    s_add_u32 s50, s56, 16384
    buffer_store_dwordx4 v[232:235], v4, s[20:23], s50 offen offset:0 sc1
kf_seb:
    s_nop 15
    s_mov_b32 s32, 0x3fb8aa3b
    v_mul_f32 v160, s32, v160
    v_mul_f32 v161, s32, v161
    v_mul_f32 v162, s32, v162
    v_mul_f32 v163, s32, v163
    v_mul_f32 v164, s32, v164
    v_mul_f32 v165, s32, v165
    v_mul_f32 v166, s32, v166
    v_mul_f32 v167, s32, v167
    v_mul_f32 v168, s32, v168
    v_mul_f32 v169, s32, v169
    v_mul_f32 v170, s32, v170
    v_mul_f32 v171, s32, v171
    v_mul_f32 v172, s32, v172
    v_mul_f32 v173, s32, v173
    v_mul_f32 v174, s32, v174
    v_mul_f32 v175, s32, v175
    v_mul_f32 v176, s32, v176
    v_mul_f32 v177, s32, v177
    v_max3_f32 v32, v160, v161, v162
    v_min3_f32 v33, v160, v161, v162
    v_max3_f32 v32, v32, v163, v164
    v_min3_f32 v33, v33, v163, v164
    v_max3_f32 v32, v32, v165, v166
    v_min3_f32 v33, v33, v165, v166
    v_max3_f32 v32, v32, v167, v168
    v_min3_f32 v33, v33, v167, v168
    v_max3_f32 v32, v32, v169, v170
    v_min3_f32 v33, v33, v169, v170
    v_max3_f32 v32, v32, v171, v172
    v_min3_f32 v33, v33, v171, v172
    v_max3_f32 v32, v32, v173, v174
    v_min3_f32 v33, v33, v173, v174
    v_max3_f32 v32, v32, v175, v176
    v_min3_f32 v33, v33, v175, v176
    v_max_f32 v32, v32, v177
    v_min_f32 v33, v33, v177
    v_sub_f32 v96, v160, v32
    v_sub_f32 v114, v33, v160
    v_sub_f32 v97, v161, v32
    v_sub_f32 v115, v33, v161
    v_sub_f32 v98, v162, v32
    v_sub_f32 v116, v33, v162
    v_sub_f32 v99, v163, v32
    v_sub_f32 v117, v33, v163
    v_sub_f32 v100, v164, v32
    v_sub_f32 v118, v33, v164
    v_sub_f32 v101, v165, v32
    v_sub_f32 v119, v33, v165
    v_sub_f32 v102, v166, v32
    v_sub_f32 v120, v33, v166
    v_sub_f32 v103, v167, v32
    v_sub_f32 v121, v33, v167
    v_sub_f32 v104, v168, v32
    v_sub_f32 v122, v33, v168
    v_sub_f32 v105, v169, v32
    v_sub_f32 v123, v33, v169
    v_sub_f32 v106, v170, v32
    v_sub_f32 v124, v33, v170
    v_sub_f32 v107, v171, v32
    v_sub_f32 v125, v33, v171
    v_sub_f32 v108, v172, v32
    v_sub_f32 v126, v33, v172
    v_sub_f32 v109, v173, v32
    v_sub_f32 v127, v33, v173
    v_sub_f32 v110, v174, v32
    v_sub_f32 v128, v33, v174
    v_sub_f32 v111, v175, v32
    v_sub_f32 v129, v33, v175
    v_sub_f32 v112, v176, v32
    v_sub_f32 v130, v33, v176
    v_sub_f32 v113, v177, v32
    v_sub_f32 v131, v33, v177
    v_exp_f32 v96, v96
    v_exp_f32 v114, v114
    v_exp_f32 v97, v97
    v_exp_f32 v115, v115
    v_exp_f32 v98, v98
    v_exp_f32 v116, v116
    v_exp_f32 v99, v99
    v_exp_f32 v117, v117
    v_exp_f32 v100, v100
    v_exp_f32 v118, v118
    v_exp_f32 v101, v101
    v_exp_f32 v119, v119
    v_exp_f32 v102, v102
    v_exp_f32 v120, v120
    v_exp_f32 v103, v103
    v_exp_f32 v121, v121
    v_exp_f32 v104, v104
    v_exp_f32 v122, v122
    v_exp_f32 v105, v105
    v_exp_f32 v123, v123
    v_exp_f32 v106, v106
    v_exp_f32 v124, v124
    v_exp_f32 v107, v107
    v_exp_f32 v125, v125
    v_exp_f32 v108, v108
    v_exp_f32 v126, v126
    v_exp_f32 v109, v109
    v_exp_f32 v127, v127
    v_exp_f32 v110, v110
    v_exp_f32 v128, v128
    v_exp_f32 v111, v111
    v_exp_f32 v129, v129
    v_exp_f32 v112, v112
    v_exp_f32 v130, v130
    v_exp_f32 v113, v113
    v_exp_f32 v131, v131
    v_add_f32 v34, v96, v97
    v_add_f32 v35, v114, v115
    v_add_f32 v34, v34, v98
    v_add_f32 v35, v35, v116
    v_add_f32 v34, v34, v99
    v_add_f32 v35, v35, v117
    v_add_f32 v34, v34, v100
    v_add_f32 v35, v35, v118
    v_add_f32 v34, v34, v101
    v_add_f32 v35, v35, v119
    v_add_f32 v34, v34, v102
    v_add_f32 v35, v35, v120
    v_add_f32 v34, v34, v103
    v_add_f32 v35, v35, v121
    v_add_f32 v34, v34, v104
    v_add_f32 v35, v35, v122
    v_add_f32 v34, v34, v105
    v_add_f32 v35, v35, v123
    v_add_f32 v34, v34, v106
    v_add_f32 v35, v35, v124
    v_add_f32 v34, v34, v107
    v_add_f32 v35, v35, v125
    v_add_f32 v34, v34, v108
    v_add_f32 v35, v35, v126
    v_add_f32 v34, v34, v109
    v_add_f32 v35, v35, v127
    v_add_f32 v34, v34, v110
    v_add_f32 v35, v35, v128
    v_add_f32 v34, v34, v111
    v_add_f32 v35, v35, v129
    v_add_f32 v34, v34, v112
    v_add_f32 v35, v35, v130
    v_add_f32 v34, v34, v113
    v_add_f32 v35, v35, v131
    v_rcp_f32 v34, v34
    v_rcp_f32 v35, v35
    s_nop 0
    v_mul_f32 v96, v34, v96
    v_mul_f32 v114, v35, v114
    v_mul_f32 v97, v34, v97
    v_mul_f32 v115, v35, v115
    v_mul_f32 v98, v34, v98
    v_mul_f32 v116, v35, v116
    v_mul_f32 v99, v34, v99
    v_mul_f32 v117, v35, v117
    v_mul_f32 v100, v34, v100
    v_mul_f32 v118, v35, v118
    v_mul_f32 v101, v34, v101
    v_mul_f32 v119, v35, v119
    v_mul_f32 v102, v34, v102
    v_mul_f32 v120, v35, v120
    v_mul_f32 v103, v34, v103
    v_mul_f32 v121, v35, v121
    v_mul_f32 v104, v34, v104
    v_mul_f32 v122, v35, v122
    v_mul_f32 v105, v34, v105
    v_mul_f32 v123, v35, v123
    v_mul_f32 v106, v34, v106
    v_mul_f32 v124, v35, v124
    v_mul_f32 v107, v34, v107
    v_mul_f32 v125, v35, v125
    v_mul_f32 v108, v34, v108
    v_mul_f32 v126, v35, v126
    v_mul_f32 v109, v34, v109
    v_mul_f32 v127, v35, v127
    v_mul_f32 v110, v34, v110
    v_mul_f32 v128, v35, v128
    v_mul_f32 v111, v34, v111
    v_mul_f32 v129, v35, v129
    v_mul_f32 v112, v34, v112
    v_mul_f32 v130, v35, v130
    v_mul_f32 v113, v34, v113
    v_mul_f32 v131, v35, v131
    v_cvt_pk_bf16_f32 v40, v96, v97
    v_cvt_pk_bf16_f32 v41, v98, v99
    v_cvt_pk_bf16_f32 v42, v100, v101
    v_cvt_pk_bf16_f32 v43, v102, v103
    v_cvt_pk_bf16_f32 v44, v104, v105
    v_cvt_pk_bf16_f32 v45, v106, v107
    v_cvt_pk_bf16_f32 v46, v108, v109
    v_cvt_pk_bf16_f32 v47, v110, v111
    v_cvt_pk_bf16_f32 v48, v112, v113
    v_cvt_pk_bf16_f32 v49, v114, v115
    v_cvt_pk_bf16_f32 v50, v116, v117
    v_cvt_pk_bf16_f32 v51, v118, v119
    v_cvt_pk_bf16_f32 v52, v120, v121
    v_cvt_pk_bf16_f32 v53, v122, v123
    v_cvt_pk_bf16_f32 v54, v124, v125
    v_cvt_pk_bf16_f32 v55, v126, v127
    v_cvt_pk_bf16_f32 v56, v128, v129
    v_cvt_pk_bf16_f32 v57, v130, v131
    v_mov_b32 v58, 0
    v_mov_b32 v59, 0
    s_cmp_eq_u32 s45, 1
    s_cbranch_scc1 kf_sbc
    s_branch kf_sec
kf_sbc:
    s_add_u32 s50, s55, 16384
    buffer_store_dwordx4 v[228:231], v4, s[20:23], s50 offen offset:1024 sc1
    s_add_u32 s50, s55, 16384
    buffer_store_dwordx4 v[224:227], v4, s[20:23], s50 offen offset:0 sc1
kf_sec:
    s_cmp_eq_u32 s45, 1
    s_cbranch_scc1 kf_phik
    s_lshl_b32 s32, s7, 2
    s_add_u32 s32, s32, s3
    s_lshl_b32 s32, s32, 4
    s_add_u32 s32, s32, s6
    s_mul_i32 s32, s32, 5120
    s_add_u32 s32, s32, 56623104
    s_add_u32 s33, s32, 4096
    buffer_store_dwordx4 v[40:43], v4, s[20:23], s32 offen offset:0 sc1
    buffer_store_dwordx4 v[44:47], v4, s[20:23], s32 offen offset:1024 sc1
    buffer_store_dwordx4 v[48:51], v4, s[20:23], s32 offen offset:2048 sc1
    buffer_store_dwordx4 v[52:55], v4, s[20:23], s32 offen offset:3072 sc1
    buffer_store_dwordx4 v[56:59], v4, s[20:23], s33 offen sc1
    v_lshrrev_b32 v5, 2, v2
    v_lshl_add_u32 v5, v81, 3, v5
    v_and_b32 v6, 1, v3
    v_lshlrev_b32 v6, 5, v6
    v_and_b32 v7, 3, v2
    v_lshl_add_u32 v6, v7, 3, v6
    v_mul_u32_u24 v7, 272, v5
    v_add_u32 v7, v7, v6
    s_mul_i32 s32, s46, 80
    s_lshl_b32 s33, s47, 6
    s_add_u32 s32, s32, s33
    s_add_u32 s32, s32, 114688
    v_add_u32 v7, s32, v7
    v_mul_u32_u24 v8, 272, v5
    v_add_u32 v8, v8, v6
    s_mul_i32 s32, s46, 40
    s_add_u32 s32, s32, 114840
    s_add_u32 s32, s32, s44
    v_add_u32 v8, s32, v8
    ds_read_b64_tr_b16 v[128:129], v8 offset:0
    ds_read_b64_tr_b16 v[130:131], v8 offset:1088
    ds_read_b64_tr_b16 v[132:133], v8 offset:4352
    ds_read_b64_tr_b16 v[134:135], v8 offset:5440
    ds_read_b64_tr_b16 v[136:137], v8 offset:8704
    ds_read_b64_tr_b16 v[138:139], v8 offset:9792
    ds_read_b64_tr_b16 v[140:141], v8 offset:13056
    ds_read_b64_tr_b16 v[142:143], v8 offset:14144
    ds_read_b64_tr_b16 v[144:145], v8 offset:17408
    ds_read_b64_tr_b16 v[146:147], v8 offset:18496
    ds_read_b64_tr_b16 v[148:149], v8 offset:21760
    ds_read_b64_tr_b16 v[150:151], v8 offset:22848
    ds_read_b64_tr_b16 v[152:153], v8 offset:26112
    ds_read_b64_tr_b16 v[154:155], v8 offset:27200
    ds_read_b64_tr_b16 v[156:157], v8 offset:30464
    ds_read_b64_tr_b16 v[158:159], v8 offset:31552
    s_branch kf_s3
kf_phik:
    v_mov_b32 v59, 0x3f800000
    v_mul_u32_u24 v6, 272, v5
    v_mul_u32_u24 v7, 80, v81
    v_add_u32 v6, v6, v7
    v_add_u32 v6, 114688, v6
    ds_write_b128 v6, v[40:43] offset:0
    ds_write_b128 v6, v[44:47] offset:16
    ds_write_b128 v6, v[48:51] offset:32
    ds_write_b128 v6, v[52:55] offset:48
    ds_write_b128 v6, v[56:59] offset:64
kf_s3:
    s_waitcnt lgkmcnt(0)
    s_barrier
    s_cmp_eq_u32 s45, 1
    s_cbranch_scc1 kf_bk
    ds_read_b64_tr_b16 v[96:97], v7 offset:0
    ds_read_b64_tr_b16 v[98:99], v7 offset:1088
    ds_read_b64_tr_b16 v[100:101], v7 offset:4352
    ds_read_b64_tr_b16 v[102:103], v7 offset:5440
    ds_read_b64_tr_b16 v[104:105], v7 offset:8704
    ds_read_b64_tr_b16 v[106:107], v7 offset:9792
    ds_read_b64_tr_b16 v[108:109], v7 offset:13056
    ds_read_b64_tr_b16 v[110:111], v7 offset:14144
    ds_read_b64_tr_b16 v[112:113], v7 offset:17408
    ds_read_b64_tr_b16 v[114:115], v7 offset:18496
    ds_read_b64_tr_b16 v[116:117], v7 offset:21760
    ds_read_b64_tr_b16 v[118:119], v7 offset:22848
    ds_read_b64_tr_b16 v[120:121], v7 offset:26112
    ds_read_b64_tr_b16 v[122:123], v7 offset:27200
    ds_read_b64_tr_b16 v[124:125], v7 offset:30464
    ds_read_b64_tr_b16 v[126:127], v7 offset:31552
    s_lshl_b32 s32, s46, 1
    s_sub_u32 s32, 4, s32
    v_subrev_u32 v5, s32, v80
    v_cmp_eq_u32 vcc, -1, v5
    v_mov_b32 v6, 18
    s_nop 0
    v_cndmask_b32 v5, v5, v6, vcc
    v_mul_u32_u24 v6, 320, v81
    v_lshl_add_u32 v5, v5, 2, v6
    s_lshl_b32 s32, s7, 5
    s_lshl_b32 s33, s6, 1
    s_add_u32 s32, s32, s33
    s_add_u32 s32, s32, s46
    s_mul_i32 s32, s32, 36
    s_lshl_b32 s33, s47, 5
    s_add_u32 s32, s32, s33
    s_mul_i32 s32, s32, 80
    s_add_u32 s32, s32, 62914560
    s_lshr_b32 s48, 4194296, s46
    s_cmp_eq_u32 s47, 0
    s_cselect_b32 s49, s48, 0
    s_waitcnt lgkmcnt(0)
    v_mfma_f32_32x32x16_bf16 v[160:175], v[96:99], v[128:131], 0
    v_mfma_f32_32x32x16_bf16 v[160:175], v[100:103], v[132:135], v[160:175]
    v_mfma_f32_32x32x16_bf16 v[160:175], v[104:107], v[136:139], v[160:175]
    v_mfma_f32_32x32x16_bf16 v[160:175], v[108:111], v[140:143], v[160:175]
    v_mfma_f32_32x32x16_bf16 v[160:175], v[112:115], v[144:147], v[160:175]
    v_mfma_f32_32x32x16_bf16 v[160:175], v[116:119], v[148:151], v[160:175]
    v_mfma_f32_32x32x16_bf16 v[160:175], v[120:123], v[152:155], v[160:175]
    v_mfma_f32_32x32x16_bf16 v[160:175], v[124:127], v[156:159], v[160:175]
    s_nop 15
    s_mov_b64 exec, s[48:49]
    buffer_store_dword v160, v5, s[20:23], s32 offen offset:0 sc1
    buffer_store_dword v161, v5, s[20:23], s32 offen offset:80 sc1
    buffer_store_dword v162, v5, s[20:23], s32 offen offset:160 sc1
    buffer_store_dword v163, v5, s[20:23], s32 offen offset:240 sc1
    s_cmp_eq_u32 s47, 1
    s_cbranch_scc1 kf_s3done
    buffer_store_dword v164, v5, s[20:23], s32 offen offset:640 sc1
    buffer_store_dword v165, v5, s[20:23], s32 offen offset:720 sc1
    buffer_store_dword v166, v5, s[20:23], s32 offen offset:800 sc1
    buffer_store_dword v167, v5, s[20:23], s32 offen offset:880 sc1
    buffer_store_dword v168, v5, s[20:23], s32 offen offset:1280 sc1
    buffer_store_dword v169, v5, s[20:23], s32 offen offset:1360 sc1
    buffer_store_dword v170, v5, s[20:23], s32 offen offset:1440 sc1
    buffer_store_dword v171, v5, s[20:23], s32 offen offset:1520 sc1
    buffer_store_dword v172, v5, s[20:23], s32 offen offset:1920 sc1
    buffer_store_dword v173, v5, s[20:23], s32 offen offset:2000 sc1
    buffer_store_dword v174, v5, s[20:23], s32 offen offset:2080 sc1
    buffer_store_dword v175, v5, s[20:23], s32 offen offset:2160 sc1
kf_s3done:
    s_mov_b64 exec, -1
    s_nop 1
    s_branch kf_bdone
kf_bk:
kf_bdone:
    s_lshl_b32 s32, s3, 5
    v_add_u32 v5, s32, v2
    v_lshlrev_b32 v5, 7, v5
    v_lshrrev_b32 v6, 1, v2
    v_or_b32 v7, 0, v3
    v_xor_b32 v6, v6, v7
    v_lshl_add_u32 v236, v6, 4, v5
    s_lshl_b32 s32, s3, 5
    v_add_u32 v5, s32, v2
    v_lshlrev_b32 v5, 7, v5
    v_lshrrev_b32 v6, 1, v2
    v_or_b32 v7, 4, v3
    v_xor_b32 v6, v6, v7
    v_lshl_add_u32 v237, v6, 4, v5
    v_lshrrev_b32 v5, 2, v2
    v_lshl_add_u32 v8, v3, 3, v5
    v_lshlrev_b32 v8, 8, v8
    v_and_b32 v7, 1, v3
    v_lshl_or_b32 v7, v7, 2, v5
    v_and_b32 v5, 3, v2
    v_lshl_add_u32 v8, v5, 3, v8
    v_xor_b32 v5, 0, v7
    v_lshl_add_u32 v238, v5, 5, v8
    v_xor_b32 v5, 1, v7
    v_lshl_add_u32 v239, v5, 5, v8
    v_xor_b32 v5, 2, v7
    v_lshl_add_u32 v240, v5, 5, v8
    v_xor_b32 v5, 3, v7
    v_lshl_add_u32 v241, v5, 5, v8
    v_xor_b32 v5, 4, v7
    v_lshl_add_u32 v242, v5, 5, v8
    v_xor_b32 v5, 5, v7
    v_lshl_add_u32 v243, v5, 5, v8
    v_xor_b32 v5, 6, v7
    v_lshl_add_u32 v244, v5, 5, v8
    v_xor_b32 v5, 7, v7
    v_lshl_add_u32 v245, v5, 5, v8
    v_mov_b64 v[128:129], 0
    v_mov_b64 v[130:131], 0
    v_mov_b64 v[132:133], 0
    v_mov_b64 v[134:135], 0
    v_mov_b64 v[136:137], 0
    v_mov_b64 v[138:139], 0
    v_mov_b64 v[140:141], 0
    v_mov_b64 v[142:143], 0
    v_mov_b64 v[144:145], 0
    v_mov_b64 v[146:147], 0
    v_mov_b64 v[148:149], 0
    v_mov_b64 v[150:151], 0
    v_mov_b64 v[152:153], 0
    v_mov_b64 v[154:155], 0
    v_mov_b64 v[156:157], 0
    v_mov_b64 v[158:159], 0
    v_mov_b64 v[160:161], 0
    v_mov_b64 v[162:163], 0
    v_mov_b64 v[164:165], 0
    v_mov_b64 v[166:167], 0
    v_mov_b64 v[168:169], 0
    v_mov_b64 v[170:171], 0
    v_mov_b64 v[172:173], 0
    v_mov_b64 v[174:175], 0
    v_mov_b64 v[176:177], 0
    v_mov_b64 v[178:179], 0
    v_mov_b64 v[180:181], 0
    v_mov_b64 v[182:183], 0
    v_mov_b64 v[184:185], 0
    v_mov_b64 v[186:187], 0
    v_mov_b64 v[188:189], 0
    v_mov_b64 v[190:191], 0
    v_add_u32 v246, 0, v236
    v_add_u32 v247, 0, v237
    v_add_u32 v248, 98304, v238
    v_add_u32 v249, 98304, v239
    v_add_u32 v250, 98304, v240
    v_add_u32 v251, 98304, v241
    v_add_u32 v252, 98304, v242
    v_add_u32 v253, 98304, v243
    v_add_u32 v254, 98304, v244
    v_add_u32 v255, 98304, v245
    s_cmp_eq_u32 s45, 1
    s_cbranch_scc1 kf_q1
kf_q0:
    s_waitcnt lgkmcnt(0)
    s_barrier
    ds_read_b128 v[32:35], v246 offset:0
    ds_read_b128 v[36:39], v246 offset:2048
    ds_read_b64_tr_b16 v[40:41], v248 offset:0
    ds_read_b64_tr_b16 v[42:43], v248 offset:1024
    ds_read_b64_tr_b16 v[44:45], v249 offset:0
    ds_read_b64_tr_b16 v[46:47], v249 offset:1024
    ds_read_b64_tr_b16 v[48:49], v250 offset:0
    ds_read_b64_tr_b16 v[50:51], v250 offset:1024
    ds_read_b64_tr_b16 v[52:53], v251 offset:0
    ds_read_b64_tr_b16 v[54:55], v251 offset:1024
    ds_read_b64_tr_b16 v[56:57], v252 offset:0
    ds_read_b64_tr_b16 v[58:59], v252 offset:1024
    ds_read_b64_tr_b16 v[60:61], v253 offset:0
    ds_read_b64_tr_b16 v[62:63], v253 offset:1024
    ds_read_b64_tr_b16 v[64:65], v254 offset:0
    ds_read_b64_tr_b16 v[66:67], v254 offset:1024
    ds_read_b64_tr_b16 v[68:69], v255 offset:0
    ds_read_b64_tr_b16 v[70:71], v255 offset:1024
    s_add_u32 m0, s43, 114688
    s_add_u32 s39, s36, 524288
    buffer_load_dwordx4 v10, s[12:15], s39 offen lds
    s_add_u32 m0, s43, 118784
    s_add_u32 s39, s36, 655360
    buffer_load_dwordx4 v10, s[12:15], s39 offen lds
    s_add_u32 m0, s43, 122880
    s_add_u32 s39, s36, 786432
    buffer_load_dwordx4 v10, s[12:15], s39 offen lds
    s_add_u32 m0, s43, 126976
    s_add_u32 s39, s36, 917504
    buffer_load_dwordx4 v10, s[12:15], s39 offen lds
    s_waitcnt lgkmcnt(0)
    v_mfma_f32_16x16x32_bf16 v[128:131], v[40:43], v[32:35], v[128:131]
    ds_read_b128 v[72:75], v247 offset:0
    ds_read_b128 v[76:79], v247 offset:2048
    v_mfma_f32_16x16x32_bf16 v[160:163], v[40:43], v[36:39], v[160:163]
    ds_read_b64_tr_b16 v[80:81], v248 offset:8192
    ds_read_b64_tr_b16 v[82:83], v248 offset:9216
    v_mfma_f32_16x16x32_bf16 v[132:135], v[44:47], v[32:35], v[132:135]
    ds_read_b64_tr_b16 v[84:85], v249 offset:8192
    ds_read_b64_tr_b16 v[86:87], v249 offset:9216
    v_mfma_f32_16x16x32_bf16 v[164:167], v[44:47], v[36:39], v[164:167]
    ds_read_b64_tr_b16 v[88:89], v250 offset:8192
    ds_read_b64_tr_b16 v[90:91], v250 offset:9216
    v_mfma_f32_16x16x32_bf16 v[136:139], v[48:51], v[32:35], v[136:139]
    ds_read_b64_tr_b16 v[92:93], v251 offset:8192
    ds_read_b64_tr_b16 v[94:95], v251 offset:9216
    v_mfma_f32_16x16x32_bf16 v[168:171], v[48:51], v[36:39], v[168:171]
    ds_read_b64_tr_b16 v[96:97], v252 offset:8192
    ds_read_b64_tr_b16 v[98:99], v252 offset:9216
    v_mfma_f32_16x16x32_bf16 v[140:143], v[52:55], v[32:35], v[140:143]
    ds_read_b64_tr_b16 v[100:101], v253 offset:8192
    ds_read_b64_tr_b16 v[102:103], v253 offset:9216
    v_mfma_f32_16x16x32_bf16 v[172:175], v[52:55], v[36:39], v[172:175]
    ds_read_b64_tr_b16 v[104:105], v254 offset:8192
    ds_read_b64_tr_b16 v[106:107], v254 offset:9216
    v_mfma_f32_16x16x32_bf16 v[144:147], v[56:59], v[32:35], v[144:147]
    ds_read_b64_tr_b16 v[108:109], v255 offset:8192
    ds_read_b64_tr_b16 v[110:111], v255 offset:9216
    s_add_u32 m0, s43, 131072
    s_add_u32 s39, s36, 1048576
    buffer_load_dwordx4 v10, s[12:15], s39 offen lds
    v_mfma_f32_16x16x32_bf16 v[176:179], v[56:59], v[36:39], v[176:179]
    v_mfma_f32_16x16x32_bf16 v[148:151], v[60:63], v[32:35], v[148:151]
    s_add_u32 m0, s43, 135168
    s_add_u32 s39, s36, 1179648
    buffer_load_dwordx4 v10, s[12:15], s39 offen lds
    v_mfma_f32_16x16x32_bf16 v[180:183], v[60:63], v[36:39], v[180:183]
    v_add_u32 v246, 32768, v236
    v_add_u32 v247, 32768, v237
    v_mfma_f32_16x16x32_bf16 v[152:155], v[64:67], v[32:35], v[152:155]
    s_add_u32 m0, s43, 139264
    s_add_u32 s39, s36, 1310720
    buffer_load_dwordx4 v10, s[12:15], s39 offen lds
    v_add_u32 v248, 114688, v238
    v_add_u32 v249, 114688, v239
    v_mfma_f32_16x16x32_bf16 v[184:187], v[64:67], v[36:39], v[184:187]
    v_add_u32 v250, 114688, v240
    v_add_u32 v251, 114688, v241
    v_mfma_f32_16x16x32_bf16 v[156:159], v[68:71], v[32:35], v[156:159]
    s_add_u32 m0, s43, 143360
    s_add_u32 s39, s36, 1441792
    buffer_load_dwordx4 v10, s[12:15], s39 offen lds
    v_add_u32 v252, 114688, v242
    v_add_u32 v253, 114688, v243
    v_mfma_f32_16x16x32_bf16 v[188:191], v[68:71], v[36:39], v[188:191]
    v_add_u32 v254, 114688, v244
    v_add_u32 v255, 114688, v245
    s_waitcnt vmcnt(4) lgkmcnt(0)
    s_barrier
    v_mfma_f32_16x16x32_bf16 v[128:131], v[80:83], v[72:75], v[128:131]
    ds_read_b128 v[32:35], v246 offset:0
    ds_read_b128 v[36:39], v246 offset:2048
    v_mfma_f32_16x16x32_bf16 v[160:163], v[80:83], v[76:79], v[160:163]
    ds_read_b64_tr_b16 v[40:41], v248 offset:0
    ds_read_b64_tr_b16 v[42:43], v248 offset:1024
    v_mfma_f32_16x16x32_bf16 v[132:135], v[84:87], v[72:75], v[132:135]
    ds_read_b64_tr_b16 v[44:45], v249 offset:0
    ds_read_b64_tr_b16 v[46:47], v249 offset:1024
    v_mfma_f32_16x16x32_bf16 v[164:167], v[84:87], v[76:79], v[164:167]
    ds_read_b64_tr_b16 v[48:49], v250 offset:0
    ds_read_b64_tr_b16 v[50:51], v250 offset:1024
    v_mfma_f32_16x16x32_bf16 v[136:139], v[88:91], v[72:75], v[136:139]
    ds_read_b64_tr_b16 v[52:53], v251 offset:0
    ds_read_b64_tr_b16 v[54:55], v251 offset:1024
    v_mfma_f32_16x16x32_bf16 v[168:171], v[88:91], v[76:79], v[168:171]
    ds_read_b64_tr_b16 v[56:57], v252 offset:0
    ds_read_b64_tr_b16 v[58:59], v252 offset:1024
    v_mfma_f32_16x16x32_bf16 v[140:143], v[92:95], v[72:75], v[140:143]
    ds_read_b64_tr_b16 v[60:61], v253 offset:0
    ds_read_b64_tr_b16 v[62:63], v253 offset:1024
    v_mfma_f32_16x16x32_bf16 v[172:175], v[92:95], v[76:79], v[172:175]
    ds_read_b64_tr_b16 v[64:65], v254 offset:0
    ds_read_b64_tr_b16 v[66:67], v254 offset:1024
    v_mfma_f32_16x16x32_bf16 v[144:147], v[96:99], v[72:75], v[144:147]
    ds_read_b64_tr_b16 v[68:69], v255 offset:0
    ds_read_b64_tr_b16 v[70:71], v255 offset:1024
    s_add_u32 m0, s43, 147456
    s_add_u32 s39, s36, 1572864
    buffer_load_dwordx4 v10, s[12:15], s39 offen lds
    v_mfma_f32_16x16x32_bf16 v[176:179], v[96:99], v[76:79], v[176:179]
    s_add_u32 m0, s43, 151552
    s_add_u32 s39, s36, 1703936
    buffer_load_dwordx4 v10, s[12:15], s39 offen lds
    v_mfma_f32_16x16x32_bf16 v[148:151], v[100:103], v[72:75], v[148:151]
    s_add_u32 m0, s43, 155648
    s_add_u32 s39, s36, 1835008
    buffer_load_dwordx4 v10, s[12:15], s39 offen lds
    v_mfma_f32_16x16x32_bf16 v[180:183], v[100:103], v[76:79], v[180:183]
    s_add_u32 m0, s43, 159744
    s_add_u32 s39, s36, 1966080
    buffer_load_dwordx4 v10, s[12:15], s39 offen lds
    v_mfma_f32_16x16x32_bf16 v[152:155], v[104:107], v[72:75], v[152:155]
    s_add_u32 m0, s43, 98304
    s_add_u32 s39, s36, 2097152
    buffer_load_dwordx4 v10, s[12:15], s39 offen lds
    v_mfma_f32_16x16x32_bf16 v[184:187], v[104:107], v[76:79], v[184:187]
    s_add_u32 m0, s43, 102400
    s_add_u32 s39, s36, 2228224
    buffer_load_dwordx4 v10, s[12:15], s39 offen lds
    v_mfma_f32_16x16x32_bf16 v[156:159], v[108:111], v[72:75], v[156:159]
    s_add_u32 m0, s43, 106496
    s_add_u32 s39, s36, 2359296
    buffer_load_dwordx4 v10, s[12:15], s39 offen lds
    v_mfma_f32_16x16x32_bf16 v[188:191], v[108:111], v[76:79], v[188:191]
    s_add_u32 m0, s43, 110592
    s_add_u32 s39, s36, 2490368
    buffer_load_dwordx4 v10, s[12:15], s39 offen lds
    s_waitcnt lgkmcnt(0)
    v_mfma_f32_16x16x32_bf16 v[128:131], v[40:43], v[32:35], v[128:131]
    ds_read_b128 v[72:75], v247 offset:0
    ds_read_b128 v[76:79], v247 offset:2048
    v_mfma_f32_16x16x32_bf16 v[160:163], v[40:43], v[36:39], v[160:163]
    ds_read_b64_tr_b16 v[80:81], v248 offset:8192
    ds_read_b64_tr_b16 v[82:83], v248 offset:9216
    v_mfma_f32_16x16x32_bf16 v[132:135], v[44:47], v[32:35], v[132:135]
    ds_read_b64_tr_b16 v[84:85], v249 offset:8192
    ds_read_b64_tr_b16 v[86:87], v249 offset:9216
    v_mfma_f32_16x16x32_bf16 v[164:167], v[44:47], v[36:39], v[164:167]
    ds_read_b64_tr_b16 v[88:89], v250 offset:8192
    ds_read_b64_tr_b16 v[90:91], v250 offset:9216
    v_mfma_f32_16x16x32_bf16 v[136:139], v[48:51], v[32:35], v[136:139]
    ds_read_b64_tr_b16 v[92:93], v251 offset:8192
    ds_read_b64_tr_b16 v[94:95], v251 offset:9216
    v_mfma_f32_16x16x32_bf16 v[168:171], v[48:51], v[36:39], v[168:171]
    ds_read_b64_tr_b16 v[96:97], v252 offset:8192
    ds_read_b64_tr_b16 v[98:99], v252 offset:9216
    v_mfma_f32_16x16x32_bf16 v[140:143], v[52:55], v[32:35], v[140:143]
    ds_read_b64_tr_b16 v[100:101], v253 offset:8192
    ds_read_b64_tr_b16 v[102:103], v253 offset:9216
    v_mfma_f32_16x16x32_bf16 v[172:175], v[52:55], v[36:39], v[172:175]
    ds_read_b64_tr_b16 v[104:105], v254 offset:8192
    ds_read_b64_tr_b16 v[106:107], v254 offset:9216
    v_mfma_f32_16x16x32_bf16 v[144:147], v[56:59], v[32:35], v[144:147]
    ds_read_b64_tr_b16 v[108:109], v255 offset:8192
    ds_read_b64_tr_b16 v[110:111], v255 offset:9216
    s_add_u32 m0, s92, 0
    s_add_u32 s39, s90, 384
    buffer_load_dwordx4 v11, s[8:11], s39 offen lds
    v_mfma_f32_16x16x32_bf16 v[176:179], v[56:59], v[36:39], v[176:179]
    s_add_u32 m0, s92, 1024
    s_add_u32 s39, s90, 384
    buffer_load_dwordx4 v24, s[8:11], s39 offen lds
    v_mfma_f32_16x16x32_bf16 v[148:151], v[60:63], v[32:35], v[148:151]
    s_add_u32 m0, s92, 2048
    s_add_u32 s39, s90, 18816
    buffer_load_dwordx4 v11, s[8:11], s39 offen lds
    v_mfma_f32_16x16x32_bf16 v[180:183], v[60:63], v[36:39], v[180:183]
    s_add_u32 m0, s92, 3072
    s_add_u32 s39, s90, 18816
    buffer_load_dwordx4 v24, s[8:11], s39 offen lds
    v_add_u32 v246, 65536, v236
    v_add_u32 v247, 65536, v237
    v_mfma_f32_16x16x32_bf16 v[152:155], v[64:67], v[32:35], v[152:155]
    s_add_u32 m0, s92, 16384
    s_add_u32 s39, s91, 384
    buffer_load_dwordx4 v11, s[8:11], s39 offen lds
    v_add_u32 v248, 131072, v238
    v_add_u32 v249, 131072, v239
    v_mfma_f32_16x16x32_bf16 v[184:187], v[64:67], v[36:39], v[184:187]
    s_add_u32 m0, s92, 17408
    s_add_u32 s39, s91, 384
    buffer_load_dwordx4 v24, s[8:11], s39 offen lds
    v_add_u32 v250, 131072, v240
    v_add_u32 v251, 131072, v241
    v_mfma_f32_16x16x32_bf16 v[156:159], v[68:71], v[32:35], v[156:159]
    s_add_u32 m0, s92, 18432
    s_add_u32 s39, s91, 18816
    buffer_load_dwordx4 v11, s[8:11], s39 offen lds
    v_add_u32 v252, 131072, v242
    v_add_u32 v253, 131072, v243
    v_mfma_f32_16x16x32_bf16 v[188:191], v[68:71], v[36:39], v[188:191]
    s_add_u32 m0, s92, 19456
    s_add_u32 s39, s91, 18816
    buffer_load_dwordx4 v24, s[8:11], s39 offen lds
    v_add_u32 v254, 131072, v244
    v_add_u32 v255, 131072, v245
    s_waitcnt vmcnt(16) lgkmcnt(0)
    s_barrier
    v_mfma_f32_16x16x32_bf16 v[128:131], v[80:83], v[72:75], v[128:131]
    ds_read_b128 v[32:35], v246 offset:0
    ds_read_b128 v[36:39], v246 offset:2048
    v_mfma_f32_16x16x32_bf16 v[160:163], v[80:83], v[76:79], v[160:163]
    ds_read_b64_tr_b16 v[40:41], v248 offset:0
    ds_read_b64_tr_b16 v[42:43], v248 offset:1024
    v_mfma_f32_16x16x32_bf16 v[132:135], v[84:87], v[72:75], v[132:135]
    ds_read_b64_tr_b16 v[44:45], v249 offset:0
    ds_read_b64_tr_b16 v[46:47], v249 offset:1024
    v_mfma_f32_16x16x32_bf16 v[164:167], v[84:87], v[76:79], v[164:167]
    ds_read_b64_tr_b16 v[48:49], v250 offset:0
    ds_read_b64_tr_b16 v[50:51], v250 offset:1024
    v_mfma_f32_16x16x32_bf16 v[136:139], v[88:91], v[72:75], v[136:139]
    ds_read_b64_tr_b16 v[52:53], v251 offset:0
    ds_read_b64_tr_b16 v[54:55], v251 offset:1024
    v_mfma_f32_16x16x32_bf16 v[168:171], v[88:91], v[76:79], v[168:171]
    ds_read_b64_tr_b16 v[56:57], v252 offset:0
    ds_read_b64_tr_b16 v[58:59], v252 offset:1024
    v_mfma_f32_16x16x32_bf16 v[140:143], v[92:95], v[72:75], v[140:143]
    ds_read_b64_tr_b16 v[60:61], v253 offset:0
    ds_read_b64_tr_b16 v[62:63], v253 offset:1024
    v_mfma_f32_16x16x32_bf16 v[172:175], v[92:95], v[76:79], v[172:175]
    ds_read_b64_tr_b16 v[64:65], v254 offset:0
    ds_read_b64_tr_b16 v[66:67], v254 offset:1024
    v_mfma_f32_16x16x32_bf16 v[144:147], v[96:99], v[72:75], v[144:147]
    ds_read_b64_tr_b16 v[68:69], v255 offset:0
    ds_read_b64_tr_b16 v[70:71], v255 offset:1024
    s_add_u32 m0, s43, 114688
    s_add_u32 s39, s36, 2621440
    buffer_load_dwordx4 v10, s[12:15], s39 offen lds
    v_mfma_f32_16x16x32_bf16 v[176:179], v[96:99], v[76:79], v[176:179]
    s_add_u32 m0, s43, 118784
    s_add_u32 s39, s36, 2752512
    buffer_load_dwordx4 v10, s[12:15], s39 offen lds
    v_mfma_f32_16x16x32_bf16 v[148:151], v[100:103], v[72:75], v[148:151]
    s_add_u32 m0, s43, 122880
    s_add_u32 s39, s36, 2883584
    buffer_load_dwordx4 v10, s[12:15], s39 offen lds
    v_mfma_f32_16x16x32_bf16 v[180:183], v[100:103], v[76:79], v[180:183]
    v_mfma_f32_16x16x32_bf16 v[152:155], v[104:107], v[72:75], v[152:155]
    s_add_u32 m0, s43, 126976
    s_add_u32 s39, s36, 3014656
    buffer_load_dwordx4 v10, s[12:15], s39 offen lds
    v_mfma_f32_16x16x32_bf16 v[184:187], v[104:107], v[76:79], v[184:187]
    s_add_u32 m0, s92, 32768
    s_add_u32 s39, s90, 512
    buffer_load_dwordx4 v11, s[8:11], s39 offen lds
    v_mfma_f32_16x16x32_bf16 v[156:159], v[108:111], v[72:75], v[156:159]
    s_add_u32 m0, s92, 33792
    s_add_u32 s39, s90, 512
    buffer_load_dwordx4 v24, s[8:11], s39 offen lds
    v_mfma_f32_16x16x32_bf16 v[188:191], v[108:111], v[76:79], v[188:191]
    s_waitcnt lgkmcnt(0)
    v_mfma_f32_16x16x32_bf16 v[128:131], v[40:43], v[32:35], v[128:131]
    ds_read_b128 v[72:75], v247 offset:0
    ds_read_b128 v[76:79], v247 offset:2048
    v_mfma_f32_16x16x32_bf16 v[160:163], v[40:43], v[36:39], v[160:163]
    ds_read_b64_tr_b16 v[80:81], v248 offset:8192
    ds_read_b64_tr_b16 v[82:83], v248 offset:9216
    v_mfma_f32_16x16x32_bf16 v[132:135], v[44:47], v[32:35], v[132:135]
    ds_read_b64_tr_b16 v[84:85], v249 offset:8192
    ds_read_b64_tr_b16 v[86:87], v249 offset:9216
    v_mfma_f32_16x16x32_bf16 v[164:167], v[44:47], v[36:39], v[164:167]
    ds_read_b64_tr_b16 v[88:89], v250 offset:8192
    ds_read_b64_tr_b16 v[90:91], v250 offset:9216
    v_mfma_f32_16x16x32_bf16 v[136:139], v[48:51], v[32:35], v[136:139]
    ds_read_b64_tr_b16 v[92:93], v251 offset:8192
    ds_read_b64_tr_b16 v[94:95], v251 offset:9216
    v_mfma_f32_16x16x32_bf16 v[168:171], v[48:51], v[36:39], v[168:171]
    ds_read_b64_tr_b16 v[96:97], v252 offset:8192
    ds_read_b64_tr_b16 v[98:99], v252 offset:9216
    v_mfma_f32_16x16x32_bf16 v[140:143], v[52:55], v[32:35], v[140:143]
    ds_read_b64_tr_b16 v[100:101], v253 offset:8192
    ds_read_b64_tr_b16 v[102:103], v253 offset:9216
    v_mfma_f32_16x16x32_bf16 v[172:175], v[52:55], v[36:39], v[172:175]
    ds_read_b64_tr_b16 v[104:105], v254 offset:8192
    ds_read_b64_tr_b16 v[106:107], v254 offset:9216
    v_mfma_f32_16x16x32_bf16 v[144:147], v[56:59], v[32:35], v[144:147]
    ds_read_b64_tr_b16 v[108:109], v255 offset:8192
    ds_read_b64_tr_b16 v[110:111], v255 offset:9216
    s_add_u32 m0, s92, 34816
    s_add_u32 s39, s90, 18944
    buffer_load_dwordx4 v11, s[8:11], s39 offen lds
    v_mfma_f32_16x16x32_bf16 v[176:179], v[56:59], v[36:39], v[176:179]
    s_add_u32 m0, s92, 35840
    s_add_u32 s39, s90, 18944
    buffer_load_dwordx4 v24, s[8:11], s39 offen lds
    v_mfma_f32_16x16x32_bf16 v[148:151], v[60:63], v[32:35], v[148:151]
    s_add_u32 m0, s92, 49152
    s_add_u32 s39, s91, 512
    buffer_load_dwordx4 v11, s[8:11], s39 offen lds
    v_mfma_f32_16x16x32_bf16 v[180:183], v[60:63], v[36:39], v[180:183]
    v_add_u32 v246, 0, v236
    v_add_u32 v247, 0, v237
    v_mfma_f32_16x16x32_bf16 v[152:155], v[64:67], v[32:35], v[152:155]
    s_add_u32 m0, s92, 50176
    s_add_u32 s39, s91, 512
    buffer_load_dwordx4 v24, s[8:11], s39 offen lds
    v_add_u32 v248, 147456, v238
    v_add_u32 v249, 147456, v239
    v_mfma_f32_16x16x32_bf16 v[184:187], v[64:67], v[36:39], v[184:187]
    s_add_u32 m0, s92, 51200
    s_add_u32 s39, s91, 18944
    buffer_load_dwordx4 v11, s[8:11], s39 offen lds
    v_add_u32 v250, 147456, v240
    v_add_u32 v251, 147456, v241
    v_mfma_f32_16x16x32_bf16 v[156:159], v[68:71], v[32:35], v[156:159]
    s_add_u32 m0, s92, 52224
    s_add_u32 s39, s91, 18944
    buffer_load_dwordx4 v24, s[8:11], s39 offen lds
    v_add_u32 v252, 147456, v242
    v_add_u32 v253, 147456, v243
    v_mfma_f32_16x16x32_bf16 v[188:191], v[68:71], v[36:39], v[188:191]
    v_add_u32 v254, 147456, v244
    v_add_u32 v255, 147456, v245
    s_waitcnt vmcnt(12) lgkmcnt(0)
    s_barrier
    v_mfma_f32_16x16x32_bf16 v[128:131], v[80:83], v[72:75], v[128:131]
    ds_read_b128 v[32:35], v246 offset:0
    ds_read_b128 v[36:39], v246 offset:2048
    v_mfma_f32_16x16x32_bf16 v[160:163], v[80:83], v[76:79], v[160:163]
    ds_read_b64_tr_b16 v[40:41], v248 offset:0
    ds_read_b64_tr_b16 v[42:43], v248 offset:1024
    v_mfma_f32_16x16x32_bf16 v[132:135], v[84:87], v[72:75], v[132:135]
    ds_read_b64_tr_b16 v[44:45], v249 offset:0
    ds_read_b64_tr_b16 v[46:47], v249 offset:1024
    v_mfma_f32_16x16x32_bf16 v[164:167], v[84:87], v[76:79], v[164:167]
    ds_read_b64_tr_b16 v[48:49], v250 offset:0
    ds_read_b64_tr_b16 v[50:51], v250 offset:1024
    v_mfma_f32_16x16x32_bf16 v[136:139], v[88:91], v[72:75], v[136:139]
    ds_read_b64_tr_b16 v[52:53], v251 offset:0
    ds_read_b64_tr_b16 v[54:55], v251 offset:1024
    v_mfma_f32_16x16x32_bf16 v[168:171], v[88:91], v[76:79], v[168:171]
    ds_read_b64_tr_b16 v[56:57], v252 offset:0
    ds_read_b64_tr_b16 v[58:59], v252 offset:1024
    v_mfma_f32_16x16x32_bf16 v[140:143], v[92:95], v[72:75], v[140:143]
    ds_read_b64_tr_b16 v[60:61], v253 offset:0
    ds_read_b64_tr_b16 v[62:63], v253 offset:1024
    v_mfma_f32_16x16x32_bf16 v[172:175], v[92:95], v[76:79], v[172:175]
    ds_read_b64_tr_b16 v[64:65], v254 offset:0
    ds_read_b64_tr_b16 v[66:67], v254 offset:1024
    v_mfma_f32_16x16x32_bf16 v[144:147], v[96:99], v[72:75], v[144:147]
    ds_read_b64_tr_b16 v[68:69], v255 offset:0
    ds_read_b64_tr_b16 v[70:71], v255 offset:1024
    s_add_u32 m0, s43, 131072
    s_add_u32 s39, s36, 3145728
    buffer_load_dwordx4 v10, s[12:15], s39 offen lds
    v_mfma_f32_16x16x32_bf16 v[176:179], v[96:99], v[76:79], v[176:179]
    s_add_u32 m0, s43, 135168
    s_add_u32 s39, s36, 3276800
    buffer_load_dwordx4 v10, s[12:15], s39 offen lds
    v_mfma_f32_16x16x32_bf16 v[148:151], v[100:103], v[72:75], v[148:151]
    s_add_u32 m0, s43, 139264
    s_add_u32 s39, s36, 3407872
    buffer_load_dwordx4 v10, s[12:15], s39 offen lds
    v_mfma_f32_16x16x32_bf16 v[180:183], v[100:103], v[76:79], v[180:183]
    v_mfma_f32_16x16x32_bf16 v[152:155], v[104:107], v[72:75], v[152:155]
    s_add_u32 m0, s43, 143360
    s_add_u32 s39, s36, 3538944
    buffer_load_dwordx4 v10, s[12:15], s39 offen lds
    v_mfma_f32_16x16x32_bf16 v[184:187], v[104:107], v[76:79], v[184:187]
    s_add_u32 m0, s92, 65536
    s_add_u32 s39, s90, 640
    buffer_load_dwordx4 v11, s[8:11], s39 offen lds
    v_mfma_f32_16x16x32_bf16 v[156:159], v[108:111], v[72:75], v[156:159]
    s_add_u32 m0, s92, 66560
    s_add_u32 s39, s90, 640
    buffer_load_dwordx4 v24, s[8:11], s39 offen lds
    v_mfma_f32_16x16x32_bf16 v[188:191], v[108:111], v[76:79], v[188:191]
    s_waitcnt lgkmcnt(0)
    v_mfma_f32_16x16x32_bf16 v[128:131], v[40:43], v[32:35], v[128:131]
    ds_read_b128 v[72:75], v247 offset:0
    ds_read_b128 v[76:79], v247 offset:2048
    v_mfma_f32_16x16x32_bf16 v[160:163], v[40:43], v[36:39], v[160:163]
    ds_read_b64_tr_b16 v[80:81], v248 offset:8192
    ds_read_b64_tr_b16 v[82:83], v248 offset:9216
    v_mfma_f32_16x16x32_bf16 v[132:135], v[44:47], v[32:35], v[132:135]
    ds_read_b64_tr_b16 v[84:85], v249 offset:8192
    ds_read_b64_tr_b16 v[86:87], v249 offset:9216
    v_mfma_f32_16x16x32_bf16 v[164:167], v[44:47], v[36:39], v[164:167]
    ds_read_b64_tr_b16 v[88:89], v250 offset:8192
    ds_read_b64_tr_b16 v[90:91], v250 offset:9216
    v_mfma_f32_16x16x32_bf16 v[136:139], v[48:51], v[32:35], v[136:139]
    ds_read_b64_tr_b16 v[92:93], v251 offset:8192
    ds_read_b64_tr_b16 v[94:95], v251 offset:9216
    v_mfma_f32_16x16x32_bf16 v[168:171], v[48:51], v[36:39], v[168:171]
    ds_read_b64_tr_b16 v[96:97], v252 offset:8192
    ds_read_b64_tr_b16 v[98:99], v252 offset:9216
    v_mfma_f32_16x16x32_bf16 v[140:143], v[52:55], v[32:35], v[140:143]
    ds_read_b64_tr_b16 v[100:101], v253 offset:8192
    ds_read_b64_tr_b16 v[102:103], v253 offset:9216
    v_mfma_f32_16x16x32_bf16 v[172:175], v[52:55], v[36:39], v[172:175]
    ds_read_b64_tr_b16 v[104:105], v254 offset:8192
    ds_read_b64_tr_b16 v[106:107], v254 offset:9216
    v_mfma_f32_16x16x32_bf16 v[144:147], v[56:59], v[32:35], v[144:147]
    ds_read_b64_tr_b16 v[108:109], v255 offset:8192
    ds_read_b64_tr_b16 v[110:111], v255 offset:9216
    s_add_u32 m0, s92, 67584
    s_add_u32 s39, s90, 19072
    buffer_load_dwordx4 v11, s[8:11], s39 offen lds
    v_mfma_f32_16x16x32_bf16 v[176:179], v[56:59], v[36:39], v[176:179]
    s_add_u32 m0, s92, 68608
    s_add_u32 s39, s90, 19072
    buffer_load_dwordx4 v24, s[8:11], s39 offen lds
    v_mfma_f32_16x16x32_bf16 v[148:151], v[60:63], v[32:35], v[148:151]
    s_add_u32 m0, s92, 81920
    s_add_u32 s39, s91, 640
    buffer_load_dwordx4 v11, s[8:11], s39 offen lds
    v_mfma_f32_16x16x32_bf16 v[180:183], v[60:63], v[36:39], v[180:183]
    v_add_u32 v246, 32768, v236
    v_add_u32 v247, 32768, v237
    v_mfma_f32_16x16x32_bf16 v[152:155], v[64:67], v[32:35], v[152:155]
    s_add_u32 m0, s92, 82944
    s_add_u32 s39, s91, 640
    buffer_load_dwordx4 v24, s[8:11], s39 offen lds
    v_add_u32 v248, 98304, v238
    v_add_u32 v249, 98304, v239
    v_mfma_f32_16x16x32_bf16 v[184:187], v[64:67], v[36:39], v[184:187]
    s_add_u32 m0, s92, 83968
    s_add_u32 s39, s91, 19072
    buffer_load_dwordx4 v11, s[8:11], s39 offen lds
    v_add_u32 v250, 98304, v240
    v_add_u32 v251, 98304, v241
    v_mfma_f32_16x16x32_bf16 v[156:159], v[68:71], v[32:35], v[156:159]
    s_add_u32 m0, s92, 84992
    s_add_u32 s39, s91, 19072
    buffer_load_dwordx4 v24, s[8:11], s39 offen lds
    v_add_u32 v252, 98304, v242
    v_add_u32 v253, 98304, v243
    v_mfma_f32_16x16x32_bf16 v[188:191], v[68:71], v[36:39], v[188:191]
    v_add_u32 v254, 98304, v244
    v_add_u32 v255, 98304, v245
    s_waitcnt vmcnt(0) lgkmcnt(0)
    s_barrier
    v_mfma_f32_16x16x32_bf16 v[128:131], v[80:83], v[72:75], v[128:131]
    ds_read_b128 v[32:35], v246 offset:0
    ds_read_b128 v[36:39], v246 offset:2048
    v_mfma_f32_16x16x32_bf16 v[160:163], v[80:83], v[76:79], v[160:163]
    ds_read_b64_tr_b16 v[40:41], v248 offset:0
    ds_read_b64_tr_b16 v[42:43], v248 offset:1024
    v_mfma_f32_16x16x32_bf16 v[132:135], v[84:87], v[72:75], v[132:135]
    ds_read_b64_tr_b16 v[44:45], v249 offset:0
    ds_read_b64_tr_b16 v[46:47], v249 offset:1024
    v_mfma_f32_16x16x32_bf16 v[164:167], v[84:87], v[76:79], v[164:167]
    ds_read_b64_tr_b16 v[48:49], v250 offset:0
    ds_read_b64_tr_b16 v[50:51], v250 offset:1024
    v_mfma_f32_16x16x32_bf16 v[136:139], v[88:91], v[72:75], v[136:139]
    ds_read_b64_tr_b16 v[52:53], v251 offset:0
    ds_read_b64_tr_b16 v[54:55], v251 offset:1024
    v_mfma_f32_16x16x32_bf16 v[168:171], v[88:91], v[76:79], v[168:171]
    ds_read_b64_tr_b16 v[56:57], v252 offset:0
    ds_read_b64_tr_b16 v[58:59], v252 offset:1024
    v_mfma_f32_16x16x32_bf16 v[140:143], v[92:95], v[72:75], v[140:143]
    ds_read_b64_tr_b16 v[60:61], v253 offset:0
    ds_read_b64_tr_b16 v[62:63], v253 offset:1024
    v_mfma_f32_16x16x32_bf16 v[172:175], v[92:95], v[76:79], v[172:175]
    ds_read_b64_tr_b16 v[64:65], v254 offset:0
    ds_read_b64_tr_b16 v[66:67], v254 offset:1024
    v_mfma_f32_16x16x32_bf16 v[144:147], v[96:99], v[72:75], v[144:147]
    ds_read_b64_tr_b16 v[68:69], v255 offset:0
    ds_read_b64_tr_b16 v[70:71], v255 offset:1024
    s_add_u32 m0, s43, 147456
    s_add_u32 s39, s36, 3670016
    buffer_load_dwordx4 v10, s[12:15], s39 offen lds
    v_mfma_f32_16x16x32_bf16 v[176:179], v[96:99], v[76:79], v[176:179]
    s_add_u32 m0, s43, 151552
    s_add_u32 s39, s36, 3801088
    buffer_load_dwordx4 v10, s[12:15], s39 offen lds
    v_mfma_f32_16x16x32_bf16 v[148:151], v[100:103], v[72:75], v[148:151]
    s_add_u32 m0, s43, 155648
    s_add_u32 s39, s36, 3932160
    buffer_load_dwordx4 v10, s[12:15], s39 offen lds
    v_mfma_f32_16x16x32_bf16 v[180:183], v[100:103], v[76:79], v[180:183]
    v_mfma_f32_16x16x32_bf16 v[152:155], v[104:107], v[72:75], v[152:155]
    s_add_u32 m0, s43, 159744
    s_add_u32 s39, s36, 4063232
    buffer_load_dwordx4 v10, s[12:15], s39 offen lds
    v_mfma_f32_16x16x32_bf16 v[184:187], v[104:107], v[76:79], v[184:187]
    s_add_u32 m0, s92, 0
    s_add_u32 s39, s90, 768
    buffer_load_dwordx4 v11, s[8:11], s39 offen lds
    v_mfma_f32_16x16x32_bf16 v[156:159], v[108:111], v[72:75], v[156:159]
    s_add_u32 m0, s92, 1024
    s_add_u32 s39, s90, 768
    buffer_load_dwordx4 v24, s[8:11], s39 offen lds
    v_mfma_f32_16x16x32_bf16 v[188:191], v[108:111], v[76:79], v[188:191]
    s_waitcnt lgkmcnt(0)
    v_mfma_f32_16x16x32_bf16 v[128:131], v[40:43], v[32:35], v[128:131]
    ds_read_b128 v[72:75], v247 offset:0
    ds_read_b128 v[76:79], v247 offset:2048
    v_mfma_f32_16x16x32_bf16 v[160:163], v[40:43], v[36:39], v[160:163]
    ds_read_b64_tr_b16 v[80:81], v248 offset:8192
    ds_read_b64_tr_b16 v[82:83], v248 offset:9216
    v_mfma_f32_16x16x32_bf16 v[132:135], v[44:47], v[32:35], v[132:135]
    ds_read_b64_tr_b16 v[84:85], v249 offset:8192
    ds_read_b64_tr_b16 v[86:87], v249 offset:9216
    v_mfma_f32_16x16x32_bf16 v[164:167], v[44:47], v[36:39], v[164:167]
    ds_read_b64_tr_b16 v[88:89], v250 offset:8192
    ds_read_b64_tr_b16 v[90:91], v250 offset:9216
    v_mfma_f32_16x16x32_bf16 v[136:139], v[48:51], v[32:35], v[136:139]
    ds_read_b64_tr_b16 v[92:93], v251 offset:8192
    ds_read_b64_tr_b16 v[94:95], v251 offset:9216
    v_mfma_f32_16x16x32_bf16 v[168:171], v[48:51], v[36:39], v[168:171]
    ds_read_b64_tr_b16 v[96:97], v252 offset:8192
    ds_read_b64_tr_b16 v[98:99], v252 offset:9216
    v_mfma_f32_16x16x32_bf16 v[140:143], v[52:55], v[32:35], v[140:143]
    ds_read_b64_tr_b16 v[100:101], v253 offset:8192
    ds_read_b64_tr_b16 v[102:103], v253 offset:9216
    v_mfma_f32_16x16x32_bf16 v[172:175], v[52:55], v[36:39], v[172:175]
    ds_read_b64_tr_b16 v[104:105], v254 offset:8192
    ds_read_b64_tr_b16 v[106:107], v254 offset:9216
    v_mfma_f32_16x16x32_bf16 v[144:147], v[56:59], v[32:35], v[144:147]
    ds_read_b64_tr_b16 v[108:109], v255 offset:8192
    ds_read_b64_tr_b16 v[110:111], v255 offset:9216
    s_add_u32 m0, s92, 2048
    s_add_u32 s39, s90, 19200
    buffer_load_dwordx4 v11, s[8:11], s39 offen lds
    v_mfma_f32_16x16x32_bf16 v[176:179], v[56:59], v[36:39], v[176:179]
    s_add_u32 m0, s92, 3072
    s_add_u32 s39, s90, 19200
    buffer_load_dwordx4 v24, s[8:11], s39 offen lds
    v_mfma_f32_16x16x32_bf16 v[148:151], v[60:63], v[32:35], v[148:151]
    s_add_u32 m0, s92, 16384
    s_add_u32 s39, s91, 768
    buffer_load_dwordx4 v11, s[8:11], s39 offen lds
    v_mfma_f32_16x16x32_bf16 v[180:183], v[60:63], v[36:39], v[180:183]
    v_add_u32 v246, 65536, v236
    v_add_u32 v247, 65536, v237
    v_mfma_f32_16x16x32_bf16 v[152:155], v[64:67], v[32:35], v[152:155]
    s_add_u32 m0, s92, 17408
    s_add_u32 s39, s91, 768
    buffer_load_dwordx4 v24, s[8:11], s39 offen lds
    v_add_u32 v248, 114688, v238
    v_add_u32 v249, 114688, v239
    v_mfma_f32_16x16x32_bf16 v[184:187], v[64:67], v[36:39], v[184:187]
    s_add_u32 m0, s92, 18432
    s_add_u32 s39, s91, 19200
    buffer_load_dwordx4 v11, s[8:11], s39 offen lds
    v_add_u32 v250, 114688, v240
    v_add_u32 v251, 114688, v241
    v_mfma_f32_16x16x32_bf16 v[156:159], v[68:71], v[32:35], v[156:159]
    s_add_u32 m0, s92, 19456
    s_add_u32 s39, s91, 19200
    buffer_load_dwordx4 v24, s[8:11], s39 offen lds
    v_add_u32 v252, 114688, v242
    v_add_u32 v253, 114688, v243
    v_mfma_f32_16x16x32_bf16 v[188:191], v[68:71], v[36:39], v[188:191]
    v_add_u32 v254, 114688, v244
    v_add_u32 v255, 114688, v245
    s_waitcnt vmcnt(12) lgkmcnt(0)
    s_barrier
    v_mfma_f32_16x16x32_bf16 v[128:131], v[80:83], v[72:75], v[128:131]
    ds_read_b128 v[32:35], v246 offset:0
    ds_read_b128 v[36:39], v246 offset:2048
    v_mfma_f32_16x16x32_bf16 v[160:163], v[80:83], v[76:79], v[160:163]
    ds_read_b64_tr_b16 v[40:41], v248 offset:0
    ds_read_b64_tr_b16 v[42:43], v248 offset:1024
    v_mfma_f32_16x16x32_bf16 v[132:135], v[84:87], v[72:75], v[132:135]
    ds_read_b64_tr_b16 v[44:45], v249 offset:0
    ds_read_b64_tr_b16 v[46:47], v249 offset:1024
    v_mfma_f32_16x16x32_bf16 v[164:167], v[84:87], v[76:79], v[164:167]
    ds_read_b64_tr_b16 v[48:49], v250 offset:0
    ds_read_b64_tr_b16 v[50:51], v250 offset:1024
    v_mfma_f32_16x16x32_bf16 v[136:139], v[88:91], v[72:75], v[136:139]
    ds_read_b64_tr_b16 v[52:53], v251 offset:0
    ds_read_b64_tr_b16 v[54:55], v251 offset:1024
    v_mfma_f32_16x16x32_bf16 v[168:171], v[88:91], v[76:79], v[168:171]
    ds_read_b64_tr_b16 v[56:57], v252 offset:0
    ds_read_b64_tr_b16 v[58:59], v252 offset:1024
    v_mfma_f32_16x16x32_bf16 v[140:143], v[92:95], v[72:75], v[140:143]
    ds_read_b64_tr_b16 v[60:61], v253 offset:0
    ds_read_b64_tr_b16 v[62:63], v253 offset:1024
    v_mfma_f32_16x16x32_bf16 v[172:175], v[92:95], v[76:79], v[172:175]
    ds_read_b64_tr_b16 v[64:65], v254 offset:0
    ds_read_b64_tr_b16 v[66:67], v254 offset:1024
    v_mfma_f32_16x16x32_bf16 v[144:147], v[96:99], v[72:75], v[144:147]
    ds_read_b64_tr_b16 v[68:69], v255 offset:0
    ds_read_b64_tr_b16 v[70:71], v255 offset:1024
    s_add_u32 m0, s43, 98304
    s_add_u32 s39, s36, 4194304
    buffer_load_dwordx4 v10, s[12:15], s39 offen lds
    v_mfma_f32_16x16x32_bf16 v[176:179], v[96:99], v[76:79], v[176:179]
    s_add_u32 m0, s43, 102400
    s_add_u32 s39, s36, 4325376
    buffer_load_dwordx4 v10, s[12:15], s39 offen lds
    v_mfma_f32_16x16x32_bf16 v[148:151], v[100:103], v[72:75], v[148:151]
    s_add_u32 m0, s43, 106496
    s_add_u32 s39, s36, 4456448
    buffer_load_dwordx4 v10, s[12:15], s39 offen lds
    v_mfma_f32_16x16x32_bf16 v[180:183], v[100:103], v[76:79], v[180:183]
    v_mfma_f32_16x16x32_bf16 v[152:155], v[104:107], v[72:75], v[152:155]
    s_add_u32 m0, s43, 110592
    s_add_u32 s39, s36, 4587520
    buffer_load_dwordx4 v10, s[12:15], s39 offen lds
    v_mfma_f32_16x16x32_bf16 v[184:187], v[104:107], v[76:79], v[184:187]
    s_add_u32 m0, s92, 32768
    s_add_u32 s39, s90, 896
    buffer_load_dwordx4 v11, s[8:11], s39 offen lds
    v_mfma_f32_16x16x32_bf16 v[156:159], v[108:111], v[72:75], v[156:159]
    s_add_u32 m0, s92, 33792
    s_add_u32 s39, s90, 896
    buffer_load_dwordx4 v24, s[8:11], s39 offen lds
    v_mfma_f32_16x16x32_bf16 v[188:191], v[108:111], v[76:79], v[188:191]
    s_waitcnt lgkmcnt(0)
    v_mfma_f32_16x16x32_bf16 v[128:131], v[40:43], v[32:35], v[128:131]
    ds_read_b128 v[72:75], v247 offset:0
    ds_read_b128 v[76:79], v247 offset:2048
    v_mfma_f32_16x16x32_bf16 v[160:163], v[40:43], v[36:39], v[160:163]
    ds_read_b64_tr_b16 v[80:81], v248 offset:8192
    ds_read_b64_tr_b16 v[82:83], v248 offset:9216
    v_mfma_f32_16x16x32_bf16 v[132:135], v[44:47], v[32:35], v[132:135]
    ds_read_b64_tr_b16 v[84:85], v249 offset:8192
    ds_read_b64_tr_b16 v[86:87], v249 offset:9216
    v_mfma_f32_16x16x32_bf16 v[164:167], v[44:47], v[36:39], v[164:167]
    ds_read_b64_tr_b16 v[88:89], v250 offset:8192
    ds_read_b64_tr_b16 v[90:91], v250 offset:9216
    v_mfma_f32_16x16x32_bf16 v[136:139], v[48:51], v[32:35], v[136:139]
    ds_read_b64_tr_b16 v[92:93], v251 offset:8192
    ds_read_b64_tr_b16 v[94:95], v251 offset:9216
    v_mfma_f32_16x16x32_bf16 v[168:171], v[48:51], v[36:39], v[168:171]
    ds_read_b64_tr_b16 v[96:97], v252 offset:8192
    ds_read_b64_tr_b16 v[98:99], v252 offset:9216
    v_mfma_f32_16x16x32_bf16 v[140:143], v[52:55], v[32:35], v[140:143]
    ds_read_b64_tr_b16 v[100:101], v253 offset:8192
    ds_read_b64_tr_b16 v[102:103], v253 offset:9216
    v_mfma_f32_16x16x32_bf16 v[172:175], v[52:55], v[36:39], v[172:175]
    ds_read_b64_tr_b16 v[104:105], v254 offset:8192
    ds_read_b64_tr_b16 v[106:107], v254 offset:9216
    v_mfma_f32_16x16x32_bf16 v[144:147], v[56:59], v[32:35], v[144:147]
    ds_read_b64_tr_b16 v[108:109], v255 offset:8192
    ds_read_b64_tr_b16 v[110:111], v255 offset:9216
    s_add_u32 m0, s92, 34816
    s_add_u32 s39, s90, 19328
    buffer_load_dwordx4 v11, s[8:11], s39 offen lds
    v_mfma_f32_16x16x32_bf16 v[176:179], v[56:59], v[36:39], v[176:179]
    s_add_u32 m0, s92, 35840
    s_add_u32 s39, s90, 19328
    buffer_load_dwordx4 v24, s[8:11], s39 offen lds
    v_mfma_f32_16x16x32_bf16 v[148:151], v[60:63], v[32:35], v[148:151]
    s_add_u32 m0, s92, 49152
    s_add_u32 s39, s91, 896
    buffer_load_dwordx4 v11, s[8:11], s39 offen lds
    v_mfma_f32_16x16x32_bf16 v[180:183], v[60:63], v[36:39], v[180:183]
    v_add_u32 v246, 0, v236
    v_add_u32 v247, 0, v237
    v_mfma_f32_16x16x32_bf16 v[152:155], v[64:67], v[32:35], v[152:155]
    s_add_u32 m0, s92, 50176
    s_add_u32 s39, s91, 896
    buffer_load_dwordx4 v24, s[8:11], s39 offen lds
    v_add_u32 v248, 131072, v238
    v_add_u32 v249, 131072, v239
    v_mfma_f32_16x16x32_bf16 v[184:187], v[64:67], v[36:39], v[184:187]
    s_add_u32 m0, s92, 51200
    s_add_u32 s39, s91, 19328
    buffer_load_dwordx4 v11, s[8:11], s39 offen lds
    v_add_u32 v250, 131072, v240
    v_add_u32 v251, 131072, v241
    v_mfma_f32_16x16x32_bf16 v[156:159], v[68:71], v[32:35], v[156:159]
    s_add_u32 m0, s92, 52224
    s_add_u32 s39, s91, 19328
    buffer_load_dwordx4 v24, s[8:11], s39 offen lds
    v_add_u32 v252, 131072, v242
    v_add_u32 v253, 131072, v243
    v_mfma_f32_16x16x32_bf16 v[188:191], v[68:71], v[36:39], v[188:191]
    v_add_u32 v254, 131072, v244
    v_add_u32 v255, 131072, v245
    s_waitcnt vmcnt(12) lgkmcnt(0)
    s_barrier
    v_mfma_f32_16x16x32_bf16 v[128:131], v[80:83], v[72:75], v[128:131]
    ds_read_b128 v[32:35], v246 offset:0
    ds_read_b128 v[36:39], v246 offset:2048
    v_mfma_f32_16x16x32_bf16 v[160:163], v[80:83], v[76:79], v[160:163]
    ds_read_b64_tr_b16 v[40:41], v248 offset:0
    ds_read_b64_tr_b16 v[42:43], v248 offset:1024
    v_mfma_f32_16x16x32_bf16 v[132:135], v[84:87], v[72:75], v[132:135]
    ds_read_b64_tr_b16 v[44:45], v249 offset:0
    ds_read_b64_tr_b16 v[46:47], v249 offset:1024
    v_mfma_f32_16x16x32_bf16 v[164:167], v[84:87], v[76:79], v[164:167]
    ds_read_b64_tr_b16 v[48:49], v250 offset:0
    ds_read_b64_tr_b16 v[50:51], v250 offset:1024
    v_mfma_f32_16x16x32_bf16 v[136:139], v[88:91], v[72:75], v[136:139]
    ds_read_b64_tr_b16 v[52:53], v251 offset:0
    ds_read_b64_tr_b16 v[54:55], v251 offset:1024
    v_mfma_f32_16x16x32_bf16 v[168:171], v[88:91], v[76:79], v[168:171]
    ds_read_b64_tr_b16 v[56:57], v252 offset:0
    ds_read_b64_tr_b16 v[58:59], v252 offset:1024
    v_mfma_f32_16x16x32_bf16 v[140:143], v[92:95], v[72:75], v[140:143]
    ds_read_b64_tr_b16 v[60:61], v253 offset:0
    ds_read_b64_tr_b16 v[62:63], v253 offset:1024
    v_mfma_f32_16x16x32_bf16 v[172:175], v[92:95], v[76:79], v[172:175]
    ds_read_b64_tr_b16 v[64:65], v254 offset:0
    ds_read_b64_tr_b16 v[66:67], v254 offset:1024
    v_mfma_f32_16x16x32_bf16 v[144:147], v[96:99], v[72:75], v[144:147]
    ds_read_b64_tr_b16 v[68:69], v255 offset:0
    ds_read_b64_tr_b16 v[70:71], v255 offset:1024
    s_add_u32 m0, s92, 65536
    s_add_u32 s39, s90, 1024
    buffer_load_dwordx4 v11, s[8:11], s39 offen lds
    v_mfma_f32_16x16x32_bf16 v[176:179], v[96:99], v[76:79], v[176:179]
    v_mfma_f32_16x16x32_bf16 v[148:151], v[100:103], v[72:75], v[148:151]
    s_add_u32 m0, s92, 66560
    s_add_u32 s39, s90, 1024
    buffer_load_dwordx4 v24, s[8:11], s39 offen lds
    v_mfma_f32_16x16x32_bf16 v[180:183], v[100:103], v[76:79], v[180:183]
    v_mfma_f32_16x16x32_bf16 v[152:155], v[104:107], v[72:75], v[152:155]
    s_add_u32 m0, s92, 67584
    s_add_u32 s39, s90, 19456
    buffer_load_dwordx4 v11, s[8:11], s39 offen lds
    v_mfma_f32_16x16x32_bf16 v[184:187], v[104:107], v[76:79], v[184:187]
    v_mfma_f32_16x16x32_bf16 v[156:159], v[108:111], v[72:75], v[156:159]
    s_add_u32 m0, s92, 68608
    s_add_u32 s39, s90, 19456
    buffer_load_dwordx4 v24, s[8:11], s39 offen lds
    v_mfma_f32_16x16x32_bf16 v[188:191], v[108:111], v[76:79], v[188:191]
    s_waitcnt lgkmcnt(0)
    v_mfma_f32_16x16x32_bf16 v[128:131], v[40:43], v[32:35], v[128:131]
    ds_read_b128 v[72:75], v247 offset:0
    ds_read_b128 v[76:79], v247 offset:2048
    v_mfma_f32_16x16x32_bf16 v[160:163], v[40:43], v[36:39], v[160:163]
    ds_read_b64_tr_b16 v[80:81], v248 offset:8192
    ds_read_b64_tr_b16 v[82:83], v248 offset:9216
    v_mfma_f32_16x16x32_bf16 v[132:135], v[44:47], v[32:35], v[132:135]
    ds_read_b64_tr_b16 v[84:85], v249 offset:8192
    ds_read_b64_tr_b16 v[86:87], v249 offset:9216
    v_mfma_f32_16x16x32_bf16 v[164:167], v[44:47], v[36:39], v[164:167]
    ds_read_b64_tr_b16 v[88:89], v250 offset:8192
    ds_read_b64_tr_b16 v[90:91], v250 offset:9216
    v_mfma_f32_16x16x32_bf16 v[136:139], v[48:51], v[32:35], v[136:139]
    ds_read_b64_tr_b16 v[92:93], v251 offset:8192
    ds_read_b64_tr_b16 v[94:95], v251 offset:9216
    v_mfma_f32_16x16x32_bf16 v[168:171], v[48:51], v[36:39], v[168:171]
    ds_read_b64_tr_b16 v[96:97], v252 offset:8192
    ds_read_b64_tr_b16 v[98:99], v252 offset:9216
    v_mfma_f32_16x16x32_bf16 v[140:143], v[52:55], v[32:35], v[140:143]
    ds_read_b64_tr_b16 v[100:101], v253 offset:8192
    ds_read_b64_tr_b16 v[102:103], v253 offset:9216
    v_mfma_f32_16x16x32_bf16 v[172:175], v[52:55], v[36:39], v[172:175]
    ds_read_b64_tr_b16 v[104:105], v254 offset:8192
    ds_read_b64_tr_b16 v[106:107], v254 offset:9216
    v_mfma_f32_16x16x32_bf16 v[144:147], v[56:59], v[32:35], v[144:147]
    ds_read_b64_tr_b16 v[108:109], v255 offset:8192
    ds_read_b64_tr_b16 v[110:111], v255 offset:9216
    s_add_u32 m0, s92, 81920
    s_add_u32 s39, s91, 1024
    buffer_load_dwordx4 v11, s[8:11], s39 offen lds
    v_mfma_f32_16x16x32_bf16 v[176:179], v[56:59], v[36:39], v[176:179]
    v_mfma_f32_16x16x32_bf16 v[148:151], v[60:63], v[32:35], v[148:151]
    s_add_u32 m0, s92, 82944
    s_add_u32 s39, s91, 1024
    buffer_load_dwordx4 v24, s[8:11], s39 offen lds
    v_mfma_f32_16x16x32_bf16 v[180:183], v[60:63], v[36:39], v[180:183]
    v_add_u32 v246, 32768, v236
    v_add_u32 v247, 32768, v237
    v_mfma_f32_16x16x32_bf16 v[152:155], v[64:67], v[32:35], v[152:155]
    s_add_u32 m0, s92, 83968
    s_add_u32 s39, s91, 19456
    buffer_load_dwordx4 v11, s[8:11], s39 offen lds
    v_add_u32 v248, 147456, v238
    v_add_u32 v249, 147456, v239
    v_mfma_f32_16x16x32_bf16 v[184:187], v[64:67], v[36:39], v[184:187]
    v_add_u32 v250, 147456, v240
    v_add_u32 v251, 147456, v241
    v_mfma_f32_16x16x32_bf16 v[156:159], v[68:71], v[32:35], v[156:159]
    s_add_u32 m0, s92, 84992
    s_add_u32 s39, s91, 19456
    buffer_load_dwordx4 v24, s[8:11], s39 offen lds
    v_add_u32 v252, 147456, v242
    v_add_u32 v253, 147456, v243
    v_mfma_f32_16x16x32_bf16 v[188:191], v[68:71], v[36:39], v[188:191]
    v_add_u32 v254, 147456, v244
    v_add_u32 v255, 147456, v245
    s_waitcnt vmcnt(8) lgkmcnt(0)
    s_barrier
    v_add_u32 v15, s60, v4
    v_lshlrev_b32 v5, 2, v3
    v_sub_u32 v16, v2, v5
    v_mov_b32 v17, 0xff800000
    s_mov_b32 s57, 0
    s_mov_b32 s36, 253952
    s_lshl_b32 s32, s5, 2
    s_add_u32 s32, s32, s40
    s_cmp_eq_u32 s45, 0
    s_cselect_b32 s44, s32, 60
    s_add_u32 s46, s44, 1
    s_mov_b32 s42, 0x4e000000
    s_lshl_b32 s32, s40, 6
    s_sub_u32 s32, s59, s32
    s_add_u32 s32, s32, 96
    s_cmp_eq_u32 s45, 0
    s_cselect_b32 s41, s32, s59
    s_mov_b64 s[48:49], 1
    s_bitset1_b64 s[48:49], s44
    s_bitset1_b64 s[48:49], s46
    s_add_u32 s32, s46, 1
    s_bitset1_b64 s[48:49], s32
    s_lshl_b32 s32, s4, 19
    s_lshl_b32 s34, s5, 15
    s_sub_u32 s34, 262144, s34
    s_add_u32 s33, s32, 0
    s_add_u32 s16, s88, s33
    s_addc_u32 s17, s89, 0
    s_and_b32 s17, s17, 0xffff
    s_mov_b32 s18, 262144
    s_mov_b32 s19, 0x20000
    s_add_u32 s33, s32, 16769024
    s_add_u32 s24, s88, s33
    s_addc_u32 s25, s89, 0
    s_and_b32 s25, s25, 0xffff
    s_mov_b32 s26, 270336
    s_mov_b32 s27, 0x20000
    s_add_u32 s33, s32, 262144
    s_add_u32 s28, s88, s33
    s_addc_u32 s29, s89, 0
    s_and_b32 s29, s29, 0xffff
    s_mov_b32 s30, s34
    s_mov_b32 s31, 0x20000
    s_add_u32 s33, s32, 17039360
    s_add_u32 s68, s88, s33
    s_addc_u32 s69, s89, 0
    s_and_b32 s69, s69, 0xffff
    s_mov_b32 s70, s34
    s_mov_b32 s71, 0x20000
    v_mfma_f32_16x16x32_bf16 v[128:131], v[80:83], v[72:75], v[128:131]
    ds_read_b128 v[32:35], v246 offset:0
    ds_read_b128 v[36:39], v246 offset:2048
    v_mfma_f32_16x16x32_bf16 v[160:163], v[80:83], v[76:79], v[160:163]
    ds_read_b64_tr_b16 v[40:41], v248 offset:0
    ds_read_b64_tr_b16 v[42:43], v248 offset:1024
    v_mfma_f32_16x16x32_bf16 v[132:135], v[84:87], v[72:75], v[132:135]
    ds_read_b64_tr_b16 v[44:45], v249 offset:0
    ds_read_b64_tr_b16 v[46:47], v249 offset:1024
    v_mfma_f32_16x16x32_bf16 v[164:167], v[84:87], v[76:79], v[164:167]
    ds_read_b64_tr_b16 v[48:49], v250 offset:0
    ds_read_b64_tr_b16 v[50:51], v250 offset:1024
    v_mfma_f32_16x16x32_bf16 v[136:139], v[88:91], v[72:75], v[136:139]
    ds_read_b64_tr_b16 v[52:53], v251 offset:0
    ds_read_b64_tr_b16 v[54:55], v251 offset:1024
    v_mfma_f32_16x16x32_bf16 v[168:171], v[88:91], v[76:79], v[168:171]
    ds_read_b64_tr_b16 v[56:57], v252 offset:0
    ds_read_b64_tr_b16 v[58:59], v252 offset:1024
    v_mfma_f32_16x16x32_bf16 v[140:143], v[92:95], v[72:75], v[140:143]
    ds_read_b64_tr_b16 v[60:61], v253 offset:0
    ds_read_b64_tr_b16 v[62:63], v253 offset:1024
    v_mfma_f32_16x16x32_bf16 v[172:175], v[92:95], v[76:79], v[172:175]
    ds_read_b64_tr_b16 v[64:65], v254 offset:0
    ds_read_b64_tr_b16 v[66:67], v254 offset:1024
    v_mfma_f32_16x16x32_bf16 v[144:147], v[96:99], v[72:75], v[144:147]
    ds_read_b64_tr_b16 v[68:69], v255 offset:0
    ds_read_b64_tr_b16 v[70:71], v255 offset:1024
    s_add_u32 m0, s60, 0
    s_nop 0
    buffer_load_dwordx4 v15, s[16:19], s57 offen sc1 lds
    s_add_u32 s57, s57, 8192
    v_mfma_f32_16x16x32_bf16 v[176:179], v[96:99], v[76:79], v[176:179]
    v_mfma_f32_16x16x32_bf16 v[148:151], v[100:103], v[72:75], v[148:151]
    s_add_u32 m0, s60, 16384
    s_nop 0
    buffer_load_dwordx4 v15, s[16:19], s57 offen sc1 lds
    v_mfma_f32_16x16x32_bf16 v[180:183], v[100:103], v[76:79], v[180:183]
    v_mfma_f32_16x16x32_bf16 v[152:155], v[104:107], v[72:75], v[152:155]
    v_mfma_f32_16x16x32_bf16 v[184:187], v[104:107], v[76:79], v[184:187]
    s_add_u32 m0, s60, 24576
    s_nop 0
    buffer_load_dwordx4 v15, s[24:27], s57 offen sc1 lds
    s_add_u32 s57, s57, 8192
    v_mfma_f32_16x16x32_bf16 v[156:159], v[108:111], v[72:75], v[156:159]
    v_mfma_f32_16x16x32_bf16 v[188:191], v[108:111], v[76:79], v[188:191]
    s_waitcnt lgkmcnt(0)
    v_mfma_f32_16x16x32_bf16 v[128:131], v[40:43], v[32:35], v[128:131]
    ds_read_b128 v[72:75], v247 offset:0
    ds_read_b128 v[76:79], v247 offset:2048
    v_mfma_f32_16x16x32_bf16 v[160:163], v[40:43], v[36:39], v[160:163]
    ds_read_b64_tr_b16 v[80:81], v248 offset:8192
    ds_read_b64_tr_b16 v[82:83], v248 offset:9216
    v_mfma_f32_16x16x32_bf16 v[132:135], v[44:47], v[32:35], v[132:135]
    ds_read_b64_tr_b16 v[84:85], v249 offset:8192
    ds_read_b64_tr_b16 v[86:87], v249 offset:9216
    v_mfma_f32_16x16x32_bf16 v[164:167], v[44:47], v[36:39], v[164:167]
    ds_read_b64_tr_b16 v[88:89], v250 offset:8192
    ds_read_b64_tr_b16 v[90:91], v250 offset:9216
    v_mfma_f32_16x16x32_bf16 v[136:139], v[48:51], v[32:35], v[136:139]
    ds_read_b64_tr_b16 v[92:93], v251 offset:8192
    ds_read_b64_tr_b16 v[94:95], v251 offset:9216
    v_mfma_f32_16x16x32_bf16 v[168:171], v[48:51], v[36:39], v[168:171]
    ds_read_b64_tr_b16 v[96:97], v252 offset:8192
    ds_read_b64_tr_b16 v[98:99], v252 offset:9216
    v_mfma_f32_16x16x32_bf16 v[140:143], v[52:55], v[32:35], v[140:143]
    ds_read_b64_tr_b16 v[100:101], v253 offset:8192
    ds_read_b64_tr_b16 v[102:103], v253 offset:9216
    v_mfma_f32_16x16x32_bf16 v[172:175], v[52:55], v[36:39], v[172:175]
    ds_read_b64_tr_b16 v[104:105], v254 offset:8192
    ds_read_b64_tr_b16 v[106:107], v254 offset:9216
    v_mfma_f32_16x16x32_bf16 v[144:147], v[56:59], v[32:35], v[144:147]
    ds_read_b64_tr_b16 v[108:109], v255 offset:8192
    ds_read_b64_tr_b16 v[110:111], v255 offset:9216
    s_add_u32 m0, s60, 114688
    s_add_u32 s43, s36, 8192
    buffer_load_dwordx4 v15, s[28:31], s36 offen sc1 lds
    v_mfma_f32_16x16x32_bf16 v[176:179], v[56:59], v[36:39], v[176:179]
    v_mfma_f32_16x16x32_bf16 v[148:151], v[60:63], v[32:35], v[148:151]
    v_mfma_f32_16x16x32_bf16 v[180:183], v[60:63], v[36:39], v[180:183]
    v_add_u32 v246, 65536, v236
    v_add_u32 v247, 65536, v237
    v_mfma_f32_16x16x32_bf16 v[152:155], v[64:67], v[32:35], v[152:155]
    s_add_u32 m0, s60, 122880
    s_sub_u32 s36, s36, 8192
    buffer_load_dwordx4 v15, s[68:71], s43 offen sc1 lds
    v_add_u32 v248, 98304, v238
    v_add_u32 v249, 98304, v239
    v_mfma_f32_16x16x32_bf16 v[184:187], v[64:67], v[36:39], v[184:187]
    v_add_u32 v250, 98304, v240
    v_add_u32 v251, 98304, v241
    v_mfma_f32_16x16x32_bf16 v[156:159], v[68:71], v[32:35], v[156:159]
    v_add_u32 v252, 98304, v242
    v_add_u32 v253, 98304, v243
    v_mfma_f32_16x16x32_bf16 v[188:191], v[68:71], v[36:39], v[188:191]
    v_add_u32 v254, 98304, v244
    v_add_u32 v255, 98304, v245
    s_waitcnt vmcnt(5) lgkmcnt(0)
    s_barrier
    v_mfma_f32_16x16x32_bf16 v[128:131], v[80:83], v[72:75], v[128:131]
    ds_read_b128 v[32:35], v246 offset:0
    ds_read_b128 v[36:39], v246 offset:2048
    v_mfma_f32_16x16x32_bf16 v[160:163], v[80:83], v[76:79], v[160:163]
    ds_read_b64_tr_b16 v[40:41], v248 offset:0
    ds_read_b64_tr_b16 v[42:43], v248 offset:1024
    v_mfma_f32_16x16x32_bf16 v[132:135], v[84:87], v[72:75], v[132:135]
    ds_read_b64_tr_b16 v[44:45], v249 offset:0
    ds_read_b64_tr_b16 v[46:47], v249 offset:1024
    v_mfma_f32_16x16x32_bf16 v[164:167], v[84:87], v[76:79], v[164:167]
    ds_read_b64_tr_b16 v[48:49], v250 offset:0
    ds_read_b64_tr_b16 v[50:51], v250 offset:1024
    v_mfma_f32_16x16x32_bf16 v[136:139], v[88:91], v[72:75], v[136:139]
    ds_read_b64_tr_b16 v[52:53], v251 offset:0
    ds_read_b64_tr_b16 v[54:55], v251 offset:1024
    v_mfma_f32_16x16x32_bf16 v[168:171], v[88:91], v[76:79], v[168:171]
    ds_read_b64_tr_b16 v[56:57], v252 offset:0
    ds_read_b64_tr_b16 v[58:59], v252 offset:1024
    v_mfma_f32_16x16x32_bf16 v[140:143], v[92:95], v[72:75], v[140:143]
    ds_read_b64_tr_b16 v[60:61], v253 offset:0
    ds_read_b64_tr_b16 v[62:63], v253 offset:1024
    v_mfma_f32_16x16x32_bf16 v[172:175], v[92:95], v[76:79], v[172:175]
    ds_read_b64_tr_b16 v[64:65], v254 offset:0
    ds_read_b64_tr_b16 v[66:67], v254 offset:1024
    v_mfma_f32_16x16x32_bf16 v[144:147], v[96:99], v[72:75], v[144:147]
    ds_read_b64_tr_b16 v[68:69], v255 offset:0
    ds_read_b64_tr_b16 v[70:71], v255 offset:1024
    s_add_u32 m0, s60, 32768
    s_nop 0
    buffer_load_dwordx4 v15, s[16:19], s57 offen sc1 lds
    v_mfma_f32_16x16x32_bf16 v[176:179], v[96:99], v[76:79], v[176:179]
    v_mfma_f32_16x16x32_bf16 v[148:151], v[100:103], v[72:75], v[148:151]
    v_mfma_f32_16x16x32_bf16 v[180:183], v[100:103], v[76:79], v[180:183]
    v_mfma_f32_16x16x32_bf16 v[152:155], v[104:107], v[72:75], v[152:155]
    s_add_u32 m0, s60, 40960
    s_nop 0
    buffer_load_dwordx4 v15, s[24:27], s57 offen sc1 lds
    s_add_u32 s57, s57, 8192
    v_mfma_f32_16x16x32_bf16 v[184:187], v[104:107], v[76:79], v[184:187]
    v_mfma_f32_16x16x32_bf16 v[156:159], v[108:111], v[72:75], v[156:159]
    v_mfma_f32_16x16x32_bf16 v[188:191], v[108:111], v[76:79], v[188:191]
    s_waitcnt lgkmcnt(0)
    v_mfma_f32_16x16x32_bf16 v[128:131], v[40:43], v[32:35], v[128:131]
    ds_read_b128 v[72:75], v247 offset:0
    ds_read_b128 v[76:79], v247 offset:2048
    v_mfma_f32_16x16x32_bf16 v[160:163], v[40:43], v[36:39], v[160:163]
    ds_read_b64_tr_b16 v[80:81], v248 offset:8192
    ds_read_b64_tr_b16 v[82:83], v248 offset:9216
    v_mfma_f32_16x16x32_bf16 v[132:135], v[44:47], v[32:35], v[132:135]
    ds_read_b64_tr_b16 v[84:85], v249 offset:8192
    ds_read_b64_tr_b16 v[86:87], v249 offset:9216
    v_mfma_f32_16x16x32_bf16 v[164:167], v[44:47], v[36:39], v[164:167]
    ds_read_b64_tr_b16 v[88:89], v250 offset:8192
    ds_read_b64_tr_b16 v[90:91], v250 offset:9216
    v_mfma_f32_16x16x32_bf16 v[136:139], v[48:51], v[32:35], v[136:139]
    ds_read_b64_tr_b16 v[92:93], v251 offset:8192
    ds_read_b64_tr_b16 v[94:95], v251 offset:9216
    v_mfma_f32_16x16x32_bf16 v[168:171], v[48:51], v[36:39], v[168:171]
    ds_read_b64_tr_b16 v[96:97], v252 offset:8192
    ds_read_b64_tr_b16 v[98:99], v252 offset:9216
    v_mfma_f32_16x16x32_bf16 v[140:143], v[52:55], v[32:35], v[140:143]
    ds_read_b64_tr_b16 v[100:101], v253 offset:8192
    ds_read_b64_tr_b16 v[102:103], v253 offset:9216
    v_mfma_f32_16x16x32_bf16 v[172:175], v[52:55], v[36:39], v[172:175]
    ds_read_b64_tr_b16 v[104:105], v254 offset:8192
    ds_read_b64_tr_b16 v[106:107], v254 offset:9216
    v_mfma_f32_16x16x32_bf16 v[144:147], v[56:59], v[32:35], v[144:147]
    ds_read_b64_tr_b16 v[108:109], v255 offset:8192
    ds_read_b64_tr_b16 v[110:111], v255 offset:9216
    s_add_u32 m0, s60, 131072
    s_add_u32 s43, s36, 8192
    buffer_load_dwordx4 v15, s[28:31], s36 offen sc1 lds
    v_mfma_f32_16x16x32_bf16 v[176:179], v[56:59], v[36:39], v[176:179]
    v_mfma_f32_16x16x32_bf16 v[148:151], v[60:63], v[32:35], v[148:151]
    v_mfma_f32_16x16x32_bf16 v[180:183], v[60:63], v[36:39], v[180:183]
    v_add_u32 v246, 0, v236
    v_add_u32 v247, 0, v237
    v_mfma_f32_16x16x32_bf16 v[152:155], v[64:67], v[32:35], v[152:155]
    s_add_u32 m0, s60, 139264
    s_sub_u32 s36, s36, 8192
    buffer_load_dwordx4 v15, s[68:71], s43 offen sc1 lds
    v_add_u32 v248, 114688, v238
    v_add_u32 v249, 114688, v239
    v_mfma_f32_16x16x32_bf16 v[184:187], v[64:67], v[36:39], v[184:187]
    v_add_u32 v250, 114688, v240
    v_add_u32 v251, 114688, v241
    v_mfma_f32_16x16x32_bf16 v[156:159], v[68:71], v[32:35], v[156:159]
    v_add_u32 v252, 114688, v242
    v_add_u32 v253, 114688, v243
    v_mfma_f32_16x16x32_bf16 v[188:191], v[68:71], v[36:39], v[188:191]
    v_add_u32 v254, 114688, v244
    v_add_u32 v255, 114688, v245
    s_branch kf_qd
kf_q1:
    s_waitcnt vmcnt(24) lgkmcnt(0)
    s_barrier
    ds_read_b128 v[32:35], v246 offset:0
    ds_read_b128 v[36:39], v246 offset:2048
    ds_read_b64_tr_b16 v[40:41], v248 offset:0
    ds_read_b64_tr_b16 v[42:43], v248 offset:1024
    ds_read_b64_tr_b16 v[44:45], v249 offset:0
    ds_read_b64_tr_b16 v[46:47], v249 offset:1024
    ds_read_b64_tr_b16 v[48:49], v250 offset:0
    ds_read_b64_tr_b16 v[50:51], v250 offset:1024
    ds_read_b64_tr_b16 v[52:53], v251 offset:0
    ds_read_b64_tr_b16 v[54:55], v251 offset:1024
    ds_read_b64_tr_b16 v[56:57], v252 offset:0
    ds_read_b64_tr_b16 v[58:59], v252 offset:1024
    ds_read_b64_tr_b16 v[60:61], v253 offset:0
    ds_read_b64_tr_b16 v[62:63], v253 offset:1024
    ds_read_b64_tr_b16 v[64:65], v254 offset:0
    ds_read_b64_tr_b16 v[66:67], v254 offset:1024
    ds_read_b64_tr_b16 v[68:69], v255 offset:0
    ds_read_b64_tr_b16 v[70:71], v255 offset:1024
    s_add_u32 s50, s56, 8192
    buffer_store_dwordx4 v[220:223], v4, s[20:23], s50 offen offset:1024 sc1
    s_add_u32 s50, s56, 8192
    buffer_store_dwordx4 v[216:219], v4, s[20:23], s50 offen offset:0 sc1
    s_waitcnt lgkmcnt(0)
    v_mfma_f32_16x16x32_bf16 v[128:131], v[40:43], v[32:35], v[128:131]
    ds_read_b128 v[72:75], v247 offset:0
    ds_read_b128 v[76:79], v247 offset:2048
    v_mfma_f32_16x16x32_bf16 v[160:163], v[40:43], v[36:39], v[160:163]
    ds_read_b64_tr_b16 v[80:81], v248 offset:8192
    ds_read_b64_tr_b16 v[82:83], v248 offset:9216
    v_mfma_f32_16x16x32_bf16 v[132:135], v[44:47], v[32:35], v[132:135]
    ds_read_b64_tr_b16 v[84:85], v249 offset:8192
    ds_read_b64_tr_b16 v[86:87], v249 offset:9216
    v_mfma_f32_16x16x32_bf16 v[164:167], v[44:47], v[36:39], v[164:167]
    ds_read_b64_tr_b16 v[88:89], v250 offset:8192
    ds_read_b64_tr_b16 v[90:91], v250 offset:9216
    v_mfma_f32_16x16x32_bf16 v[136:139], v[48:51], v[32:35], v[136:139]
    ds_read_b64_tr_b16 v[92:93], v251 offset:8192
    ds_read_b64_tr_b16 v[94:95], v251 offset:9216
    v_mfma_f32_16x16x32_bf16 v[168:171], v[48:51], v[36:39], v[168:171]
    ds_read_b64_tr_b16 v[96:97], v252 offset:8192
    ds_read_b64_tr_b16 v[98:99], v252 offset:9216
    v_mfma_f32_16x16x32_bf16 v[140:143], v[52:55], v[32:35], v[140:143]
    ds_read_b64_tr_b16 v[100:101], v253 offset:8192
    ds_read_b64_tr_b16 v[102:103], v253 offset:9216
    v_mfma_f32_16x16x32_bf16 v[172:175], v[52:55], v[36:39], v[172:175]
    ds_read_b64_tr_b16 v[104:105], v254 offset:8192
    ds_read_b64_tr_b16 v[106:107], v254 offset:9216
    v_mfma_f32_16x16x32_bf16 v[144:147], v[56:59], v[32:35], v[144:147]
    ds_read_b64_tr_b16 v[108:109], v255 offset:8192
    ds_read_b64_tr_b16 v[110:111], v255 offset:9216
    s_add_u32 s50, s55, 8192
    buffer_store_dwordx4 v[212:215], v4, s[20:23], s50 offen offset:1024 sc1
    v_mfma_f32_16x16x32_bf16 v[176:179], v[56:59], v[36:39], v[176:179]
    v_mfma_f32_16x16x32_bf16 v[148:151], v[60:63], v[32:35], v[148:151]
    v_mfma_f32_16x16x32_bf16 v[180:183], v[60:63], v[36:39], v[180:183]
    v_add_u32 v246, 32768, v236
    v_add_u32 v247, 32768, v237
    v_mfma_f32_16x16x32_bf16 v[152:155], v[64:67], v[32:35], v[152:155]
    v_add_u32 v248, 114688, v238
    v_add_u32 v249, 114688, v239
    v_mfma_f32_16x16x32_bf16 v[184:187], v[64:67], v[36:39], v[184:187]
    v_add_u32 v250, 114688, v240
    v_add_u32 v251, 114688, v241
    v_mfma_f32_16x16x32_bf16 v[156:159], v[68:71], v[32:35], v[156:159]
    v_add_u32 v252, 114688, v242
    v_add_u32 v253, 114688, v243
    v_mfma_f32_16x16x32_bf16 v[188:191], v[68:71], v[36:39], v[188:191]
    v_add_u32 v254, 114688, v244
    v_add_u32 v255, 114688, v245
    s_waitcnt vmcnt(19) lgkmcnt(0)
    s_barrier
    v_mfma_f32_16x16x32_bf16 v[128:131], v[80:83], v[72:75], v[128:131]
    ds_read_b128 v[32:35], v246 offset:0
    ds_read_b128 v[36:39], v246 offset:2048
    v_mfma_f32_16x16x32_bf16 v[160:163], v[80:83], v[76:79], v[160:163]
    ds_read_b64_tr_b16 v[40:41], v248 offset:0
    ds_read_b64_tr_b16 v[42:43], v248 offset:1024
    v_mfma_f32_16x16x32_bf16 v[132:135], v[84:87], v[72:75], v[132:135]
    ds_read_b64_tr_b16 v[44:45], v249 offset:0
    ds_read_b64_tr_b16 v[46:47], v249 offset:1024
    v_mfma_f32_16x16x32_bf16 v[164:167], v[84:87], v[76:79], v[164:167]
    ds_read_b64_tr_b16 v[48:49], v250 offset:0
    ds_read_b64_tr_b16 v[50:51], v250 offset:1024
    v_mfma_f32_16x16x32_bf16 v[136:139], v[88:91], v[72:75], v[136:139]
    ds_read_b64_tr_b16 v[52:53], v251 offset:0
    ds_read_b64_tr_b16 v[54:55], v251 offset:1024
    v_mfma_f32_16x16x32_bf16 v[168:171], v[88:91], v[76:79], v[168:171]
    ds_read_b64_tr_b16 v[56:57], v252 offset:0
    ds_read_b64_tr_b16 v[58:59], v252 offset:1024
    v_mfma_f32_16x16x32_bf16 v[140:143], v[92:95], v[72:75], v[140:143]
    ds_read_b64_tr_b16 v[60:61], v253 offset:0
    ds_read_b64_tr_b16 v[62:63], v253 offset:1024
    v_mfma_f32_16x16x32_bf16 v[172:175], v[92:95], v[76:79], v[172:175]
    ds_read_b64_tr_b16 v[64:65], v254 offset:0
    ds_read_b64_tr_b16 v[66:67], v254 offset:1024
    v_mfma_f32_16x16x32_bf16 v[144:147], v[96:99], v[72:75], v[144:147]
    ds_read_b64_tr_b16 v[68:69], v255 offset:0
    ds_read_b64_tr_b16 v[70:71], v255 offset:1024
    s_add_u32 s50, s55, 8192
    buffer_store_dwordx4 v[208:211], v4, s[20:23], s50 offen offset:0 sc1
    v_mfma_f32_16x16x32_bf16 v[176:179], v[96:99], v[76:79], v[176:179]
    v_mfma_f32_16x16x32_bf16 v[148:151], v[100:103], v[72:75], v[148:151]
    v_mfma_f32_16x16x32_bf16 v[180:183], v[100:103], v[76:79], v[180:183]
    v_mfma_f32_16x16x32_bf16 v[152:155], v[104:107], v[72:75], v[152:155]
    s_add_u32 s50, s56, 0
    buffer_store_dwordx4 v[204:207], v4, s[20:23], s50 offen offset:1024 sc1
    v_mfma_f32_16x16x32_bf16 v[184:187], v[104:107], v[76:79], v[184:187]
    v_mfma_f32_16x16x32_bf16 v[156:159], v[108:111], v[72:75], v[156:159]
    v_mfma_f32_16x16x32_bf16 v[188:191], v[108:111], v[76:79], v[188:191]
    s_waitcnt lgkmcnt(0)
    v_mfma_f32_16x16x32_bf16 v[128:131], v[40:43], v[32:35], v[128:131]
    ds_read_b128 v[72:75], v247 offset:0
    ds_read_b128 v[76:79], v247 offset:2048
    v_mfma_f32_16x16x32_bf16 v[160:163], v[40:43], v[36:39], v[160:163]
    ds_read_b64_tr_b16 v[80:81], v248 offset:8192
    ds_read_b64_tr_b16 v[82:83], v248 offset:9216
    v_mfma_f32_16x16x32_bf16 v[132:135], v[44:47], v[32:35], v[132:135]
    ds_read_b64_tr_b16 v[84:85], v249 offset:8192
    ds_read_b64_tr_b16 v[86:87], v249 offset:9216
    v_mfma_f32_16x16x32_bf16 v[164:167], v[44:47], v[36:39], v[164:167]
    ds_read_b64_tr_b16 v[88:89], v250 offset:8192
    ds_read_b64_tr_b16 v[90:91], v250 offset:9216
    v_mfma_f32_16x16x32_bf16 v[136:139], v[48:51], v[32:35], v[136:139]
    ds_read_b64_tr_b16 v[92:93], v251 offset:8192
    ds_read_b64_tr_b16 v[94:95], v251 offset:9216
    v_mfma_f32_16x16x32_bf16 v[168:171], v[48:51], v[36:39], v[168:171]
    ds_read_b64_tr_b16 v[96:97], v252 offset:8192
    ds_read_b64_tr_b16 v[98:99], v252 offset:9216
    v_mfma_f32_16x16x32_bf16 v[140:143], v[52:55], v[32:35], v[140:143]
    ds_read_b64_tr_b16 v[100:101], v253 offset:8192
    ds_read_b64_tr_b16 v[102:103], v253 offset:9216
    v_mfma_f32_16x16x32_bf16 v[172:175], v[52:55], v[36:39], v[172:175]
    ds_read_b64_tr_b16 v[104:105], v254 offset:8192
    ds_read_b64_tr_b16 v[106:107], v254 offset:9216
    v_mfma_f32_16x16x32_bf16 v[144:147], v[56:59], v[32:35], v[144:147]
    ds_read_b64_tr_b16 v[108:109], v255 offset:8192
    ds_read_b64_tr_b16 v[110:111], v255 offset:9216
    s_add_u32 s50, s56, 0
    buffer_store_dwordx4 v[200:203], v4, s[20:23], s50 offen offset:0 sc1
    v_mfma_f32_16x16x32_bf16 v[176:179], v[56:59], v[36:39], v[176:179]
    v_mfma_f32_16x16x32_bf16 v[148:151], v[60:63], v[32:35], v[148:151]
    v_mfma_f32_16x16x32_bf16 v[180:183], v[60:63], v[36:39], v[180:183]
    v_add_u32 v246, 65536, v236
    v_add_u32 v247, 65536, v237
    v_mfma_f32_16x16x32_bf16 v[152:155], v[64:67], v[32:35], v[152:155]
    v_add_u32 v248, 131072, v238
    v_add_u32 v249, 131072, v239
    v_mfma_f32_16x16x32_bf16 v[184:187], v[64:67], v[36:39], v[184:187]
    v_add_u32 v250, 131072, v240
    v_add_u32 v251, 131072, v241
    v_mfma_f32_16x16x32_bf16 v[156:159], v[68:71], v[32:35], v[156:159]
    v_add_u32 v252, 131072, v242
    v_add_u32 v253, 131072, v243
    v_mfma_f32_16x16x32_bf16 v[188:191], v[68:71], v[36:39], v[188:191]
    v_add_u32 v254, 131072, v244
    v_add_u32 v255, 131072, v245
    s_waitcnt vmcnt(12) lgkmcnt(0)
    s_barrier
    v_mfma_f32_16x16x32_bf16 v[128:131], v[80:83], v[72:75], v[128:131]
    ds_read_b128 v[32:35], v246 offset:0
    ds_read_b128 v[36:39], v246 offset:2048
    v_mfma_f32_16x16x32_bf16 v[160:163], v[80:83], v[76:79], v[160:163]
    ds_read_b64_tr_b16 v[40:41], v248 offset:0
    ds_read_b64_tr_b16 v[42:43], v248 offset:1024
    v_mfma_f32_16x16x32_bf16 v[132:135], v[84:87], v[72:75], v[132:135]
    ds_read_b64_tr_b16 v[44:45], v249 offset:0
    ds_read_b64_tr_b16 v[46:47], v249 offset:1024
    v_mfma_f32_16x16x32_bf16 v[164:167], v[84:87], v[76:79], v[164:167]
    ds_read_b64_tr_b16 v[48:49], v250 offset:0
    ds_read_b64_tr_b16 v[50:51], v250 offset:1024
    v_mfma_f32_16x16x32_bf16 v[136:139], v[88:91], v[72:75], v[136:139]
    ds_read_b64_tr_b16 v[52:53], v251 offset:0
    ds_read_b64_tr_b16 v[54:55], v251 offset:1024
    v_mfma_f32_16x16x32_bf16 v[168:171], v[88:91], v[76:79], v[168:171]
    ds_read_b64_tr_b16 v[56:57], v252 offset:0
    ds_read_b64_tr_b16 v[58:59], v252 offset:1024
    v_mfma_f32_16x16x32_bf16 v[140:143], v[92:95], v[72:75], v[140:143]
    ds_read_b64_tr_b16 v[60:61], v253 offset:0
    ds_read_b64_tr_b16 v[62:63], v253 offset:1024
    v_mfma_f32_16x16x32_bf16 v[172:175], v[92:95], v[76:79], v[172:175]
    ds_read_b64_tr_b16 v[64:65], v254 offset:0
    ds_read_b64_tr_b16 v[66:67], v254 offset:1024
    v_mfma_f32_16x16x32_bf16 v[144:147], v[96:99], v[72:75], v[144:147]
    ds_read_b64_tr_b16 v[68:69], v255 offset:0
    ds_read_b64_tr_b16 v[70:71], v255 offset:1024
    s_add_u32 s50, s55, 0
    buffer_store_dwordx4 v[196:199], v4, s[20:23], s50 offen offset:1024 sc1
    v_mfma_f32_16x16x32_bf16 v[176:179], v[96:99], v[76:79], v[176:179]
    v_mfma_f32_16x16x32_bf16 v[148:151], v[100:103], v[72:75], v[148:151]
    v_mfma_f32_16x16x32_bf16 v[180:183], v[100:103], v[76:79], v[180:183]
    v_mfma_f32_16x16x32_bf16 v[152:155], v[104:107], v[72:75], v[152:155]
    v_mfma_f32_16x16x32_bf16 v[184:187], v[104:107], v[76:79], v[184:187]
    v_mfma_f32_16x16x32_bf16 v[156:159], v[108:111], v[72:75], v[156:159]
    v_mfma_f32_16x16x32_bf16 v[188:191], v[108:111], v[76:79], v[188:191]
    s_waitcnt lgkmcnt(0)
    v_mfma_f32_16x16x32_bf16 v[128:131], v[40:43], v[32:35], v[128:131]
    ds_read_b128 v[72:75], v247 offset:0
    ds_read_b128 v[76:79], v247 offset:2048
    v_mfma_f32_16x16x32_bf16 v[160:163], v[40:43], v[36:39], v[160:163]
    ds_read_b64_tr_b16 v[80:81], v248 offset:8192
    ds_read_b64_tr_b16 v[82:83], v248 offset:9216
    v_mfma_f32_16x16x32_bf16 v[132:135], v[44:47], v[32:35], v[132:135]
    ds_read_b64_tr_b16 v[84:85], v249 offset:8192
    ds_read_b64_tr_b16 v[86:87], v249 offset:9216
    v_mfma_f32_16x16x32_bf16 v[164:167], v[44:47], v[36:39], v[164:167]
    ds_read_b64_tr_b16 v[88:89], v250 offset:8192
    ds_read_b64_tr_b16 v[90:91], v250 offset:9216
    v_mfma_f32_16x16x32_bf16 v[136:139], v[48:51], v[32:35], v[136:139]
    ds_read_b64_tr_b16 v[92:93], v251 offset:8192
    ds_read_b64_tr_b16 v[94:95], v251 offset:9216
    v_mfma_f32_16x16x32_bf16 v[168:171], v[48:51], v[36:39], v[168:171]
    ds_read_b64_tr_b16 v[96:97], v252 offset:8192
    ds_read_b64_tr_b16 v[98:99], v252 offset:9216
    v_mfma_f32_16x16x32_bf16 v[140:143], v[52:55], v[32:35], v[140:143]
    ds_read_b64_tr_b16 v[100:101], v253 offset:8192
    ds_read_b64_tr_b16 v[102:103], v253 offset:9216
    v_mfma_f32_16x16x32_bf16 v[172:175], v[52:55], v[36:39], v[172:175]
    ds_read_b64_tr_b16 v[104:105], v254 offset:8192
    ds_read_b64_tr_b16 v[106:107], v254 offset:9216
    v_mfma_f32_16x16x32_bf16 v[144:147], v[56:59], v[32:35], v[144:147]
    ds_read_b64_tr_b16 v[108:109], v255 offset:8192
    ds_read_b64_tr_b16 v[110:111], v255 offset:9216
    s_add_u32 s50, s55, 0
    buffer_store_dwordx4 v[192:195], v4, s[20:23], s50 offen offset:0 sc1
    v_mfma_f32_16x16x32_bf16 v[176:179], v[56:59], v[36:39], v[176:179]
    v_mfma_f32_16x16x32_bf16 v[148:151], v[60:63], v[32:35], v[148:151]
    v_mfma_f32_16x16x32_bf16 v[180:183], v[60:63], v[36:39], v[180:183]
    v_add_u32 v246, 0, v236
    v_add_u32 v247, 0, v237
    v_mfma_f32_16x16x32_bf16 v[152:155], v[64:67], v[32:35], v[152:155]
    v_add_u32 v248, 147456, v238
    v_add_u32 v249, 147456, v239
    v_mfma_f32_16x16x32_bf16 v[184:187], v[64:67], v[36:39], v[184:187]
    v_add_u32 v250, 147456, v240
    v_add_u32 v251, 147456, v241
    v_mfma_f32_16x16x32_bf16 v[156:159], v[68:71], v[32:35], v[156:159]
    v_add_u32 v252, 147456, v242
    v_add_u32 v253, 147456, v243
    v_mfma_f32_16x16x32_bf16 v[188:191], v[68:71], v[36:39], v[188:191]
    v_add_u32 v254, 147456, v244
    v_add_u32 v255, 147456, v245
    s_waitcnt lgkmcnt(0)
    s_barrier
    v_mfma_f32_16x16x32_bf16 v[128:131], v[80:83], v[72:75], v[128:131]
    ds_read_b128 v[32:35], v246 offset:0
    ds_read_b128 v[36:39], v246 offset:2048
    v_mfma_f32_16x16x32_bf16 v[160:163], v[80:83], v[76:79], v[160:163]
    ds_read_b64_tr_b16 v[40:41], v248 offset:0
    ds_read_b64_tr_b16 v[42:43], v248 offset:1024
    v_mfma_f32_16x16x32_bf16 v[132:135], v[84:87], v[72:75], v[132:135]
    ds_read_b64_tr_b16 v[44:45], v249 offset:0
    ds_read_b64_tr_b16 v[46:47], v249 offset:1024
    v_mfma_f32_16x16x32_bf16 v[164:167], v[84:87], v[76:79], v[164:167]
    ds_read_b64_tr_b16 v[48:49], v250 offset:0
    ds_read_b64_tr_b16 v[50:51], v250 offset:1024
    v_mfma_f32_16x16x32_bf16 v[136:139], v[88:91], v[72:75], v[136:139]
    ds_read_b64_tr_b16 v[52:53], v251 offset:0
    ds_read_b64_tr_b16 v[54:55], v251 offset:1024
    v_mfma_f32_16x16x32_bf16 v[168:171], v[88:91], v[76:79], v[168:171]
    ds_read_b64_tr_b16 v[56:57], v252 offset:0
    ds_read_b64_tr_b16 v[58:59], v252 offset:1024
    v_mfma_f32_16x16x32_bf16 v[140:143], v[92:95], v[72:75], v[140:143]
    ds_read_b64_tr_b16 v[60:61], v253 offset:0
    ds_read_b64_tr_b16 v[62:63], v253 offset:1024
    v_mfma_f32_16x16x32_bf16 v[172:175], v[92:95], v[76:79], v[172:175]
    ds_read_b64_tr_b16 v[64:65], v254 offset:0
    ds_read_b64_tr_b16 v[66:67], v254 offset:1024
    v_mfma_f32_16x16x32_bf16 v[144:147], v[96:99], v[72:75], v[144:147]
    ds_read_b64_tr_b16 v[68:69], v255 offset:0
    ds_read_b64_tr_b16 v[70:71], v255 offset:1024
    v_mfma_f32_16x16x32_bf16 v[176:179], v[96:99], v[76:79], v[176:179]
    v_mfma_f32_16x16x32_bf16 v[148:151], v[100:103], v[72:75], v[148:151]
    v_mfma_f32_16x16x32_bf16 v[180:183], v[100:103], v[76:79], v[180:183]
    v_mfma_f32_16x16x32_bf16 v[152:155], v[104:107], v[72:75], v[152:155]
    v_mfma_f32_16x16x32_bf16 v[184:187], v[104:107], v[76:79], v[184:187]
    v_mfma_f32_16x16x32_bf16 v[156:159], v[108:111], v[72:75], v[156:159]
    v_mfma_f32_16x16x32_bf16 v[188:191], v[108:111], v[76:79], v[188:191]
    s_waitcnt lgkmcnt(0)
    v_mfma_f32_16x16x32_bf16 v[128:131], v[40:43], v[32:35], v[128:131]
    ds_read_b128 v[72:75], v247 offset:0
    ds_read_b128 v[76:79], v247 offset:2048
    v_mfma_f32_16x16x32_bf16 v[160:163], v[40:43], v[36:39], v[160:163]
    ds_read_b64_tr_b16 v[80:81], v248 offset:8192
    ds_read_b64_tr_b16 v[82:83], v248 offset:9216
    v_mfma_f32_16x16x32_bf16 v[132:135], v[44:47], v[32:35], v[132:135]
    ds_read_b64_tr_b16 v[84:85], v249 offset:8192
    ds_read_b64_tr_b16 v[86:87], v249 offset:9216
    v_mfma_f32_16x16x32_bf16 v[164:167], v[44:47], v[36:39], v[164:167]
    ds_read_b64_tr_b16 v[88:89], v250 offset:8192
    ds_read_b64_tr_b16 v[90:91], v250 offset:9216
    v_mfma_f32_16x16x32_bf16 v[136:139], v[48:51], v[32:35], v[136:139]
    ds_read_b64_tr_b16 v[92:93], v251 offset:8192
    ds_read_b64_tr_b16 v[94:95], v251 offset:9216
    v_mfma_f32_16x16x32_bf16 v[168:171], v[48:51], v[36:39], v[168:171]
    ds_read_b64_tr_b16 v[96:97], v252 offset:8192
    ds_read_b64_tr_b16 v[98:99], v252 offset:9216
    v_mfma_f32_16x16x32_bf16 v[140:143], v[52:55], v[32:35], v[140:143]
    ds_read_b64_tr_b16 v[100:101], v253 offset:8192
    ds_read_b64_tr_b16 v[102:103], v253 offset:9216
    v_mfma_f32_16x16x32_bf16 v[172:175], v[52:55], v[36:39], v[172:175]
    ds_read_b64_tr_b16 v[104:105], v254 offset:8192
    ds_read_b64_tr_b16 v[106:107], v254 offset:9216
    v_mfma_f32_16x16x32_bf16 v[144:147], v[56:59], v[32:35], v[144:147]
    ds_read_b64_tr_b16 v[108:109], v255 offset:8192
    ds_read_b64_tr_b16 v[110:111], v255 offset:9216
    v_mfma_f32_16x16x32_bf16 v[176:179], v[56:59], v[36:39], v[176:179]
    v_mfma_f32_16x16x32_bf16 v[148:151], v[60:63], v[32:35], v[148:151]
    v_mfma_f32_16x16x32_bf16 v[180:183], v[60:63], v[36:39], v[180:183]
    v_add_u32 v246, 32768, v236
    v_add_u32 v247, 32768, v237
    v_mfma_f32_16x16x32_bf16 v[152:155], v[64:67], v[32:35], v[152:155]
    v_add_u32 v248, 98304, v238
    v_add_u32 v249, 98304, v239
    v_mfma_f32_16x16x32_bf16 v[184:187], v[64:67], v[36:39], v[184:187]
    v_add_u32 v250, 98304, v240
    v_add_u32 v251, 98304, v241
    v_mfma_f32_16x16x32_bf16 v[156:159], v[68:71], v[32:35], v[156:159]
    v_add_u32 v252, 98304, v242
    v_add_u32 v253, 98304, v243
    v_mfma_f32_16x16x32_bf16 v[188:191], v[68:71], v[36:39], v[188:191]
    v_add_u32 v254, 98304, v244
    v_add_u32 v255, 98304, v245
    s_waitcnt vmcnt(0) lgkmcnt(0)
    s_barrier
    s_cmp_lg_u32 s3, 6
    s_cbranch_scc1 kf_nosig
    s_mov_b32 s16, s86
    s_and_b32 s17, s87, 0xffff
    s_mov_b32 s18, 256
    s_mov_b32 s19, 0x20000
    s_add_u32 s32, s41, 256
    v_mov_b32 v26, s32
    s_mov_b64 exec, 1
    buffer_store_dword v26, v27, s[20:23], 0 offen sc1
    s_mov_b64 exec, -1
    s_and_b32 s32, s2, 0xc0
    v_add_u32 v22, s32, v1
    v_lshlrev_b32 v27, 7, v22
    v_add_u32 v27, 66846720, v27
kf_nosig:
    s_min_u32 s32, s40, 2
    s_mul_i32 s54, s2, 3
    s_add_u32 s54, s54, s32
    s_cmp_eq_u32 s3, 6
    s_cselect_b32 s54, 1000, s54
    s_cmp_ge_u32 s54, 648
    s_cbranch_scc1 kf_nowb1
    s_mov_b32 s28, s82
    s_and_b32 s29, s83, 0xffff
    s_mov_b32 s30, 663552
    s_mov_b32 s31, 0x20000
    s_mul_i32 s34, s54, 3641
    s_lshr_b32 s34, s34, 16
    s_mul_i32 s33, s34, 18
    s_sub_u32 s47, s54, s33
    s_lshl_b32 s47, s47, 6
    v_lshrrev_b32 v5, 5, v1
    v_mul_u32_u24 v5, 20736, v5
    v_and_b32 v6, 31, v1
    v_lshl_add_u32 v5, v6, 1, v5
    s_lshl_b32 s32, s34, 3
    s_add_u32 s32, s32, 0
    s_mul_i32 s33, s32, 3641
    s_lshr_b32 s33, s33, 16
    s_mul_i32 s33, s33, 18
    s_add_u32 s32, s32, s33
    s_mul_i32 s32, s32, 1152
    s_add_u32 s32, s32, s47
    buffer_load_ushort v112, v5, s[28:31], s32 offen
    s_lshl_b32 s32, s34, 3
    s_add_u32 s32, s32, 1
    s_mul_i32 s33, s32, 3641
    s_lshr_b32 s33, s33, 16
    s_mul_i32 s33, s33, 18
    s_add_u32 s32, s32, s33
    s_mul_i32 s32, s32, 1152
    s_add_u32 s32, s32, s47
    buffer_load_ushort v113, v5, s[28:31], s32 offen
    s_lshl_b32 s32, s34, 3
    s_add_u32 s32, s32, 2
    s_mul_i32 s33, s32, 3641
    s_lshr_b32 s33, s33, 16
    s_mul_i32 s33, s33, 18
    s_add_u32 s32, s32, s33
    s_mul_i32 s32, s32, 1152
    s_add_u32 s32, s32, s47
    buffer_load_ushort v114, v5, s[28:31], s32 offen
    s_lshl_b32 s32, s34, 3
    s_add_u32 s32, s32, 3
    s_mul_i32 s33, s32, 3641
    s_lshr_b32 s33, s33, 16
    s_mul_i32 s33, s33, 18
    s_add_u32 s32, s32, s33
    s_mul_i32 s32, s32, 1152
    s_add_u32 s32, s32, s47
    buffer_load_ushort v115, v5, s[28:31], s32 offen
    s_lshl_b32 s32, s34, 3
    s_add_u32 s32, s32, 4
    s_mul_i32 s33, s32, 3641
    s_lshr_b32 s33, s33, 16
    s_mul_i32 s33, s33, 18
    s_add_u32 s32, s32, s33
    s_mul_i32 s32, s32, 1152
    s_add_u32 s32, s32, s47
    buffer_load_ushort v116, v5, s[28:31], s32 offen
    s_lshl_b32 s32, s34, 3
    s_add_u32 s32, s32, 5
    s_mul_i32 s33, s32, 3641
    s_lshr_b32 s33, s33, 16
    s_mul_i32 s33, s33, 18
    s_add_u32 s32, s32, s33
    s_mul_i32 s32, s32, 1152
    s_add_u32 s32, s32, s47
    buffer_load_ushort v117, v5, s[28:31], s32 offen
    s_lshl_b32 s32, s34, 3
    s_add_u32 s32, s32, 6
    s_mul_i32 s33, s32, 3641
    s_lshr_b32 s33, s33, 16
    s_mul_i32 s33, s33, 18
    s_add_u32 s32, s32, s33
    s_mul_i32 s32, s32, 1152
    s_add_u32 s32, s32, s47
    buffer_load_ushort v118, v5, s[28:31], s32 offen
    s_lshl_b32 s32, s34, 3
    s_add_u32 s32, s32, 7
    s_mul_i32 s33, s32, 3641
    s_lshr_b32 s33, s33, 16
    s_mul_i32 s33, s33, 18
    s_add_u32 s32, s32, s33
    s_mul_i32 s32, s32, 1152
    s_add_u32 s32, s32, s47
    buffer_load_ushort v119, v5, s[28:31], s32 offen
kf_nowb1:
    v_mfma_f32_16x16x32_bf16 v[128:131], v[80:83], v[72:75], v[128:131]
    ds_read_b128 v[32:35], v246 offset:0
    ds_read_b128 v[36:39], v246 offset:2048
    v_mfma_f32_16x16x32_bf16 v[160:163], v[80:83], v[76:79], v[160:163]
    ds_read_b64_tr_b16 v[40:41], v248 offset:0
    ds_read_b64_tr_b16 v[42:43], v248 offset:1024
    v_mfma_f32_16x16x32_bf16 v[132:135], v[84:87], v[72:75], v[132:135]
    ds_read_b64_tr_b16 v[44:45], v249 offset:0
    ds_read_b64_tr_b16 v[46:47], v249 offset:1024
    v_mfma_f32_16x16x32_bf16 v[164:167], v[84:87], v[76:79], v[164:167]
    ds_read_b64_tr_b16 v[48:49], v250 offset:0
    ds_read_b64_tr_b16 v[50:51], v250 offset:1024
    v_mfma_f32_16x16x32_bf16 v[136:139], v[88:91], v[72:75], v[136:139]
    ds_read_b64_tr_b16 v[52:53], v251 offset:0
    ds_read_b64_tr_b16 v[54:55], v251 offset:1024
    v_mfma_f32_16x16x32_bf16 v[168:171], v[88:91], v[76:79], v[168:171]
    ds_read_b64_tr_b16 v[56:57], v252 offset:0
    ds_read_b64_tr_b16 v[58:59], v252 offset:1024
    v_mfma_f32_16x16x32_bf16 v[140:143], v[92:95], v[72:75], v[140:143]
    ds_read_b64_tr_b16 v[60:61], v253 offset:0
    ds_read_b64_tr_b16 v[62:63], v253 offset:1024
    v_mfma_f32_16x16x32_bf16 v[172:175], v[92:95], v[76:79], v[172:175]
    ds_read_b64_tr_b16 v[64:65], v254 offset:0
    ds_read_b64_tr_b16 v[66:67], v254 offset:1024
    v_mfma_f32_16x16x32_bf16 v[144:147], v[96:99], v[72:75], v[144:147]
    ds_read_b64_tr_b16 v[68:69], v255 offset:0
    ds_read_b64_tr_b16 v[70:71], v255 offset:1024
    v_mfma_f32_16x16x32_bf16 v[176:179], v[96:99], v[76:79], v[176:179]
    v_mfma_f32_16x16x32_bf16 v[148:151], v[100:103], v[72:75], v[148:151]
    v_mfma_f32_16x16x32_bf16 v[180:183], v[100:103], v[76:79], v[180:183]
    v_mfma_f32_16x16x32_bf16 v[152:155], v[104:107], v[72:75], v[152:155]
    v_mfma_f32_16x16x32_bf16 v[184:187], v[104:107], v[76:79], v[184:187]
    v_mfma_f32_16x16x32_bf16 v[156:159], v[108:111], v[72:75], v[156:159]
    v_mfma_f32_16x16x32_bf16 v[188:191], v[108:111], v[76:79], v[188:191]
    s_waitcnt lgkmcnt(0)
    v_mfma_f32_16x16x32_bf16 v[128:131], v[40:43], v[32:35], v[128:131]
    ds_read_b128 v[72:75], v247 offset:0
    ds_read_b128 v[76:79], v247 offset:2048
    v_mfma_f32_16x16x32_bf16 v[160:163], v[40:43], v[36:39], v[160:163]
    ds_read_b64_tr_b16 v[80:81], v248 offset:8192
    ds_read_b64_tr_b16 v[82:83], v248 offset:9216
    v_mfma_f32_16x16x32_bf16 v[132:135], v[44:47], v[32:35], v[132:135]
    ds_read_b64_tr_b16 v[84:85], v249 offset:8192
    ds_read_b64_tr_b16 v[86:87], v249 offset:9216
    v_mfma_f32_16x16x32_bf16 v[164:167], v[44:47], v[36:39], v[164:167]
    ds_read_b64_tr_b16 v[88:89], v250 offset:8192
    ds_read_b64_tr_b16 v[90:91], v250 offset:9216
    v_mfma_f32_16x16x32_bf16 v[136:139], v[48:51], v[32:35], v[136:139]
    ds_read_b64_tr_b16 v[92:93], v251 offset:8192
    ds_read_b64_tr_b16 v[94:95], v251 offset:9216
    v_mfma_f32_16x16x32_bf16 v[168:171], v[48:51], v[36:39], v[168:171]
    ds_read_b64_tr_b16 v[96:97], v252 offset:8192
    ds_read_b64_tr_b16 v[98:99], v252 offset:9216
    v_mfma_f32_16x16x32_bf16 v[140:143], v[52:55], v[32:35], v[140:143]
    ds_read_b64_tr_b16 v[100:101], v253 offset:8192
    ds_read_b64_tr_b16 v[102:103], v253 offset:9216
    v_mfma_f32_16x16x32_bf16 v[172:175], v[52:55], v[36:39], v[172:175]
    ds_read_b64_tr_b16 v[104:105], v254 offset:8192
    ds_read_b64_tr_b16 v[106:107], v254 offset:9216
    v_mfma_f32_16x16x32_bf16 v[144:147], v[56:59], v[32:35], v[144:147]
    ds_read_b64_tr_b16 v[108:109], v255 offset:8192
    ds_read_b64_tr_b16 v[110:111], v255 offset:9216
    v_mfma_f32_16x16x32_bf16 v[176:179], v[56:59], v[36:39], v[176:179]
    v_mfma_f32_16x16x32_bf16 v[148:151], v[60:63], v[32:35], v[148:151]
    v_mfma_f32_16x16x32_bf16 v[180:183], v[60:63], v[36:39], v[180:183]
    v_add_u32 v246, 65536, v236
    v_add_u32 v247, 65536, v237
    v_mfma_f32_16x16x32_bf16 v[152:155], v[64:67], v[32:35], v[152:155]
    v_add_u32 v248, 114688, v238
    v_add_u32 v249, 114688, v239
    v_mfma_f32_16x16x32_bf16 v[184:187], v[64:67], v[36:39], v[184:187]
    v_add_u32 v250, 114688, v240
    v_add_u32 v251, 114688, v241
    v_mfma_f32_16x16x32_bf16 v[156:159], v[68:71], v[32:35], v[156:159]
    v_add_u32 v252, 114688, v242
    v_add_u32 v253, 114688, v243
    v_mfma_f32_16x16x32_bf16 v[188:191], v[68:71], v[36:39], v[188:191]
    v_add_u32 v254, 114688, v244
    v_add_u32 v255, 114688, v245
    s_waitcnt lgkmcnt(0)
    s_barrier
    s_cmp_lg_u32 s3, 6
    s_cbranch_scc1 kf_nopoll0
    buffer_load_ubyte v26, v22, s[16:19], 0 offen sc0 sc1
    buffer_load_dword v21, v27, s[20:23], 0 offen sc1
kf_nopoll0:
    v_mfma_f32_16x16x32_bf16 v[128:131], v[80:83], v[72:75], v[128:131]
    ds_read_b128 v[32:35], v246 offset:0
    ds_read_b128 v[36:39], v246 offset:2048
    v_mfma_f32_16x16x32_bf16 v[160:163], v[80:83], v[76:79], v[160:163]
    ds_read_b64_tr_b16 v[40:41], v248 offset:0
    ds_read_b64_tr_b16 v[42:43], v248 offset:1024
    v_mfma_f32_16x16x32_bf16 v[132:135], v[84:87], v[72:75], v[132:135]
    ds_read_b64_tr_b16 v[44:45], v249 offset:0
    ds_read_b64_tr_b16 v[46:47], v249 offset:1024
    v_mfma_f32_16x16x32_bf16 v[164:167], v[84:87], v[76:79], v[164:167]
    ds_read_b64_tr_b16 v[48:49], v250 offset:0
    ds_read_b64_tr_b16 v[50:51], v250 offset:1024
    v_mfma_f32_16x16x32_bf16 v[136:139], v[88:91], v[72:75], v[136:139]
    ds_read_b64_tr_b16 v[52:53], v251 offset:0
    ds_read_b64_tr_b16 v[54:55], v251 offset:1024
    v_mfma_f32_16x16x32_bf16 v[168:171], v[88:91], v[76:79], v[168:171]
    ds_read_b64_tr_b16 v[56:57], v252 offset:0
    ds_read_b64_tr_b16 v[58:59], v252 offset:1024
    v_mfma_f32_16x16x32_bf16 v[140:143], v[92:95], v[72:75], v[140:143]
    ds_read_b64_tr_b16 v[60:61], v253 offset:0
    ds_read_b64_tr_b16 v[62:63], v253 offset:1024
    v_mfma_f32_16x16x32_bf16 v[172:175], v[92:95], v[76:79], v[172:175]
    ds_read_b64_tr_b16 v[64:65], v254 offset:0
    ds_read_b64_tr_b16 v[66:67], v254 offset:1024
    v_mfma_f32_16x16x32_bf16 v[144:147], v[96:99], v[72:75], v[144:147]
    ds_read_b64_tr_b16 v[68:69], v255 offset:0
    ds_read_b64_tr_b16 v[70:71], v255 offset:1024
    v_mfma_f32_16x16x32_bf16 v[176:179], v[96:99], v[76:79], v[176:179]
    v_mfma_f32_16x16x32_bf16 v[148:151], v[100:103], v[72:75], v[148:151]
    v_mfma_f32_16x16x32_bf16 v[180:183], v[100:103], v[76:79], v[180:183]
    v_mfma_f32_16x16x32_bf16 v[152:155], v[104:107], v[72:75], v[152:155]
    v_mfma_f32_16x16x32_bf16 v[184:187], v[104:107], v[76:79], v[184:187]
    v_mfma_f32_16x16x32_bf16 v[156:159], v[108:111], v[72:75], v[156:159]
    v_mfma_f32_16x16x32_bf16 v[188:191], v[108:111], v[76:79], v[188:191]
    s_waitcnt lgkmcnt(0)
    v_mfma_f32_16x16x32_bf16 v[128:131], v[40:43], v[32:35], v[128:131]
    ds_read_b128 v[72:75], v247 offset:0
    ds_read_b128 v[76:79], v247 offset:2048
    v_mfma_f32_16x16x32_bf16 v[160:163], v[40:43], v[36:39], v[160:163]
    ds_read_b64_tr_b16 v[80:81], v248 offset:8192
    ds_read_b64_tr_b16 v[82:83], v248 offset:9216
    v_mfma_f32_16x16x32_bf16 v[132:135], v[44:47], v[32:35], v[132:135]
    ds_read_b64_tr_b16 v[84:85], v249 offset:8192
    ds_read_b64_tr_b16 v[86:87], v249 offset:9216
    v_mfma_f32_16x16x32_bf16 v[164:167], v[44:47], v[36:39], v[164:167]
    ds_read_b64_tr_b16 v[88:89], v250 offset:8192
    ds_read_b64_tr_b16 v[90:91], v250 offset:9216
    v_mfma_f32_16x16x32_bf16 v[136:139], v[48:51], v[32:35], v[136:139]
    ds_read_b64_tr_b16 v[92:93], v251 offset:8192
    ds_read_b64_tr_b16 v[94:95], v251 offset:9216
    v_mfma_f32_16x16x32_bf16 v[168:171], v[48:51], v[36:39], v[168:171]
    ds_read_b64_tr_b16 v[96:97], v252 offset:8192
    ds_read_b64_tr_b16 v[98:99], v252 offset:9216
    v_mfma_f32_16x16x32_bf16 v[140:143], v[52:55], v[32:35], v[140:143]
    ds_read_b64_tr_b16 v[100:101], v253 offset:8192
    ds_read_b64_tr_b16 v[102:103], v253 offset:9216
    v_mfma_f32_16x16x32_bf16 v[172:175], v[52:55], v[36:39], v[172:175]
    ds_read_b64_tr_b16 v[104:105], v254 offset:8192
    ds_read_b64_tr_b16 v[106:107], v254 offset:9216
    v_mfma_f32_16x16x32_bf16 v[144:147], v[56:59], v[32:35], v[144:147]
    ds_read_b64_tr_b16 v[108:109], v255 offset:8192
    ds_read_b64_tr_b16 v[110:111], v255 offset:9216
    v_mfma_f32_16x16x32_bf16 v[176:179], v[56:59], v[36:39], v[176:179]
    v_mfma_f32_16x16x32_bf16 v[148:151], v[60:63], v[32:35], v[148:151]
    v_mfma_f32_16x16x32_bf16 v[180:183], v[60:63], v[36:39], v[180:183]
    v_add_u32 v246, 0, v236
    v_add_u32 v247, 0, v237
    v_mfma_f32_16x16x32_bf16 v[152:155], v[64:67], v[32:35], v[152:155]
    v_add_u32 v248, 131072, v238
    v_add_u32 v249, 131072, v239
    v_mfma_f32_16x16x32_bf16 v[184:187], v[64:67], v[36:39], v[184:187]
    v_add_u32 v250, 131072, v240
    v_add_u32 v251, 131072, v241
    v_mfma_f32_16x16x32_bf16 v[156:159], v[68:71], v[32:35], v[156:159]
    v_add_u32 v252, 131072, v242
    v_add_u32 v253, 131072, v243
    v_mfma_f32_16x16x32_bf16 v[188:191], v[68:71], v[36:39], v[188:191]
    v_add_u32 v254, 131072, v244
    v_add_u32 v255, 131072, v245
    s_waitcnt lgkmcnt(0)
    s_barrier
    s_cmp_lg_u32 s3, 6
    s_cbranch_scc1 kf_nopoll
    s_mov_b32 s33, 0
kf_poll:
    s_waitcnt vmcnt(0)
    v_subrev_u32 v21, 256, v21
    v_cmp_ne_u32 vcc, v26, v21
    v_cmp_eq_u32 s[50:51], 0, v26
    s_add_u32 s33, s33, 1
    s_nop 1
    s_or_b64 vcc, vcc, s[50:51]
    s_cbranch_vccz kf_polled
    s_cmp_ge_u32 s33, 400000
    s_cbranch_scc1 kf_polled
    s_sleep 1
    buffer_load_ubyte v26, v22, s[16:19], 0 offen sc0 sc1
    buffer_load_dword v21, v27, s[20:23], 0 offen sc1
    s_branch kf_poll
kf_polled:
    s_mul_i32 s32, s7, 23
    v_min_u32 v20, 22, v1
    v_add_u32 v20, s32, v20
    v_min_u32 v20, 359, v20
    v_lshlrev_b32 v19, 4, v20
    s_mul_i32 s32, s6, 5760
    s_add_u32 s32, s32, 62914560
    buffer_load_dwordx4 v[192:195], v19, s[20:23], s32 offen sc1
    s_add_u32 s32, s32, 92160
    buffer_load_dwordx4 v[196:199], v19, s[20:23], s32 offen sc1
    s_add_u32 s32, s32, 92160
    buffer_load_dwordx4 v[200:203], v19, s[20:23], s32 offen sc1
    s_add_u32 s32, s32, 92160
    buffer_load_dwordx4 v[204:207], v19, s[20:23], s32 offen sc1
    s_add_u32 s32, s32, 92160
    buffer_load_dwordx4 v[208:211], v19, s[20:23], s32 offen sc1
    s_add_u32 s32, s32, 92160
    buffer_load_dwordx4 v[212:215], v19, s[20:23], s32 offen sc1
    s_add_u32 s32, s32, 92160
    buffer_load_dwordx4 v[216:219], v19, s[20:23], s32 offen sc1
    s_add_u32 s32, s32, 92160
    buffer_load_dwordx4 v[220:223], v19, s[20:23], s32 offen sc1
    s_add_u32 s32, s32, 92160
    buffer_load_dwordx4 v[224:227], v19, s[20:23], s32 offen sc1
    s_add_u32 s32, s32, 92160
    buffer_load_dwordx4 v[228:231], v19, s[20:23], s32 offen sc1
    s_add_u32 s32, s32, 92160
    buffer_load_dwordx4 v[232:235], v19, s[20:23], s32 offen sc1
    s_add_u32 s32, s32, 92160
    buffer_load_dwordx4 v[112:115], v19, s[20:23], s32 offen sc1
    s_add_u32 s32, s32, 92160
    buffer_load_dwordx4 v[116:119], v19, s[20:23], s32 offen sc1
    s_add_u32 s32, s32, 92160
    buffer_load_dwordx4 v[120:123], v19, s[20:23], s32 offen sc1
    s_add_u32 s32, s32, 92160
    buffer_load_dwordx4 v[124:127], v19, s[20:23], s32 offen sc1
    s_add_u32 s32, s32, 92160
    buffer_load_dwordx4 v[28:31], v19, s[20:23], s32 offen sc1
kf_nopoll:
    s_cmp_ge_u32 s54, 648
    s_cbranch_scc1 kf_nowb2
    s_waitcnt vmcnt(0)
    v_lshl_or_b32 v112, v113, 16, v112
    v_lshl_or_b32 v113, v115, 16, v114
    v_lshl_or_b32 v114, v117, 16, v116
    v_lshl_or_b32 v115, v119, 16, v118
    s_lshl_b32 s32, s54, 10
    s_add_u32 s32, s32, 66060288
    buffer_store_dwordx4 v[112:115], v4, s[20:23], s32 offen sc1
kf_nowb2:
    v_mfma_f32_16x16x32_bf16 v[128:131], v[80:83], v[72:75], v[128:131]
    ds_read_b128 v[32:35], v246 offset:0
    ds_read_b128 v[36:39], v246 offset:2048
    v_mfma_f32_16x16x32_bf16 v[160:163], v[80:83], v[76:79], v[160:163]
    ds_read_b64_tr_b16 v[40:41], v248 offset:0
    ds_read_b64_tr_b16 v[42:43], v248 offset:1024
    v_mfma_f32_16x16x32_bf16 v[132:135], v[84:87], v[72:75], v[132:135]
    ds_read_b64_tr_b16 v[44:45], v249 offset:0
    ds_read_b64_tr_b16 v[46:47], v249 offset:1024
    v_mfma_f32_16x16x32_bf16 v[164:167], v[84:87], v[76:79], v[164:167]
    ds_read_b64_tr_b16 v[48:49], v250 offset:0
    ds_read_b64_tr_b16 v[50:51], v250 offset:1024
    v_mfma_f32_16x16x32_bf16 v[136:139], v[88:91], v[72:75], v[136:139]
    ds_read_b64_tr_b16 v[52:53], v251 offset:0
    ds_read_b64_tr_b16 v[54:55], v251 offset:1024
    v_mfma_f32_16x16x32_bf16 v[168:171], v[88:91], v[76:79], v[168:171]
    ds_read_b64_tr_b16 v[56:57], v252 offset:0
    ds_read_b64_tr_b16 v[58:59], v252 offset:1024
    v_mfma_f32_16x16x32_bf16 v[140:143], v[92:95], v[72:75], v[140:143]
    ds_read_b64_tr_b16 v[60:61], v253 offset:0
    ds_read_b64_tr_b16 v[62:63], v253 offset:1024
    v_mfma_f32_16x16x32_bf16 v[172:175], v[92:95], v[76:79], v[172:175]
    ds_read_b64_tr_b16 v[64:65], v254 offset:0
    ds_read_b64_tr_b16 v[66:67], v254 offset:1024
    v_mfma_f32_16x16x32_bf16 v[144:147], v[96:99], v[72:75], v[144:147]
    ds_read_b64_tr_b16 v[68:69], v255 offset:0
    ds_read_b64_tr_b16 v[70:71], v255 offset:1024
    v_mfma_f32_16x16x32_bf16 v[176:179], v[96:99], v[76:79], v[176:179]
    v_mfma_f32_16x16x32_bf16 v[148:151], v[100:103], v[72:75], v[148:151]
    v_mfma_f32_16x16x32_bf16 v[180:183], v[100:103], v[76:79], v[180:183]
    v_mfma_f32_16x16x32_bf16 v[152:155], v[104:107], v[72:75], v[152:155]
    v_mfma_f32_16x16x32_bf16 v[184:187], v[104:107], v[76:79], v[184:187]
    v_mfma_f32_16x16x32_bf16 v[156:159], v[108:111], v[72:75], v[156:159]
    v_mfma_f32_16x16x32_bf16 v[188:191], v[108:111], v[76:79], v[188:191]
    s_waitcnt lgkmcnt(0)
    v_mfma_f32_16x16x32_bf16 v[128:131], v[40:43], v[32:35], v[128:131]
    ds_read_b128 v[72:75], v247 offset:0
    ds_read_b128 v[76:79], v247 offset:2048
    v_mfma_f32_16x16x32_bf16 v[160:163], v[40:43], v[36:39], v[160:163]
    ds_read_b64_tr_b16 v[80:81], v248 offset:8192
    ds_read_b64_tr_b16 v[82:83], v248 offset:9216
    v_mfma_f32_16x16x32_bf16 v[132:135], v[44:47], v[32:35], v[132:135]
    ds_read_b64_tr_b16 v[84:85], v249 offset:8192
    ds_read_b64_tr_b16 v[86:87], v249 offset:9216
    v_mfma_f32_16x16x32_bf16 v[164:167], v[44:47], v[36:39], v[164:167]
    ds_read_b64_tr_b16 v[88:89], v250 offset:8192
    ds_read_b64_tr_b16 v[90:91], v250 offset:9216
    v_mfma_f32_16x16x32_bf16 v[136:139], v[48:51], v[32:35], v[136:139]
    ds_read_b64_tr_b16 v[92:93], v251 offset:8192
    ds_read_b64_tr_b16 v[94:95], v251 offset:9216
    v_mfma_f32_16x16x32_bf16 v[168:171], v[48:51], v[36:39], v[168:171]
    ds_read_b64_tr_b16 v[96:97], v252 offset:8192
    ds_read_b64_tr_b16 v[98:99], v252 offset:9216
    v_mfma_f32_16x16x32_bf16 v[140:143], v[52:55], v[32:35], v[140:143]
    ds_read_b64_tr_b16 v[100:101], v253 offset:8192
    ds_read_b64_tr_b16 v[102:103], v253 offset:9216
    v_mfma_f32_16x16x32_bf16 v[172:175], v[52:55], v[36:39], v[172:175]
    ds_read_b64_tr_b16 v[104:105], v254 offset:8192
    ds_read_b64_tr_b16 v[106:107], v254 offset:9216
    v_mfma_f32_16x16x32_bf16 v[144:147], v[56:59], v[32:35], v[144:147]
    ds_read_b64_tr_b16 v[108:109], v255 offset:8192
    ds_read_b64_tr_b16 v[110:111], v255 offset:9216
    v_mfma_f32_16x16x32_bf16 v[176:179], v[56:59], v[36:39], v[176:179]
    v_mfma_f32_16x16x32_bf16 v[148:151], v[60:63], v[32:35], v[148:151]
    v_mfma_f32_16x16x32_bf16 v[180:183], v[60:63], v[36:39], v[180:183]
    v_add_u32 v246, 32768, v236
    v_add_u32 v247, 32768, v237
    v_mfma_f32_16x16x32_bf16 v[152:155], v[64:67], v[32:35], v[152:155]
    v_add_u32 v248, 147456, v238
    v_add_u32 v249, 147456, v239
    v_mfma_f32_16x16x32_bf16 v[184:187], v[64:67], v[36:39], v[184:187]
    v_add_u32 v250, 147456, v240
    v_add_u32 v251, 147456, v241
    v_mfma_f32_16x16x32_bf16 v[156:159], v[68:71], v[32:35], v[156:159]
    v_add_u32 v252, 147456, v242
    v_add_u32 v253, 147456, v243
    v_mfma_f32_16x16x32_bf16 v[188:191], v[68:71], v[36:39], v[188:191]
    v_add_u32 v254, 147456, v244
    v_add_u32 v255, 147456, v245
    s_waitcnt lgkmcnt(0)
    s_barrier
    v_add_u32 v15, s60, v4
    v_lshlrev_b32 v5, 2, v3
    v_sub_u32 v16, v2, v5
    v_mov_b32 v17, 0xff800000
    s_mov_b32 s57, 0
    s_mov_b32 s36, 253952
    s_lshl_b32 s32, s5, 2
    s_add_u32 s32, s32, s40
    s_cmp_eq_u32 s45, 0
    s_cselect_b32 s44, s32, 60
    s_add_u32 s46, s44, 1
    s_mov_b32 s42, 0x4e000000
    s_lshl_b32 s32, s40, 6
    s_sub_u32 s32, s59, s32
    s_add_u32 s32, s32, 96
    s_cmp_eq_u32 s45, 0
    s_cselect_b32 s41, s32, s59
    s_mov_b64 s[48:49], 1
    s_bitset1_b64 s[48:49], s44
    s_bitset1_b64 s[48:49], s46
    s_add_u32 s32, s46, 1
    s_bitset1_b64 s[48:49], s32
    s_lshl_b32 s32, s4, 19
    s_lshl_b32 s34, s5, 15
    s_sub_u32 s34, 262144, s34
    s_add_u32 s33, s32, 0
    s_add_u32 s16, s88, s33
    s_addc_u32 s17, s89, 0
    s_and_b32 s17, s17, 0xffff
    s_mov_b32 s18, 262144
    s_mov_b32 s19, 0x20000
    s_add_u32 s33, s32, 16769024
    s_add_u32 s24, s88, s33
    s_addc_u32 s25, s89, 0
    s_and_b32 s25, s25, 0xffff
    s_mov_b32 s26, 270336
    s_mov_b32 s27, 0x20000
    s_add_u32 s33, s32, 262144
    s_add_u32 s28, s88, s33
    s_addc_u32 s29, s89, 0
    s_and_b32 s29, s29, 0xffff
    s_mov_b32 s30, s34
    s_mov_b32 s31, 0x20000
    s_add_u32 s33, s32, 17039360
    s_add_u32 s68, s88, s33
    s_addc_u32 s69, s89, 0
    s_and_b32 s69, s69, 0xffff
    s_mov_b32 s70, s34
    s_mov_b32 s71, 0x20000
    v_mfma_f32_16x16x32_bf16 v[128:131], v[80:83], v[72:75], v[128:131]
    ds_read_b128 v[32:35], v246 offset:0
    ds_read_b128 v[36:39], v246 offset:2048
    v_mfma_f32_16x16x32_bf16 v[160:163], v[80:83], v[76:79], v[160:163]
    ds_read_b64_tr_b16 v[40:41], v248 offset:0
    ds_read_b64_tr_b16 v[42:43], v248 offset:1024
    v_mfma_f32_16x16x32_bf16 v[132:135], v[84:87], v[72:75], v[132:135]
    ds_read_b64_tr_b16 v[44:45], v249 offset:0
    ds_read_b64_tr_b16 v[46:47], v249 offset:1024
    v_mfma_f32_16x16x32_bf16 v[164:167], v[84:87], v[76:79], v[164:167]
    ds_read_b64_tr_b16 v[48:49], v250 offset:0
    ds_read_b64_tr_b16 v[50:51], v250 offset:1024
    v_mfma_f32_16x16x32_bf16 v[136:139], v[88:91], v[72:75], v[136:139]
    ds_read_b64_tr_b16 v[52:53], v251 offset:0
    ds_read_b64_tr_b16 v[54:55], v251 offset:1024
    v_mfma_f32_16x16x32_bf16 v[168:171], v[88:91], v[76:79], v[168:171]
    ds_read_b64_tr_b16 v[56:57], v252 offset:0
    ds_read_b64_tr_b16 v[58:59], v252 offset:1024
    v_mfma_f32_16x16x32_bf16 v[140:143], v[92:95], v[72:75], v[140:143]
    ds_read_b64_tr_b16 v[60:61], v253 offset:0
    ds_read_b64_tr_b16 v[62:63], v253 offset:1024
    v_mfma_f32_16x16x32_bf16 v[172:175], v[92:95], v[76:79], v[172:175]
    ds_read_b64_tr_b16 v[64:65], v254 offset:0
    ds_read_b64_tr_b16 v[66:67], v254 offset:1024
    v_mfma_f32_16x16x32_bf16 v[144:147], v[96:99], v[72:75], v[144:147]
    ds_read_b64_tr_b16 v[68:69], v255 offset:0
    ds_read_b64_tr_b16 v[70:71], v255 offset:1024
    s_add_u32 m0, s60, 0
    s_nop 0
    buffer_load_dwordx4 v15, s[16:19], s57 offen sc1 lds
    s_add_u32 s57, s57, 8192
    v_mfma_f32_16x16x32_bf16 v[176:179], v[96:99], v[76:79], v[176:179]
    v_mfma_f32_16x16x32_bf16 v[148:151], v[100:103], v[72:75], v[148:151]
    s_add_u32 m0, s60, 16384
    s_nop 0
    buffer_load_dwordx4 v15, s[16:19], s57 offen sc1 lds
    v_mfma_f32_16x16x32_bf16 v[180:183], v[100:103], v[76:79], v[180:183]
    v_mfma_f32_16x16x32_bf16 v[152:155], v[104:107], v[72:75], v[152:155]
    v_mfma_f32_16x16x32_bf16 v[184:187], v[104:107], v[76:79], v[184:187]
    s_add_u32 m0, s60, 24576
    s_nop 0
    buffer_load_dwordx4 v15, s[24:27], s57 offen sc1 lds
    s_add_u32 s57, s57, 8192
    v_mfma_f32_16x16x32_bf16 v[156:159], v[108:111], v[72:75], v[156:159]
    v_mfma_f32_16x16x32_bf16 v[188:191], v[108:111], v[76:79], v[188:191]
    s_waitcnt lgkmcnt(0)
    v_mfma_f32_16x16x32_bf16 v[128:131], v[40:43], v[32:35], v[128:131]
    ds_read_b128 v[72:75], v247 offset:0
    ds_read_b128 v[76:79], v247 offset:2048
    v_mfma_f32_16x16x32_bf16 v[160:163], v[40:43], v[36:39], v[160:163]
    ds_read_b64_tr_b16 v[80:81], v248 offset:8192
    ds_read_b64_tr_b16 v[82:83], v248 offset:9216
    v_mfma_f32_16x16x32_bf16 v[132:135], v[44:47], v[32:35], v[132:135]
    ds_read_b64_tr_b16 v[84:85], v249 offset:8192
    ds_read_b64_tr_b16 v[86:87], v249 offset:9216
    v_mfma_f32_16x16x32_bf16 v[164:167], v[44:47], v[36:39], v[164:167]
    ds_read_b64_tr_b16 v[88:89], v250 offset:8192
    ds_read_b64_tr_b16 v[90:91], v250 offset:9216
    v_mfma_f32_16x16x32_bf16 v[136:139], v[48:51], v[32:35], v[136:139]
    ds_read_b64_tr_b16 v[92:93], v251 offset:8192
    ds_read_b64_tr_b16 v[94:95], v251 offset:9216
    v_mfma_f32_16x16x32_bf16 v[168:171], v[48:51], v[36:39], v[168:171]
    ds_read_b64_tr_b16 v[96:97], v252 offset:8192
    ds_read_b64_tr_b16 v[98:99], v252 offset:9216
    v_mfma_f32_16x16x32_bf16 v[140:143], v[52:55], v[32:35], v[140:143]
    ds_read_b64_tr_b16 v[100:101], v253 offset:8192
    ds_read_b64_tr_b16 v[102:103], v253 offset:9216
    v_mfma_f32_16x16x32_bf16 v[172:175], v[52:55], v[36:39], v[172:175]
    ds_read_b64_tr_b16 v[104:105], v254 offset:8192
    ds_read_b64_tr_b16 v[106:107], v254 offset:9216
    v_mfma_f32_16x16x32_bf16 v[144:147], v[56:59], v[32:35], v[144:147]
    ds_read_b64_tr_b16 v[108:109], v255 offset:8192
    ds_read_b64_tr_b16 v[110:111], v255 offset:9216
    s_add_u32 m0, s60, 114688
    s_add_u32 s43, s36, 8192
    buffer_load_dwordx4 v15, s[28:31], s36 offen sc1 lds
    v_mfma_f32_16x16x32_bf16 v[176:179], v[56:59], v[36:39], v[176:179]
    v_mfma_f32_16x16x32_bf16 v[148:151], v[60:63], v[32:35], v[148:151]
    v_mfma_f32_16x16x32_bf16 v[180:183], v[60:63], v[36:39], v[180:183]
    v_add_u32 v246, 65536, v236
    v_add_u32 v247, 65536, v237
    v_mfma_f32_16x16x32_bf16 v[152:155], v[64:67], v[32:35], v[152:155]
    s_add_u32 m0, s60, 122880
    s_sub_u32 s36, s36, 8192
    buffer_load_dwordx4 v15, s[68:71], s43 offen sc1 lds
    v_add_u32 v248, 98304, v238
    v_add_u32 v249, 98304, v239
    v_mfma_f32_16x16x32_bf16 v[184:187], v[64:67], v[36:39], v[184:187]
    v_add_u32 v250, 98304, v240
    v_add_u32 v251, 98304, v241
    v_mfma_f32_16x16x32_bf16 v[156:159], v[68:71], v[32:35], v[156:159]
    v_add_u32 v252, 98304, v242
    v_add_u32 v253, 98304, v243
    v_mfma_f32_16x16x32_bf16 v[188:191], v[68:71], v[36:39], v[188:191]
    v_add_u32 v254, 98304, v244
    v_add_u32 v255, 98304, v245
    s_waitcnt lgkmcnt(0)
    s_barrier
    s_cmp_lg_u32 s3, 6
    s_cbranch_scc1 kf_nored2
    s_waitcnt vmcnt(5)
    v_add_f32 v192, v192, v196
    v_add_f32 v193, v193, v197
    v_add_f32 v194, v194, v198
    v_add_f32 v195, v195, v199
    v_add_f32 v192, v192, v200
    v_add_f32 v193, v193, v201
    v_add_f32 v194, v194, v202
    v_add_f32 v195, v195, v203
    v_add_f32 v192, v192, v204
    v_add_f32 v193, v193, v205
    v_add_f32 v194, v194, v206
    v_add_f32 v195, v195, v207
    v_add_f32 v192, v192, v208
    v_add_f32 v193, v193, v209
    v_add_f32 v194, v194, v210
    v_add_f32 v195, v195, v211
    v_add_f32 v192, v192, v212
    v_add_f32 v193, v193, v213
    v_add_f32 v194, v194, v214
    v_add_f32 v195, v195, v215
    v_add_f32 v192, v192, v216
    v_add_f32 v193, v193, v217
    v_add_f32 v194, v194, v218
    v_add_f32 v195, v195, v219
    v_add_f32 v192, v192, v220
    v_add_f32 v193, v193, v221
    v_add_f32 v194, v194, v222
    v_add_f32 v195, v195, v223
    v_add_f32 v192, v192, v224
    v_add_f32 v193, v193, v225
    v_add_f32 v194, v194, v226
    v_add_f32 v195, v195, v227
    v_add_f32 v192, v192, v228
    v_add_f32 v193, v193, v229
    v_add_f32 v194, v194, v230
    v_add_f32 v195, v195, v231
    v_add_f32 v192, v192, v232
    v_add_f32 v193, v193, v233
    v_add_f32 v194, v194, v234
    v_add_f32 v195, v195, v235
    v_add_f32 v192, v192, v112
    v_add_f32 v193, v193, v113
    v_add_f32 v194, v194, v114
    v_add_f32 v195, v195, v115
    v_add_f32 v192, v192, v116
    v_add_f32 v193, v193, v117
    v_add_f32 v194, v194, v118
    v_add_f32 v195, v195, v119
    v_add_f32 v192, v192, v120
    v_add_f32 v193, v193, v121
    v_add_f32 v194, v194, v122
    v_add_f32 v195, v195, v123
    v_add_f32 v192, v192, v124
    v_add_f32 v193, v193, v125
    v_add_f32 v194, v194, v126
    v_add_f32 v195, v195, v127
    v_add_f32 v192, v192, v28
    v_add_f32 v193, v193, v29
    v_add_f32 v194, v194, v30
    v_add_f32 v195, v195, v31
    v_cmp_lt_u32 vcc, 179, v20
    v_mov_b32 v8, 0
    v_mov_b32 v7, 1
    v_cndmask_b32 v8, v8, v7, vcc
    v_mul_u32_u24 v7, 180, v8
    v_sub_u32 v5, v20, v7
    v_mul_u32_u24 v6, 205, v5
    v_lshrrev_b32 v6, 10, v6
    v_mul_u32_u24 v7, 5, v6
    v_sub_u32 v5, v5, v7
    v_lshrrev_b32 v7, 3, v6
    v_lshlrev_b32 v19, 10, v7
    v_and_b32 v6, 7, v6
    v_lshl_add_u32 v19, v6, 1, v19
    v_lshrrev_b32 v7, 2, v5
    v_mul_u32_u24 v7, 5120, v7
    v_add_u32 v19, v19, v7
    v_and_b32 v7, 3, v5
    v_lshl_add_u32 v19, v7, 7, v19
    v_mul_u32_u24 v8, 576, v8
    v_add_u32 v19, v19, v8
    s_mul_i32 s32, s6, 10240
    s_add_u32 s32, s32, 65011712
    v_cvt_pk_bf16_f32 v192, v192, v192
    v_cvt_pk_bf16_f32 v193, v193, v193
    v_cvt_pk_bf16_f32 v194, v194, v194
    v_cvt_pk_bf16_f32 v195, v195, v195
    buffer_store_short v192, v19, s[20:23], s32 offen offset:0 sc1
    buffer_store_short v193, v19, s[20:23], s32 offen offset:16 sc1
    buffer_store_short v194, v19, s[20:23], s32 offen offset:32 sc1
    buffer_store_short v195, v19, s[20:23], s32 offen offset:48 sc1
kf_nored2:
    v_mfma_f32_16x16x32_bf16 v[128:131], v[80:83], v[72:75], v[128:131]
    ds_read_b128 v[32:35], v246 offset:0
    ds_read_b128 v[36:39], v246 offset:2048
    v_mfma_f32_16x16x32_bf16 v[160:163], v[80:83], v[76:79], v[160:163]
    ds_read_b64_tr_b16 v[40:41], v248 offset:0
    ds_read_b64_tr_b16 v[42:43], v248 offset:1024
    v_mfma_f32_16x16x32_bf16 v[132:135], v[84:87], v[72:75], v[132:135]
    ds_read_b64_tr_b16 v[44:45], v249 offset:0
    ds_read_b64_tr_b16 v[46:47], v249 offset:1024
    v_mfma_f32_16x16x32_bf16 v[164:167], v[84:87], v[76:79], v[164:167]
    ds_read_b64_tr_b16 v[48:49], v250 offset:0
    ds_read_b64_tr_b16 v[50:51], v250 offset:1024
    v_mfma_f32_16x16x32_bf16 v[136:139], v[88:91], v[72:75], v[136:139]
    ds_read_b64_tr_b16 v[52:53], v251 offset:0
    ds_read_b64_tr_b16 v[54:55], v251 offset:1024
    v_mfma_f32_16x16x32_bf16 v[168:171], v[88:91], v[76:79], v[168:171]
    ds_read_b64_tr_b16 v[56:57], v252 offset:0
    ds_read_b64_tr_b16 v[58:59], v252 offset:1024
    v_mfma_f32_16x16x32_bf16 v[140:143], v[92:95], v[72:75], v[140:143]
    ds_read_b64_tr_b16 v[60:61], v253 offset:0
    ds_read_b64_tr_b16 v[62:63], v253 offset:1024
    v_mfma_f32_16x16x32_bf16 v[172:175], v[92:95], v[76:79], v[172:175]
    ds_read_b64_tr_b16 v[64:65], v254 offset:0
    ds_read_b64_tr_b16 v[66:67], v254 offset:1024
    v_mfma_f32_16x16x32_bf16 v[144:147], v[96:99], v[72:75], v[144:147]
    ds_read_b64_tr_b16 v[68:69], v255 offset:0
    ds_read_b64_tr_b16 v[70:71], v255 offset:1024
    s_add_u32 m0, s60, 32768
    s_nop 0
    buffer_load_dwordx4 v15, s[16:19], s57 offen sc1 lds
    v_mfma_f32_16x16x32_bf16 v[176:179], v[96:99], v[76:79], v[176:179]
    v_mfma_f32_16x16x32_bf16 v[148:151], v[100:103], v[72:75], v[148:151]
    v_mfma_f32_16x16x32_bf16 v[180:183], v[100:103], v[76:79], v[180:183]
    v_mfma_f32_16x16x32_bf16 v[152:155], v[104:107], v[72:75], v[152:155]
    s_add_u32 m0, s60, 40960
    s_nop 0
    buffer_load_dwordx4 v15, s[24:27], s57 offen sc1 lds
    s_add_u32 s57, s57, 8192
    v_mfma_f32_16x16x32_bf16 v[184:187], v[104:107], v[76:79], v[184:187]
    v_mfma_f32_16x16x32_bf16 v[156:159], v[108:111], v[72:75], v[156:159]
    v_mfma_f32_16x16x32_bf16 v[188:191], v[108:111], v[76:79], v[188:191]
    s_waitcnt lgkmcnt(0)
    v_mfma_f32_16x16x32_bf16 v[128:131], v[40:43], v[32:35], v[128:131]
    ds_read_b128 v[72:75], v247 offset:0
    ds_read_b128 v[76:79], v247 offset:2048
    v_mfma_f32_16x16x32_bf16 v[160:163], v[40:43], v[36:39], v[160:163]
    ds_read_b64_tr_b16 v[80:81], v248 offset:8192
    ds_read_b64_tr_b16 v[82:83], v248 offset:9216
    v_mfma_f32_16x16x32_bf16 v[132:135], v[44:47], v[32:35], v[132:135]
    ds_read_b64_tr_b16 v[84:85], v249 offset:8192
    ds_read_b64_tr_b16 v[86:87], v249 offset:9216
    v_mfma_f32_16x16x32_bf16 v[164:167], v[44:47], v[36:39], v[164:167]
    ds_read_b64_tr_b16 v[88:89], v250 offset:8192
    ds_read_b64_tr_b16 v[90:91], v250 offset:9216
    v_mfma_f32_16x16x32_bf16 v[136:139], v[48:51], v[32:35], v[136:139]
    ds_read_b64_tr_b16 v[92:93], v251 offset:8192
    ds_read_b64_tr_b16 v[94:95], v251 offset:9216
    v_mfma_f32_16x16x32_bf16 v[168:171], v[48:51], v[36:39], v[168:171]
    ds_read_b64_tr_b16 v[96:97], v252 offset:8192
    ds_read_b64_tr_b16 v[98:99], v252 offset:9216
    v_mfma_f32_16x16x32_bf16 v[140:143], v[52:55], v[32:35], v[140:143]
    ds_read_b64_tr_b16 v[100:101], v253 offset:8192
    ds_read_b64_tr_b16 v[102:103], v253 offset:9216
    v_mfma_f32_16x16x32_bf16 v[172:175], v[52:55], v[36:39], v[172:175]
    ds_read_b64_tr_b16 v[104:105], v254 offset:8192
    ds_read_b64_tr_b16 v[106:107], v254 offset:9216
    v_mfma_f32_16x16x32_bf16 v[144:147], v[56:59], v[32:35], v[144:147]
    ds_read_b64_tr_b16 v[108:109], v255 offset:8192
    ds_read_b64_tr_b16 v[110:111], v255 offset:9216
    s_add_u32 m0, s60, 131072
    s_add_u32 s43, s36, 8192
    buffer_load_dwordx4 v15, s[28:31], s36 offen sc1 lds
    v_mfma_f32_16x16x32_bf16 v[176:179], v[56:59], v[36:39], v[176:179]
    v_mfma_f32_16x16x32_bf16 v[148:151], v[60:63], v[32:35], v[148:151]
    v_mfma_f32_16x16x32_bf16 v[180:183], v[60:63], v[36:39], v[180:183]
    v_add_u32 v246, 0, v236
    v_add_u32 v247, 0, v237
    v_mfma_f32_16x16x32_bf16 v[152:155], v[64:67], v[32:35], v[152:155]
    s_add_u32 m0, s60, 139264
    s_sub_u32 s36, s36, 8192
    buffer_load_dwordx4 v15, s[68:71], s43 offen sc1 lds
    v_add_u32 v248, 114688, v238
    v_add_u32 v249, 114688, v239
    v_mfma_f32_16x16x32_bf16 v[184:187], v[64:67], v[36:39], v[184:187]
    v_add_u32 v250, 114688, v240
    v_add_u32 v251, 114688, v241
    v_mfma_f32_16x16x32_bf16 v[156:159], v[68:71], v[32:35], v[156:159]
    v_add_u32 v252, 114688, v242
    v_add_u32 v253, 114688, v243
    v_mfma_f32_16x16x32_bf16 v[188:191], v[68:71], v[36:39], v[188:191]
    v_add_u32 v254, 114688, v244
    v_add_u32 v255, 114688, v245
kf_qd:
    s_waitcnt lgkmcnt(0)
    v_mfma_f32_16x16x32_bf16 v[128:131], v[80:83], v[72:75], v[128:131]
    v_mfma_f32_16x16x32_bf16 v[160:163], v[80:83], v[76:79], v[160:163]
    v_mfma_f32_16x16x32_bf16 v[132:135], v[84:87], v[72:75], v[132:135]
    v_mfma_f32_16x16x32_bf16 v[164:167], v[84:87], v[76:79], v[164:167]
    v_mfma_f32_16x16x32_bf16 v[136:139], v[88:91], v[72:75], v[136:139]
    v_mfma_f32_16x16x32_bf16 v[168:171], v[88:91], v[76:79], v[168:171]
    v_mfma_f32_16x16x32_bf16 v[140:143], v[92:95], v[72:75], v[140:143]
    v_mfma_f32_16x16x32_bf16 v[172:175], v[92:95], v[76:79], v[172:175]
    v_mfma_f32_16x16x32_bf16 v[144:147], v[96:99], v[72:75], v[144:147]
    v_mfma_f32_16x16x32_bf16 v[176:179], v[96:99], v[76:79], v[176:179]
    v_mfma_f32_16x16x32_bf16 v[148:151], v[100:103], v[72:75], v[148:151]
    v_mfma_f32_16x16x32_bf16 v[180:183], v[100:103], v[76:79], v[180:183]
    v_mfma_f32_16x16x32_bf16 v[152:155], v[104:107], v[72:75], v[152:155]
    v_mfma_f32_16x16x32_bf16 v[184:187], v[104:107], v[76:79], v[184:187]
    v_mfma_f32_16x16x32_bf16 v[156:159], v[108:111], v[72:75], v[156:159]
    v_mfma_f32_16x16x32_bf16 v[188:191], v[108:111], v[76:79], v[188:191]
    s_waitcnt vmcnt(8)
    s_barrier
    ds_read_b128 v[32:35], v4 offset:0
    ds_read_b128 v[36:39], v4 offset:1024
    ds_read_b128 v[40:43], v4 offset:2048
    ds_read_b128 v[44:47], v4 offset:3072
    ds_read_b128 v[48:51], v4 offset:4096
    ds_read_b128 v[52:55], v4 offset:5120
    ds_read_b128 v[56:59], v4 offset:6144
    ds_read_b128 v[60:63], v4 offset:7168
    v_mov_b32 v24, 0
    v_mov_b32 v25, 0
    v_mov_b32 v26, 0
    v_mov_b32 v27, 0
    v_mov_b32 v28, 0
    v_mov_b32 v29, 0
    v_mov_b32 v30, 0
    v_mov_b32 v31, 0
    v_cvt_pk_bf16_f32 v96, v128, v129
    v_cvt_pk_bf16_f32 v97, v130, v131
    v_cvt_pk_bf16_f32 v98, v132, v133
    v_cvt_pk_bf16_f32 v99, v134, v135
    v_cvt_pk_bf16_f32 v100, v136, v137
    v_cvt_pk_bf16_f32 v101, v138, v139
    v_cvt_pk_bf16_f32 v102, v140, v141
    v_cvt_pk_bf16_f32 v103, v142, v143
    v_cvt_pk_bf16_f32 v104, v144, v145
    v_cvt_pk_bf16_f32 v105, v146, v147
    v_cvt_pk_bf16_f32 v106, v148, v149
    v_cvt_pk_bf16_f32 v107, v150, v151
    v_cvt_pk_bf16_f32 v108, v152, v153
    v_cvt_pk_bf16_f32 v109, v154, v155
    v_cvt_pk_bf16_f32 v110, v156, v157
    v_cvt_pk_bf16_f32 v111, v158, v159
    v_cvt_pk_bf16_f32 v112, v160, v161
    v_cvt_pk_bf16_f32 v113, v162, v163
    v_cvt_pk_bf16_f32 v114, v164, v165
    v_cvt_pk_bf16_f32 v115, v166, v167
    v_cvt_pk_bf16_f32 v116, v168, v169
    v_cvt_pk_bf16_f32 v117, v170, v171
    v_cvt_pk_bf16_f32 v118, v172, v173
    v_cvt_pk_bf16_f32 v119, v174, v175
    v_cvt_pk_bf16_f32 v120, v176, v177
    v_cvt_pk_bf16_f32 v121, v178, v179
    v_cvt_pk_bf16_f32 v122, v180, v181
    v_cvt_pk_bf16_f32 v123, v182, v183
    v_cvt_pk_bf16_f32 v124, v184, v185
    v_cvt_pk_bf16_f32 v125, v186, v187
    v_cvt_pk_bf16_f32 v126, v188, v189
    v_cvt_pk_bf16_f32 v127, v190, v191
    s_sub_u32 s33, 3, s40
    s_cmp_eq_u32 s45, 0
    s_cselect_b32 s32, s33, s40
    s_lshl_b32 s32, s32, 13
    s_add_u32 s32, s32, 65536
    v_add_u32 v12, s32, v4
    v_cmp_gt_i32 s[90:91], 0, v16
    v_cmp_gt_i32 s[92:93], 1, v16
    v_cmp_gt_i32 s[94:95], 2, v16
    v_cmp_gt_i32 s[96:97], 3, v16
    s_cmp_eq_u32 s45, 0
    s_cbranch_scc1 kf_nostash
    ds_write_b128 v12, v[96:99] offset:0
    ds_write_b128 v12, v[100:103] offset:1024
    ds_write_b128 v12, v[104:107] offset:2048
    ds_write_b128 v12, v[108:111] offset:3072
    ds_write_b128 v12, v[112:115] offset:4096
    ds_write_b128 v12, v[116:119] offset:5120
    ds_write_b128 v12, v[120:123] offset:6144
    ds_write_b128 v12, v[124:127] offset:7168
kf_nostash:
    s_waitcnt lgkmcnt(0)
    v_mfma_f32_16x16x32_bf16 v[192:195], v[32:35], v[96:99], v[24:27]
    v_mov_b64 v[128:129], 0
    v_mov_b64 v[130:131], 0
    v_mov_b64 v[132:133], 0
    v_mov_b64 v[134:135], 0
    v_mfma_f32_16x16x32_bf16 v[192:195], v[36:39], v[100:103], v[192:195]
    v_mov_b64 v[136:137], 0
    v_mov_b64 v[138:139], 0
    v_mov_b64 v[140:141], 0
    v_mfma_f32_16x16x32_bf16 v[192:195], v[40:43], v[104:107], v[192:195]
    v_mov_b64 v[142:143], 0
    v_mov_b64 v[144:145], 0
    v_mov_b64 v[146:147], 0
    v_mov_b64 v[148:149], 0
    v_mfma_f32_16x16x32_bf16 v[192:195], v[44:47], v[108:111], v[192:195]
    v_mov_b64 v[150:151], 0
    v_mov_b64 v[152:153], 0
    v_mov_b64 v[154:155], 0
    v_mfma_f32_16x16x32_bf16 v[196:199], v[48:51], v[96:99], v[24:27]
    v_mov_b64 v[156:157], 0
    v_mov_b64 v[158:159], 0
    v_mov_b64 v[160:161], 0
    v_mfma_f32_16x16x32_bf16 v[196:199], v[52:55], v[100:103], v[196:199]
    v_mov_b64 v[162:163], 0
    v_mov_b64 v[164:165], 0
    v_mov_b64 v[166:167], 0
    v_mov_b64 v[168:169], 0
    v_mfma_f32_16x16x32_bf16 v[196:199], v[56:59], v[104:107], v[196:199]
    v_mov_b64 v[170:171], 0
    v_mov_b64 v[172:173], 0
    v_mov_b64 v[174:175], 0
    v_mfma_f32_16x16x32_bf16 v[196:199], v[60:63], v[108:111], v[196:199]
    v_mov_b64 v[176:177], 0
    v_mov_b64 v[178:179], 0
    v_mov_b64 v[180:181], 0
    v_mfma_f32_16x16x32_bf16 v[200:203], v[32:35], v[112:115], v[28:31]
    v_mov_b64 v[182:183], 0
    v_mov_b64 v[184:185], 0
    v_mov_b64 v[186:187], 0
    v_mov_b64 v[188:189], 0
    v_mfma_f32_16x16x32_bf16 v[200:203], v[36:39], v[116:119], v[200:203]
    v_mov_b64 v[190:191], 0
    v_mov_b64 v[64:65], 0
    v_mov_b64 v[66:67], 0
    v_mfma_f32_16x16x32_bf16 v[200:203], v[40:43], v[120:123], v[200:203]
    v_mov_b64 v[68:69], 0
    v_mov_b64 v[70:71], 0
    v_mov_b64 v[72:73], 0
    v_mov_b64 v[74:75], 0
    v_mfma_f32_16x16x32_bf16 v[200:203], v[44:47], v[124:127], v[200:203]
    v_mov_b64 v[76:77], 0
    v_mov_b64 v[78:79], 0
    v_mov_b64 v[80:81], 0
    v_mfma_f32_16x16x32_bf16 v[204:207], v[48:51], v[112:115], v[28:31]
    v_mov_b64 v[82:83], 0
    v_mov_b64 v[84:85], 0
    v_mov_b64 v[86:87], 0
    v_mfma_f32_16x16x32_bf16 v[204:207], v[52:55], v[116:119], v[204:207]
    v_mov_b64 v[88:89], 0
    v_mov_b64 v[90:91], 0
    v_mov_b64 v[92:93], 0
    v_mov_b64 v[94:95], 0
    v_mfma_f32_16x16x32_bf16 v[204:207], v[56:59], v[120:123], v[204:207]
    v_mov_b64 v[232:233], 0
    v_mov_b64 v[234:235], 0
    v_mov_b64 v[236:237], 0
    v_mfma_f32_16x16x32_bf16 v[204:207], v[60:63], v[124:127], v[204:207]
    v_mov_b64 v[238:239], 0
    v_mov_b64 v[248:249], 0
    v_mov_b64 v[250:251], 0
    s_mov_b32 s38, 0
    v_mov_b32 v13, v4
    v_mov_b32 v14, v4
kf_loop:
    s_waitcnt vmcnt(0) lgkmcnt(0)
    s_barrier
    s_bitcmp1_b32 s48, 0
    s_cbranch_scc1 kf_sp0loop
kf_spret0loop:
    v_mfma_f32_16x16x32_bf16 v[128:131], v[64:67], v[232:235], v[128:131]
    v_add_f32 v248, v248, v250
    v_add_f32 v249, v249, v251
    ds_read_b128 v[32:35], v13 offset:16384
    v_mfma_f32_16x16x32_bf16 v[160:163], v[64:67], v[236:239], v[160:163]
    ds_read_b128 v[36:39], v13 offset:17408
    v_exp_f32 v240, v192
    v_exp_f32 v241, v193
    v_mfma_f32_16x16x32_bf16 v[132:135], v[68:71], v[232:235], v[132:135]
    ds_read_b128 v[40:43], v13 offset:18432
    v_exp_f32 v242, v194
    v_mfma_f32_16x16x32_bf16 v[164:167], v[68:71], v[236:239], v[164:167]
    ds_read_b128 v[44:47], v13 offset:19456
    v_exp_f32 v243, v195
    v_add_f32 v250, v240, v241
    v_mfma_f32_16x16x32_bf16 v[136:139], v[72:75], v[232:235], v[136:139]
    ds_read_b128 v[48:51], v13 offset:20480
    v_cvt_pk_bf16_f32 v224, v240, v241
    v_mfma_f32_16x16x32_bf16 v[168:171], v[72:75], v[236:239], v[168:171]
    ds_read_b128 v[52:55], v13 offset:21504
    v_exp_f32 v244, v196
    v_mfma_f32_16x16x32_bf16 v[140:143], v[76:79], v[232:235], v[140:143]
    ds_read_b128 v[56:59], v13 offset:22528
    v_exp_f32 v245, v197
    v_add_f32 v250, v250, v242
    v_mfma_f32_16x16x32_bf16 v[172:175], v[76:79], v[236:239], v[172:175]
    ds_read_b128 v[60:63], v13 offset:23552
    v_add_f32 v250, v250, v243
    v_mfma_f32_16x16x32_bf16 v[144:147], v[80:83], v[232:235], v[144:147]
    v_cvt_pk_bf16_f32 v225, v242, v243
    s_add_u32 m0, s60, 49152
    s_nop 0
    buffer_load_dwordx4 v15, s[16:19], s57 offen sc1 lds
    v_mfma_f32_16x16x32_bf16 v[176:179], v[80:83], v[236:239], v[176:179]
    v_exp_f32 v246, v198
    v_exp_f32 v247, v199
    v_mfma_f32_16x16x32_bf16 v[148:151], v[84:87], v[232:235], v[148:151]
    v_add_f32 v250, v250, v244
    s_add_u32 m0, s60, 57344
    s_nop 0
    buffer_load_dwordx4 v15, s[24:27], s57 offen sc1 lds
    s_add_u32 s57, s57, 8192
    v_mfma_f32_16x16x32_bf16 v[180:183], v[84:87], v[236:239], v[180:183]
    v_add_f32 v250, v250, v245
    v_mfma_f32_16x16x32_bf16 v[152:155], v[88:91], v[232:235], v[152:155]
    v_cvt_pk_bf16_f32 v226, v244, v245
    v_exp_f32 v240, v200
    s_add_u32 m0, s60, 147456
    s_add_u32 s43, s36, 8192
    buffer_load_dwordx4 v15, s[28:31], s36 offen sc1 lds
    v_mfma_f32_16x16x32_bf16 v[184:187], v[88:91], v[236:239], v[184:187]
    v_exp_f32 v241, v201
    v_mfma_f32_16x16x32_bf16 v[156:159], v[92:95], v[232:235], v[156:159]
    v_add_f32 v250, v250, v246
    s_add_u32 m0, s60, 155648
    s_sub_u32 s36, s36, 8192
    buffer_load_dwordx4 v15, s[68:71], s43 offen sc1 lds
    v_mfma_f32_16x16x32_bf16 v[188:191], v[92:95], v[236:239], v[188:191]
    s_waitcnt lgkmcnt(0)
    v_add_f32 v250, v250, v247
    v_cvt_pk_bf16_f32 v227, v246, v247
    v_mfma_f32_16x16x32_bf16 v[208:211], v[32:35], v[96:99], v[24:27]
    ds_read_b128 v[64:67], v14 offset:24576
    v_exp_f32 v242, v202
    v_mfma_f32_16x16x32_bf16 v[208:211], v[36:39], v[100:103], v[208:211]
    ds_read_b128 v[68:71], v14 offset:25600
    v_exp_f32 v243, v203
    v_add_f32 v251, v240, v241
    v_mfma_f32_16x16x32_bf16 v[208:211], v[40:43], v[104:107], v[208:211]
    ds_read_b128 v[72:75], v14 offset:26624
    v_cvt_pk_bf16_f32 v228, v240, v241
    v_mfma_f32_16x16x32_bf16 v[208:211], v[44:47], v[108:111], v[208:211]
    ds_read_b128 v[76:79], v14 offset:27648
    v_exp_f32 v244, v204
    v_mfma_f32_16x16x32_bf16 v[212:215], v[48:51], v[96:99], v[24:27]
    ds_read_b128 v[80:83], v14 offset:28672
    v_exp_f32 v245, v205
    v_add_f32 v251, v251, v242
    v_mfma_f32_16x16x32_bf16 v[212:215], v[52:55], v[100:103], v[212:215]
    ds_read_b128 v[84:87], v14 offset:29696
    v_add_f32 v251, v251, v243
    v_mfma_f32_16x16x32_bf16 v[212:215], v[56:59], v[104:107], v[212:215]
    ds_read_b128 v[88:91], v14 offset:30720
    v_cvt_pk_bf16_f32 v229, v242, v243
    v_mfma_f32_16x16x32_bf16 v[212:215], v[60:63], v[108:111], v[212:215]
    ds_read_b128 v[92:95], v14 offset:31744
    v_exp_f32 v246, v206
    v_exp_f32 v247, v207
    v_mfma_f32_16x16x32_bf16 v[216:219], v[32:35], v[112:115], v[28:31]
    v_add_f32 v251, v251, v244
    s_add_u32 m0, s60, 0
    s_nop 0
    buffer_load_dwordx4 v15, s[16:19], s57 offen sc1 lds
    v_mfma_f32_16x16x32_bf16 v[216:219], v[36:39], v[116:119], v[216:219]
    v_add_f32 v251, v251, v245
    v_mfma_f32_16x16x32_bf16 v[216:219], v[40:43], v[120:123], v[216:219]
    v_cvt_pk_bf16_f32 v230, v244, v245
    v_add_f32 v251, v251, v246
    s_add_u32 m0, s60, 8192
    s_nop 0
    buffer_load_dwordx4 v15, s[24:27], s57 offen sc1 lds
    s_add_u32 s57, s57, 8192
    v_mfma_f32_16x16x32_bf16 v[216:219], v[44:47], v[124:127], v[216:219]
    v_add_f32 v251, v251, v247
    v_mfma_f32_16x16x32_bf16 v[220:223], v[48:51], v[112:115], v[28:31]
    v_cvt_pk_bf16_f32 v231, v246, v247
    s_add_u32 m0, s60, 98304
    s_add_u32 s43, s36, 8192
    buffer_load_dwordx4 v15, s[28:31], s36 offen sc1 lds
    v_mfma_f32_16x16x32_bf16 v[220:223], v[52:55], v[116:119], v[220:223]
    v_max_f32 v252, v250, v251
    v_mfma_f32_16x16x32_bf16 v[220:223], v[56:59], v[120:123], v[220:223]
    s_add_u32 m0, s60, 106496
    s_sub_u32 s36, s36, 8192
    buffer_load_dwordx4 v15, s[68:71], s43 offen sc1 lds
    v_cmp_nge_f32 vcc, s42, v252
    v_mfma_f32_16x16x32_bf16 v[220:223], v[60:63], v[124:127], v[220:223]
    s_cbranch_vccnz kf_sl0loop
kf_slret0loop:
    s_waitcnt lgkmcnt(0)
    s_bitcmp1_b32 s48, 1
    s_cbranch_scc1 kf_sp1loop
kf_spret1loop:
    v_mfma_f32_16x16x32_bf16 v[128:131], v[64:67], v[224:227], v[128:131]
    v_add_f32 v248, v248, v250
    v_add_f32 v249, v249, v251
    ds_read_b128 v[32:35], v13 offset:32768
    v_mfma_f32_16x16x32_bf16 v[160:163], v[64:67], v[228:231], v[160:163]
    ds_read_b128 v[36:39], v13 offset:33792
    v_exp_f32 v240, v208
    v_exp_f32 v241, v209
    v_mfma_f32_16x16x32_bf16 v[132:135], v[68:71], v[224:227], v[132:135]
    ds_read_b128 v[40:43], v13 offset:34816
    v_exp_f32 v242, v210
    v_mfma_f32_16x16x32_bf16 v[164:167], v[68:71], v[228:231], v[164:167]
    ds_read_b128 v[44:47], v13 offset:35840
    v_exp_f32 v243, v211
    v_add_f32 v250, v240, v241
    v_mfma_f32_16x16x32_bf16 v[136:139], v[72:75], v[224:227], v[136:139]
    ds_read_b128 v[48:51], v13 offset:36864
    v_cvt_pk_bf16_f32 v232, v240, v241
    v_mfma_f32_16x16x32_bf16 v[168:171], v[72:75], v[228:231], v[168:171]
    ds_read_b128 v[52:55], v13 offset:37888
    v_exp_f32 v244, v212
    v_mfma_f32_16x16x32_bf16 v[140:143], v[76:79], v[224:227], v[140:143]
    ds_read_b128 v[56:59], v13 offset:38912
    v_exp_f32 v245, v213
    v_add_f32 v250, v250, v242
    v_mfma_f32_16x16x32_bf16 v[172:175], v[76:79], v[228:231], v[172:175]
    ds_read_b128 v[60:63], v13 offset:39936
    v_add_f32 v250, v250, v243
    v_mfma_f32_16x16x32_bf16 v[144:147], v[80:83], v[224:227], v[144:147]
    v_cvt_pk_bf16_f32 v233, v242, v243
    v_mfma_f32_16x16x32_bf16 v[176:179], v[80:83], v[228:231], v[176:179]
    v_exp_f32 v246, v214
    v_exp_f32 v247, v215
    v_mfma_f32_16x16x32_bf16 v[148:151], v[84:87], v[224:227], v[148:151]
    v_add_f32 v250, v250, v244
    v_mfma_f32_16x16x32_bf16 v[180:183], v[84:87], v[228:231], v[180:183]
    v_add_f32 v250, v250, v245
    v_mfma_f32_16x16x32_bf16 v[152:155], v[88:91], v[224:227], v[152:155]
    v_cvt_pk_bf16_f32 v234, v244, v245
    v_exp_f32 v240, v216
    v_mfma_f32_16x16x32_bf16 v[184:187], v[88:91], v[228:231], v[184:187]
    v_exp_f32 v241, v217
    v_mfma_f32_16x16x32_bf16 v[156:159], v[92:95], v[224:227], v[156:159]
    v_add_f32 v250, v250, v246
    v_mfma_f32_16x16x32_bf16 v[188:191], v[92:95], v[228:231], v[188:191]
    s_waitcnt lgkmcnt(0)
    v_add_f32 v250, v250, v247
    v_cvt_pk_bf16_f32 v235, v246, v247
    v_mfma_f32_16x16x32_bf16 v[192:195], v[32:35], v[96:99], v[24:27]
    ds_read_b128 v[64:67], v14 offset:40960
    v_exp_f32 v242, v218
    v_mfma_f32_16x16x32_bf16 v[192:195], v[36:39], v[100:103], v[192:195]
    ds_read_b128 v[68:71], v14 offset:41984
    v_exp_f32 v243, v219
    v_add_f32 v251, v240, v241
    v_mfma_f32_16x16x32_bf16 v[192:195], v[40:43], v[104:107], v[192:195]
    ds_read_b128 v[72:75], v14 offset:43008
    v_cvt_pk_bf16_f32 v236, v240, v241
    v_mfma_f32_16x16x32_bf16 v[192:195], v[44:47], v[108:111], v[192:195]
    ds_read_b128 v[76:79], v14 offset:44032
    v_exp_f32 v244, v220
    v_mfma_f32_16x16x32_bf16 v[196:199], v[48:51], v[96:99], v[24:27]
    ds_read_b128 v[80:83], v14 offset:45056
    v_exp_f32 v245, v221
    v_add_f32 v251, v251, v242
    v_mfma_f32_16x16x32_bf16 v[196:199], v[52:55], v[100:103], v[196:199]
    ds_read_b128 v[84:87], v14 offset:46080
    v_add_f32 v251, v251, v243
    v_mfma_f32_16x16x32_bf16 v[196:199], v[56:59], v[104:107], v[196:199]
    ds_read_b128 v[88:91], v14 offset:47104
    v_cvt_pk_bf16_f32 v237, v242, v243
    v_mfma_f32_16x16x32_bf16 v[196:199], v[60:63], v[108:111], v[196:199]
    ds_read_b128 v[92:95], v14 offset:48128
    v_exp_f32 v246, v222
    v_exp_f32 v247, v223
    v_mfma_f32_16x16x32_bf16 v[200:203], v[32:35], v[112:115], v[28:31]
    v_add_f32 v251, v251, v244
    v_mfma_f32_16x16x32_bf16 v[200:203], v[36:39], v[116:119], v[200:203]
    v_add_f32 v251, v251, v245
    v_mfma_f32_16x16x32_bf16 v[200:203], v[40:43], v[120:123], v[200:203]
    v_cvt_pk_bf16_f32 v238, v244, v245
    v_add_f32 v251, v251, v246
    v_mfma_f32_16x16x32_bf16 v[200:203], v[44:47], v[124:127], v[200:203]
    v_add_f32 v251, v251, v247
    v_mfma_f32_16x16x32_bf16 v[204:207], v[48:51], v[112:115], v[28:31]
    v_cvt_pk_bf16_f32 v239, v246, v247
    v_mfma_f32_16x16x32_bf16 v[204:207], v[52:55], v[116:119], v[204:207]
    v_max_f32 v252, v250, v251
    v_mfma_f32_16x16x32_bf16 v[204:207], v[56:59], v[120:123], v[204:207]
    v_cmp_nge_f32 vcc, s42, v252
    v_mfma_f32_16x16x32_bf16 v[204:207], v[60:63], v[124:127], v[204:207]
    s_cbranch_vccnz kf_sl1loop
kf_slret1loop:
    s_waitcnt vmcnt(0) lgkmcnt(0)
    s_barrier
    s_bitcmp1_b32 s48, 2
    s_cbranch_scc1 kf_sp2loop
kf_spret2loop:
    v_mfma_f32_16x16x32_bf16 v[128:131], v[64:67], v[232:235], v[128:131]
    v_add_f32 v248, v248, v250
    v_add_f32 v249, v249, v251
    ds_read_b128 v[32:35], v13 offset:49152
    v_mfma_f32_16x16x32_bf16 v[160:163], v[64:67], v[236:239], v[160:163]
    ds_read_b128 v[36:39], v13 offset:50176
    v_exp_f32 v240, v192
    v_exp_f32 v241, v193
    v_mfma_f32_16x16x32_bf16 v[132:135], v[68:71], v[232:235], v[132:135]
    ds_read_b128 v[40:43], v13 offset:51200
    v_exp_f32 v242, v194
    v_mfma_f32_16x16x32_bf16 v[164:167], v[68:71], v[236:239], v[164:167]
    ds_read_b128 v[44:47], v13 offset:52224
    v_exp_f32 v243, v195
    v_add_f32 v250, v240, v241
    v_mfma_f32_16x16x32_bf16 v[136:139], v[72:75], v[232:235], v[136:139]
    ds_read_b128 v[48:51], v13 offset:53248
    v_cvt_pk_bf16_f32 v224, v240, v241
    v_mfma_f32_16x16x32_bf16 v[168:171], v[72:75], v[236:239], v[168:171]
    ds_read_b128 v[52:55], v13 offset:54272
    v_exp_f32 v244, v196
    v_mfma_f32_16x16x32_bf16 v[140:143], v[76:79], v[232:235], v[140:143]
    ds_read_b128 v[56:59], v13 offset:55296
    v_exp_f32 v245, v197
    v_add_f32 v250, v250, v242
    v_mfma_f32_16x16x32_bf16 v[172:175], v[76:79], v[236:239], v[172:175]
    ds_read_b128 v[60:63], v13 offset:56320
    v_add_f32 v250, v250, v243
    v_mfma_f32_16x16x32_bf16 v[144:147], v[80:83], v[232:235], v[144:147]
    v_cvt_pk_bf16_f32 v225, v242, v243
    s_add_u32 m0, s60, 16384
    s_nop 0
    buffer_load_dwordx4 v15, s[16:19], s57 offen sc1 lds
    v_mfma_f32_16x16x32_bf16 v[176:179], v[80:83], v[236:239], v[176:179]
    v_exp_f32 v246, v198
    v_exp_f32 v247, v199
    v_mfma_f32_16x16x32_bf16 v[148:151], v[84:87], v[232:235], v[148:151]
    v_add_f32 v250, v250, v244
    s_add_u32 m0, s60, 24576
    s_nop 0
    buffer_load_dwordx4 v15, s[24:27], s57 offen sc1 lds
    s_add_u32 s57, s57, 8192
    v_mfma_f32_16x16x32_bf16 v[180:183], v[84:87], v[236:239], v[180:183]
    v_add_f32 v250, v250, v245
    v_mfma_f32_16x16x32_bf16 v[152:155], v[88:91], v[232:235], v[152:155]
    v_cvt_pk_bf16_f32 v226, v244, v245
    v_exp_f32 v240, v200
    s_add_u32 m0, s60, 114688
    s_add_u32 s43, s36, 8192
    buffer_load_dwordx4 v15, s[28:31], s36 offen sc1 lds
    v_mfma_f32_16x16x32_bf16 v[184:187], v[88:91], v[236:239], v[184:187]
    v_exp_f32 v241, v201
    v_mfma_f32_16x16x32_bf16 v[156:159], v[92:95], v[232:235], v[156:159]
    v_add_f32 v250, v250, v246
    s_add_u32 m0, s60, 122880
    s_sub_u32 s36, s36, 8192
    buffer_load_dwordx4 v15, s[68:71], s43 offen sc1 lds
    v_mfma_f32_16x16x32_bf16 v[188:191], v[92:95], v[236:239], v[188:191]
    s_waitcnt lgkmcnt(0)
    v_add_f32 v250, v250, v247
    v_cvt_pk_bf16_f32 v227, v246, v247
    v_mfma_f32_16x16x32_bf16 v[208:211], v[32:35], v[96:99], v[24:27]
    ds_read_b128 v[64:67], v14 offset:57344
    v_exp_f32 v242, v202
    v_mfma_f32_16x16x32_bf16 v[208:211], v[36:39], v[100:103], v[208:211]
    ds_read_b128 v[68:71], v14 offset:58368
    v_exp_f32 v243, v203
    v_add_f32 v251, v240, v241
    v_mfma_f32_16x16x32_bf16 v[208:211], v[40:43], v[104:107], v[208:211]
    ds_read_b128 v[72:75], v14 offset:59392
    v_cvt_pk_bf16_f32 v228, v240, v241
    v_mfma_f32_16x16x32_bf16 v[208:211], v[44:47], v[108:111], v[208:211]
    ds_read_b128 v[76:79], v14 offset:60416
    v_exp_f32 v244, v204
    v_mfma_f32_16x16x32_bf16 v[212:215], v[48:51], v[96:99], v[24:27]
    ds_read_b128 v[80:83], v14 offset:61440
    v_exp_f32 v245, v205
    v_add_f32 v251, v251, v242
    v_mfma_f32_16x16x32_bf16 v[212:215], v[52:55], v[100:103], v[212:215]
    ds_read_b128 v[84:87], v14 offset:62464
    v_add_f32 v251, v251, v243
    v_mfma_f32_16x16x32_bf16 v[212:215], v[56:59], v[104:107], v[212:215]
    ds_read_b128 v[88:91], v14 offset:63488
    v_cvt_pk_bf16_f32 v229, v242, v243
    v_mfma_f32_16x16x32_bf16 v[212:215], v[60:63], v[108:111], v[212:215]
    ds_read_b128 v[92:95], v14 offset:64512
    v_exp_f32 v246, v206
    v_exp_f32 v247, v207
    v_mfma_f32_16x16x32_bf16 v[216:219], v[32:35], v[112:115], v[28:31]
    v_add_f32 v251, v251, v244
    s_add_u32 m0, s60, 32768
    s_nop 0
    buffer_load_dwordx4 v15, s[16:19], s57 offen sc1 lds
    v_mfma_f32_16x16x32_bf16 v[216:219], v[36:39], v[116:119], v[216:219]
    v_add_f32 v251, v251, v245
    v_mfma_f32_16x16x32_bf16 v[216:219], v[40:43], v[120:123], v[216:219]
    v_cvt_pk_bf16_f32 v230, v244, v245
    v_add_f32 v251, v251, v246
    s_add_u32 m0, s60, 40960
    s_nop 0
    buffer_load_dwordx4 v15, s[24:27], s57 offen sc1 lds
    s_add_u32 s57, s57, 8192
    v_mfma_f32_16x16x32_bf16 v[216:219], v[44:47], v[124:127], v[216:219]
    v_add_f32 v251, v251, v247
    v_mfma_f32_16x16x32_bf16 v[220:223], v[48:51], v[112:115], v[28:31]
    v_cvt_pk_bf16_f32 v231, v246, v247
    s_add_u32 m0, s60, 131072
    s_add_u32 s43, s36, 8192
    buffer_load_dwordx4 v15, s[28:31], s36 offen sc1 lds
    v_mfma_f32_16x16x32_bf16 v[220:223], v[52:55], v[116:119], v[220:223]
    v_max_f32 v252, v250, v251
    v_mfma_f32_16x16x32_bf16 v[220:223], v[56:59], v[120:123], v[220:223]
    s_add_u32 m0, s60, 139264
    s_sub_u32 s36, s36, 8192
    buffer_load_dwordx4 v15, s[68:71], s43 offen sc1 lds
    v_cmp_nge_f32 vcc, s42, v252
    v_mfma_f32_16x16x32_bf16 v[220:223], v[60:63], v[124:127], v[220:223]
    s_cbranch_vccnz kf_sl2loop
kf_slret2loop:
    s_waitcnt lgkmcnt(0)
    s_bitcmp1_b32 s48, 3
    s_cbranch_scc1 kf_sp3loop
kf_spret3loop:
    v_mfma_f32_16x16x32_bf16 v[128:131], v[64:67], v[224:227], v[128:131]
    v_add_f32 v248, v248, v250
    v_add_f32 v249, v249, v251
    ds_read_b128 v[32:35], v13 offset:0
    v_mfma_f32_16x16x32_bf16 v[160:163], v[64:67], v[228:231], v[160:163]
    ds_read_b128 v[36:39], v13 offset:1024
    v_exp_f32 v240, v208
    v_exp_f32 v241, v209
    v_mfma_f32_16x16x32_bf16 v[132:135], v[68:71], v[224:227], v[132:135]
    ds_read_b128 v[40:43], v13 offset:2048
    v_exp_f32 v242, v210
    v_mfma_f32_16x16x32_bf16 v[164:167], v[68:71], v[228:231], v[164:167]
    ds_read_b128 v[44:47], v13 offset:3072
    v_exp_f32 v243, v211
    v_add_f32 v250, v240, v241
    v_mfma_f32_16x16x32_bf16 v[136:139], v[72:75], v[224:227], v[136:139]
    ds_read_b128 v[48:51], v13 offset:4096
    v_cvt_pk_bf16_f32 v232, v240, v241
    v_mfma_f32_16x16x32_bf16 v[168:171], v[72:75], v[228:231], v[168:171]
    ds_read_b128 v[52:55], v13 offset:5120
    v_exp_f32 v244, v212
    v_mfma_f32_16x16x32_bf16 v[140:143], v[76:79], v[224:227], v[140:143]
    ds_read_b128 v[56:59], v13 offset:6144
    v_exp_f32 v245, v213
    v_add_f32 v250, v250, v242
    v_mfma_f32_16x16x32_bf16 v[172:175], v[76:79], v[228:231], v[172:175]
    ds_read_b128 v[60:63], v13 offset:7168
    v_add_f32 v250, v250, v243
    v_mfma_f32_16x16x32_bf16 v[144:147], v[80:83], v[224:227], v[144:147]
    v_cvt_pk_bf16_f32 v233, v242, v243
    v_mfma_f32_16x16x32_bf16 v[176:179], v[80:83], v[228:231], v[176:179]
    v_exp_f32 v246, v214
    v_exp_f32 v247, v215
    v_mfma_f32_16x16x32_bf16 v[148:151], v[84:87], v[224:227], v[148:151]
    v_add_f32 v250, v250, v244
    v_mfma_f32_16x16x32_bf16 v[180:183], v[84:87], v[228:231], v[180:183]
    v_add_f32 v250, v250, v245
    v_mfma_f32_16x16x32_bf16 v[152:155], v[88:91], v[224:227], v[152:155]
    v_cvt_pk_bf16_f32 v234, v244, v245
    v_exp_f32 v240, v216
    v_mfma_f32_16x16x32_bf16 v[184:187], v[88:91], v[228:231], v[184:187]
    v_exp_f32 v241, v217
    v_mfma_f32_16x16x32_bf16 v[156:159], v[92:95], v[224:227], v[156:159]
    v_add_f32 v250, v250, v246
    v_mfma_f32_16x16x32_bf16 v[188:191], v[92:95], v[228:231], v[188:191]
    s_waitcnt lgkmcnt(0)
    v_add_f32 v250, v250, v247
    v_cvt_pk_bf16_f32 v235, v246, v247
    v_mfma_f32_16x16x32_bf16 v[192:195], v[32:35], v[96:99], v[24:27]
    ds_read_b128 v[64:67], v14 offset:8192
    v_exp_f32 v242, v218
    v_mfma_f32_16x16x32_bf16 v[192:195], v[36:39], v[100:103], v[192:195]
    ds_read_b128 v[68:71], v14 offset:9216
    v_exp_f32 v243, v219
    v_add_f32 v251, v240, v241
    v_mfma_f32_16x16x32_bf16 v[192:195], v[40:43], v[104:107], v[192:195]
    ds_read_b128 v[72:75], v14 offset:10240
    v_cvt_pk_bf16_f32 v236, v240, v241
    v_mfma_f32_16x16x32_bf16 v[192:195], v[44:47], v[108:111], v[192:195]
    ds_read_b128 v[76:79], v14 offset:11264
    v_exp_f32 v244, v220
    v_mfma_f32_16x16x32_bf16 v[196:199], v[48:51], v[96:99], v[24:27]
    ds_read_b128 v[80:83], v14 offset:12288
    v_exp_f32 v245, v221
    v_add_f32 v251, v251, v242
    v_mfma_f32_16x16x32_bf16 v[196:199], v[52:55], v[100:103], v[196:199]
    ds_read_b128 v[84:87], v14 offset:13312
    v_add_f32 v251, v251, v243
    v_mfma_f32_16x16x32_bf16 v[196:199], v[56:59], v[104:107], v[196:199]
    ds_read_b128 v[88:91], v14 offset:14336
    v_cvt_pk_bf16_f32 v237, v242, v243
    v_mfma_f32_16x16x32_bf16 v[196:199], v[60:63], v[108:111], v[196:199]
    ds_read_b128 v[92:95], v14 offset:15360
    v_exp_f32 v246, v222
    v_exp_f32 v247, v223
    v_mfma_f32_16x16x32_bf16 v[200:203], v[32:35], v[112:115], v[28:31]
    v_add_f32 v251, v251, v244
    v_mfma_f32_16x16x32_bf16 v[200:203], v[36:39], v[116:119], v[200:203]
    v_add_f32 v251, v251, v245
    v_mfma_f32_16x16x32_bf16 v[200:203], v[40:43], v[120:123], v[200:203]
    v_cvt_pk_bf16_f32 v238, v244, v245
    v_add_f32 v251, v251, v246
    v_mfma_f32_16x16x32_bf16 v[200:203], v[44:47], v[124:127], v[200:203]
    v_add_f32 v251, v251, v247
    v_mfma_f32_16x16x32_bf16 v[204:207], v[48:51], v[112:115], v[28:31]
    v_cvt_pk_bf16_f32 v239, v246, v247
    v_mfma_f32_16x16x32_bf16 v[204:207], v[52:55], v[116:119], v[204:207]
    v_max_f32 v252, v250, v251
    s_lshr_b64 s[48:49], s[48:49], 4
    s_add_u32 s38, s38, 4
    v_mfma_f32_16x16x32_bf16 v[204:207], v[56:59], v[120:123], v[204:207]
    v_cmp_nge_f32 vcc, s42, v252
    v_mfma_f32_16x16x32_bf16 v[204:207], v[60:63], v[124:127], v[204:207]
    s_cbranch_vccnz kf_sl3loop
kf_slret3loop:
    s_cmp_lt_u32 s38, 32
    s_cbranch_scc1 kf_loop
    s_waitcnt vmcnt(0) lgkmcnt(0)
    s_barrier
    s_cmp_eq_u32 s45, 1
    s_cbranch_scc1 kf_lastB
    s_bitcmp1_b32 s48, 0
    s_cbranch_scc1 kf_sp0last
kf_spret0last:
    v_mfma_f32_16x16x32_bf16 v[128:131], v[64:67], v[232:235], v[128:131]
    v_add_f32 v248, v248, v250
    v_add_f32 v249, v249, v251
    v_mfma_f32_16x16x32_bf16 v[160:163], v[64:67], v[236:239], v[160:163]
    v_exp_f32 v240, v192
    v_exp_f32 v241, v193
    v_exp_f32 v242, v194
    v_mfma_f32_16x16x32_bf16 v[132:135], v[68:71], v[232:235], v[132:135]
    v_exp_f32 v243, v195
    v_add_f32 v250, v240, v241
    v_cvt_pk_bf16_f32 v224, v240, v241
    v_mfma_f32_16x16x32_bf16 v[164:167], v[68:71], v[236:239], v[164:167]
    v_exp_f32 v244, v196
    v_exp_f32 v245, v197
    v_mfma_f32_16x16x32_bf16 v[136:139], v[72:75], v[232:235], v[136:139]
    v_add_f32 v250, v250, v242
    v_add_f32 v250, v250, v243
    v_cvt_pk_bf16_f32 v225, v242, v243
    v_mfma_f32_16x16x32_bf16 v[168:171], v[72:75], v[236:239], v[168:171]
    v_exp_f32 v246, v198
    v_exp_f32 v247, v199
    v_mfma_f32_16x16x32_bf16 v[140:143], v[76:79], v[232:235], v[140:143]
    v_add_f32 v250, v250, v244
    v_add_f32 v250, v250, v245
    v_cvt_pk_bf16_f32 v226, v244, v245
    v_mfma_f32_16x16x32_bf16 v[172:175], v[76:79], v[236:239], v[172:175]
    v_exp_f32 v240, v200
    v_exp_f32 v241, v201
    v_mfma_f32_16x16x32_bf16 v[144:147], v[80:83], v[232:235], v[144:147]
    v_add_f32 v250, v250, v246
    v_add_f32 v250, v250, v247
    v_cvt_pk_bf16_f32 v227, v246, v247
    v_mfma_f32_16x16x32_bf16 v[176:179], v[80:83], v[236:239], v[176:179]
    v_exp_f32 v242, v202
    v_exp_f32 v243, v203
    v_mfma_f32_16x16x32_bf16 v[148:151], v[84:87], v[232:235], v[148:151]
    v_add_f32 v251, v240, v241
    v_cvt_pk_bf16_f32 v228, v240, v241
    v_exp_f32 v244, v204
    v_mfma_f32_16x16x32_bf16 v[180:183], v[84:87], v[236:239], v[180:183]
    v_exp_f32 v245, v205
    v_add_f32 v251, v251, v242
    v_mfma_f32_16x16x32_bf16 v[152:155], v[88:91], v[232:235], v[152:155]
    v_add_f32 v251, v251, v243
    v_cvt_pk_bf16_f32 v229, v242, v243
    v_exp_f32 v246, v206
    v_mfma_f32_16x16x32_bf16 v[184:187], v[88:91], v[236:239], v[184:187]
    v_exp_f32 v247, v207
    v_add_f32 v251, v251, v244
    v_mfma_f32_16x16x32_bf16 v[156:159], v[92:95], v[232:235], v[156:159]
    v_add_f32 v251, v251, v245
    v_cvt_pk_bf16_f32 v230, v244, v245
    v_add_f32 v251, v251, v246
    v_mfma_f32_16x16x32_bf16 v[188:191], v[92:95], v[236:239], v[188:191]
    v_add_f32 v251, v251, v247
    v_cvt_pk_bf16_f32 v231, v246, v247
    ds_read_b128 v[64:67], v14 offset:24576
    ds_read_b128 v[68:71], v14 offset:25600
    ds_read_b128 v[72:75], v14 offset:26624
    ds_read_b128 v[76:79], v14 offset:27648
    ds_read_b128 v[80:83], v14 offset:28672
    ds_read_b128 v[84:87], v14 offset:29696
    ds_read_b128 v[88:91], v14 offset:30720
    ds_read_b128 v[92:95], v14 offset:31744
    v_max_f32 v252, v250, v251
    s_nop 0
    v_cmp_nge_f32 vcc, s42, v252
    s_nop 1
    s_cbranch_vccnz kf_sl0last
kf_slret0last:
    v_add_f32 v248, v248, v250
    v_add_f32 v249, v249, v251
    s_cmp_lg_u32 s46, 32
    s_cbranch_scc1 kf_nolf
    s_nop 7
    s_call_b64 s[52:53], kf_final
kf_nolf:
    s_waitcnt lgkmcnt(0)
    v_mfma_f32_16x16x32_bf16 v[128:131], v[64:67], v[224:227], v[128:131]
    v_mfma_f32_16x16x32_bf16 v[160:163], v[64:67], v[228:231], v[160:163]
    v_mfma_f32_16x16x32_bf16 v[132:135], v[68:71], v[224:227], v[132:135]
    v_mfma_f32_16x16x32_bf16 v[164:167], v[68:71], v[228:231], v[164:167]
    v_mfma_f32_16x16x32_bf16 v[136:139], v[72:75], v[224:227], v[136:139]
    v_mfma_f32_16x16x32_bf16 v[168:171], v[72:75], v[228:231], v[168:171]
    v_mfma_f32_16x16x32_bf16 v[140:143], v[76:79], v[224:227], v[140:143]
    v_mfma_f32_16x16x32_bf16 v[172:175], v[76:79], v[228:231], v[172:175]
    v_mfma_f32_16x16x32_bf16 v[144:147], v[80:83], v[224:227], v[144:147]
    v_mfma_f32_16x16x32_bf16 v[176:179], v[80:83], v[228:231], v[176:179]
    v_mfma_f32_16x16x32_bf16 v[148:151], v[84:87], v[224:227], v[148:151]
    v_mfma_f32_16x16x32_bf16 v[180:183], v[84:87], v[228:231], v[180:183]
    v_mfma_f32_16x16x32_bf16 v[152:155], v[88:91], v[224:227], v[152:155]
    v_mfma_f32_16x16x32_bf16 v[184:187], v[88:91], v[228:231], v[184:187]
    v_mfma_f32_16x16x32_bf16 v[156:159], v[92:95], v[224:227], v[156:159]
    v_mfma_f32_16x16x32_bf16 v[188:191], v[92:95], v[228:231], v[188:191]
    s_branch kf_merge
kf_lastB:
    v_mfma_f32_16x16x32_bf16 v[128:131], v[64:67], v[232:235], v[128:131]
    v_mfma_f32_16x16x32_bf16 v[160:163], v[64:67], v[236:239], v[160:163]
    v_mfma_f32_16x16x32_bf16 v[132:135], v[68:71], v[232:235], v[132:135]
    v_mfma_f32_16x16x32_bf16 v[164:167], v[68:71], v[236:239], v[164:167]
    v_mfma_f32_16x16x32_bf16 v[136:139], v[72:75], v[232:235], v[136:139]
    v_mfma_f32_16x16x32_bf16 v[168:171], v[72:75], v[236:239], v[168:171]
    v_mfma_f32_16x16x32_bf16 v[140:143], v[76:79], v[232:235], v[140:143]
    v_mfma_f32_16x16x32_bf16 v[172:175], v[76:79], v[236:239], v[172:175]
    v_mfma_f32_16x16x32_bf16 v[144:147], v[80:83], v[232:235], v[144:147]
    v_mfma_f32_16x16x32_bf16 v[176:179], v[80:83], v[236:239], v[176:179]
    v_mfma_f32_16x16x32_bf16 v[148:151], v[84:87], v[232:235], v[148:151]
    v_mfma_f32_16x16x32_bf16 v[180:183], v[84:87], v[236:239], v[180:183]
    v_mfma_f32_16x16x32_bf16 v[152:155], v[88:91], v[232:235], v[152:155]
    v_mfma_f32_16x16x32_bf16 v[184:187], v[88:91], v[236:239], v[184:187]
    v_mfma_f32_16x16x32_bf16 v[156:159], v[92:95], v[232:235], v[156:159]
    v_mfma_f32_16x16x32_bf16 v[188:191], v[92:95], v[236:239], v[188:191]
    v_add_f32 v248, v248, v250
    v_add_f32 v249, v249, v251
    s_getpc_b64 s[98:99]
pc_2:
    s_add_u32 s98, s98, k3_kernel-pc_2
    s_addc_u32 s99, s99, (k3_kernel-pc_2)>>32
    v_min_u32 v5, 1, v1
    s_mul_i32 s100, s61, 2
    v_add_u32 v5, s100, v5
    v_lshlrev_b32 v5, 7, v5
    v_min_u32 v5, code_end-k3_kernel-4, v5
    global_load_dword v9, v5, s[98:99]
    s_cmp_eq_u32 s3, 7
    s_cbranch_scc1 kf_nosj1
    s_mov_b32 s24, s74
    s_and_b32 s25, s75, 0xffff
    s_mov_b32 s26, 4718592
    s_mov_b32 s27, 0x20000
    s_mul_i32 s54, s5, 3
    s_add_u32 s54, s54, s40
    s_mul_i32 s33, s54, 43
    s_lshr_b32 s33, s33, 8
    s_mul_i32 s32, s33, 6
    s_sub_u32 s32, s54, s32
    s_lshl_b32 s34, s4, 2
    s_add_u32 s33, s33, s34
    s_lshl_b32 s34, s32, 7
    s_add_u32 s34, s34, s33
    s_mul_i32 s47, s34, 6144
    s_add_u32 s47, s47, 50331648
    s_mul_i32 s33, s33, 36864
    s_mul_i32 s32, s32, 192
    s_add_u32 s50, s33, s32
    s_add_u32 s51, s50, 18432
    v_mul_u32_u24 v5, 4608, v3
    v_mad_u32_u24 v5, v2, 12, v5
    buffer_load_dwordx3 v[96:98], v5, s[24:27], s50 offen offset:0
    buffer_load_dwordx3 v[100:102], v5, s[24:27], s50 offen offset:1152
    buffer_load_dwordx3 v[104:106], v5, s[24:27], s50 offen offset:2304
    buffer_load_dwordx3 v[108:110], v5, s[24:27], s50 offen offset:3456
    buffer_load_dwordx3 v[112:114], v5, s[24:27], s51 offen offset:0
    buffer_load_dwordx3 v[116:118], v5, s[24:27], s51 offen offset:1152
    buffer_load_dwordx3 v[120:122], v5, s[24:27], s51 offen offset:2304
    buffer_load_dwordx3 v[124:126], v5, s[24:27], s51 offen offset:3456
kf_nosj1:
kf_merge:
    v_mov_b32 v240, v248
    s_nop 1
    v_permlane16_swap_b32 v248, v240
    s_nop 0
    v_add_f32 v248, v248, v240
    v_mov_b32 v240, v248
    s_nop 1
    v_permlane32_swap_b32 v248, v240
    s_nop 0
    v_add_f32 v248, v248, v240
    v_mov_b32 v240, v249
    s_nop 1
    v_permlane16_swap_b32 v249, v240
    s_nop 0
    v_add_f32 v249, v249, v240
    v_mov_b32 v240, v249
    s_nop 1
    v_permlane32_swap_b32 v249, v240
    s_nop 0
    v_add_f32 v249, v249, v240
    v_mov_b32 v240, v24
    v_mov_b32 v241, v28
    v_mov_b32 v242, v248
    v_mov_b32 v243, v249
    s_add_u32 s32, s60, 65536
    v_add_u32 v5, s32, v4
    ds_write_b128 v5, v[240:243]
    s_sub_u32 s32, 72704, s60
    v_add_u32 v5, s32, v4
    s_lshl_b32 s32, s40, 13
    s_mul_i32 s33, s45, 98304
    s_add_u32 s34, s32, s33
    s_add_u32 s34, s34, 32768
    v_add_u32 v6, s34, v4
    s_sub_u32 s34, 188416, s34
    v_add_u32 v7, s34, v4
    s_cmp_eq_u32 s45, 1
    s_cbranch_scc1 kf_mergeB
    ds_write_b128 v6, v[160:163] offset:0
    ds_write_b128 v6, v[164:167] offset:1024
    ds_write_b128 v6, v[168:171] offset:2048
    ds_write_b128 v6, v[172:175] offset:3072
    ds_write_b128 v6, v[176:179] offset:4096
    ds_write_b128 v6, v[180:183] offset:5120
    ds_write_b128 v6, v[184:187] offset:6144
    ds_write_b128 v6, v[188:191] offset:7168
    s_waitcnt lgkmcnt(0)
    s_barrier
    ds_read_b128 v[244:247], v5
    ds_read_b128 v[32:35], v7 offset:0
    ds_read_b128 v[36:39], v7 offset:1024
    ds_read_b128 v[40:43], v7 offset:2048
    ds_read_b128 v[44:47], v7 offset:3072
    ds_read_b128 v[48:51], v7 offset:4096
    ds_read_b128 v[52:55], v7 offset:5120
    ds_read_b128 v[56:59], v7 offset:6144
    ds_read_b128 v[60:63], v7 offset:7168
    s_waitcnt lgkmcnt(8)
    v_min_f32 v252, v240, v244
    v_sub_f32 v253, v252, v240
    v_sub_f32 v254, v252, v244
    v_exp_f32 v253, v253
    v_exp_f32 v254, v254
    s_nop 0
    v_mul_f32 v252, v253, v242
    v_fmac_f32 v252, v254, v246
    v_rcp_f32 v252, v252
    s_nop 0
    v_mul_f32 v252, 0x29000000, v252
    s_waitcnt lgkmcnt(0)
    v_mul_f32 v128, v253, v128
    v_fmac_f32 v128, v254, v32
    v_mul_f32 v129, v253, v129
    v_fmac_f32 v129, v254, v33
    v_mul_f32 v130, v253, v130
    v_fmac_f32 v130, v254, v34
    v_mul_f32 v131, v253, v131
    v_fmac_f32 v131, v254, v35
    v_mul_f32 v132, v253, v132
    v_fmac_f32 v132, v254, v36
    v_mul_f32 v133, v253, v133
    v_fmac_f32 v133, v254, v37
    v_mul_f32 v134, v253, v134
    v_fmac_f32 v134, v254, v38
    v_mul_f32 v135, v253, v135
    v_fmac_f32 v135, v254, v39
    v_mul_f32 v136, v253, v136
    v_fmac_f32 v136, v254, v40
    v_mul_f32 v137, v253, v137
    v_fmac_f32 v137, v254, v41
    v_mul_f32 v138, v253, v138
    v_fmac_f32 v138, v254, v42
    v_mul_f32 v139, v253, v139
    v_fmac_f32 v139, v254, v43
    v_mul_f32 v140, v253, v140
    v_fmac_f32 v140, v254, v44
    v_mul_f32 v141, v253, v141
    v_fmac_f32 v141, v254, v45
    v_mul_f32 v142, v253, v142
    v_fmac_f32 v142, v254, v46
    v_mul_f32 v143, v253, v143
    v_fmac_f32 v143, v254, v47
    v_mul_f32 v144, v253, v144
    v_fmac_f32 v144, v254, v48
    v_mul_f32 v145, v253, v145
    v_fmac_f32 v145, v254, v49
    v_mul_f32 v146, v253, v146
    v_fmac_f32 v146, v254, v50
    v_mul_f32 v147, v253, v147
    v_fmac_f32 v147, v254, v51
    v_mul_f32 v148, v253, v148
    v_fmac_f32 v148, v254, v52
    v_mul_f32 v149, v253, v149
    v_fmac_f32 v149, v254, v53
    v_mul_f32 v150, v253, v150
    v_fmac_f32 v150, v254, v54
    v_mul_f32 v151, v253, v151
    v_fmac_f32 v151, v254, v55
    v_mul_f32 v152, v253, v152
    v_fmac_f32 v152, v254, v56
    v_mul_f32 v153, v253, v153
    v_fmac_f32 v153, v254, v57
    v_mul_f32 v154, v253, v154
    v_fmac_f32 v154, v254, v58
    v_mul_f32 v155, v253, v155
    v_fmac_f32 v155, v254, v59
    v_mul_f32 v156, v253, v156
    v_fmac_f32 v156, v254, v60
    v_mul_f32 v157, v253, v157
    v_fmac_f32 v157, v254, v61
    v_mul_f32 v158, v253, v158
    v_fmac_f32 v158, v254, v62
    v_mul_f32 v159, v253, v159
    v_fmac_f32 v159, v254, v63
    s_lshr_b32 s32, s41, 4
    s_lshl_b32 s32, s32, 5
    s_add_u32 s32, s32, s4
    s_lshl_b32 s32, s32, 12
    s_add_u32 s32, s32, 33554432
    s_add_u32 s33, s32, 131072
    v_mul_f32 v128, v252, v128
    v_mul_f32 v129, v252, v129
    v_mul_f32 v130, v252, v130
    v_mul_f32 v131, v252, v131
    v_mul_f32 v132, v252, v132
    v_mul_f32 v133, v252, v133
    v_mul_f32 v134, v252, v134
    v_mul_f32 v135, v252, v135
    v_cvt_pk_bf16_f32 v128, v128, v129
    v_cvt_pk_bf16_f32 v129, v130, v131
    v_cvt_pk_bf16_f32 v130, v132, v133
    v_cvt_pk_bf16_f32 v131, v134, v135
    buffer_store_dwordx4 v[128:131], v4, s[20:23], s32 offen offset:0 sc1
    v_mul_f32 v136, v252, v136
    v_mul_f32 v137, v252, v137
    v_mul_f32 v138, v252, v138
    v_mul_f32 v139, v252, v139
    v_mul_f32 v140, v252, v140
    v_mul_f32 v141, v252, v141
    v_mul_f32 v142, v252, v142
    v_mul_f32 v143, v252, v143
    v_cvt_pk_bf16_f32 v136, v136, v137
    v_cvt_pk_bf16_f32 v137, v138, v139
    v_cvt_pk_bf16_f32 v138, v140, v141
    v_cvt_pk_bf16_f32 v139, v142, v143
    buffer_store_dwordx4 v[136:139], v4, s[20:23], s32 offen offset:1024 sc1
    v_mul_f32 v144, v252, v144
    v_mul_f32 v145, v252, v145
    v_mul_f32 v146, v252, v146
    v_mul_f32 v147, v252, v147
    v_mul_f32 v148, v252, v148
    v_mul_f32 v149, v252, v149
    v_mul_f32 v150, v252, v150
    v_mul_f32 v151, v252, v151
    v_cvt_pk_bf16_f32 v144, v144, v145
    v_cvt_pk_bf16_f32 v145, v146, v147
    v_cvt_pk_bf16_f32 v146, v148, v149
    v_cvt_pk_bf16_f32 v147, v150, v151
    buffer_store_dwordx4 v[144:147], v4, s[20:23], s32 offen offset:2048 sc1
    v_mul_f32 v152, v252, v152
    v_mul_f32 v153, v252, v153
    v_mul_f32 v154, v252, v154
    v_mul_f32 v155, v252, v155
    v_mul_f32 v156, v252, v156
    v_mul_f32 v157, v252, v157
    v_mul_f32 v158, v252, v158
    v_mul_f32 v159, v252, v159
    v_cvt_pk_bf16_f32 v152, v152, v153
    v_cvt_pk_bf16_f32 v153, v154, v155
    v_cvt_pk_bf16_f32 v154, v156, v157
    v_cvt_pk_bf16_f32 v155, v158, v159
    buffer_store_dwordx4 v[152:155], v4, s[20:23], s32 offen offset:3072 sc1
    s_branch kf_done
kf_mergeB:
    ds_write_b128 v6, v[128:131] offset:0
    ds_write_b128 v6, v[132:135] offset:1024
    ds_write_b128 v6, v[136:139] offset:2048
    ds_write_b128 v6, v[140:143] offset:3072
    ds_write_b128 v6, v[144:147] offset:4096
    ds_write_b128 v6, v[148:151] offset:5120
    ds_write_b128 v6, v[152:155] offset:6144
    ds_write_b128 v6, v[156:159] offset:7168
    s_waitcnt lgkmcnt(0)
    s_barrier
    ds_read_b128 v[244:247], v5
    ds_read_b128 v[32:35], v7 offset:0
    ds_read_b128 v[36:39], v7 offset:1024
    ds_read_b128 v[40:43], v7 offset:2048
    ds_read_b128 v[44:47], v7 offset:3072
    ds_read_b128 v[48:51], v7 offset:4096
    ds_read_b128 v[52:55], v7 offset:5120
    ds_read_b128 v[56:59], v7 offset:6144
    ds_read_b128 v[60:63], v7 offset:7168
    s_waitcnt lgkmcnt(8)
    v_min_f32 v252, v241, v245
    v_sub_f32 v253, v252, v241
    v_sub_f32 v254, v252, v245
    v_exp_f32 v253, v253
    v_exp_f32 v254, v254
    s_nop 0
    v_mul_f32 v252, v253, v243
    v_fmac_f32 v252, v254, v247
    v_rcp_f32 v252, v252
    s_nop 0
    v_mul_f32 v252, 0x29000000, v252
    s_waitcnt lgkmcnt(0)
    v_mul_f32 v160, v253, v160
    v_fmac_f32 v160, v254, v32
    v_mul_f32 v161, v253, v161
    v_fmac_f32 v161, v254, v33
    v_mul_f32 v162, v253, v162
    v_fmac_f32 v162, v254, v34
    v_mul_f32 v163, v253, v163
    v_fmac_f32 v163, v254, v35
    v_mul_f32 v164, v253, v164
    v_fmac_f32 v164, v254, v36
    v_mul_f32 v165, v253, v165
    v_fmac_f32 v165, v254, v37
    v_mul_f32 v166, v253, v166
    v_fmac_f32 v166, v254, v38
    v_mul_f32 v167, v253, v167
    v_fmac_f32 v167, v254, v39
    v_mul_f32 v168, v253, v168
    v_fmac_f32 v168, v254, v40
    v_mul_f32 v169, v253, v169
    v_fmac_f32 v169, v254, v41
    v_mul_f32 v170, v253, v170
    v_fmac_f32 v170, v254, v42
    v_mul_f32 v171, v253, v171
    v_fmac_f32 v171, v254, v43
    v_mul_f32 v172, v253, v172
    v_fmac_f32 v172, v254, v44
    v_mul_f32 v173, v253, v173
    v_fmac_f32 v173, v254, v45
    v_mul_f32 v174, v253, v174
    v_fmac_f32 v174, v254, v46
    v_mul_f32 v175, v253, v175
    v_fmac_f32 v175, v254, v47
    v_mul_f32 v176, v253, v176
    v_fmac_f32 v176, v254, v48
    v_mul_f32 v177, v253, v177
    v_fmac_f32 v177, v254, v49
    v_mul_f32 v178, v253, v178
    v_fmac_f32 v178, v254, v50
    v_mul_f32 v179, v253, v179
    v_fmac_f32 v179, v254, v51
    v_mul_f32 v180, v253, v180
    v_fmac_f32 v180, v254, v52
    v_mul_f32 v181, v253, v181
    v_fmac_f32 v181, v254, v53
    v_mul_f32 v182, v253, v182
    v_fmac_f32 v182, v254, v54
    v_mul_f32 v183, v253, v183
    v_fmac_f32 v183, v254, v55
    v_mul_f32 v184, v253, v184
    v_fmac_f32 v184, v254, v56
    v_mul_f32 v185, v253, v185
    v_fmac_f32 v185, v254, v57
    v_mul_f32 v186, v253, v186
    v_fmac_f32 v186, v254, v58
    v_mul_f32 v187, v253, v187
    v_fmac_f32 v187, v254, v59
    v_mul_f32 v188, v253, v188
    v_fmac_f32 v188, v254, v60
    v_mul_f32 v189, v253, v189
    v_fmac_f32 v189, v254, v61
    v_mul_f32 v190, v253, v190
    v_fmac_f32 v190, v254, v62
    v_mul_f32 v191, v253, v191
    v_fmac_f32 v191, v254, v63
    s_lshr_b32 s32, s41, 4
    s_lshl_b32 s32, s32, 5
    s_add_u32 s32, s32, s4
    s_lshl_b32 s32, s32, 12
    s_add_u32 s32, s32, 33554432
    s_add_u32 s33, s32, 131072
    v_mul_f32 v160, v252, v160
    v_mul_f32 v161, v252, v161
    v_mul_f32 v162, v252, v162
    v_mul_f32 v163, v252, v163
    v_mul_f32 v164, v252, v164
    v_mul_f32 v165, v252, v165
    v_mul_f32 v166, v252, v166
    v_mul_f32 v167, v252, v167
    v_cvt_pk_bf16_f32 v160, v160, v161
    v_cvt_pk_bf16_f32 v161, v162, v163
    v_cvt_pk_bf16_f32 v162, v164, v165
    v_cvt_pk_bf16_f32 v163, v166, v167
    buffer_store_dwordx4 v[160:163], v4, s[20:23], s33 offen offset:0 sc1
    v_mul_f32 v168, v252, v168
    v_mul_f32 v169, v252, v169
    v_mul_f32 v170, v252, v170
    v_mul_f32 v171, v252, v171
    v_mul_f32 v172, v252, v172
    v_mul_f32 v173, v252, v173
    v_mul_f32 v174, v252, v174
    v_mul_f32 v175, v252, v175
    v_cvt_pk_bf16_f32 v168, v168, v169
    v_cvt_pk_bf16_f32 v169, v170, v171
    v_cvt_pk_bf16_f32 v170, v172, v173
    v_cvt_pk_bf16_f32 v171, v174, v175
    buffer_store_dwordx4 v[168:171], v4, s[20:23], s33 offen offset:1024 sc1
    v_mul_f32 v176, v252, v176
    v_mul_f32 v177, v252, v177
    v_mul_f32 v178, v252, v178
    v_mul_f32 v179, v252, v179
    v_mul_f32 v180, v252, v180
    v_mul_f32 v181, v252, v181
    v_mul_f32 v182, v252, v182
    v_mul_f32 v183, v252, v183
    v_cvt_pk_bf16_f32 v176, v176, v177
    v_cvt_pk_bf16_f32 v177, v178, v179
    v_cvt_pk_bf16_f32 v178, v180, v181
    v_cvt_pk_bf16_f32 v179, v182, v183
    buffer_store_dwordx4 v[176:179], v4, s[20:23], s33 offen offset:2048 sc1
    v_mul_f32 v184, v252, v184
    v_mul_f32 v185, v252, v185
    v_mul_f32 v186, v252, v186
    v_mul_f32 v187, v252, v187
    v_mul_f32 v188, v252, v188
    v_mul_f32 v189, v252, v189
    v_mul_f32 v190, v252, v190
    v_mul_f32 v191, v252, v191
    v_cvt_pk_bf16_f32 v184, v184, v185
    v_cvt_pk_bf16_f32 v185, v186, v187
    v_cvt_pk_bf16_f32 v186, v188, v189
    v_cvt_pk_bf16_f32 v187, v190, v191
    buffer_store_dwordx4 v[184:187], v4, s[20:23], s33 offen offset:3072 sc1
    s_cmp_eq_u32 s3, 7
    s_cbranch_scc1 kf_nosj2
    s_waitcnt vmcnt(4)
    s_mov_b32 s50, 0x05040100
    s_mov_b32 s51, 0x07060302
    s_add_u32 s32, s47, 4096
    v_perm_b32 v64, v100, v96, s50
    v_perm_b32 v65, v108, v104, s50
    v_perm_b32 v66, v116, v112, s50
    v_perm_b32 v67, v124, v120, s50
    buffer_store_dwordx4 v[64:67], v4, s[20:23], s47 offen offset:0 sc1
    v_perm_b32 v68, v100, v96, s51
    v_perm_b32 v69, v108, v104, s51
    v_perm_b32 v70, v116, v112, s51
    v_perm_b32 v71, v124, v120, s51
    buffer_store_dwordx4 v[68:71], v4, s[20:23], s47 offen offset:1024 sc1
    v_perm_b32 v72, v101, v97, s50
    v_perm_b32 v73, v109, v105, s50
    v_perm_b32 v74, v117, v113, s50
    v_perm_b32 v75, v125, v121, s50
    buffer_store_dwordx4 v[72:75], v4, s[20:23], s47 offen offset:2048 sc1
    v_perm_b32 v76, v101, v97, s51
    v_perm_b32 v77, v109, v105, s51
    v_perm_b32 v78, v117, v113, s51
    v_perm_b32 v79, v125, v121, s51
    buffer_store_dwordx4 v[76:79], v4, s[20:23], s47 offen offset:3072 sc1
    v_perm_b32 v80, v102, v98, s50
    v_perm_b32 v81, v110, v106, s50
    v_perm_b32 v82, v118, v114, s50
    v_perm_b32 v83, v126, v122, s50
    buffer_store_dwordx4 v[80:83], v4, s[20:23], s32 offen offset:0 sc1
    v_perm_b32 v84, v102, v98, s51
    v_perm_b32 v85, v110, v106, s51
    v_perm_b32 v86, v118, v114, s51
    v_perm_b32 v87, v126, v122, s51
    buffer_store_dwordx4 v[84:87], v4, s[20:23], s32 offen offset:1024 sc1
kf_nosj2:
kf_done:
    s_endpgm
kf_sp0loop:
    s_add_u32 s35, s38, 0
    s_call_b64 s[52:53], kf_special0
    s_branch kf_spret0loop
kf_sl0loop:
    s_call_b64 s[52:53], kf_slow0
    s_branch kf_slret0loop
kf_sp1loop:
    s_add_u32 s35, s38, 1
    s_call_b64 s[52:53], kf_special1
    s_branch kf_spret1loop
kf_sl1loop:
    s_call_b64 s[52:53], kf_slow1
    s_branch kf_slret1loop
kf_sp2loop:
    s_add_u32 s35, s38, 2
    s_call_b64 s[52:53], kf_special0
    s_branch kf_spret2loop
kf_sl2loop:
    s_call_b64 s[52:53], kf_slow0
    s_branch kf_slret2loop
kf_sp3loop:
    s_add_u32 s35, s38, 3
    s_call_b64 s[52:53], kf_special1
    s_branch kf_spret3loop
kf_sl3loop:
    s_call_b64 s[52:53], kf_slow1
    s_branch kf_slret3loop
kf_sp0last:
    s_add_u32 s35, s38, 0
    s_call_b64 s[52:53], kf_special0
    s_branch kf_spret0last
kf_sl0last:
    s_call_b64 s[52:53], kf_slow0
    s_branch kf_slret0last
kf_slow0:
    s_nop 15
    v_max3_f32 v252, v192, v193, v194
    v_max3_f32 v252, v252, v195, v196
    v_max3_f32 v252, v252, v197, v198
    v_max_f32 v252, v252, v199
    v_max3_f32 v253, v200, v201, v202
    v_max3_f32 v253, v253, v203, v204
    v_max3_f32 v253, v253, v205, v206
    v_max_f32 v253, v253, v207
    v_mov_b32 v240, v252
    s_nop 1
    v_permlane16_swap_b32 v252, v240
    s_nop 0
    v_max_f32 v252, v252, v240
    v_mov_b32 v240, v252
    s_nop 1
    v_permlane32_swap_b32 v252, v240
    s_nop 0
    v_max_f32 v252, v252, v240
    v_mov_b32 v240, v253
    s_nop 1
    v_permlane16_swap_b32 v253, v240
    s_nop 0
    v_max_f32 v253, v253, v240
    v_mov_b32 v240, v253
    s_nop 1
    v_permlane32_swap_b32 v253, v240
    s_nop 0
    v_max_f32 v253, v253, v240
    v_mov_b32 v254, v248
    v_mov_b32 v240, v254
    s_nop 1
    v_permlane16_swap_b32 v254, v240
    s_nop 0
    v_add_f32 v254, v254, v240
    v_mov_b32 v240, v254
    s_nop 1
    v_permlane32_swap_b32 v254, v240
    s_nop 0
    v_add_f32 v254, v254, v240
    v_log_f32 v254, v254
    s_nop 0
    v_max_f32 v252, v252, v254
    v_add_f32 v252, 0x42b60000, v252
    v_max_f32 v252, 0, v252
    v_sub_f32 v254, 0, v252
    v_exp_f32 v254, v254
    v_mov_b32 v255, v249
    v_mov_b32 v240, v255
    s_nop 1
    v_permlane16_swap_b32 v255, v240
    s_nop 0
    v_add_f32 v255, v255, v240
    v_mov_b32 v240, v255
    s_nop 1
    v_permlane32_swap_b32 v255, v240
    s_nop 0
    v_add_f32 v255, v255, v240
    v_log_f32 v255, v255
    s_nop 0
    v_max_f32 v253, v253, v255
    v_add_f32 v253, 0x42b60000, v253
    v_max_f32 v253, 0, v253
    v_sub_f32 v255, 0, v253
    v_exp_f32 v255, v255
    v_sub_f32 v24, v24, v252
    v_sub_f32 v25, v25, v252
    v_sub_f32 v26, v26, v252
    v_sub_f32 v27, v27, v252
    v_sub_f32 v192, v192, v252
    v_sub_f32 v208, v208, v252
    v_sub_f32 v193, v193, v252
    v_sub_f32 v209, v209, v252
    v_sub_f32 v194, v194, v252
    v_sub_f32 v210, v210, v252
    v_sub_f32 v195, v195, v252
    v_sub_f32 v211, v211, v252
    v_sub_f32 v196, v196, v252
    v_sub_f32 v212, v212, v252
    v_sub_f32 v197, v197, v252
    v_sub_f32 v213, v213, v252
    v_sub_f32 v198, v198, v252
    v_sub_f32 v214, v214, v252
    v_sub_f32 v199, v199, v252
    v_sub_f32 v215, v215, v252
    v_mul_f32 v248, v254, v248
    v_mul_f32 v128, v254, v128
    v_mul_f32 v129, v254, v129
    v_mul_f32 v130, v254, v130
    v_mul_f32 v131, v254, v131
    v_mul_f32 v132, v254, v132
    v_mul_f32 v133, v254, v133
    v_mul_f32 v134, v254, v134
    v_mul_f32 v135, v254, v135
    v_mul_f32 v136, v254, v136
    v_mul_f32 v137, v254, v137
    v_mul_f32 v138, v254, v138
    v_mul_f32 v139, v254, v139
    v_mul_f32 v140, v254, v140
    v_mul_f32 v141, v254, v141
    v_mul_f32 v142, v254, v142
    v_mul_f32 v143, v254, v143
    v_mul_f32 v144, v254, v144
    v_mul_f32 v145, v254, v145
    v_mul_f32 v146, v254, v146
    v_mul_f32 v147, v254, v147
    v_mul_f32 v148, v254, v148
    v_mul_f32 v149, v254, v149
    v_mul_f32 v150, v254, v150
    v_mul_f32 v151, v254, v151
    v_mul_f32 v152, v254, v152
    v_mul_f32 v153, v254, v153
    v_mul_f32 v154, v254, v154
    v_mul_f32 v155, v254, v155
    v_mul_f32 v156, v254, v156
    v_mul_f32 v157, v254, v157
    v_mul_f32 v158, v254, v158
    v_mul_f32 v159, v254, v159
    v_sub_f32 v28, v28, v253
    v_sub_f32 v29, v29, v253
    v_sub_f32 v30, v30, v253
    v_sub_f32 v31, v31, v253
    v_sub_f32 v200, v200, v253
    v_sub_f32 v216, v216, v253
    v_sub_f32 v201, v201, v253
    v_sub_f32 v217, v217, v253
    v_sub_f32 v202, v202, v253
    v_sub_f32 v218, v218, v253
    v_sub_f32 v203, v203, v253
    v_sub_f32 v219, v219, v253
    v_sub_f32 v204, v204, v253
    v_sub_f32 v220, v220, v253
    v_sub_f32 v205, v205, v253
    v_sub_f32 v221, v221, v253
    v_sub_f32 v206, v206, v253
    v_sub_f32 v222, v222, v253
    v_sub_f32 v207, v207, v253
    v_sub_f32 v223, v223, v253
    v_mul_f32 v249, v255, v249
    v_mul_f32 v160, v255, v160
    v_mul_f32 v161, v255, v161
    v_mul_f32 v162, v255, v162
    v_mul_f32 v163, v255, v163
    v_mul_f32 v164, v255, v164
    v_mul_f32 v165, v255, v165
    v_mul_f32 v166, v255, v166
    v_mul_f32 v167, v255, v167
    v_mul_f32 v168, v255, v168
    v_mul_f32 v169, v255, v169
    v_mul_f32 v170, v255, v170
    v_mul_f32 v171, v255, v171
    v_mul_f32 v172, v255, v172
    v_mul_f32 v173, v255, v173
    v_mul_f32 v174, v255, v174
    v_mul_f32 v175, v255, v175
    v_mul_f32 v176, v255, v176
    v_mul_f32 v177, v255, v177
    v_mul_f32 v178, v255, v178
    v_mul_f32 v179, v255, v179
    v_mul_f32 v180, v255, v180
    v_mul_f32 v181, v255, v181
    v_mul_f32 v182, v255, v182
    v_mul_f32 v183, v255, v183
    v_mul_f32 v184, v255, v184
    v_mul_f32 v185, v255, v185
    v_mul_f32 v186, v255, v186
    v_mul_f32 v187, v255, v187
    v_mul_f32 v188, v255, v188
    v_mul_f32 v189, v255, v189
    v_mul_f32 v190, v255, v190
    v_mul_f32 v191, v255, v191
    v_exp_f32 v240, v192
    v_exp_f32 v241, v193
    v_exp_f32 v242, v194
    v_exp_f32 v243, v195
    v_add_f32 v250, v240, v241
    v_cvt_pk_bf16_f32 v224, v240, v241
    v_exp_f32 v244, v196
    v_exp_f32 v245, v197
    v_add_f32 v250, v250, v242
    v_add_f32 v250, v250, v243
    v_cvt_pk_bf16_f32 v225, v242, v243
    v_exp_f32 v246, v198
    v_exp_f32 v247, v199
    v_add_f32 v250, v250, v244
    v_add_f32 v250, v250, v245
    v_cvt_pk_bf16_f32 v226, v244, v245
    v_exp_f32 v240, v200
    v_exp_f32 v241, v201
    v_add_f32 v250, v250, v246
    v_add_f32 v250, v250, v247
    v_cvt_pk_bf16_f32 v227, v246, v247
    v_exp_f32 v242, v202
    v_exp_f32 v243, v203
    v_add_f32 v251, v240, v241
    v_cvt_pk_bf16_f32 v228, v240, v241
    v_exp_f32 v244, v204
    v_exp_f32 v245, v205
    v_add_f32 v251, v251, v242
    v_add_f32 v251, v251, v243
    v_cvt_pk_bf16_f32 v229, v242, v243
    v_exp_f32 v246, v206
    v_exp_f32 v247, v207
    v_add_f32 v251, v251, v244
    v_add_f32 v251, v251, v245
    v_cvt_pk_bf16_f32 v230, v244, v245
    v_add_f32 v251, v251, v246
    v_add_f32 v251, v251, v247
    v_cvt_pk_bf16_f32 v231, v246, v247
    s_setpc_b64 s[52:53]
kf_slow1:
    s_nop 15
    v_max3_f32 v252, v208, v209, v210
    v_max3_f32 v252, v252, v211, v212
    v_max3_f32 v252, v252, v213, v214
    v_max_f32 v252, v252, v215
    v_max3_f32 v253, v216, v217, v218
    v_max3_f32 v253, v253, v219, v220
    v_max3_f32 v253, v253, v221, v222
    v_max_f32 v253, v253, v223
    v_mov_b32 v240, v252
    s_nop 1
    v_permlane16_swap_b32 v252, v240
    s_nop 0
    v_max_f32 v252, v252, v240
    v_mov_b32 v240, v252
    s_nop 1
    v_permlane32_swap_b32 v252, v240
    s_nop 0
    v_max_f32 v252, v252, v240
    v_mov_b32 v240, v253
    s_nop 1
    v_permlane16_swap_b32 v253, v240
    s_nop 0
    v_max_f32 v253, v253, v240
    v_mov_b32 v240, v253
    s_nop 1
    v_permlane32_swap_b32 v253, v240
    s_nop 0
    v_max_f32 v253, v253, v240
    v_mov_b32 v254, v248
    v_mov_b32 v240, v254
    s_nop 1
    v_permlane16_swap_b32 v254, v240
    s_nop 0
    v_add_f32 v254, v254, v240
    v_mov_b32 v240, v254
    s_nop 1
    v_permlane32_swap_b32 v254, v240
    s_nop 0
    v_add_f32 v254, v254, v240
    v_log_f32 v254, v254
    s_nop 0
    v_max_f32 v252, v252, v254
    v_add_f32 v252, 0x42b60000, v252
    v_max_f32 v252, 0, v252
    v_sub_f32 v254, 0, v252
    v_exp_f32 v254, v254
    v_mov_b32 v255, v249
    v_mov_b32 v240, v255
    s_nop 1
    v_permlane16_swap_b32 v255, v240
    s_nop 0
    v_add_f32 v255, v255, v240
    v_mov_b32 v240, v255
    s_nop 1
    v_permlane32_swap_b32 v255, v240
    s_nop 0
    v_add_f32 v255, v255, v240
    v_log_f32 v255, v255
    s_nop 0
    v_max_f32 v253, v253, v255
    v_add_f32 v253, 0x42b60000, v253
    v_max_f32 v253, 0, v253
    v_sub_f32 v255, 0, v253
    v_exp_f32 v255, v255
    v_sub_f32 v24, v24, v252
    v_sub_f32 v25, v25, v252
    v_sub_f32 v26, v26, v252
    v_sub_f32 v27, v27, v252
    v_sub_f32 v208, v208, v252
    v_sub_f32 v192, v192, v252
    v_sub_f32 v209, v209, v252
    v_sub_f32 v193, v193, v252
    v_sub_f32 v210, v210, v252
    v_sub_f32 v194, v194, v252
    v_sub_f32 v211, v211, v252
    v_sub_f32 v195, v195, v252
    v_sub_f32 v212, v212, v252
    v_sub_f32 v196, v196, v252
    v_sub_f32 v213, v213, v252
    v_sub_f32 v197, v197, v252
    v_sub_f32 v214, v214, v252
    v_sub_f32 v198, v198, v252
    v_sub_f32 v215, v215, v252
    v_sub_f32 v199, v199, v252
    v_mul_f32 v248, v254, v248
    v_mul_f32 v128, v254, v128
    v_mul_f32 v129, v254, v129
    v_mul_f32 v130, v254, v130
    v_mul_f32 v131, v254, v131
    v_mul_f32 v132, v254, v132
    v_mul_f32 v133, v254, v133
    v_mul_f32 v134, v254, v134
    v_mul_f32 v135, v254, v135
    v_mul_f32 v136, v254, v136
    v_mul_f32 v137, v254, v137
    v_mul_f32 v138, v254, v138
    v_mul_f32 v139, v254, v139
    v_mul_f32 v140, v254, v140
    v_mul_f32 v141, v254, v141
    v_mul_f32 v142, v254, v142
    v_mul_f32 v143, v254, v143
    v_mul_f32 v144, v254, v144
    v_mul_f32 v145, v254, v145
    v_mul_f32 v146, v254, v146
    v_mul_f32 v147, v254, v147
    v_mul_f32 v148, v254, v148
    v_mul_f32 v149, v254, v149
    v_mul_f32 v150, v254, v150
    v_mul_f32 v151, v254, v151
    v_mul_f32 v152, v254, v152
    v_mul_f32 v153, v254, v153
    v_mul_f32 v154, v254, v154
    v_mul_f32 v155, v254, v155
    v_mul_f32 v156, v254, v156
    v_mul_f32 v157, v254, v157
    v_mul_f32 v158, v254, v158
    v_mul_f32 v159, v254, v159
    v_sub_f32 v28, v28, v253
    v_sub_f32 v29, v29, v253
    v_sub_f32 v30, v30, v253
    v_sub_f32 v31, v31, v253
    v_sub_f32 v216, v216, v253
    v_sub_f32 v200, v200, v253
    v_sub_f32 v217, v217, v253
    v_sub_f32 v201, v201, v253
    v_sub_f32 v218, v218, v253
    v_sub_f32 v202, v202, v253
    v_sub_f32 v219, v219, v253
    v_sub_f32 v203, v203, v253
    v_sub_f32 v220, v220, v253
    v_sub_f32 v204, v204, v253
    v_sub_f32 v221, v221, v253
    v_sub_f32 v205, v205, v253
    v_sub_f32 v222, v222, v253
    v_sub_f32 v206, v206, v253
    v_sub_f32 v223, v223, v253
    v_sub_f32 v207, v207, v253
    v_mul_f32 v249, v255, v249
    v_mul_f32 v160, v255, v160
    v_mul_f32 v161, v255, v161
    v_mul_f32 v162, v255, v162
    v_mul_f32 v163, v255, v163
    v_mul_f32 v164, v255, v164
    v_mul_f32 v165, v255, v165
    v_mul_f32 v166, v255, v166
    v_mul_f32 v167, v255, v167
    v_mul_f32 v168, v255, v168
    v_mul_f32 v169, v255, v169
    v_mul_f32 v170, v255, v170
    v_mul_f32 v171, v255, v171
    v_mul_f32 v172, v255, v172
    v_mul_f32 v173, v255, v173
    v_mul_f32 v174, v255, v174
    v_mul_f32 v175, v255, v175
    v_mul_f32 v176, v255, v176
    v_mul_f32 v177, v255, v177
    v_mul_f32 v178, v255, v178
    v_mul_f32 v179, v255, v179
    v_mul_f32 v180, v255, v180
    v_mul_f32 v181, v255, v181
    v_mul_f32 v182, v255, v182
    v_mul_f32 v183, v255, v183
    v_mul_f32 v184, v255, v184
    v_mul_f32 v185, v255, v185
    v_mul_f32 v186, v255, v186
    v_mul_f32 v187, v255, v187
    v_mul_f32 v188, v255, v188
    v_mul_f32 v189, v255, v189
    v_mul_f32 v190, v255, v190
    v_mul_f32 v191, v255, v191
    v_exp_f32 v240, v208
    v_exp_f32 v241, v209
    v_exp_f32 v242, v210
    v_exp_f32 v243, v211
    v_add_f32 v250, v240, v241
    v_cvt_pk_bf16_f32 v232, v240, v241
    v_exp_f32 v244, v212
    v_exp_f32 v245, v213
    v_add_f32 v250, v250, v242
    v_add_f32 v250, v250, v243
    v_cvt_pk_bf16_f32 v233, v242, v243
    v_exp_f32 v246, v214
    v_exp_f32 v247, v215
    v_add_f32 v250, v250, v244
    v_add_f32 v250, v250, v245
    v_cvt_pk_bf16_f32 v234, v244, v245
    v_exp_f32 v240, v216
    v_exp_f32 v241, v217
    v_add_f32 v250, v250, v246
    v_add_f32 v250, v250, v247
    v_cvt_pk_bf16_f32 v235, v246, v247
    v_exp_f32 v242, v218
    v_exp_f32 v243, v219
    v_add_f32 v251, v240, v241
    v_cvt_pk_bf16_f32 v236, v240, v241
    v_exp_f32 v244, v220
    v_exp_f32 v245, v221
    v_add_f32 v251, v251, v242
    v_add_f32 v251, v251, v243
    v_cvt_pk_bf16_f32 v237, v242, v243
    v_exp_f32 v246, v222
    v_exp_f32 v247, v223
    v_add_f32 v251, v251, v244
    v_add_f32 v251, v251, v245
    v_cvt_pk_bf16_f32 v238, v244, v245
    v_add_f32 v251, v251, v246
    v_add_f32 v251, v251, v247
    v_cvt_pk_bf16_f32 v239, v246, v247
    s_setpc_b64 s[52:53]
kf_special0:
    s_sub_u32 s32, s35, s44
    s_cmp_gt_u32 s32, 1
    s_cbranch_scc1 kf_nomask0
    s_nop 7
    v_cndmask_b32 v192, v192, v17, s[90:91]
    v_cndmask_b32 v193, v193, v17, s[92:93]
    v_cndmask_b32 v194, v194, v17, s[94:95]
    v_cndmask_b32 v195, v195, v17, s[96:97]
    v_cndmask_b32 v204, v204, v17, s[90:91]
    v_cndmask_b32 v205, v205, v17, s[92:93]
    v_cndmask_b32 v206, v206, v17, s[94:95]
    v_cndmask_b32 v207, v207, v17, s[96:97]
    v_mov_b32 v196, v17
    v_mov_b32 v197, v17
    v_mov_b32 v198, v17
    v_mov_b32 v199, v17
kf_nomask0:
    s_cmp_eq_u32 s32, 2
    s_cbranch_scc1 kf_final
    s_cmp_eq_u32 s35, 0
    s_cbranch_scc1 kf_fresh0
    s_cmp_lg_u32 s35, s46
    s_cbranch_scc1 kf_nox20
    v_add_u32 v14, 98304, v4
    v_add_f32 v10, v248, v250
    v_add_f32 v11, v249, v251
    v_mov_b64 v[248:249], 0
    v_mov_b64 v[250:251], 0
kf_fresh0:
    s_nop 7
    v_max3_f32 v252, v192, v193, v194
    v_max3_f32 v252, v252, v195, v196
    v_max3_f32 v252, v252, v197, v198
    v_max_f32 v252, v252, v199
    v_max3_f32 v253, v200, v201, v202
    v_max3_f32 v253, v253, v203, v204
    v_max3_f32 v253, v253, v205, v206
    v_max_f32 v253, v253, v207
    v_mov_b32 v240, v252
    s_nop 1
    v_permlane16_swap_b32 v252, v240
    s_nop 0
    v_max_f32 v252, v252, v240
    v_mov_b32 v240, v252
    s_nop 1
    v_permlane32_swap_b32 v252, v240
    s_nop 0
    v_max_f32 v252, v252, v240
    v_mov_b32 v240, v253
    s_nop 1
    v_permlane16_swap_b32 v253, v240
    s_nop 0
    v_max_f32 v253, v253, v240
    v_mov_b32 v240, v253
    s_nop 1
    v_permlane32_swap_b32 v253, v240
    s_nop 0
    v_max_f32 v253, v253, v240
    v_max_f32 v252, 0xf149f2ca, v252
    v_add_f32 v252, 0x42b60000, v252
    v_sub_f32 v24, v24, v252
    v_sub_f32 v25, v25, v252
    v_sub_f32 v26, v26, v252
    v_sub_f32 v27, v27, v252
    v_sub_f32 v192, v192, v252
    v_sub_f32 v193, v193, v252
    v_sub_f32 v194, v194, v252
    v_sub_f32 v195, v195, v252
    v_sub_f32 v196, v196, v252
    v_sub_f32 v197, v197, v252
    v_sub_f32 v198, v198, v252
    v_sub_f32 v199, v199, v252
    v_max_f32 v253, 0xf149f2ca, v253
    v_add_f32 v253, 0x42b60000, v253
    v_sub_f32 v28, v28, v253
    v_sub_f32 v29, v29, v253
    v_sub_f32 v30, v30, v253
    v_sub_f32 v31, v31, v253
    v_sub_f32 v200, v200, v253
    v_sub_f32 v201, v201, v253
    v_sub_f32 v202, v202, v253
    v_sub_f32 v203, v203, v253
    v_sub_f32 v204, v204, v253
    v_sub_f32 v205, v205, v253
    v_sub_f32 v206, v206, v253
    v_sub_f32 v207, v207, v253
kf_nox20:
    s_cmp_lg_u32 s35, s44
    s_cbranch_scc1 kf_nox10
    ds_read_b128 v[96:99], v12 offset:0
    ds_read_b128 v[100:103], v12 offset:1024
    ds_read_b128 v[104:107], v12 offset:2048
    ds_read_b128 v[108:111], v12 offset:3072
    ds_read_b128 v[112:115], v12 offset:4096
    ds_read_b128 v[116:119], v12 offset:5120
    ds_read_b128 v[120:123], v12 offset:6144
    ds_read_b128 v[124:127], v12 offset:7168
    v_add_u32 v13, 98304, v4
kf_nox10:
    s_setpc_b64 s[52:53]
kf_special1:
    s_sub_u32 s32, s35, s44
    s_cmp_gt_u32 s32, 1
    s_cbranch_scc1 kf_nomask1
    s_nop 7
    v_cndmask_b32 v208, v208, v17, s[90:91]
    v_cndmask_b32 v209, v209, v17, s[92:93]
    v_cndmask_b32 v210, v210, v17, s[94:95]
    v_cndmask_b32 v211, v211, v17, s[96:97]
    v_cndmask_b32 v220, v220, v17, s[90:91]
    v_cndmask_b32 v221, v221, v17, s[92:93]
    v_cndmask_b32 v222, v222, v17, s[94:95]
    v_cndmask_b32 v223, v223, v17, s[96:97]
    v_mov_b32 v212, v17
    v_mov_b32 v213, v17
    v_mov_b32 v214, v17
    v_mov_b32 v215, v17
kf_nomask1:
    s_cmp_eq_u32 s32, 2
    s_cbranch_scc1 kf_final
    s_cmp_eq_u32 s35, 0
    s_cbranch_scc1 kf_fresh1
    s_cmp_lg_u32 s35, s46
    s_cbranch_scc1 kf_nox21
    v_add_u32 v14, 98304, v4
    v_add_f32 v10, v248, v250
    v_add_f32 v11, v249, v251
    v_mov_b64 v[248:249], 0
    v_mov_b64 v[250:251], 0
kf_fresh1:
    s_nop 7
    v_max3_f32 v252, v208, v209, v210
    v_max3_f32 v252, v252, v211, v212
    v_max3_f32 v252, v252, v213, v214
    v_max_f32 v252, v252, v215
    v_max3_f32 v253, v216, v217, v218
    v_max3_f32 v253, v253, v219, v220
    v_max3_f32 v253, v253, v221, v222
    v_max_f32 v253, v253, v223
    v_mov_b32 v240, v252
    s_nop 1
    v_permlane16_swap_b32 v252, v240
    s_nop 0
    v_max_f32 v252, v252, v240
    v_mov_b32 v240, v252
    s_nop 1
    v_permlane32_swap_b32 v252, v240
    s_nop 0
    v_max_f32 v252, v252, v240
    v_mov_b32 v240, v253
    s_nop 1
    v_permlane16_swap_b32 v253, v240
    s_nop 0
    v_max_f32 v253, v253, v240
    v_mov_b32 v240, v253
    s_nop 1
    v_permlane32_swap_b32 v253, v240
    s_nop 0
    v_max_f32 v253, v253, v240
    v_max_f32 v252, 0xf149f2ca, v252
    v_add_f32 v252, 0x42b60000, v252
    v_sub_f32 v24, v24, v252
    v_sub_f32 v25, v25, v252
    v_sub_f32 v26, v26, v252
    v_sub_f32 v27, v27, v252
    v_sub_f32 v208, v208, v252
    v_sub_f32 v209, v209, v252
    v_sub_f32 v210, v210, v252
    v_sub_f32 v211, v211, v252
    v_sub_f32 v212, v212, v252
    v_sub_f32 v213, v213, v252
    v_sub_f32 v214, v214, v252
    v_sub_f32 v215, v215, v252
    v_max_f32 v253, 0xf149f2ca, v253
    v_add_f32 v253, 0x42b60000, v253
    v_sub_f32 v28, v28, v253
    v_sub_f32 v29, v29, v253
    v_sub_f32 v30, v30, v253
    v_sub_f32 v31, v31, v253
    v_sub_f32 v216, v216, v253
    v_sub_f32 v217, v217, v253
    v_sub_f32 v218, v218, v253
    v_sub_f32 v219, v219, v253
    v_sub_f32 v220, v220, v253
    v_sub_f32 v221, v221, v253
    v_sub_f32 v222, v222, v253
    v_sub_f32 v223, v223, v253
kf_nox21:
    s_cmp_lg_u32 s35, s44
    s_cbranch_scc1 kf_nox11
    ds_read_b128 v[96:99], v12 offset:0
    ds_read_b128 v[100:103], v12 offset:1024
    ds_read_b128 v[104:107], v12 offset:2048
    ds_read_b128 v[108:111], v12 offset:3072
    ds_read_b128 v[112:115], v12 offset:4096
    ds_read_b128 v[116:119], v12 offset:5120
    ds_read_b128 v[120:123], v12 offset:6144
    ds_read_b128 v[124:127], v12 offset:7168
    v_add_u32 v13, 98304, v4
kf_nox11:
    s_setpc_b64 s[52:53]
kf_final:
    v_mov_b32 v240, v10
    s_nop 1
    v_permlane16_swap_b32 v10, v240
    s_nop 0
    v_add_f32 v10, v10, v240
    v_mov_b32 v240, v10
    s_nop 1
    v_permlane32_swap_b32 v10, v240
    s_nop 0
    v_add_f32 v10, v10, v240
    v_rcp_f32 v10, v10
    s_nop 0
    v_mul_f32 v10, 0x29000000, v10
    v_mov_b32 v240, v11
    s_nop 1
    v_permlane16_swap_b32 v11, v240
    s_nop 0
    v_add_f32 v11, v11, v240
    v_mov_b32 v240, v11
    s_nop 1
    v_permlane32_swap_b32 v11, v240
    s_nop 0
    v_add_f32 v11, v11, v240
    v_rcp_f32 v11, v11
    s_nop 0
    v_mul_f32 v11, 0x29000000, v11
    s_lshr_b32 s32, s58, 4
    s_lshl_b32 s32, s32, 5
    s_add_u32 s32, s32, s4
    s_lshl_b32 s32, s32, 12
    s_add_u32 s32, s32, 33554432
    s_add_u32 s33, s32, 131072
    v_mul_f32 v128, v10, v128
    v_mul_f32 v129, v10, v129
    v_mul_f32 v130, v10, v130
    v_mul_f32 v131, v10, v131
    v_mul_f32 v132, v10, v132
    v_mul_f32 v133, v10, v133
    v_mul_f32 v134, v10, v134
    v_mul_f32 v135, v10, v135
    v_cvt_pk_bf16_f32 v128, v128, v129
    v_cvt_pk_bf16_f32 v129, v130, v131
    v_cvt_pk_bf16_f32 v130, v132, v133
    v_cvt_pk_bf16_f32 v131, v134, v135
    buffer_store_dwordx4 v[128:131], v4, s[20:23], s32 offen offset:0 sc1
    v_mul_f32 v136, v10, v136
    v_mul_f32 v137, v10, v137
    v_mul_f32 v138, v10, v138
    v_mul_f32 v139, v10, v139
    v_mul_f32 v140, v10, v140
    v_mul_f32 v141, v10, v141
    v_mul_f32 v142, v10, v142
    v_mul_f32 v143, v10, v143
    v_cvt_pk_bf16_f32 v136, v136, v137
    v_cvt_pk_bf16_f32 v137, v138, v139
    v_cvt_pk_bf16_f32 v138, v140, v141
    v_cvt_pk_bf16_f32 v139, v142, v143
    buffer_store_dwordx4 v[136:139], v4, s[20:23], s32 offen offset:1024 sc1
    v_mul_f32 v144, v10, v144
    v_mul_f32 v145, v10, v145
    v_mul_f32 v146, v10, v146
    v_mul_f32 v147, v10, v147
    v_mul_f32 v148, v10, v148
    v_mul_f32 v149, v10, v149
    v_mul_f32 v150, v10, v150
    v_mul_f32 v151, v10, v151
    v_cvt_pk_bf16_f32 v144, v144, v145
    v_cvt_pk_bf16_f32 v145, v146, v147
    v_cvt_pk_bf16_f32 v146, v148, v149
    v_cvt_pk_bf16_f32 v147, v150, v151
    buffer_store_dwordx4 v[144:147], v4, s[20:23], s32 offen offset:2048 sc1
    v_mul_f32 v152, v10, v152
    v_mul_f32 v153, v10, v153
    v_mul_f32 v154, v10, v154
    v_mul_f32 v155, v10, v155
    v_mul_f32 v156, v10, v156
    v_mul_f32 v157, v10, v157
    v_mul_f32 v158, v10, v158
    v_mul_f32 v159, v10, v159
    v_cvt_pk_bf16_f32 v152, v152, v153
    v_cvt_pk_bf16_f32 v153, v154, v155
    v_cvt_pk_bf16_f32 v154, v156, v157
    v_cvt_pk_bf16_f32 v155, v158, v159
    buffer_store_dwordx4 v[152:155], v4, s[20:23], s32 offen offset:3072 sc1
    v_mul_f32 v160, v11, v160
    v_mul_f32 v161, v11, v161
    v_mul_f32 v162, v11, v162
    v_mul_f32 v163, v11, v163
    v_mul_f32 v164, v11, v164
    v_mul_f32 v165, v11, v165
    v_mul_f32 v166, v11, v166
    v_mul_f32 v167, v11, v167
    v_cvt_pk_bf16_f32 v160, v160, v161
    v_cvt_pk_bf16_f32 v161, v162, v163
    v_cvt_pk_bf16_f32 v162, v164, v165
    v_cvt_pk_bf16_f32 v163, v166, v167
    buffer_store_dwordx4 v[160:163], v4, s[20:23], s33 offen offset:0 sc1
    v_mul_f32 v168, v11, v168
    v_mul_f32 v169, v11, v169
    v_mul_f32 v170, v11, v170
    v_mul_f32 v171, v11, v171
    v_mul_f32 v172, v11, v172
    v_mul_f32 v173, v11, v173
    v_mul_f32 v174, v11, v174
    v_mul_f32 v175, v11, v175
    v_cvt_pk_bf16_f32 v168, v168, v169
    v_cvt_pk_bf16_f32 v169, v170, v171
    v_cvt_pk_bf16_f32 v170, v172, v173
    v_cvt_pk_bf16_f32 v171, v174, v175
    buffer_store_dwordx4 v[168:171], v4, s[20:23], s33 offen offset:1024 sc1
    v_mul_f32 v176, v11, v176
    v_mul_f32 v177, v11, v177
    v_mul_f32 v178, v11, v178
    v_mul_f32 v179, v11, v179
    v_mul_f32 v180, v11, v180
    v_mul_f32 v181, v11, v181
    v_mul_f32 v182, v11, v182
    v_mul_f32 v183, v11, v183
    v_cvt_pk_bf16_f32 v176, v176, v177
    v_cvt_pk_bf16_f32 v177, v178, v179
    v_cvt_pk_bf16_f32 v178, v180, v181
    v_cvt_pk_bf16_f32 v179, v182, v183
    buffer_store_dwordx4 v[176:179], v4, s[20:23], s33 offen offset:2048 sc1
    v_mul_f32 v184, v11, v184
    v_mul_f32 v185, v11, v185
    v_mul_f32 v186, v11, v186
    v_mul_f32 v187, v11, v187
    v_mul_f32 v188, v11, v188
    v_mul_f32 v189, v11, v189
    v_mul_f32 v190, v11, v190
    v_mul_f32 v191, v11, v191
    v_cvt_pk_bf16_f32 v184, v184, v185
    v_cvt_pk_bf16_f32 v185, v186, v187
    v_cvt_pk_bf16_f32 v186, v188, v189
    v_cvt_pk_bf16_f32 v187, v190, v191
    buffer_store_dwordx4 v[184:187], v4, s[20:23], s33 offen offset:3072 sc1
    s_nop 1
    v_mov_b64 v[128:129], 0
    v_mov_b64 v[130:131], 0
    v_mov_b64 v[132:133], 0
    v_mov_b64 v[134:135], 0
    v_mov_b64 v[136:137], 0
    v_mov_b64 v[138:139], 0
    v_mov_b64 v[140:141], 0
    v_mov_b64 v[142:143], 0
    v_mov_b64 v[144:145], 0
    v_mov_b64 v[146:147], 0
    v_mov_b64 v[148:149], 0
    v_mov_b64 v[150:151], 0
    v_mov_b64 v[152:153], 0
    v_mov_b64 v[154:155], 0
    v_mov_b64 v[156:157], 0
    v_mov_b64 v[158:159], 0
    v_mov_b64 v[160:161], 0
    v_mov_b64 v[162:163], 0
    v_mov_b64 v[164:165], 0
    v_mov_b64 v[166:167], 0
    v_mov_b64 v[168:169], 0
    v_mov_b64 v[170:171], 0
    v_mov_b64 v[172:173], 0
    v_mov_b64 v[174:175], 0
    v_mov_b64 v[176:177], 0
    v_mov_b64 v[178:179], 0
    v_mov_b64 v[180:181], 0
    v_mov_b64 v[182:183], 0
    v_mov_b64 v[184:185], 0
    v_mov_b64 v[186:187], 0
    v_mov_b64 v[188:189], 0
    v_mov_b64 v[190:191], 0
    s_setpc_b64 s[52:53]
kf_end:
    s_endpgm
    .globl k3_kernel
    .p2align 8
    .type k3_kernel,@function
k3_kernel:
    s_cmp_ge_u32 s2, 256
    s_cbranch_scc1 k3_end
    s_load_dwordx2 s[84:85], s[0:1], 80
    s_load_dwordx2 s[88:89], s[0:1], 96
    s_load_dwordx2 s[74:75], s[0:1], 40
    v_lshrrev_b32 v5, 6, v0
    v_and_b32 v1, 63, v0
    v_readfirstlane_b32 s3, v5
    v_and_b32 v2, 15, v1
    v_lshrrev_b32 v3, 4, v1
    v_lshlrev_b32 v4, 4, v1
    s_and_b32 s35, s2, 7
    s_lshr_b32 s36, s2, 3
    s_lshl_b32 s32, s36, 2
    s_add_u32 s32, s32, s3
    s_getpc_b64 s[90:91]
pc_3:
    s_add_u32 s90, s90, k3_kernel-pc_3
    s_addc_u32 s91, s91, (k3_kernel-pc_3)>>32
    v_min_u32 v5, 1, v1
    s_mul_i32 s92, s32, 2
    v_add_u32 v5, s92, v5
    v_lshlrev_b32 v5, 7, v5
    v_min_u32 v5, code_end-k3_kernel-4, v5
    global_load_dword v14, v5, s[90:91]
    s_waitcnt lgkmcnt(0)
    s_mov_b32 s20, s88
    s_and_b32 s21, s89, 0xffff
    s_mov_b32 s22, 268435456
    s_mov_b32 s23, 0x20000
    s_mov_b32 s8, s84
    s_and_b32 s9, s85, 0xffff
    s_mov_b32 s10, 4718592
    s_mov_b32 s11, 0x20000
    s_cmp_ge_u32 s36, 24
    s_cbranch_scc1 k3_B
    s_mul_i32 s32, s36, 43
    s_lshr_b32 s32, s32, 8
    s_mul_i32 s33, s32, 6
    s_sub_u32 s38, s36, s33
    s_lshl_b32 s37, s35, 2
    s_add_u32 s37, s37, s32
    s_add_u32 s32, s3, 0
    s_and_b32 s32, s32, 3
    s_lshl_b32 s32, s32, 17
    v_add_u32 v9, s32, v4
    s_add_u32 s32, s3, 1
    s_and_b32 s32, s32, 3
    s_lshl_b32 s32, s32, 17
    v_add_u32 v10, s32, v4
    s_add_u32 s32, s3, 2
    s_and_b32 s32, s32, 3
    s_lshl_b32 s32, s32, 17
    v_add_u32 v11, s32, v4
    s_add_u32 s32, s3, 3
    s_and_b32 s32, s32, 3
    s_lshl_b32 s32, s32, 17
    v_add_u32 v12, s32, v4
    v_add_u32 v13, 4096, v4
    s_lshl_b32 s39, s37, 19
    s_lshl_b32 s32, s3, 15
    s_add_u32 s39, s39, s32
    s_add_u32 s39, s39, 33554432
    s_mul_i32 s40, s38, 786432
    s_mul_i32 s32, s3, 196608
    s_add_u32 s40, s40, s32
    s_add_u32 s40, s40, 50331648
    buffer_load_dwordx4 v[32:35], v4, s[20:23], s40 offen offset:0
    buffer_load_dwordx4 v[16:19], v9, s[20:23], s39 offen
    buffer_load_dwordx4 v[36:39], v4, s[20:23], s40 offen offset:1024
    buffer_load_dwordx4 v[20:23], v10, s[20:23], s39 offen
    buffer_load_dwordx4 v[40:43], v4, s[20:23], s40 offen offset:2048
    buffer_load_dwordx4 v[24:27], v11, s[20:23], s39 offen
    buffer_load_dwordx4 v[44:47], v4, s[20:23], s40 offen offset:3072
    buffer_load_dwordx4 v[28:31], v12, s[20:23], s39 offen
    buffer_load_dwordx4 v[48:51], v13, s[20:23], s40 offen offset:0
    buffer_load_dwordx4 v[52:55], v13, s[20:23], s40 offen offset:1024
    s_add_u32 s40, s40, 6144
    s_add_u32 s39, s39, 1024
    buffer_load_dwordx4 v[72:75], v4, s[20:23], s40 offen offset:0
    buffer_load_dwordx4 v[56:59], v9, s[20:23], s39 offen
    buffer_load_dwordx4 v[76:79], v4, s[20:23], s40 offen offset:1024
    buffer_load_dwordx4 v[60:63], v10, s[20:23], s39 offen
    buffer_load_dwordx4 v[80:83], v4, s[20:23], s40 offen offset:2048
    buffer_load_dwordx4 v[64:67], v11, s[20:23], s39 offen
    buffer_load_dwordx4 v[84:87], v4, s[20:23], s40 offen offset:3072
    buffer_load_dwordx4 v[68:71], v12, s[20:23], s39 offen
    buffer_load_dwordx4 v[88:91], v13, s[20:23], s40 offen offset:0
    buffer_load_dwordx4 v[92:95], v13, s[20:23], s40 offen offset:1024
    s_add_u32 s40, s40, 6144
    s_add_u32 s39, s39, 1024
    buffer_load_dwordx4 v[112:115], v4, s[20:23], s40 offen offset:0
    buffer_load_dwordx4 v[96:99], v9, s[20:23], s39 offen
    buffer_load_dwordx4 v[116:119], v4, s[20:23], s40 offen offset:1024
    buffer_load_dwordx4 v[100:103], v10, s[20:23], s39 offen
    buffer_load_dwordx4 v[120:123], v4, s[20:23], s40 offen offset:2048
    buffer_load_dwordx4 v[104:107], v11, s[20:23], s39 offen
    buffer_load_dwordx4 v[124:127], v4, s[20:23], s40 offen offset:3072
    buffer_load_dwordx4 v[108:111], v12, s[20:23], s39 offen
    buffer_load_dwordx4 v[128:131], v13, s[20:23], s40 offen offset:0
    buffer_load_dwordx4 v[132:135], v13, s[20:23], s40 offen offset:1024
    s_add_u32 s40, s40, 6144
    s_add_u32 s39, s39, 1024
    buffer_load_dwordx4 v[152:155], v4, s[20:23], s40 offen offset:0
    buffer_load_dwordx4 v[136:139], v9, s[20:23], s39 offen
    buffer_load_dwordx4 v[156:159], v4, s[20:23], s40 offen offset:1024
    buffer_load_dwordx4 v[140:143], v10, s[20:23], s39 offen
    buffer_load_dwordx4 v[160:163], v4, s[20:23], s40 offen offset:2048
    buffer_load_dwordx4 v[144:147], v11, s[20:23], s39 offen
    buffer_load_dwordx4 v[164:167], v4, s[20:23], s40 offen offset:3072
    buffer_load_dwordx4 v[148:151], v12, s[20:23], s39 offen
    buffer_load_dwordx4 v[168:171], v13, s[20:23], s40 offen offset:0
    buffer_load_dwordx4 v[172:175], v13, s[20:23], s40 offen offset:1024
    s_add_u32 s40, s40, 6144
    s_add_u32 s39, s39, 1024
    buffer_load_dwordx4 v[192:195], v4, s[20:23], s40 offen offset:0
    buffer_load_dwordx4 v[176:179], v9, s[20:23], s39 offen
    buffer_load_dwordx4 v[196:199], v4, s[20:23], s40 offen offset:1024
    buffer_load_dwordx4 v[180:183], v10, s[20:23], s39 offen
    buffer_load_dwordx4 v[200:203], v4, s[20:23], s40 offen offset:2048
    buffer_load_dwordx4 v[184:187], v11, s[20:23], s39 offen
    buffer_load_dwordx4 v[204:207], v4, s[20:23], s40 offen offset:3072
    buffer_load_dwordx4 v[188:191], v12, s[20:23], s39 offen
    buffer_load_dwordx4 v[208:211], v13, s[20:23], s40 offen offset:0
    buffer_load_dwordx4 v[212:215], v13, s[20:23], s40 offen offset:1024
    s_add_u32 s40, s40, 6144
    s_add_u32 s39, s39, 1024
    s_waitcnt vmcnt(40)
    v_mfma_f32_16x16x32_bf16 a[0:3], v[32:35], v[16:19], 0
    buffer_load_dwordx4 v[232:235], v4, s[20:23], s40 offen offset:0
    v_mfma_f32_16x16x32_bf16 a[4:7], v[36:39], v[16:19], 0
    v_mfma_f32_16x16x32_bf16 a[8:11], v[40:43], v[16:19], 0
    buffer_load_dwordx4 v[216:219], v9, s[20:23], s39 offen
    v_mfma_f32_16x16x32_bf16 a[12:15], v[44:47], v[16:19], 0
    v_mfma_f32_16x16x32_bf16 a[16:19], v[48:51], v[16:19], 0
    buffer_load_dwordx4 v[236:239], v4, s[20:23], s40 offen offset:1024
    v_mfma_f32_16x16x32_bf16 a[20:23], v[52:55], v[16:19], 0
    v_mfma_f32_16x16x32_bf16 a[24:27], v[32:35], v[20:23], 0
    buffer_load_dwordx4 v[220:223], v10, s[20:23], s39 offen
    v_mfma_f32_16x16x32_bf16 a[28:31], v[36:39], v[20:23], 0
    v_mfma_f32_16x16x32_bf16 a[32:35], v[40:43], v[20:23], 0
    buffer_load_dwordx4 v[240:243], v4, s[20:23], s40 offen offset:2048
    v_mfma_f32_16x16x32_bf16 a[36:39], v[44:47], v[20:23], 0
    v_mfma_f32_16x16x32_bf16 a[40:43], v[48:51], v[20:23], 0
    buffer_load_dwordx4 v[224:227], v11, s[20:23], s39 offen
    v_mfma_f32_16x16x32_bf16 a[44:47], v[52:55], v[20:23], 0
    v_mfma_f32_16x16x32_bf16 a[48:51], v[32:35], v[24:27], 0
    buffer_load_dwordx4 v[244:247], v4, s[20:23], s40 offen offset:3072
    v_mfma_f32_16x16x32_bf16 a[52:55], v[36:39], v[24:27], 0
    v_mfma_f32_16x16x32_bf16 a[56:59], v[40:43], v[24:27], 0
    buffer_load_dwordx4 v[228:231], v12, s[20:23], s39 offen
    v_mfma_f32_16x16x32_bf16 a[60:63], v[44:47], v[24:27], 0
    v_mfma_f32_16x16x32_bf16 a[64:67], v[48:51], v[24:27], 0
    buffer_load_dwordx4 v[248:251], v13, s[20:23], s40 offen offset:0
    v_mfma_f32_16x16x32_bf16 a[68:71], v[52:55], v[24:27], 0
    v_mfma_f32_16x16x32_bf16 a[72:75], v[32:35], v[28:31], 0
    buffer_load_dwordx4 v[252:255], v13, s[20:23], s40 offen offset:1024
    s_add_u32 s40, s40, 6144
    s_add_u32 s39, s39, 1024
    v_mfma_f32_16x16x32_bf16 a[76:79], v[36:39], v[28:31], 0
    v_mfma_f32_16x16x32_bf16 a[80:83], v[40:43], v[28:31], 0
    v_mfma_f32_16x16x32_bf16 a[84:87], v[44:47], v[28:31], 0
    v_mfma_f32_16x16x32_bf16 a[88:91], v[48:51], v[28:31], 0
    v_mfma_f32_16x16x32_bf16 a[92:95], v[52:55], v[28:31], 0
    s_waitcnt vmcnt(40)
    v_mfma_f32_16x16x32_bf16 a[0:3], v[72:75], v[56:59], a[0:3]
    buffer_load_dwordx4 v[32:35], v4, s[20:23], s40 offen offset:0
    v_mfma_f32_16x16x32_bf16 a[4:7], v[76:79], v[56:59], a[4:7]
    v_mfma_f32_16x16x32_bf16 a[8:11], v[80:83], v[56:59], a[8:11]
    buffer_load_dwordx4 v[16:19], v9, s[20:23], s39 offen
    v_mfma_f32_16x16x32_bf16 a[12:15], v[84:87], v[56:59], a[12:15]
    v_mfma_f32_16x16x32_bf16 a[16:19], v[88:91], v[56:59], a[16:19]
    buffer_load_dwordx4 v[36:39], v4, s[20:23], s40 offen offset:1024
    v_mfma_f32_16x16x32_bf16 a[20:23], v[92:95], v[56:59], a[20:23]
    v_mfma_f32_16x16x32_bf16 a[24:27], v[72:75], v[60:63], a[24:27]
    buffer_load_dwordx4 v[20:23], v10, s[20:23], s39 offen
    v_mfma_f32_16x16x32_bf16 a[28:31], v[76:79], v[60:63], a[28:31]
    v_mfma_f32_16x16x32_bf16 a[32:35], v[80:83], v[60:63], a[32:35]
    buffer_load_dwordx4 v[40:43], v4, s[20:23], s40 offen offset:2048
    v_mfma_f32_16x16x32_bf16 a[36:39], v[84:87], v[60:63], a[36:39]
    v_mfma_f32_16x16x32_bf16 a[40:43], v[88:91], v[60:63], a[40:43]
    buffer_load_dwordx4 v[24:27], v11, s[20:23], s39 offen
    v_mfma_f32_16x16x32_bf16 a[44:47], v[92:95], v[60:63], a[44:47]
    v_mfma_f32_16x16x32_bf16 a[48:51], v[72:75], v[64:67], a[48:51]
    buffer_load_dwordx4 v[44:47], v4, s[20:23], s40 offen offset:3072
    v_mfma_f32_16x16x32_bf16 a[52:55], v[76:79], v[64:67], a[52:55]
    v_mfma_f32_16x16x32_bf16 a[56:59], v[80:83], v[64:67], a[56:59]
    buffer_load_dwordx4 v[28:31], v12, s[20:23], s39 offen
    v_mfma_f32_16x16x32_bf16 a[60:63], v[84:87], v[64:67], a[60:63]
    v_mfma_f32_16x16x32_bf16 a[64:67], v[88:91], v[64:67], a[64:67]
    buffer_load_dwordx4 v[48:51], v13, s[20:23], s40 offen offset:0
    v_mfma_f32_16x16x32_bf16 a[68:71], v[92:95], v[64:67], a[68:71]
    v_mfma_f32_16x16x32_bf16 a[72:75], v[72:75], v[68:71], a[72:75]
    buffer_load_dwordx4 v[52:55], v13, s[20:23], s40 offen offset:1024
    s_add_u32 s40, s40, 6144
    s_add_u32 s39, s39, 1024
    v_mfma_f32_16x16x32_bf16 a[76:79], v[76:79], v[68:71], a[76:79]
    v_mfma_f32_16x16x32_bf16 a[80:83], v[80:83], v[68:71], a[80:83]
    v_mfma_f32_16x16x32_bf16 a[84:87], v[84:87], v[68:71], a[84:87]
    v_mfma_f32_16x16x32_bf16 a[88:91], v[88:91], v[68:71], a[88:91]
    v_mfma_f32_16x16x32_bf16 a[92:95], v[92:95], v[68:71], a[92:95]
    s_waitcnt vmcnt(40)
    v_mfma_f32_16x16x32_bf16 a[0:3], v[112:115], v[96:99], a[0:3]
    buffer_load_dwordx4 v[72:75], v4, s[20:23], s40 offen offset:0
    v_mfma_f32_16x16x32_bf16 a[4:7], v[116:119], v[96:99], a[4:7]
    v_mfma_f32_16x16x32_bf16 a[8:11], v[120:123], v[96:99], a[8:11]
    buffer_load_dwordx4 v[56:59], v9, s[20:23], s39 offen
    v_mfma_f32_16x16x32_bf16 a[12:15], v[124:127], v[96:99], a[12:15]
    v_mfma_f32_16x16x32_bf16 a[16:19], v[128:131], v[96:99], a[16:19]
    buffer_load_dwordx4 v[76:79], v4, s[20:23], s40 offen offset:1024
    v_mfma_f32_16x16x32_bf16 a[20:23], v[132:135], v[96:99], a[20:23]
    v_mfma_f32_16x16x32_bf16 a[24:27], v[112:115], v[100:103], a[24:27]
    buffer_load_dwordx4 v[60:63], v10, s[20:23], s39 offen
    v_mfma_f32_16x16x32_bf16 a[28:31], v[116:119], v[100:103], a[28:31]
    v_mfma_f32_16x16x32_bf16 a[32:35], v[120:123], v[100:103], a[32:35]
    buffer_load_dwordx4 v[80:83], v4, s[20:23], s40 offen offset:2048
    v_mfma_f32_16x16x32_bf16 a[36:39], v[124:127], v[100:103], a[36:39]
    v_mfma_f32_16x16x32_bf16 a[40:43], v[128:131], v[100:103], a[40:43]
    buffer_load_dwordx4 v[64:67], v11, s[20:23], s39 offen
    v_mfma_f32_16x16x32_bf16 a[44:47], v[132:135], v[100:103], a[44:47]
    v_mfma_f32_16x16x32_bf16 a[48:51], v[112:115], v[104:107], a[48:51]
    buffer_load_dwordx4 v[84:87], v4, s[20:23], s40 offen offset:3072
    v_mfma_f32_16x16x32_bf16 a[52:55], v[116:119], v[104:107], a[52:55]
    v_mfma_f32_16x16x32_bf16 a[56:59], v[120:123], v[104:107], a[56:59]
    buffer_load_dwordx4 v[68:71], v12, s[20:23], s39 offen
    v_mfma_f32_16x16x32_bf16 a[60:63], v[124:127], v[104:107], a[60:63]
    v_mfma_f32_16x16x32_bf16 a[64:67], v[128:131], v[104:107], a[64:67]
    buffer_load_dwordx4 v[88:91], v13, s[20:23], s40 offen offset:0
    v_mfma_f32_16x16x32_bf16 a[68:71], v[132:135], v[104:107], a[68:71]
    v_mfma_f32_16x16x32_bf16 a[72:75], v[112:115], v[108:111], a[72:75]
    buffer_load_dwordx4 v[92:95], v13, s[20:23], s40 offen offset:1024
    s_add_u32 s40, s40, 6144
    s_add_u32 s39, s39, 1024
    v_mfma_f32_16x16x32_bf16 a[76:79], v[116:119], v[108:111], a[76:79]
    v_mfma_f32_16x16x32_bf16 a[80:83], v[120:123], v[108:111], a[80:83]
    v_mfma_f32_16x16x32_bf16 a[84:87], v[124:127], v[108:111], a[84:87]
    v_mfma_f32_16x16x32_bf16 a[88:91], v[128:131], v[108:111], a[88:91]
    v_mfma_f32_16x16x32_bf16 a[92:95], v[132:135], v[108:111], a[92:95]
    s_waitcnt vmcnt(40)
    v_mfma_f32_16x16x32_bf16 a[0:3], v[152:155], v[136:139], a[0:3]
    buffer_load_dwordx4 v[112:115], v4, s[20:23], s40 offen offset:0
    v_mfma_f32_16x16x32_bf16 a[4:7], v[156:159], v[136:139], a[4:7]
    v_mfma_f32_16x16x32_bf16 a[8:11], v[160:163], v[136:139], a[8:11]
    buffer_load_dwordx4 v[96:99], v9, s[20:23], s39 offen
    v_mfma_f32_16x16x32_bf16 a[12:15], v[164:167], v[136:139], a[12:15]
    v_mfma_f32_16x16x32_bf16 a[16:19], v[168:171], v[136:139], a[16:19]
    buffer_load_dwordx4 v[116:119], v4, s[20:23], s40 offen offset:1024
    v_mfma_f32_16x16x32_bf16 a[20:23], v[172:175], v[136:139], a[20:23]
    v_mfma_f32_16x16x32_bf16 a[24:27], v[152:155], v[140:143], a[24:27]
    buffer_load_dwordx4 v[100:103], v10, s[20:23], s39 offen
    v_mfma_f32_16x16x32_bf16 a[28:31], v[156:159], v[140:143], a[28:31]
    v_mfma_f32_16x16x32_bf16 a[32:35], v[160:163], v[140:143], a[32:35]
    buffer_load_dwordx4 v[120:123], v4, s[20:23], s40 offen offset:2048
    v_mfma_f32_16x16x32_bf16 a[36:39], v[164:167], v[140:143], a[36:39]
    v_mfma_f32_16x16x32_bf16 a[40:43], v[168:171], v[140:143], a[40:43]
    buffer_load_dwordx4 v[104:107], v11, s[20:23], s39 offen
    v_mfma_f32_16x16x32_bf16 a[44:47], v[172:175], v[140:143], a[44:47]
    v_mfma_f32_16x16x32_bf16 a[48:51], v[152:155], v[144:147], a[48:51]
    buffer_load_dwordx4 v[124:127], v4, s[20:23], s40 offen offset:3072
    v_mfma_f32_16x16x32_bf16 a[52:55], v[156:159], v[144:147], a[52:55]
    v_mfma_f32_16x16x32_bf16 a[56:59], v[160:163], v[144:147], a[56:59]
    buffer_load_dwordx4 v[108:111], v12, s[20:23], s39 offen
    v_mfma_f32_16x16x32_bf16 a[60:63], v[164:167], v[144:147], a[60:63]
    v_mfma_f32_16x16x32_bf16 a[64:67], v[168:171], v[144:147], a[64:67]
    buffer_load_dwordx4 v[128:131], v13, s[20:23], s40 offen offset:0
    v_mfma_f32_16x16x32_bf16 a[68:71], v[172:175], v[144:147], a[68:71]
    v_mfma_f32_16x16x32_bf16 a[72:75], v[152:155], v[148:151], a[72:75]
    buffer_load_dwordx4 v[132:135], v13, s[20:23], s40 offen offset:1024
    s_add_u32 s40, s40, 6144
    s_add_u32 s39, s39, 1024
    v_mfma_f32_16x16x32_bf16 a[76:79], v[156:159], v[148:151], a[76:79]
    v_mfma_f32_16x16x32_bf16 a[80:83], v[160:163], v[148:151], a[80:83]
    v_mfma_f32_16x16x32_bf16 a[84:87], v[164:167], v[148:151], a[84:87]
    v_mfma_f32_16x16x32_bf16 a[88:91], v[168:171], v[148:151], a[88:91]
    v_mfma_f32_16x16x32_bf16 a[92:95], v[172:175], v[148:151], a[92:95]
    s_waitcnt vmcnt(40)
    v_mfma_f32_16x16x32_bf16 a[0:3], v[192:195], v[176:179], a[0:3]
    buffer_load_dwordx4 v[152:155], v4, s[20:23], s40 offen offset:0
    v_mfma_f32_16x16x32_bf16 a[4:7], v[196:199], v[176:179], a[4:7]
    v_mfma_f32_16x16x32_bf16 a[8:11], v[200:203], v[176:179], a[8:11]
    buffer_load_dwordx4 v[136:139], v9, s[20:23], s39 offen
    v_mfma_f32_16x16x32_bf16 a[12:15], v[204:207], v[176:179], a[12:15]
    v_mfma_f32_16x16x32_bf16 a[16:19], v[208:211], v[176:179], a[16:19]
    buffer_load_dwordx4 v[156:159], v4, s[20:23], s40 offen offset:1024
    v_mfma_f32_16x16x32_bf16 a[20:23], v[212:215], v[176:179], a[20:23]
    v_mfma_f32_16x16x32_bf16 a[24:27], v[192:195], v[180:183], a[24:27]
    buffer_load_dwordx4 v[140:143], v10, s[20:23], s39 offen
    v_mfma_f32_16x16x32_bf16 a[28:31], v[196:199], v[180:183], a[28:31]
    v_mfma_f32_16x16x32_bf16 a[32:35], v[200:203], v[180:183], a[32:35]
    buffer_load_dwordx4 v[160:163], v4, s[20:23], s40 offen offset:2048
    v_mfma_f32_16x16x32_bf16 a[36:39], v[204:207], v[180:183], a[36:39]
    v_mfma_f32_16x16x32_bf16 a[40:43], v[208:211], v[180:183], a[40:43]
    buffer_load_dwordx4 v[144:147], v11, s[20:23], s39 offen
    v_mfma_f32_16x16x32_bf16 a[44:47], v[212:215], v[180:183], a[44:47]
    v_mfma_f32_16x16x32_bf16 a[48:51], v[192:195], v[184:187], a[48:51]
    buffer_load_dwordx4 v[164:167], v4, s[20:23], s40 offen offset:3072
    v_mfma_f32_16x16x32_bf16 a[52:55], v[196:199], v[184:187], a[52:55]
    v_mfma_f32_16x16x32_bf16 a[56:59], v[200:203], v[184:187], a[56:59]
    buffer_load_dwordx4 v[148:151], v12, s[20:23], s39 offen
    v_mfma_f32_16x16x32_bf16 a[60:63], v[204:207], v[184:187], a[60:63]
    v_mfma_f32_16x16x32_bf16 a[64:67], v[208:211], v[184:187], a[64:67]
    buffer_load_dwordx4 v[168:171], v13, s[20:23], s40 offen offset:0
    v_mfma_f32_16x16x32_bf16 a[68:71], v[212:215], v[184:187], a[68:71]
    v_mfma_f32_16x16x32_bf16 a[72:75], v[192:195], v[188:191], a[72:75]
    buffer_load_dwordx4 v[172:175], v13, s[20:23], s40 offen offset:1024
    s_add_u32 s40, s40, 6144
    s_add_u32 s39, s39, 1024
    v_mfma_f32_16x16x32_bf16 a[76:79], v[196:199], v[188:191], a[76:79]
    v_mfma_f32_16x16x32_bf16 a[80:83], v[200:203], v[188:191], a[80:83]
    v_mfma_f32_16x16x32_bf16 a[84:87], v[204:207], v[188:191], a[84:87]
    v_mfma_f32_16x16x32_bf16 a[88:91], v[208:211], v[188:191], a[88:91]
    v_mfma_f32_16x16x32_bf16 a[92:95], v[212:215], v[188:191], a[92:95]
    s_waitcnt vmcnt(40)
    v_mfma_f32_16x16x32_bf16 a[0:3], v[232:235], v[216:219], a[0:3]
    buffer_load_dwordx4 v[192:195], v4, s[20:23], s40 offen offset:0
    v_mfma_f32_16x16x32_bf16 a[4:7], v[236:239], v[216:219], a[4:7]
    v_mfma_f32_16x16x32_bf16 a[8:11], v[240:243], v[216:219], a[8:11]
    buffer_load_dwordx4 v[176:179], v9, s[20:23], s39 offen
    v_mfma_f32_16x16x32_bf16 a[12:15], v[244:247], v[216:219], a[12:15]
    v_mfma_f32_16x16x32_bf16 a[16:19], v[248:251], v[216:219], a[16:19]
    buffer_load_dwordx4 v[196:199], v4, s[20:23], s40 offen offset:1024
    v_mfma_f32_16x16x32_bf16 a[20:23], v[252:255], v[216:219], a[20:23]
    v_mfma_f32_16x16x32_bf16 a[24:27], v[232:235], v[220:223], a[24:27]
    buffer_load_dwordx4 v[180:183], v10, s[20:23], s39 offen
    v_mfma_f32_16x16x32_bf16 a[28:31], v[236:239], v[220:223], a[28:31]
    v_mfma_f32_16x16x32_bf16 a[32:35], v[240:243], v[220:223], a[32:35]
    buffer_load_dwordx4 v[200:203], v4, s[20:23], s40 offen offset:2048
    v_mfma_f32_16x16x32_bf16 a[36:39], v[244:247], v[220:223], a[36:39]
    v_mfma_f32_16x16x32_bf16 a[40:43], v[248:251], v[220:223], a[40:43]
    buffer_load_dwordx4 v[184:187], v11, s[20:23], s39 offen
    v_mfma_f32_16x16x32_bf16 a[44:47], v[252:255], v[220:223], a[44:47]
    v_mfma_f32_16x16x32_bf16 a[48:51], v[232:235], v[224:227], a[48:51]
    buffer_load_dwordx4 v[204:207], v4, s[20:23], s40 offen offset:3072
    v_mfma_f32_16x16x32_bf16 a[52:55], v[236:239], v[224:227], a[52:55]
    v_mfma_f32_16x16x32_bf16 a[56:59], v[240:243], v[224:227], a[56:59]
    buffer_load_dwordx4 v[188:191], v12, s[20:23], s39 offen
    v_mfma_f32_16x16x32_bf16 a[60:63], v[244:247], v[224:227], a[60:63]
    v_mfma_f32_16x16x32_bf16 a[64:67], v[248:251], v[224:227], a[64:67]
    buffer_load_dwordx4 v[208:211], v13, s[20:23], s40 offen offset:0
    v_mfma_f32_16x16x32_bf16 a[68:71], v[252:255], v[224:227], a[68:71]
    v_mfma_f32_16x16x32_bf16 a[72:75], v[232:235], v[228:231], a[72:75]
    buffer_load_dwordx4 v[212:215], v13, s[20:23], s40 offen offset:1024
    s_add_u32 s40, s40, 6144
    s_add_u32 s39, s39, 1024
    v_mfma_f32_16x16x32_bf16 a[76:79], v[236:239], v[228:231], a[76:79]
    v_mfma_f32_16x16x32_bf16 a[80:83], v[240:243], v[228:231], a[80:83]
    v_mfma_f32_16x16x32_bf16 a[84:87], v[244:247], v[228:231], a[84:87]
    v_mfma_f32_16x16x32_bf16 a[88:91], v[248:251], v[228:231], a[88:91]
    v_mfma_f32_16x16x32_bf16 a[92:95], v[252:255], v[228:231], a[92:95]
    s_waitcnt vmcnt(40)
    v_mfma_f32_16x16x32_bf16 a[0:3], v[32:35], v[16:19], a[0:3]
    buffer_load_dwordx4 v[232:235], v4, s[20:23], s40 offen offset:0
    v_mfma_f32_16x16x32_bf16 a[4:7], v[36:39], v[16:19], a[4:7]
    v_mfma_f32_16x16x32_bf16 a[8:11], v[40:43], v[16:19], a[8:11]
    buffer_load_dwordx4 v[216:219], v9, s[20:23], s39 offen
    v_mfma_f32_16x16x32_bf16 a[12:15], v[44:47], v[16:19], a[12:15]
    v_mfma_f32_16x16x32_bf16 a[16:19], v[48:51], v[16:19], a[16:19]
    buffer_load_dwordx4 v[236:239], v4, s[20:23], s40 offen offset:1024
    v_mfma_f32_16x16x32_bf16 a[20:23], v[52:55], v[16:19], a[20:23]
    v_mfma_f32_16x16x32_bf16 a[24:27], v[32:35], v[20:23], a[24:27]
    buffer_load_dwordx4 v[220:223], v10, s[20:23], s39 offen
    v_mfma_f32_16x16x32_bf16 a[28:31], v[36:39], v[20:23], a[28:31]
    v_mfma_f32_16x16x32_bf16 a[32:35], v[40:43], v[20:23], a[32:35]
    buffer_load_dwordx4 v[240:243], v4, s[20:23], s40 offen offset:2048
    v_mfma_f32_16x16x32_bf16 a[36:39], v[44:47], v[20:23], a[36:39]
    v_mfma_f32_16x16x32_bf16 a[40:43], v[48:51], v[20:23], a[40:43]
    buffer_load_dwordx4 v[224:227], v11, s[20:23], s39 offen
    v_mfma_f32_16x16x32_bf16 a[44:47], v[52:55], v[20:23], a[44:47]
    v_mfma_f32_16x16x32_bf16 a[48:51], v[32:35], v[24:27], a[48:51]
    buffer_load_dwordx4 v[244:247], v4, s[20:23], s40 offen offset:3072
    v_mfma_f32_16x16x32_bf16 a[52:55], v[36:39], v[24:27], a[52:55]
    v_mfma_f32_16x16x32_bf16 a[56:59], v[40:43], v[24:27], a[56:59]
    buffer_load_dwordx4 v[228:231], v12, s[20:23], s39 offen
    v_mfma_f32_16x16x32_bf16 a[60:63], v[44:47], v[24:27], a[60:63]
    v_mfma_f32_16x16x32_bf16 a[64:67], v[48:51], v[24:27], a[64:67]
    buffer_load_dwordx4 v[248:251], v13, s[20:23], s40 offen offset:0
    v_mfma_f32_16x16x32_bf16 a[68:71], v[52:55], v[24:27], a[68:71]
    v_mfma_f32_16x16x32_bf16 a[72:75], v[32:35], v[28:31], a[72:75]
    buffer_load_dwordx4 v[252:255], v13, s[20:23], s40 offen offset:1024
    s_add_u32 s40, s40, 6144
    s_add_u32 s39, s39, 1024
    v_mfma_f32_16x16x32_bf16 a[76:79], v[36:39], v[28:31], a[76:79]
    v_mfma_f32_16x16x32_bf16 a[80:83], v[40:43], v[28:31], a[80:83]
    v_mfma_f32_16x16x32_bf16 a[84:87], v[44:47], v[28:31], a[84:87]
    v_mfma_f32_16x16x32_bf16 a[88:91], v[48:51], v[28:31], a[88:91]
    v_mfma_f32_16x16x32_bf16 a[92:95], v[52:55], v[28:31], a[92:95]
    s_waitcnt vmcnt(40)
    v_mfma_f32_16x16x32_bf16 a[0:3], v[72:75], v[56:59], a[0:3]
    buffer_load_dwordx4 v[32:35], v4, s[20:23], s40 offen offset:0
    v_mfma_f32_16x16x32_bf16 a[4:7], v[76:79], v[56:59], a[4:7]
    v_mfma_f32_16x16x32_bf16 a[8:11], v[80:83], v[56:59], a[8:11]
    buffer_load_dwordx4 v[16:19], v9, s[20:23], s39 offen
    v_mfma_f32_16x16x32_bf16 a[12:15], v[84:87], v[56:59], a[12:15]
    v_mfma_f32_16x16x32_bf16 a[16:19], v[88:91], v[56:59], a[16:19]
    buffer_load_dwordx4 v[36:39], v4, s[20:23], s40 offen offset:1024
    v_mfma_f32_16x16x32_bf16 a[20:23], v[92:95], v[56:59], a[20:23]
    v_mfma_f32_16x16x32_bf16 a[24:27], v[72:75], v[60:63], a[24:27]
    buffer_load_dwordx4 v[20:23], v10, s[20:23], s39 offen
    v_mfma_f32_16x16x32_bf16 a[28:31], v[76:79], v[60:63], a[28:31]
    v_mfma_f32_16x16x32_bf16 a[32:35], v[80:83], v[60:63], a[32:35]
    buffer_load_dwordx4 v[40:43], v4, s[20:23], s40 offen offset:2048
    v_mfma_f32_16x16x32_bf16 a[36:39], v[84:87], v[60:63], a[36:39]
    v_mfma_f32_16x16x32_bf16 a[40:43], v[88:91], v[60:63], a[40:43]
    buffer_load_dwordx4 v[24:27], v11, s[20:23], s39 offen
    v_mfma_f32_16x16x32_bf16 a[44:47], v[92:95], v[60:63], a[44:47]
    v_mfma_f32_16x16x32_bf16 a[48:51], v[72:75], v[64:67], a[48:51]
    buffer_load_dwordx4 v[44:47], v4, s[20:23], s40 offen offset:3072
    v_mfma_f32_16x16x32_bf16 a[52:55], v[76:79], v[64:67], a[52:55]
    v_mfma_f32_16x16x32_bf16 a[56:59], v[80:83], v[64:67], a[56:59]
    buffer_load_dwordx4 v[28:31], v12, s[20:23], s39 offen
    v_mfma_f32_16x16x32_bf16 a[60:63], v[84:87], v[64:67], a[60:63]
    v_mfma_f32_16x16x32_bf16 a[64:67], v[88:91], v[64:67], a[64:67]
    buffer_load_dwordx4 v[48:51], v13, s[20:23], s40 offen offset:0
    v_mfma_f32_16x16x32_bf16 a[68:71], v[92:95], v[64:67], a[68:71]
    v_mfma_f32_16x16x32_bf16 a[72:75], v[72:75], v[68:71], a[72:75]
    buffer_load_dwordx4 v[52:55], v13, s[20:23], s40 offen offset:1024
    s_add_u32 s40, s40, 6144
    s_add_u32 s39, s39, 1024
    v_mfma_f32_16x16x32_bf16 a[76:79], v[76:79], v[68:71], a[76:79]
    v_mfma_f32_16x16x32_bf16 a[80:83], v[80:83], v[68:71], a[80:83]
    v_mfma_f32_16x16x32_bf16 a[84:87], v[84:87], v[68:71], a[84:87]
    v_mfma_f32_16x16x32_bf16 a[88:91], v[88:91], v[68:71], a[88:91]
    v_mfma_f32_16x16x32_bf16 a[92:95], v[92:95], v[68:71], a[92:95]
    s_waitcnt vmcnt(40)
    v_mfma_f32_16x16x32_bf16 a[0:3], v[112:115], v[96:99], a[0:3]
    buffer_load_dwordx4 v[72:75], v4, s[20:23], s40 offen offset:0
    v_mfma_f32_16x16x32_bf16 a[4:7], v[116:119], v[96:99], a[4:7]
    v_mfma_f32_16x16x32_bf16 a[8:11], v[120:123], v[96:99], a[8:11]
    buffer_load_dwordx4 v[56:59], v9, s[20:23], s39 offen
    v_mfma_f32_16x16x32_bf16 a[12:15], v[124:127], v[96:99], a[12:15]
    v_mfma_f32_16x16x32_bf16 a[16:19], v[128:131], v[96:99], a[16:19]
    buffer_load_dwordx4 v[76:79], v4, s[20:23], s40 offen offset:1024
    v_mfma_f32_16x16x32_bf16 a[20:23], v[132:135], v[96:99], a[20:23]
    v_mfma_f32_16x16x32_bf16 a[24:27], v[112:115], v[100:103], a[24:27]
    buffer_load_dwordx4 v[60:63], v10, s[20:23], s39 offen
    v_mfma_f32_16x16x32_bf16 a[28:31], v[116:119], v[100:103], a[28:31]
    v_mfma_f32_16x16x32_bf16 a[32:35], v[120:123], v[100:103], a[32:35]
    buffer_load_dwordx4 v[80:83], v4, s[20:23], s40 offen offset:2048
    v_mfma_f32_16x16x32_bf16 a[36:39], v[124:127], v[100:103], a[36:39]
    v_mfma_f32_16x16x32_bf16 a[40:43], v[128:131], v[100:103], a[40:43]
    buffer_load_dwordx4 v[64:67], v11, s[20:23], s39 offen
    v_mfma_f32_16x16x32_bf16 a[44:47], v[132:135], v[100:103], a[44:47]
    v_mfma_f32_16x16x32_bf16 a[48:51], v[112:115], v[104:107], a[48:51]
    buffer_load_dwordx4 v[84:87], v4, s[20:23], s40 offen offset:3072
    v_mfma_f32_16x16x32_bf16 a[52:55], v[116:119], v[104:107], a[52:55]
    v_mfma_f32_16x16x32_bf16 a[56:59], v[120:123], v[104:107], a[56:59]
    buffer_load_dwordx4 v[68:71], v12, s[20:23], s39 offen
    v_mfma_f32_16x16x32_bf16 a[60:63], v[124:127], v[104:107], a[60:63]
    v_mfma_f32_16x16x32_bf16 a[64:67], v[128:131], v[104:107], a[64:67]
    buffer_load_dwordx4 v[88:91], v13, s[20:23], s40 offen offset:0
    v_mfma_f32_16x16x32_bf16 a[68:71], v[132:135], v[104:107], a[68:71]
    v_mfma_f32_16x16x32_bf16 a[72:75], v[112:115], v[108:111], a[72:75]
    buffer_load_dwordx4 v[92:95], v13, s[20:23], s40 offen offset:1024
    s_add_u32 s40, s40, 6144
    s_add_u32 s39, s39, 1024
    v_mfma_f32_16x16x32_bf16 a[76:79], v[116:119], v[108:111], a[76:79]
    v_mfma_f32_16x16x32_bf16 a[80:83], v[120:123], v[108:111], a[80:83]
    v_mfma_f32_16x16x32_bf16 a[84:87], v[124:127], v[108:111], a[84:87]
    v_mfma_f32_16x16x32_bf16 a[88:91], v[128:131], v[108:111], a[88:91]
    v_mfma_f32_16x16x32_bf16 a[92:95], v[132:135], v[108:111], a[92:95]
    s_waitcnt vmcnt(40)
    v_mfma_f32_16x16x32_bf16 a[0:3], v[152:155], v[136:139], a[0:3]
    buffer_load_dwordx4 v[112:115], v4, s[20:23], s40 offen offset:0
    v_mfma_f32_16x16x32_bf16 a[4:7], v[156:159], v[136:139], a[4:7]
    v_mfma_f32_16x16x32_bf16 a[8:11], v[160:163], v[136:139], a[8:11]
    buffer_load_dwordx4 v[96:99], v9, s[20:23], s39 offen
    v_mfma_f32_16x16x32_bf16 a[12:15], v[164:167], v[136:139], a[12:15]
    v_mfma_f32_16x16x32_bf16 a[16:19], v[168:171], v[136:139], a[16:19]
    buffer_load_dwordx4 v[116:119], v4, s[20:23], s40 offen offset:1024
    v_mfma_f32_16x16x32_bf16 a[20:23], v[172:175], v[136:139], a[20:23]
    v_mfma_f32_16x16x32_bf16 a[24:27], v[152:155], v[140:143], a[24:27]
    buffer_load_dwordx4 v[100:103], v10, s[20:23], s39 offen
    v_mfma_f32_16x16x32_bf16 a[28:31], v[156:159], v[140:143], a[28:31]
    v_mfma_f32_16x16x32_bf16 a[32:35], v[160:163], v[140:143], a[32:35]
    buffer_load_dwordx4 v[120:123], v4, s[20:23], s40 offen offset:2048
    v_mfma_f32_16x16x32_bf16 a[36:39], v[164:167], v[140:143], a[36:39]
    v_mfma_f32_16x16x32_bf16 a[40:43], v[168:171], v[140:143], a[40:43]
    buffer_load_dwordx4 v[104:107], v11, s[20:23], s39 offen
    v_mfma_f32_16x16x32_bf16 a[44:47], v[172:175], v[140:143], a[44:47]
    v_mfma_f32_16x16x32_bf16 a[48:51], v[152:155], v[144:147], a[48:51]
    buffer_load_dwordx4 v[124:127], v4, s[20:23], s40 offen offset:3072
    v_mfma_f32_16x16x32_bf16 a[52:55], v[156:159], v[144:147], a[52:55]
    v_mfma_f32_16x16x32_bf16 a[56:59], v[160:163], v[144:147], a[56:59]
    buffer_load_dwordx4 v[108:111], v12, s[20:23], s39 offen
    v_mfma_f32_16x16x32_bf16 a[60:63], v[164:167], v[144:147], a[60:63]
    v_mfma_f32_16x16x32_bf16 a[64:67], v[168:171], v[144:147], a[64:67]
    buffer_load_dwordx4 v[128:131], v13, s[20:23], s40 offen offset:0
    v_mfma_f32_16x16x32_bf16 a[68:71], v[172:175], v[144:147], a[68:71]
    v_mfma_f32_16x16x32_bf16 a[72:75], v[152:155], v[148:151], a[72:75]
    buffer_load_dwordx4 v[132:135], v13, s[20:23], s40 offen offset:1024
    s_add_u32 s40, s40, 6144
    s_add_u32 s39, s39, 1024
    v_mfma_f32_16x16x32_bf16 a[76:79], v[156:159], v[148:151], a[76:79]
    v_mfma_f32_16x16x32_bf16 a[80:83], v[160:163], v[148:151], a[80:83]
    v_mfma_f32_16x16x32_bf16 a[84:87], v[164:167], v[148:151], a[84:87]
    v_mfma_f32_16x16x32_bf16 a[88:91], v[168:171], v[148:151], a[88:91]
    v_mfma_f32_16x16x32_bf16 a[92:95], v[172:175], v[148:151], a[92:95]
    s_waitcnt vmcnt(40)
    v_mfma_f32_16x16x32_bf16 a[0:3], v[192:195], v[176:179], a[0:3]
    buffer_load_dwordx4 v[152:155], v4, s[20:23], s40 offen offset:0
    v_mfma_f32_16x16x32_bf16 a[4:7], v[196:199], v[176:179], a[4:7]
    v_mfma_f32_16x16x32_bf16 a[8:11], v[200:203], v[176:179], a[8:11]
    buffer_load_dwordx4 v[136:139], v9, s[20:23], s39 offen
    v_mfma_f32_16x16x32_bf16 a[12:15], v[204:207], v[176:179], a[12:15]
    v_mfma_f32_16x16x32_bf16 a[16:19], v[208:211], v[176:179], a[16:19]
    buffer_load_dwordx4 v[156:159], v4, s[20:23], s40 offen offset:1024
    v_mfma_f32_16x16x32_bf16 a[20:23], v[212:215], v[176:179], a[20:23]
    v_mfma_f32_16x16x32_bf16 a[24:27], v[192:195], v[180:183], a[24:27]
    buffer_load_dwordx4 v[140:143], v10, s[20:23], s39 offen
    v_mfma_f32_16x16x32_bf16 a[28:31], v[196:199], v[180:183], a[28:31]
    v_mfma_f32_16x16x32_bf16 a[32:35], v[200:203], v[180:183], a[32:35]
    buffer_load_dwordx4 v[160:163], v4, s[20:23], s40 offen offset:2048
    v_mfma_f32_16x16x32_bf16 a[36:39], v[204:207], v[180:183], a[36:39]
    v_mfma_f32_16x16x32_bf16 a[40:43], v[208:211], v[180:183], a[40:43]
    buffer_load_dwordx4 v[144:147], v11, s[20:23], s39 offen
    v_mfma_f32_16x16x32_bf16 a[44:47], v[212:215], v[180:183], a[44:47]
    v_mfma_f32_16x16x32_bf16 a[48:51], v[192:195], v[184:187], a[48:51]
    buffer_load_dwordx4 v[164:167], v4, s[20:23], s40 offen offset:3072
    v_mfma_f32_16x16x32_bf16 a[52:55], v[196:199], v[184:187], a[52:55]
    v_mfma_f32_16x16x32_bf16 a[56:59], v[200:203], v[184:187], a[56:59]
    buffer_load_dwordx4 v[148:151], v12, s[20:23], s39 offen
    v_mfma_f32_16x16x32_bf16 a[60:63], v[204:207], v[184:187], a[60:63]
    v_mfma_f32_16x16x32_bf16 a[64:67], v[208:211], v[184:187], a[64:67]
    buffer_load_dwordx4 v[168:171], v13, s[20:23], s40 offen offset:0
    v_mfma_f32_16x16x32_bf16 a[68:71], v[212:215], v[184:187], a[68:71]
    v_mfma_f32_16x16x32_bf16 a[72:75], v[192:195], v[188:191], a[72:75]
    buffer_load_dwordx4 v[172:175], v13, s[20:23], s40 offen offset:1024
    s_add_u32 s40, s40, 6144
    s_add_u32 s39, s39, 1024
    v_mfma_f32_16x16x32_bf16 a[76:79], v[196:199], v[188:191], a[76:79]
    v_mfma_f32_16x16x32_bf16 a[80:83], v[200:203], v[188:191], a[80:83]
    v_mfma_f32_16x16x32_bf16 a[84:87], v[204:207], v[188:191], a[84:87]
    v_mfma_f32_16x16x32_bf16 a[88:91], v[208:211], v[188:191], a[88:91]
    v_mfma_f32_16x16x32_bf16 a[92:95], v[212:215], v[188:191], a[92:95]
    s_waitcnt vmcnt(40)
    v_mfma_f32_16x16x32_bf16 a[0:3], v[232:235], v[216:219], a[0:3]
    buffer_load_dwordx4 v[192:195], v4, s[20:23], s40 offen offset:0
    v_mfma_f32_16x16x32_bf16 a[4:7], v[236:239], v[216:219], a[4:7]
    v_mfma_f32_16x16x32_bf16 a[8:11], v[240:243], v[216:219], a[8:11]
    buffer_load_dwordx4 v[176:179], v9, s[20:23], s39 offen
    v_mfma_f32_16x16x32_bf16 a[12:15], v[244:247], v[216:219], a[12:15]
    v_mfma_f32_16x16x32_bf16 a[16:19], v[248:251], v[216:219], a[16:19]
    buffer_load_dwordx4 v[196:199], v4, s[20:23], s40 offen offset:1024
    v_mfma_f32_16x16x32_bf16 a[20:23], v[252:255], v[216:219], a[20:23]
    v_mfma_f32_16x16x32_bf16 a[24:27], v[232:235], v[220:223], a[24:27]
    buffer_load_dwordx4 v[180:183], v10, s[20:23], s39 offen
    v_mfma_f32_16x16x32_bf16 a[28:31], v[236:239], v[220:223], a[28:31]
    v_mfma_f32_16x16x32_bf16 a[32:35], v[240:243], v[220:223], a[32:35]
    buffer_load_dwordx4 v[200:203], v4, s[20:23], s40 offen offset:2048
    v_mfma_f32_16x16x32_bf16 a[36:39], v[244:247], v[220:223], a[36:39]
    v_mfma_f32_16x16x32_bf16 a[40:43], v[248:251], v[220:223], a[40:43]
    buffer_load_dwordx4 v[184:187], v11, s[20:23], s39 offen
    v_mfma_f32_16x16x32_bf16 a[44:47], v[252:255], v[220:223], a[44:47]
    v_mfma_f32_16x16x32_bf16 a[48:51], v[232:235], v[224:227], a[48:51]
    buffer_load_dwordx4 v[204:207], v4, s[20:23], s40 offen offset:3072
    v_mfma_f32_16x16x32_bf16 a[52:55], v[236:239], v[224:227], a[52:55]
    v_mfma_f32_16x16x32_bf16 a[56:59], v[240:243], v[224:227], a[56:59]
    buffer_load_dwordx4 v[188:191], v12, s[20:23], s39 offen
    v_mfma_f32_16x16x32_bf16 a[60:63], v[244:247], v[224:227], a[60:63]
    v_mfma_f32_16x16x32_bf16 a[64:67], v[248:251], v[224:227], a[64:67]
    buffer_load_dwordx4 v[208:211], v13, s[20:23], s40 offen offset:0
    v_mfma_f32_16x16x32_bf16 a[68:71], v[252:255], v[224:227], a[68:71]
    v_mfma_f32_16x16x32_bf16 a[72:75], v[232:235], v[228:231], a[72:75]
    buffer_load_dwordx4 v[212:215], v13, s[20:23], s40 offen offset:1024
    s_add_u32 s40, s40, 6144
    s_add_u32 s39, s39, 1024
    v_mfma_f32_16x16x32_bf16 a[76:79], v[236:239], v[228:231], a[76:79]
    v_mfma_f32_16x16x32_bf16 a[80:83], v[240:243], v[228:231], a[80:83]
    v_mfma_f32_16x16x32_bf16 a[84:87], v[244:247], v[228:231], a[84:87]
    v_mfma_f32_16x16x32_bf16 a[88:91], v[248:251], v[228:231], a[88:91]
    v_mfma_f32_16x16x32_bf16 a[92:95], v[252:255], v[228:231], a[92:95]
    s_waitcnt vmcnt(40)
    v_mfma_f32_16x16x32_bf16 a[0:3], v[32:35], v[16:19], a[0:3]
    buffer_load_dwordx4 v[232:235], v4, s[20:23], s40 offen offset:0
    v_mfma_f32_16x16x32_bf16 a[4:7], v[36:39], v[16:19], a[4:7]
    v_mfma_f32_16x16x32_bf16 a[8:11], v[40:43], v[16:19], a[8:11]
    buffer_load_dwordx4 v[216:219], v9, s[20:23], s39 offen
    v_mfma_f32_16x16x32_bf16 a[12:15], v[44:47], v[16:19], a[12:15]
    v_mfma_f32_16x16x32_bf16 a[16:19], v[48:51], v[16:19], a[16:19]
    buffer_load_dwordx4 v[236:239], v4, s[20:23], s40 offen offset:1024
    v_mfma_f32_16x16x32_bf16 a[20:23], v[52:55], v[16:19], a[20:23]
    v_mfma_f32_16x16x32_bf16 a[24:27], v[32:35], v[20:23], a[24:27]
    buffer_load_dwordx4 v[220:223], v10, s[20:23], s39 offen
    v_mfma_f32_16x16x32_bf16 a[28:31], v[36:39], v[20:23], a[28:31]
    v_mfma_f32_16x16x32_bf16 a[32:35], v[40:43], v[20:23], a[32:35]
    buffer_load_dwordx4 v[240:243], v4, s[20:23], s40 offen offset:2048
    v_mfma_f32_16x16x32_bf16 a[36:39], v[44:47], v[20:23], a[36:39]
    v_mfma_f32_16x16x32_bf16 a[40:43], v[48:51], v[20:23], a[40:43]
    buffer_load_dwordx4 v[224:227], v11, s[20:23], s39 offen
    v_mfma_f32_16x16x32_bf16 a[44:47], v[52:55], v[20:23], a[44:47]
    v_mfma_f32_16x16x32_bf16 a[48:51], v[32:35], v[24:27], a[48:51]
    buffer_load_dwordx4 v[244:247], v4, s[20:23], s40 offen offset:3072
    v_mfma_f32_16x16x32_bf16 a[52:55], v[36:39], v[24:27], a[52:55]
    v_mfma_f32_16x16x32_bf16 a[56:59], v[40:43], v[24:27], a[56:59]
    buffer_load_dwordx4 v[228:231], v12, s[20:23], s39 offen
    v_mfma_f32_16x16x32_bf16 a[60:63], v[44:47], v[24:27], a[60:63]
    v_mfma_f32_16x16x32_bf16 a[64:67], v[48:51], v[24:27], a[64:67]
    buffer_load_dwordx4 v[248:251], v13, s[20:23], s40 offen offset:0
    v_mfma_f32_16x16x32_bf16 a[68:71], v[52:55], v[24:27], a[68:71]
    v_mfma_f32_16x16x32_bf16 a[72:75], v[32:35], v[28:31], a[72:75]
    buffer_load_dwordx4 v[252:255], v13, s[20:23], s40 offen offset:1024
    s_add_u32 s40, s40, 6144
    s_add_u32 s39, s39, 1024
    v_mfma_f32_16x16x32_bf16 a[76:79], v[36:39], v[28:31], a[76:79]
    v_mfma_f32_16x16x32_bf16 a[80:83], v[40:43], v[28:31], a[80:83]
    v_mfma_f32_16x16x32_bf16 a[84:87], v[44:47], v[28:31], a[84:87]
    v_mfma_f32_16x16x32_bf16 a[88:91], v[48:51], v[28:31], a[88:91]
    v_mfma_f32_16x16x32_bf16 a[92:95], v[52:55], v[28:31], a[92:95]
    s_waitcnt vmcnt(40)
    v_mfma_f32_16x16x32_bf16 a[0:3], v[72:75], v[56:59], a[0:3]
    buffer_load_dwordx4 v[32:35], v4, s[20:23], s40 offen offset:0
    v_mfma_f32_16x16x32_bf16 a[4:7], v[76:79], v[56:59], a[4:7]
    v_mfma_f32_16x16x32_bf16 a[8:11], v[80:83], v[56:59], a[8:11]
    buffer_load_dwordx4 v[16:19], v9, s[20:23], s39 offen
    v_mfma_f32_16x16x32_bf16 a[12:15], v[84:87], v[56:59], a[12:15]
    v_mfma_f32_16x16x32_bf16 a[16:19], v[88:91], v[56:59], a[16:19]
    buffer_load_dwordx4 v[36:39], v4, s[20:23], s40 offen offset:1024
    v_mfma_f32_16x16x32_bf16 a[20:23], v[92:95], v[56:59], a[20:23]
    v_mfma_f32_16x16x32_bf16 a[24:27], v[72:75], v[60:63], a[24:27]
    buffer_load_dwordx4 v[20:23], v10, s[20:23], s39 offen
    v_mfma_f32_16x16x32_bf16 a[28:31], v[76:79], v[60:63], a[28:31]
    v_mfma_f32_16x16x32_bf16 a[32:35], v[80:83], v[60:63], a[32:35]
    buffer_load_dwordx4 v[40:43], v4, s[20:23], s40 offen offset:2048
    v_mfma_f32_16x16x32_bf16 a[36:39], v[84:87], v[60:63], a[36:39]
    v_mfma_f32_16x16x32_bf16 a[40:43], v[88:91], v[60:63], a[40:43]
    buffer_load_dwordx4 v[24:27], v11, s[20:23], s39 offen
    v_mfma_f32_16x16x32_bf16 a[44:47], v[92:95], v[60:63], a[44:47]
    v_mfma_f32_16x16x32_bf16 a[48:51], v[72:75], v[64:67], a[48:51]
    buffer_load_dwordx4 v[44:47], v4, s[20:23], s40 offen offset:3072
    v_mfma_f32_16x16x32_bf16 a[52:55], v[76:79], v[64:67], a[52:55]
    v_mfma_f32_16x16x32_bf16 a[56:59], v[80:83], v[64:67], a[56:59]
    buffer_load_dwordx4 v[28:31], v12, s[20:23], s39 offen
    v_mfma_f32_16x16x32_bf16 a[60:63], v[84:87], v[64:67], a[60:63]
    v_mfma_f32_16x16x32_bf16 a[64:67], v[88:91], v[64:67], a[64:67]
    buffer_load_dwordx4 v[48:51], v13, s[20:23], s40 offen offset:0
    v_mfma_f32_16x16x32_bf16 a[68:71], v[92:95], v[64:67], a[68:71]
    v_mfma_f32_16x16x32_bf16 a[72:75], v[72:75], v[68:71], a[72:75]
    buffer_load_dwordx4 v[52:55], v13, s[20:23], s40 offen offset:1024
    s_add_u32 s40, s40, 6144
    s_add_u32 s39, s39, 1024
    v_mfma_f32_16x16x32_bf16 a[76:79], v[76:79], v[68:71], a[76:79]
    v_mfma_f32_16x16x32_bf16 a[80:83], v[80:83], v[68:71], a[80:83]
    v_mfma_f32_16x16x32_bf16 a[84:87], v[84:87], v[68:71], a[84:87]
    v_mfma_f32_16x16x32_bf16 a[88:91], v[88:91], v[68:71], a[88:91]
    v_mfma_f32_16x16x32_bf16 a[92:95], v[92:95], v[68:71], a[92:95]
    s_waitcnt vmcnt(40)
    v_mfma_f32_16x16x32_bf16 a[0:3], v[112:115], v[96:99], a[0:3]
    buffer_load_dwordx4 v[72:75], v4, s[20:23], s40 offen offset:0
    v_mfma_f32_16x16x32_bf16 a[4:7], v[116:119], v[96:99], a[4:7]
    v_mfma_f32_16x16x32_bf16 a[8:11], v[120:123], v[96:99], a[8:11]
    buffer_load_dwordx4 v[56:59], v9, s[20:23], s39 offen
    v_mfma_f32_16x16x32_bf16 a[12:15], v[124:127], v[96:99], a[12:15]
    v_mfma_f32_16x16x32_bf16 a[16:19], v[128:131], v[96:99], a[16:19]
    buffer_load_dwordx4 v[76:79], v4, s[20:23], s40 offen offset:1024
    v_mfma_f32_16x16x32_bf16 a[20:23], v[132:135], v[96:99], a[20:23]
    v_mfma_f32_16x16x32_bf16 a[24:27], v[112:115], v[100:103], a[24:27]
    buffer_load_dwordx4 v[60:63], v10, s[20:23], s39 offen
    v_mfma_f32_16x16x32_bf16 a[28:31], v[116:119], v[100:103], a[28:31]
    v_mfma_f32_16x16x32_bf16 a[32:35], v[120:123], v[100:103], a[32:35]
    buffer_load_dwordx4 v[80:83], v4, s[20:23], s40 offen offset:2048
    v_mfma_f32_16x16x32_bf16 a[36:39], v[124:127], v[100:103], a[36:39]
    v_mfma_f32_16x16x32_bf16 a[40:43], v[128:131], v[100:103], a[40:43]
    buffer_load_dwordx4 v[64:67], v11, s[20:23], s39 offen
    v_mfma_f32_16x16x32_bf16 a[44:47], v[132:135], v[100:103], a[44:47]
    v_mfma_f32_16x16x32_bf16 a[48:51], v[112:115], v[104:107], a[48:51]
    buffer_load_dwordx4 v[84:87], v4, s[20:23], s40 offen offset:3072
    v_mfma_f32_16x16x32_bf16 a[52:55], v[116:119], v[104:107], a[52:55]
    v_mfma_f32_16x16x32_bf16 a[56:59], v[120:123], v[104:107], a[56:59]
    buffer_load_dwordx4 v[68:71], v12, s[20:23], s39 offen
    v_mfma_f32_16x16x32_bf16 a[60:63], v[124:127], v[104:107], a[60:63]
    v_mfma_f32_16x16x32_bf16 a[64:67], v[128:131], v[104:107], a[64:67]
    buffer_load_dwordx4 v[88:91], v13, s[20:23], s40 offen offset:0
    v_mfma_f32_16x16x32_bf16 a[68:71], v[132:135], v[104:107], a[68:71]
    v_mfma_f32_16x16x32_bf16 a[72:75], v[112:115], v[108:111], a[72:75]
    buffer_load_dwordx4 v[92:95], v13, s[20:23], s40 offen offset:1024
    s_add_u32 s40, s40, 6144
    s_add_u32 s39, s39, 1024
    v_mfma_f32_16x16x32_bf16 a[76:79], v[116:119], v[108:111], a[76:79]
    v_mfma_f32_16x16x32_bf16 a[80:83], v[120:123], v[108:111], a[80:83]
    v_mfma_f32_16x16x32_bf16 a[84:87], v[124:127], v[108:111], a[84:87]
    v_mfma_f32_16x16x32_bf16 a[88:91], v[128:131], v[108:111], a[88:91]
    v_mfma_f32_16x16x32_bf16 a[92:95], v[132:135], v[108:111], a[92:95]
    s_waitcnt vmcnt(40)
    v_mfma_f32_16x16x32_bf16 a[0:3], v[152:155], v[136:139], a[0:3]
    buffer_load_dwordx4 v[112:115], v4, s[20:23], s40 offen offset:0
    v_mfma_f32_16x16x32_bf16 a[4:7], v[156:159], v[136:139], a[4:7]
    v_mfma_f32_16x16x32_bf16 a[8:11], v[160:163], v[136:139], a[8:11]
    buffer_load_dwordx4 v[96:99], v9, s[20:23], s39 offen
    v_mfma_f32_16x16x32_bf16 a[12:15], v[164:167], v[136:139], a[12:15]
    v_mfma_f32_16x16x32_bf16 a[16:19], v[168:171], v[136:139], a[16:19]
    buffer_load_dwordx4 v[116:119], v4, s[20:23], s40 offen offset:1024
    v_mfma_f32_16x16x32_bf16 a[20:23], v[172:175], v[136:139], a[20:23]
    v_mfma_f32_16x16x32_bf16 a[24:27], v[152:155], v[140:143], a[24:27]
    buffer_load_dwordx4 v[100:103], v10, s[20:23], s39 offen
    v_mfma_f32_16x16x32_bf16 a[28:31], v[156:159], v[140:143], a[28:31]
    v_mfma_f32_16x16x32_bf16 a[32:35], v[160:163], v[140:143], a[32:35]
    buffer_load_dwordx4 v[120:123], v4, s[20:23], s40 offen offset:2048
    v_mfma_f32_16x16x32_bf16 a[36:39], v[164:167], v[140:143], a[36:39]
    v_mfma_f32_16x16x32_bf16 a[40:43], v[168:171], v[140:143], a[40:43]
    buffer_load_dwordx4 v[104:107], v11, s[20:23], s39 offen
    v_mfma_f32_16x16x32_bf16 a[44:47], v[172:175], v[140:143], a[44:47]
    v_mfma_f32_16x16x32_bf16 a[48:51], v[152:155], v[144:147], a[48:51]
    buffer_load_dwordx4 v[124:127], v4, s[20:23], s40 offen offset:3072
    v_mfma_f32_16x16x32_bf16 a[52:55], v[156:159], v[144:147], a[52:55]
    v_mfma_f32_16x16x32_bf16 a[56:59], v[160:163], v[144:147], a[56:59]
    buffer_load_dwordx4 v[108:111], v12, s[20:23], s39 offen
    v_mfma_f32_16x16x32_bf16 a[60:63], v[164:167], v[144:147], a[60:63]
    v_mfma_f32_16x16x32_bf16 a[64:67], v[168:171], v[144:147], a[64:67]
    buffer_load_dwordx4 v[128:131], v13, s[20:23], s40 offen offset:0
    v_mfma_f32_16x16x32_bf16 a[68:71], v[172:175], v[144:147], a[68:71]
    v_mfma_f32_16x16x32_bf16 a[72:75], v[152:155], v[148:151], a[72:75]
    buffer_load_dwordx4 v[132:135], v13, s[20:23], s40 offen offset:1024
    s_add_u32 s40, s40, 6144
    s_add_u32 s39, s39, 1024
    v_mfma_f32_16x16x32_bf16 a[76:79], v[156:159], v[148:151], a[76:79]
    v_mfma_f32_16x16x32_bf16 a[80:83], v[160:163], v[148:151], a[80:83]
    v_mfma_f32_16x16x32_bf16 a[84:87], v[164:167], v[148:151], a[84:87]
    v_mfma_f32_16x16x32_bf16 a[88:91], v[168:171], v[148:151], a[88:91]
    v_mfma_f32_16x16x32_bf16 a[92:95], v[172:175], v[148:151], a[92:95]
    s_waitcnt vmcnt(40)
    v_mfma_f32_16x16x32_bf16 a[0:3], v[192:195], v[176:179], a[0:3]
    buffer_load_dwordx4 v[152:155], v4, s[20:23], s40 offen offset:0
    v_mfma_f32_16x16x32_bf16 a[4:7], v[196:199], v[176:179], a[4:7]
    v_mfma_f32_16x16x32_bf16 a[8:11], v[200:203], v[176:179], a[8:11]
    buffer_load_dwordx4 v[136:139], v9, s[20:23], s39 offen
    v_mfma_f32_16x16x32_bf16 a[12:15], v[204:207], v[176:179], a[12:15]
    v_mfma_f32_16x16x32_bf16 a[16:19], v[208:211], v[176:179], a[16:19]
    buffer_load_dwordx4 v[156:159], v4, s[20:23], s40 offen offset:1024
    v_mfma_f32_16x16x32_bf16 a[20:23], v[212:215], v[176:179], a[20:23]
    v_mfma_f32_16x16x32_bf16 a[24:27], v[192:195], v[180:183], a[24:27]
    buffer_load_dwordx4 v[140:143], v10, s[20:23], s39 offen
    v_mfma_f32_16x16x32_bf16 a[28:31], v[196:199], v[180:183], a[28:31]
    v_mfma_f32_16x16x32_bf16 a[32:35], v[200:203], v[180:183], a[32:35]
    buffer_load_dwordx4 v[160:163], v4, s[20:23], s40 offen offset:2048
    v_mfma_f32_16x16x32_bf16 a[36:39], v[204:207], v[180:183], a[36:39]
    v_mfma_f32_16x16x32_bf16 a[40:43], v[208:211], v[180:183], a[40:43]
    buffer_load_dwordx4 v[144:147], v11, s[20:23], s39 offen
    v_mfma_f32_16x16x32_bf16 a[44:47], v[212:215], v[180:183], a[44:47]
    v_mfma_f32_16x16x32_bf16 a[48:51], v[192:195], v[184:187], a[48:51]
    buffer_load_dwordx4 v[164:167], v4, s[20:23], s40 offen offset:3072
    v_mfma_f32_16x16x32_bf16 a[52:55], v[196:199], v[184:187], a[52:55]
    v_mfma_f32_16x16x32_bf16 a[56:59], v[200:203], v[184:187], a[56:59]
    buffer_load_dwordx4 v[148:151], v12, s[20:23], s39 offen
    v_mfma_f32_16x16x32_bf16 a[60:63], v[204:207], v[184:187], a[60:63]
    v_mfma_f32_16x16x32_bf16 a[64:67], v[208:211], v[184:187], a[64:67]
    buffer_load_dwordx4 v[168:171], v13, s[20:23], s40 offen offset:0
    v_mfma_f32_16x16x32_bf16 a[68:71], v[212:215], v[184:187], a[68:71]
    v_mfma_f32_16x16x32_bf16 a[72:75], v[192:195], v[188:191], a[72:75]
    buffer_load_dwordx4 v[172:175], v13, s[20:23], s40 offen offset:1024
    s_add_u32 s40, s40, 6144
    s_add_u32 s39, s39, 1024
    v_mfma_f32_16x16x32_bf16 a[76:79], v[196:199], v[188:191], a[76:79]
    v_mfma_f32_16x16x32_bf16 a[80:83], v[200:203], v[188:191], a[80:83]
    v_mfma_f32_16x16x32_bf16 a[84:87], v[204:207], v[188:191], a[84:87]
    v_mfma_f32_16x16x32_bf16 a[88:91], v[208:211], v[188:191], a[88:91]
    v_mfma_f32_16x16x32_bf16 a[92:95], v[212:215], v[188:191], a[92:95]
    s_waitcnt vmcnt(40)
    v_mfma_f32_16x16x32_bf16 a[0:3], v[232:235], v[216:219], a[0:3]
    buffer_load_dwordx4 v[192:195], v4, s[20:23], s40 offen offset:0
    v_mfma_f32_16x16x32_bf16 a[4:7], v[236:239], v[216:219], a[4:7]
    v_mfma_f32_16x16x32_bf16 a[8:11], v[240:243], v[216:219], a[8:11]
    buffer_load_dwordx4 v[176:179], v9, s[20:23], s39 offen
    v_mfma_f32_16x16x32_bf16 a[12:15], v[244:247], v[216:219], a[12:15]
    v_mfma_f32_16x16x32_bf16 a[16:19], v[248:251], v[216:219], a[16:19]
    buffer_load_dwordx4 v[196:199], v4, s[20:23], s40 offen offset:1024
    v_mfma_f32_16x16x32_bf16 a[20:23], v[252:255], v[216:219], a[20:23]
    v_mfma_f32_16x16x32_bf16 a[24:27], v[232:235], v[220:223], a[24:27]
    buffer_load_dwordx4 v[180:183], v10, s[20:23], s39 offen
    v_mfma_f32_16x16x32_bf16 a[28:31], v[236:239], v[220:223], a[28:31]
    v_mfma_f32_16x16x32_bf16 a[32:35], v[240:243], v[220:223], a[32:35]
    buffer_load_dwordx4 v[200:203], v4, s[20:23], s40 offen offset:2048
    v_mfma_f32_16x16x32_bf16 a[36:39], v[244:247], v[220:223], a[36:39]
    v_mfma_f32_16x16x32_bf16 a[40:43], v[248:251], v[220:223], a[40:43]
    buffer_load_dwordx4 v[184:187], v11, s[20:23], s39 offen
    v_mfma_f32_16x16x32_bf16 a[44:47], v[252:255], v[220:223], a[44:47]
    v_mfma_f32_16x16x32_bf16 a[48:51], v[232:235], v[224:227], a[48:51]
    buffer_load_dwordx4 v[204:207], v4, s[20:23], s40 offen offset:3072
    v_mfma_f32_16x16x32_bf16 a[52:55], v[236:239], v[224:227], a[52:55]
    v_mfma_f32_16x16x32_bf16 a[56:59], v[240:243], v[224:227], a[56:59]
    buffer_load_dwordx4 v[188:191], v12, s[20:23], s39 offen
    v_mfma_f32_16x16x32_bf16 a[60:63], v[244:247], v[224:227], a[60:63]
    v_mfma_f32_16x16x32_bf16 a[64:67], v[248:251], v[224:227], a[64:67]
    buffer_load_dwordx4 v[208:211], v13, s[20:23], s40 offen offset:0
    v_mfma_f32_16x16x32_bf16 a[68:71], v[252:255], v[224:227], a[68:71]
    v_mfma_f32_16x16x32_bf16 a[72:75], v[232:235], v[228:231], a[72:75]
    buffer_load_dwordx4 v[212:215], v13, s[20:23], s40 offen offset:1024
    s_add_u32 s40, s40, 6144
    s_add_u32 s39, s39, 1024
    v_mfma_f32_16x16x32_bf16 a[76:79], v[236:239], v[228:231], a[76:79]
    v_mfma_f32_16x16x32_bf16 a[80:83], v[240:243], v[228:231], a[80:83]
    v_mfma_f32_16x16x32_bf16 a[84:87], v[244:247], v[228:231], a[84:87]
    v_mfma_f32_16x16x32_bf16 a[88:91], v[248:251], v[228:231], a[88:91]
    v_mfma_f32_16x16x32_bf16 a[92:95], v[252:255], v[228:231], a[92:95]
    s_waitcnt vmcnt(40)
    v_mfma_f32_16x16x32_bf16 a[0:3], v[32:35], v[16:19], a[0:3]
    buffer_load_dwordx4 v[232:235], v4, s[20:23], s40 offen offset:0
    v_mfma_f32_16x16x32_bf16 a[4:7], v[36:39], v[16:19], a[4:7]
    v_mfma_f32_16x16x32_bf16 a[8:11], v[40:43], v[16:19], a[8:11]
    buffer_load_dwordx4 v[216:219], v9, s[20:23], s39 offen
    v_mfma_f32_16x16x32_bf16 a[12:15], v[44:47], v[16:19], a[12:15]
    v_mfma_f32_16x16x32_bf16 a[16:19], v[48:51], v[16:19], a[16:19]
    buffer_load_dwordx4 v[236:239], v4, s[20:23], s40 offen offset:1024
    v_mfma_f32_16x16x32_bf16 a[20:23], v[52:55], v[16:19], a[20:23]
    v_mfma_f32_16x16x32_bf16 a[24:27], v[32:35], v[20:23], a[24:27]
    buffer_load_dwordx4 v[220:223], v10, s[20:23], s39 offen
    v_mfma_f32_16x16x32_bf16 a[28:31], v[36:39], v[20:23], a[28:31]
    v_mfma_f32_16x16x32_bf16 a[32:35], v[40:43], v[20:23], a[32:35]
    buffer_load_dwordx4 v[240:243], v4, s[20:23], s40 offen offset:2048
    v_mfma_f32_16x16x32_bf16 a[36:39], v[44:47], v[20:23], a[36:39]
    v_mfma_f32_16x16x32_bf16 a[40:43], v[48:51], v[20:23], a[40:43]
    buffer_load_dwordx4 v[224:227], v11, s[20:23], s39 offen
    v_mfma_f32_16x16x32_bf16 a[44:47], v[52:55], v[20:23], a[44:47]
    v_mfma_f32_16x16x32_bf16 a[48:51], v[32:35], v[24:27], a[48:51]
    buffer_load_dwordx4 v[244:247], v4, s[20:23], s40 offen offset:3072
    v_mfma_f32_16x16x32_bf16 a[52:55], v[36:39], v[24:27], a[52:55]
    v_mfma_f32_16x16x32_bf16 a[56:59], v[40:43], v[24:27], a[56:59]
    buffer_load_dwordx4 v[228:231], v12, s[20:23], s39 offen
    v_mfma_f32_16x16x32_bf16 a[60:63], v[44:47], v[24:27], a[60:63]
    v_mfma_f32_16x16x32_bf16 a[64:67], v[48:51], v[24:27], a[64:67]
    buffer_load_dwordx4 v[248:251], v13, s[20:23], s40 offen offset:0
    v_mfma_f32_16x16x32_bf16 a[68:71], v[52:55], v[24:27], a[68:71]
    v_mfma_f32_16x16x32_bf16 a[72:75], v[32:35], v[28:31], a[72:75]
    buffer_load_dwordx4 v[252:255], v13, s[20:23], s40 offen offset:1024
    s_add_u32 s40, s40, 6144
    s_add_u32 s39, s39, 1024
    v_mfma_f32_16x16x32_bf16 a[76:79], v[36:39], v[28:31], a[76:79]
    v_mfma_f32_16x16x32_bf16 a[80:83], v[40:43], v[28:31], a[80:83]
    v_mfma_f32_16x16x32_bf16 a[84:87], v[44:47], v[28:31], a[84:87]
    v_mfma_f32_16x16x32_bf16 a[88:91], v[48:51], v[28:31], a[88:91]
    v_mfma_f32_16x16x32_bf16 a[92:95], v[52:55], v[28:31], a[92:95]
    s_waitcnt vmcnt(40)
    v_mfma_f32_16x16x32_bf16 a[0:3], v[72:75], v[56:59], a[0:3]
    buffer_load_dwordx4 v[32:35], v4, s[20:23], s40 offen offset:0
    v_mfma_f32_16x16x32_bf16 a[4:7], v[76:79], v[56:59], a[4:7]
    v_mfma_f32_16x16x32_bf16 a[8:11], v[80:83], v[56:59], a[8:11]
    buffer_load_dwordx4 v[16:19], v9, s[20:23], s39 offen
    v_mfma_f32_16x16x32_bf16 a[12:15], v[84:87], v[56:59], a[12:15]
    v_mfma_f32_16x16x32_bf16 a[16:19], v[88:91], v[56:59], a[16:19]
    buffer_load_dwordx4 v[36:39], v4, s[20:23], s40 offen offset:1024
    v_mfma_f32_16x16x32_bf16 a[20:23], v[92:95], v[56:59], a[20:23]
    v_mfma_f32_16x16x32_bf16 a[24:27], v[72:75], v[60:63], a[24:27]
    buffer_load_dwordx4 v[20:23], v10, s[20:23], s39 offen
    v_mfma_f32_16x16x32_bf16 a[28:31], v[76:79], v[60:63], a[28:31]
    v_mfma_f32_16x16x32_bf16 a[32:35], v[80:83], v[60:63], a[32:35]
    buffer_load_dwordx4 v[40:43], v4, s[20:23], s40 offen offset:2048
    v_mfma_f32_16x16x32_bf16 a[36:39], v[84:87], v[60:63], a[36:39]
    v_mfma_f32_16x16x32_bf16 a[40:43], v[88:91], v[60:63], a[40:43]
    buffer_load_dwordx4 v[24:27], v11, s[20:23], s39 offen
    v_mfma_f32_16x16x32_bf16 a[44:47], v[92:95], v[60:63], a[44:47]
    v_mfma_f32_16x16x32_bf16 a[48:51], v[72:75], v[64:67], a[48:51]
    buffer_load_dwordx4 v[44:47], v4, s[20:23], s40 offen offset:3072
    v_mfma_f32_16x16x32_bf16 a[52:55], v[76:79], v[64:67], a[52:55]
    v_mfma_f32_16x16x32_bf16 a[56:59], v[80:83], v[64:67], a[56:59]
    buffer_load_dwordx4 v[28:31], v12, s[20:23], s39 offen
    v_mfma_f32_16x16x32_bf16 a[60:63], v[84:87], v[64:67], a[60:63]
    v_mfma_f32_16x16x32_bf16 a[64:67], v[88:91], v[64:67], a[64:67]
    buffer_load_dwordx4 v[48:51], v13, s[20:23], s40 offen offset:0
    v_mfma_f32_16x16x32_bf16 a[68:71], v[92:95], v[64:67], a[68:71]
    v_mfma_f32_16x16x32_bf16 a[72:75], v[72:75], v[68:71], a[72:75]
    buffer_load_dwordx4 v[52:55], v13, s[20:23], s40 offen offset:1024
    s_add_u32 s40, s40, 6144
    s_add_u32 s39, s39, 1024
    v_mfma_f32_16x16x32_bf16 a[76:79], v[76:79], v[68:71], a[76:79]
    v_mfma_f32_16x16x32_bf16 a[80:83], v[80:83], v[68:71], a[80:83]
    v_mfma_f32_16x16x32_bf16 a[84:87], v[84:87], v[68:71], a[84:87]
    v_mfma_f32_16x16x32_bf16 a[88:91], v[88:91], v[68:71], a[88:91]
    v_mfma_f32_16x16x32_bf16 a[92:95], v[92:95], v[68:71], a[92:95]
    s_waitcnt vmcnt(40)
    v_mfma_f32_16x16x32_bf16 a[0:3], v[112:115], v[96:99], a[0:3]
    buffer_load_dwordx4 v[72:75], v4, s[20:23], s40 offen offset:0
    v_mfma_f32_16x16x32_bf16 a[4:7], v[116:119], v[96:99], a[4:7]
    v_mfma_f32_16x16x32_bf16 a[8:11], v[120:123], v[96:99], a[8:11]
    buffer_load_dwordx4 v[56:59], v9, s[20:23], s39 offen
    v_mfma_f32_16x16x32_bf16 a[12:15], v[124:127], v[96:99], a[12:15]
    v_mfma_f32_16x16x32_bf16 a[16:19], v[128:131], v[96:99], a[16:19]
    buffer_load_dwordx4 v[76:79], v4, s[20:23], s40 offen offset:1024
    v_mfma_f32_16x16x32_bf16 a[20:23], v[132:135], v[96:99], a[20:23]
    v_mfma_f32_16x16x32_bf16 a[24:27], v[112:115], v[100:103], a[24:27]
    buffer_load_dwordx4 v[60:63], v10, s[20:23], s39 offen
    v_mfma_f32_16x16x32_bf16 a[28:31], v[116:119], v[100:103], a[28:31]
    v_mfma_f32_16x16x32_bf16 a[32:35], v[120:123], v[100:103], a[32:35]
    buffer_load_dwordx4 v[80:83], v4, s[20:23], s40 offen offset:2048
    v_mfma_f32_16x16x32_bf16 a[36:39], v[124:127], v[100:103], a[36:39]
    v_mfma_f32_16x16x32_bf16 a[40:43], v[128:131], v[100:103], a[40:43]
    buffer_load_dwordx4 v[64:67], v11, s[20:23], s39 offen
    v_mfma_f32_16x16x32_bf16 a[44:47], v[132:135], v[100:103], a[44:47]
    v_mfma_f32_16x16x32_bf16 a[48:51], v[112:115], v[104:107], a[48:51]
    buffer_load_dwordx4 v[84:87], v4, s[20:23], s40 offen offset:3072
    v_mfma_f32_16x16x32_bf16 a[52:55], v[116:119], v[104:107], a[52:55]
    v_mfma_f32_16x16x32_bf16 a[56:59], v[120:123], v[104:107], a[56:59]
    buffer_load_dwordx4 v[68:71], v12, s[20:23], s39 offen
    v_mfma_f32_16x16x32_bf16 a[60:63], v[124:127], v[104:107], a[60:63]
    v_mfma_f32_16x16x32_bf16 a[64:67], v[128:131], v[104:107], a[64:67]
    buffer_load_dwordx4 v[88:91], v13, s[20:23], s40 offen offset:0
    v_mfma_f32_16x16x32_bf16 a[68:71], v[132:135], v[104:107], a[68:71]
    v_mfma_f32_16x16x32_bf16 a[72:75], v[112:115], v[108:111], a[72:75]
    buffer_load_dwordx4 v[92:95], v13, s[20:23], s40 offen offset:1024
    s_add_u32 s40, s40, 6144
    s_add_u32 s39, s39, 1024
    v_mfma_f32_16x16x32_bf16 a[76:79], v[116:119], v[108:111], a[76:79]
    v_mfma_f32_16x16x32_bf16 a[80:83], v[120:123], v[108:111], a[80:83]
    v_mfma_f32_16x16x32_bf16 a[84:87], v[124:127], v[108:111], a[84:87]
    v_mfma_f32_16x16x32_bf16 a[88:91], v[128:131], v[108:111], a[88:91]
    v_mfma_f32_16x16x32_bf16 a[92:95], v[132:135], v[108:111], a[92:95]
    s_waitcnt vmcnt(40)
    v_mfma_f32_16x16x32_bf16 a[0:3], v[152:155], v[136:139], a[0:3]
    buffer_load_dwordx4 v[112:115], v4, s[20:23], s40 offen offset:0
    v_mfma_f32_16x16x32_bf16 a[4:7], v[156:159], v[136:139], a[4:7]
    v_mfma_f32_16x16x32_bf16 a[8:11], v[160:163], v[136:139], a[8:11]
    buffer_load_dwordx4 v[96:99], v9, s[20:23], s39 offen
    v_mfma_f32_16x16x32_bf16 a[12:15], v[164:167], v[136:139], a[12:15]
    v_mfma_f32_16x16x32_bf16 a[16:19], v[168:171], v[136:139], a[16:19]
    buffer_load_dwordx4 v[116:119], v4, s[20:23], s40 offen offset:1024
    v_mfma_f32_16x16x32_bf16 a[20:23], v[172:175], v[136:139], a[20:23]
    v_mfma_f32_16x16x32_bf16 a[24:27], v[152:155], v[140:143], a[24:27]
    buffer_load_dwordx4 v[100:103], v10, s[20:23], s39 offen
    v_mfma_f32_16x16x32_bf16 a[28:31], v[156:159], v[140:143], a[28:31]
    v_mfma_f32_16x16x32_bf16 a[32:35], v[160:163], v[140:143], a[32:35]
    buffer_load_dwordx4 v[120:123], v4, s[20:23], s40 offen offset:2048
    v_mfma_f32_16x16x32_bf16 a[36:39], v[164:167], v[140:143], a[36:39]
    v_mfma_f32_16x16x32_bf16 a[40:43], v[168:171], v[140:143], a[40:43]
    buffer_load_dwordx4 v[104:107], v11, s[20:23], s39 offen
    v_mfma_f32_16x16x32_bf16 a[44:47], v[172:175], v[140:143], a[44:47]
    v_mfma_f32_16x16x32_bf16 a[48:51], v[152:155], v[144:147], a[48:51]
    buffer_load_dwordx4 v[124:127], v4, s[20:23], s40 offen offset:3072
    v_mfma_f32_16x16x32_bf16 a[52:55], v[156:159], v[144:147], a[52:55]
    v_mfma_f32_16x16x32_bf16 a[56:59], v[160:163], v[144:147], a[56:59]
    buffer_load_dwordx4 v[108:111], v12, s[20:23], s39 offen
    v_mfma_f32_16x16x32_bf16 a[60:63], v[164:167], v[144:147], a[60:63]
    v_mfma_f32_16x16x32_bf16 a[64:67], v[168:171], v[144:147], a[64:67]
    buffer_load_dwordx4 v[128:131], v13, s[20:23], s40 offen offset:0
    v_mfma_f32_16x16x32_bf16 a[68:71], v[172:175], v[144:147], a[68:71]
    v_mfma_f32_16x16x32_bf16 a[72:75], v[152:155], v[148:151], a[72:75]
    buffer_load_dwordx4 v[132:135], v13, s[20:23], s40 offen offset:1024
    s_add_u32 s40, s40, 6144
    s_add_u32 s39, s39, 1024
    v_mfma_f32_16x16x32_bf16 a[76:79], v[156:159], v[148:151], a[76:79]
    v_mfma_f32_16x16x32_bf16 a[80:83], v[160:163], v[148:151], a[80:83]
    v_mfma_f32_16x16x32_bf16 a[84:87], v[164:167], v[148:151], a[84:87]
    v_mfma_f32_16x16x32_bf16 a[88:91], v[168:171], v[148:151], a[88:91]
    v_mfma_f32_16x16x32_bf16 a[92:95], v[172:175], v[148:151], a[92:95]
    s_waitcnt vmcnt(40)
    v_mfma_f32_16x16x32_bf16 a[0:3], v[192:195], v[176:179], a[0:3]
    buffer_load_dwordx4 v[152:155], v4, s[20:23], s40 offen offset:0
    v_mfma_f32_16x16x32_bf16 a[4:7], v[196:199], v[176:179], a[4:7]
    v_mfma_f32_16x16x32_bf16 a[8:11], v[200:203], v[176:179], a[8:11]
    buffer_load_dwordx4 v[136:139], v9, s[20:23], s39 offen
    v_mfma_f32_16x16x32_bf16 a[12:15], v[204:207], v[176:179], a[12:15]
    v_mfma_f32_16x16x32_bf16 a[16:19], v[208:211], v[176:179], a[16:19]
    buffer_load_dwordx4 v[156:159], v4, s[20:23], s40 offen offset:1024
    v_mfma_f32_16x16x32_bf16 a[20:23], v[212:215], v[176:179], a[20:23]
    v_mfma_f32_16x16x32_bf16 a[24:27], v[192:195], v[180:183], a[24:27]
    buffer_load_dwordx4 v[140:143], v10, s[20:23], s39 offen
    v_mfma_f32_16x16x32_bf16 a[28:31], v[196:199], v[180:183], a[28:31]
    v_mfma_f32_16x16x32_bf16 a[32:35], v[200:203], v[180:183], a[32:35]
    buffer_load_dwordx4 v[160:163], v4, s[20:23], s40 offen offset:2048
    v_mfma_f32_16x16x32_bf16 a[36:39], v[204:207], v[180:183], a[36:39]
    v_mfma_f32_16x16x32_bf16 a[40:43], v[208:211], v[180:183], a[40:43]
    buffer_load_dwordx4 v[144:147], v11, s[20:23], s39 offen
    v_mfma_f32_16x16x32_bf16 a[44:47], v[212:215], v[180:183], a[44:47]
    v_mfma_f32_16x16x32_bf16 a[48:51], v[192:195], v[184:187], a[48:51]
    buffer_load_dwordx4 v[164:167], v4, s[20:23], s40 offen offset:3072
    v_mfma_f32_16x16x32_bf16 a[52:55], v[196:199], v[184:187], a[52:55]
    v_mfma_f32_16x16x32_bf16 a[56:59], v[200:203], v[184:187], a[56:59]
    buffer_load_dwordx4 v[148:151], v12, s[20:23], s39 offen
    v_mfma_f32_16x16x32_bf16 a[60:63], v[204:207], v[184:187], a[60:63]
    v_mfma_f32_16x16x32_bf16 a[64:67], v[208:211], v[184:187], a[64:67]
    buffer_load_dwordx4 v[168:171], v13, s[20:23], s40 offen offset:0
    v_mfma_f32_16x16x32_bf16 a[68:71], v[212:215], v[184:187], a[68:71]
    v_mfma_f32_16x16x32_bf16 a[72:75], v[192:195], v[188:191], a[72:75]
    buffer_load_dwordx4 v[172:175], v13, s[20:23], s40 offen offset:1024
    s_add_u32 s40, s40, 6144
    s_add_u32 s39, s39, 1024
    v_mfma_f32_16x16x32_bf16 a[76:79], v[196:199], v[188:191], a[76:79]
    v_mfma_f32_16x16x32_bf16 a[80:83], v[200:203], v[188:191], a[80:83]
    v_mfma_f32_16x16x32_bf16 a[84:87], v[204:207], v[188:191], a[84:87]
    v_mfma_f32_16x16x32_bf16 a[88:91], v[208:211], v[188:191], a[88:91]
    v_mfma_f32_16x16x32_bf16 a[92:95], v[212:215], v[188:191], a[92:95]
    s_waitcnt vmcnt(40)
    v_mfma_f32_16x16x32_bf16 a[0:3], v[232:235], v[216:219], a[0:3]
    buffer_load_dwordx4 v[192:195], v4, s[20:23], s40 offen offset:0
    v_mfma_f32_16x16x32_bf16 a[4:7], v[236:239], v[216:219], a[4:7]
    v_mfma_f32_16x16x32_bf16 a[8:11], v[240:243], v[216:219], a[8:11]
    buffer_load_dwordx4 v[176:179], v9, s[20:23], s39 offen
    v_mfma_f32_16x16x32_bf16 a[12:15], v[244:247], v[216:219], a[12:15]
    v_mfma_f32_16x16x32_bf16 a[16:19], v[248:251], v[216:219], a[16:19]
    buffer_load_dwordx4 v[196:199], v4, s[20:23], s40 offen offset:1024
    v_mfma_f32_16x16x32_bf16 a[20:23], v[252:255], v[216:219], a[20:23]
    v_mfma_f32_16x16x32_bf16 a[24:27], v[232:235], v[220:223], a[24:27]
    buffer_load_dwordx4 v[180:183], v10, s[20:23], s39 offen
    v_mfma_f32_16x16x32_bf16 a[28:31], v[236:239], v[220:223], a[28:31]
    v_mfma_f32_16x16x32_bf16 a[32:35], v[240:243], v[220:223], a[32:35]
    buffer_load_dwordx4 v[200:203], v4, s[20:23], s40 offen offset:2048
    v_mfma_f32_16x16x32_bf16 a[36:39], v[244:247], v[220:223], a[36:39]
    v_mfma_f32_16x16x32_bf16 a[40:43], v[248:251], v[220:223], a[40:43]
    buffer_load_dwordx4 v[184:187], v11, s[20:23], s39 offen
    v_mfma_f32_16x16x32_bf16 a[44:47], v[252:255], v[220:223], a[44:47]
    v_mfma_f32_16x16x32_bf16 a[48:51], v[232:235], v[224:227], a[48:51]
    buffer_load_dwordx4 v[204:207], v4, s[20:23], s40 offen offset:3072
    v_mfma_f32_16x16x32_bf16 a[52:55], v[236:239], v[224:227], a[52:55]
    v_mfma_f32_16x16x32_bf16 a[56:59], v[240:243], v[224:227], a[56:59]
    buffer_load_dwordx4 v[188:191], v12, s[20:23], s39 offen
    v_mfma_f32_16x16x32_bf16 a[60:63], v[244:247], v[224:227], a[60:63]
    v_mfma_f32_16x16x32_bf16 a[64:67], v[248:251], v[224:227], a[64:67]
    buffer_load_dwordx4 v[208:211], v13, s[20:23], s40 offen offset:0
    v_mfma_f32_16x16x32_bf16 a[68:71], v[252:255], v[224:227], a[68:71]
    v_mfma_f32_16x16x32_bf16 a[72:75], v[232:235], v[228:231], a[72:75]
    buffer_load_dwordx4 v[212:215], v13, s[20:23], s40 offen offset:1024
    s_add_u32 s40, s40, 6144
    s_add_u32 s39, s39, 1024
    v_mfma_f32_16x16x32_bf16 a[76:79], v[236:239], v[228:231], a[76:79]
    v_mfma_f32_16x16x32_bf16 a[80:83], v[240:243], v[228:231], a[80:83]
    v_mfma_f32_16x16x32_bf16 a[84:87], v[244:247], v[228:231], a[84:87]
    v_mfma_f32_16x16x32_bf16 a[88:91], v[248:251], v[228:231], a[88:91]
    v_mfma_f32_16x16x32_bf16 a[92:95], v[252:255], v[228:231], a[92:95]
    s_waitcnt vmcnt(40)
    v_mfma_f32_16x16x32_bf16 a[0:3], v[32:35], v[16:19], a[0:3]
    buffer_load_dwordx4 v[232:235], v4, s[20:23], s40 offen offset:0
    v_mfma_f32_16x16x32_bf16 a[4:7], v[36:39], v[16:19], a[4:7]
    v_mfma_f32_16x16x32_bf16 a[8:11], v[40:43], v[16:19], a[8:11]
    buffer_load_dwordx4 v[216:219], v9, s[20:23], s39 offen
    v_mfma_f32_16x16x32_bf16 a[12:15], v[44:47], v[16:19], a[12:15]
    v_mfma_f32_16x16x32_bf16 a[16:19], v[48:51], v[16:19], a[16:19]
    buffer_load_dwordx4 v[236:239], v4, s[20:23], s40 offen offset:1024
    v_mfma_f32_16x16x32_bf16 a[20:23], v[52:55], v[16:19], a[20:23]
    v_mfma_f32_16x16x32_bf16 a[24:27], v[32:35], v[20:23], a[24:27]
    buffer_load_dwordx4 v[220:223], v10, s[20:23], s39 offen
    v_mfma_f32_16x16x32_bf16 a[28:31], v[36:39], v[20:23], a[28:31]
    v_mfma_f32_16x16x32_bf16 a[32:35], v[40:43], v[20:23], a[32:35]
    buffer_load_dwordx4 v[240:243], v4, s[20:23], s40 offen offset:2048
    v_mfma_f32_16x16x32_bf16 a[36:39], v[44:47], v[20:23], a[36:39]
    v_mfma_f32_16x16x32_bf16 a[40:43], v[48:51], v[20:23], a[40:43]
    buffer_load_dwordx4 v[224:227], v11, s[20:23], s39 offen
    v_mfma_f32_16x16x32_bf16 a[44:47], v[52:55], v[20:23], a[44:47]
    v_mfma_f32_16x16x32_bf16 a[48:51], v[32:35], v[24:27], a[48:51]
    buffer_load_dwordx4 v[244:247], v4, s[20:23], s40 offen offset:3072
    v_mfma_f32_16x16x32_bf16 a[52:55], v[36:39], v[24:27], a[52:55]
    v_mfma_f32_16x16x32_bf16 a[56:59], v[40:43], v[24:27], a[56:59]
    buffer_load_dwordx4 v[228:231], v12, s[20:23], s39 offen
    v_mfma_f32_16x16x32_bf16 a[60:63], v[44:47], v[24:27], a[60:63]
    v_mfma_f32_16x16x32_bf16 a[64:67], v[48:51], v[24:27], a[64:67]
    buffer_load_dwordx4 v[248:251], v13, s[20:23], s40 offen offset:0
    v_mfma_f32_16x16x32_bf16 a[68:71], v[52:55], v[24:27], a[68:71]
    v_mfma_f32_16x16x32_bf16 a[72:75], v[32:35], v[28:31], a[72:75]
    buffer_load_dwordx4 v[252:255], v13, s[20:23], s40 offen offset:1024
    s_add_u32 s40, s40, 6144
    s_add_u32 s39, s39, 1024
    v_mfma_f32_16x16x32_bf16 a[76:79], v[36:39], v[28:31], a[76:79]
    v_mfma_f32_16x16x32_bf16 a[80:83], v[40:43], v[28:31], a[80:83]
    v_mfma_f32_16x16x32_bf16 a[84:87], v[44:47], v[28:31], a[84:87]
    v_mfma_f32_16x16x32_bf16 a[88:91], v[48:51], v[28:31], a[88:91]
    v_mfma_f32_16x16x32_bf16 a[92:95], v[52:55], v[28:31], a[92:95]
    s_waitcnt vmcnt(40)
    v_mfma_f32_16x16x32_bf16 a[0:3], v[72:75], v[56:59], a[0:3]
    buffer_load_dwordx4 v[32:35], v4, s[20:23], s40 offen offset:0
    v_mfma_f32_16x16x32_bf16 a[4:7], v[76:79], v[56:59], a[4:7]
    v_mfma_f32_16x16x32_bf16 a[8:11], v[80:83], v[56:59], a[8:11]
    buffer_load_dwordx4 v[16:19], v9, s[20:23], s39 offen
    v_mfma_f32_16x16x32_bf16 a[12:15], v[84:87], v[56:59], a[12:15]
    v_mfma_f32_16x16x32_bf16 a[16:19], v[88:91], v[56:59], a[16:19]
    buffer_load_dwordx4 v[36:39], v4, s[20:23], s40 offen offset:1024
    v_mfma_f32_16x16x32_bf16 a[20:23], v[92:95], v[56:59], a[20:23]
    v_mfma_f32_16x16x32_bf16 a[24:27], v[72:75], v[60:63], a[24:27]
    buffer_load_dwordx4 v[20:23], v10, s[20:23], s39 offen
    v_mfma_f32_16x16x32_bf16 a[28:31], v[76:79], v[60:63], a[28:31]
    v_mfma_f32_16x16x32_bf16 a[32:35], v[80:83], v[60:63], a[32:35]
    buffer_load_dwordx4 v[40:43], v4, s[20:23], s40 offen offset:2048
    v_mfma_f32_16x16x32_bf16 a[36:39], v[84:87], v[60:63], a[36:39]
    v_mfma_f32_16x16x32_bf16 a[40:43], v[88:91], v[60:63], a[40:43]
    buffer_load_dwordx4 v[24:27], v11, s[20:23], s39 offen
    v_mfma_f32_16x16x32_bf16 a[44:47], v[92:95], v[60:63], a[44:47]
    v_mfma_f32_16x16x32_bf16 a[48:51], v[72:75], v[64:67], a[48:51]
    buffer_load_dwordx4 v[44:47], v4, s[20:23], s40 offen offset:3072
    v_mfma_f32_16x16x32_bf16 a[52:55], v[76:79], v[64:67], a[52:55]
    v_mfma_f32_16x16x32_bf16 a[56:59], v[80:83], v[64:67], a[56:59]
    buffer_load_dwordx4 v[28:31], v12, s[20:23], s39 offen
    v_mfma_f32_16x16x32_bf16 a[60:63], v[84:87], v[64:67], a[60:63]
    v_mfma_f32_16x16x32_bf16 a[64:67], v[88:91], v[64:67], a[64:67]
    buffer_load_dwordx4 v[48:51], v13, s[20:23], s40 offen offset:0
    v_mfma_f32_16x16x32_bf16 a[68:71], v[92:95], v[64:67], a[68:71]
    v_mfma_f32_16x16x32_bf16 a[72:75], v[72:75], v[68:71], a[72:75]
    buffer_load_dwordx4 v[52:55], v13, s[20:23], s40 offen offset:1024
    s_add_u32 s40, s40, 6144
    s_add_u32 s39, s39, 1024
    v_mfma_f32_16x16x32_bf16 a[76:79], v[76:79], v[68:71], a[76:79]
    v_mfma_f32_16x16x32_bf16 a[80:83], v[80:83], v[68:71], a[80:83]
    v_mfma_f32_16x16x32_bf16 a[84:87], v[84:87], v[68:71], a[84:87]
    v_mfma_f32_16x16x32_bf16 a[88:91], v[88:91], v[68:71], a[88:91]
    v_mfma_f32_16x16x32_bf16 a[92:95], v[92:95], v[68:71], a[92:95]
    s_waitcnt vmcnt(40)
    v_mfma_f32_16x16x32_bf16 a[0:3], v[112:115], v[96:99], a[0:3]
    buffer_load_dwordx4 v[72:75], v4, s[20:23], s40 offen offset:0
    v_mfma_f32_16x16x32_bf16 a[4:7], v[116:119], v[96:99], a[4:7]
    v_mfma_f32_16x16x32_bf16 a[8:11], v[120:123], v[96:99], a[8:11]
    buffer_load_dwordx4 v[56:59], v9, s[20:23], s39 offen
    v_mfma_f32_16x16x32_bf16 a[12:15], v[124:127], v[96:99], a[12:15]
    v_mfma_f32_16x16x32_bf16 a[16:19], v[128:131], v[96:99], a[16:19]
    buffer_load_dwordx4 v[76:79], v4, s[20:23], s40 offen offset:1024
    v_mfma_f32_16x16x32_bf16 a[20:23], v[132:135], v[96:99], a[20:23]
    v_mfma_f32_16x16x32_bf16 a[24:27], v[112:115], v[100:103], a[24:27]
    buffer_load_dwordx4 v[60:63], v10, s[20:23], s39 offen
    v_mfma_f32_16x16x32_bf16 a[28:31], v[116:119], v[100:103], a[28:31]
    v_mfma_f32_16x16x32_bf16 a[32:35], v[120:123], v[100:103], a[32:35]
    buffer_load_dwordx4 v[80:83], v4, s[20:23], s40 offen offset:2048
    v_mfma_f32_16x16x32_bf16 a[36:39], v[124:127], v[100:103], a[36:39]
    v_mfma_f32_16x16x32_bf16 a[40:43], v[128:131], v[100:103], a[40:43]
    buffer_load_dwordx4 v[64:67], v11, s[20:23], s39 offen
    v_mfma_f32_16x16x32_bf16 a[44:47], v[132:135], v[100:103], a[44:47]
    v_mfma_f32_16x16x32_bf16 a[48:51], v[112:115], v[104:107], a[48:51]
    buffer_load_dwordx4 v[84:87], v4, s[20:23], s40 offen offset:3072
    v_mfma_f32_16x16x32_bf16 a[52:55], v[116:119], v[104:107], a[52:55]
    v_mfma_f32_16x16x32_bf16 a[56:59], v[120:123], v[104:107], a[56:59]
    buffer_load_dwordx4 v[68:71], v12, s[20:23], s39 offen
    v_mfma_f32_16x16x32_bf16 a[60:63], v[124:127], v[104:107], a[60:63]
    v_mfma_f32_16x16x32_bf16 a[64:67], v[128:131], v[104:107], a[64:67]
    buffer_load_dwordx4 v[88:91], v13, s[20:23], s40 offen offset:0
    v_mfma_f32_16x16x32_bf16 a[68:71], v[132:135], v[104:107], a[68:71]
    v_mfma_f32_16x16x32_bf16 a[72:75], v[112:115], v[108:111], a[72:75]
    buffer_load_dwordx4 v[92:95], v13, s[20:23], s40 offen offset:1024
    s_add_u32 s40, s40, 6144
    s_add_u32 s39, s39, 1024
    v_mfma_f32_16x16x32_bf16 a[76:79], v[116:119], v[108:111], a[76:79]
    v_mfma_f32_16x16x32_bf16 a[80:83], v[120:123], v[108:111], a[80:83]
    v_mfma_f32_16x16x32_bf16 a[84:87], v[124:127], v[108:111], a[84:87]
    v_mfma_f32_16x16x32_bf16 a[88:91], v[128:131], v[108:111], a[88:91]
    v_mfma_f32_16x16x32_bf16 a[92:95], v[132:135], v[108:111], a[92:95]
    s_waitcnt vmcnt(40)
    v_mfma_f32_16x16x32_bf16 a[0:3], v[152:155], v[136:139], a[0:3]
    v_mfma_f32_16x16x32_bf16 a[4:7], v[156:159], v[136:139], a[4:7]
    v_mfma_f32_16x16x32_bf16 a[8:11], v[160:163], v[136:139], a[8:11]
    v_mfma_f32_16x16x32_bf16 a[12:15], v[164:167], v[136:139], a[12:15]
    v_mfma_f32_16x16x32_bf16 a[16:19], v[168:171], v[136:139], a[16:19]
    v_mfma_f32_16x16x32_bf16 a[20:23], v[172:175], v[136:139], a[20:23]
    v_mfma_f32_16x16x32_bf16 a[24:27], v[152:155], v[140:143], a[24:27]
    v_mfma_f32_16x16x32_bf16 a[28:31], v[156:159], v[140:143], a[28:31]
    v_mfma_f32_16x16x32_bf16 a[32:35], v[160:163], v[140:143], a[32:35]
    v_mfma_f32_16x16x32_bf16 a[36:39], v[164:167], v[140:143], a[36:39]
    v_mfma_f32_16x16x32_bf16 a[40:43], v[168:171], v[140:143], a[40:43]
    v_mfma_f32_16x16x32_bf16 a[44:47], v[172:175], v[140:143], a[44:47]
    v_mfma_f32_16x16x32_bf16 a[48:51], v[152:155], v[144:147], a[48:51]
    v_mfma_f32_16x16x32_bf16 a[52:55], v[156:159], v[144:147], a[52:55]
    v_mfma_f32_16x16x32_bf16 a[56:59], v[160:163], v[144:147], a[56:59]
    v_mfma_f32_16x16x32_bf16 a[60:63], v[164:167], v[144:147], a[60:63]
    v_mfma_f32_16x16x32_bf16 a[64:67], v[168:171], v[144:147], a[64:67]
    v_mfma_f32_16x16x32_bf16 a[68:71], v[172:175], v[144:147], a[68:71]
    v_mfma_f32_16x16x32_bf16 a[72:75], v[152:155], v[148:151], a[72:75]
    v_mfma_f32_16x16x32_bf16 a[76:79], v[156:159], v[148:151], a[76:79]
    v_mfma_f32_16x16x32_bf16 a[80:83], v[160:163], v[148:151], a[80:83]
    v_mfma_f32_16x16x32_bf16 a[84:87], v[164:167], v[148:151], a[84:87]
    v_mfma_f32_16x16x32_bf16 a[88:91], v[168:171], v[148:151], a[88:91]
    v_mfma_f32_16x16x32_bf16 a[92:95], v[172:175], v[148:151], a[92:95]
    s_waitcnt vmcnt(30)
    v_mfma_f32_16x16x32_bf16 a[0:3], v[192:195], v[176:179], a[0:3]
    v_mfma_f32_16x16x32_bf16 a[4:7], v[196:199], v[176:179], a[4:7]
    v_mfma_f32_16x16x32_bf16 a[8:11], v[200:203], v[176:179], a[8:11]
    v_mfma_f32_16x16x32_bf16 a[12:15], v[204:207], v[176:179], a[12:15]
    v_mfma_f32_16x16x32_bf16 a[16:19], v[208:211], v[176:179], a[16:19]
    v_mfma_f32_16x16x32_bf16 a[20:23], v[212:215], v[176:179], a[20:23]
    v_mfma_f32_16x16x32_bf16 a[24:27], v[192:195], v[180:183], a[24:27]
    v_mfma_f32_16x16x32_bf16 a[28:31], v[196:199], v[180:183], a[28:31]
    v_mfma_f32_16x16x32_bf16 a[32:35], v[200:203], v[180:183], a[32:35]
    v_mfma_f32_16x16x32_bf16 a[36:39], v[204:207], v[180:183], a[36:39]
    v_mfma_f32_16x16x32_bf16 a[40:43], v[208:211], v[180:183], a[40:43]
    v_mfma_f32_16x16x32_bf16 a[44:47], v[212:215], v[180:183], a[44:47]
    v_mfma_f32_16x16x32_bf16 a[48:51], v[192:195], v[184:187], a[48:51]
    v_mfma_f32_16x16x32_bf16 a[52:55], v[196:199], v[184:187], a[52:55]
    v_mfma_f32_16x16x32_bf16 a[56:59], v[200:203], v[184:187], a[56:59]
    v_mfma_f32_16x16x32_bf16 a[60:63], v[204:207], v[184:187], a[60:63]
    v_mfma_f32_16x16x32_bf16 a[64:67], v[208:211], v[184:187], a[64:67]
    v_mfma_f32_16x16x32_bf16 a[68:71], v[212:215], v[184:187], a[68:71]
    v_mfma_f32_16x16x32_bf16 a[72:75], v[192:195], v[188:191], a[72:75]
    v_mfma_f32_16x16x32_bf16 a[76:79], v[196:199], v[188:191], a[76:79]
    v_mfma_f32_16x16x32_bf16 a[80:83], v[200:203], v[188:191], a[80:83]
    v_mfma_f32_16x16x32_bf16 a[84:87], v[204:207], v[188:191], a[84:87]
    v_mfma_f32_16x16x32_bf16 a[88:91], v[208:211], v[188:191], a[88:91]
    v_mfma_f32_16x16x32_bf16 a[92:95], v[212:215], v[188:191], a[92:95]
    s_waitcnt vmcnt(20)
    v_mfma_f32_16x16x32_bf16 a[0:3], v[232:235], v[216:219], a[0:3]
    v_mfma_f32_16x16x32_bf16 a[4:7], v[236:239], v[216:219], a[4:7]
    v_mfma_f32_16x16x32_bf16 a[8:11], v[240:243], v[216:219], a[8:11]
    v_mfma_f32_16x16x32_bf16 a[12:15], v[244:247], v[216:219], a[12:15]
    v_mfma_f32_16x16x32_bf16 a[16:19], v[248:251], v[216:219], a[16:19]
    v_mfma_f32_16x16x32_bf16 a[20:23], v[252:255], v[216:219], a[20:23]
    v_mfma_f32_16x16x32_bf16 a[24:27], v[232:235], v[220:223], a[24:27]
    v_mfma_f32_16x16x32_bf16 a[28:31], v[236:239], v[220:223], a[28:31]
    v_mfma_f32_16x16x32_bf16 a[32:35], v[240:243], v[220:223], a[32:35]
    v_mfma_f32_16x16x32_bf16 a[36:39], v[244:247], v[220:223], a[36:39]
    v_mfma_f32_16x16x32_bf16 a[40:43], v[248:251], v[220:223], a[40:43]
    v_mfma_f32_16x16x32_bf16 a[44:47], v[252:255], v[220:223], a[44:47]
    v_mfma_f32_16x16x32_bf16 a[48:51], v[232:235], v[224:227], a[48:51]
    v_mfma_f32_16x16x32_bf16 a[52:55], v[236:239], v[224:227], a[52:55]
    v_mfma_f32_16x16x32_bf16 a[56:59], v[240:243], v[224:227], a[56:59]
    v_mfma_f32_16x16x32_bf16 a[60:63], v[244:247], v[224:227], a[60:63]
    v_mfma_f32_16x16x32_bf16 a[64:67], v[248:251], v[224:227], a[64:67]
    v_mfma_f32_16x16x32_bf16 a[68:71], v[252:255], v[224:227], a[68:71]
    v_mfma_f32_16x16x32_bf16 a[72:75], v[232:235], v[228:231], a[72:75]
    v_mfma_f32_16x16x32_bf16 a[76:79], v[236:239], v[228:231], a[76:79]
    v_mfma_f32_16x16x32_bf16 a[80:83], v[240:243], v[228:231], a[80:83]
    v_mfma_f32_16x16x32_bf16 a[84:87], v[244:247], v[228:231], a[84:87]
    v_mfma_f32_16x16x32_bf16 a[88:91], v[248:251], v[228:231], a[88:91]
    v_mfma_f32_16x16x32_bf16 a[92:95], v[252:255], v[228:231], a[92:95]
    s_waitcnt vmcnt(10)
    v_mfma_f32_16x16x32_bf16 a[0:3], v[32:35], v[16:19], a[0:3]
    v_mfma_f32_16x16x32_bf16 a[4:7], v[36:39], v[16:19], a[4:7]
    v_mfma_f32_16x16x32_bf16 a[8:11], v[40:43], v[16:19], a[8:11]
    v_mfma_f32_16x16x32_bf16 a[12:15], v[44:47], v[16:19], a[12:15]
    v_mfma_f32_16x16x32_bf16 a[16:19], v[48:51], v[16:19], a[16:19]
    v_mfma_f32_16x16x32_bf16 a[20:23], v[52:55], v[16:19], a[20:23]
    v_mfma_f32_16x16x32_bf16 a[24:27], v[32:35], v[20:23], a[24:27]
    v_mfma_f32_16x16x32_bf16 a[28:31], v[36:39], v[20:23], a[28:31]
    v_mfma_f32_16x16x32_bf16 a[32:35], v[40:43], v[20:23], a[32:35]
    v_mfma_f32_16x16x32_bf16 a[36:39], v[44:47], v[20:23], a[36:39]
    v_mfma_f32_16x16x32_bf16 a[40:43], v[48:51], v[20:23], a[40:43]
    v_mfma_f32_16x16x32_bf16 a[44:47], v[52:55], v[20:23], a[44:47]
    v_mfma_f32_16x16x32_bf16 a[48:51], v[32:35], v[24:27], a[48:51]
    v_mfma_f32_16x16x32_bf16 a[52:55], v[36:39], v[24:27], a[52:55]
    v_mfma_f32_16x16x32_bf16 a[56:59], v[40:43], v[24:27], a[56:59]
    v_mfma_f32_16x16x32_bf16 a[60:63], v[44:47], v[24:27], a[60:63]
    v_mfma_f32_16x16x32_bf16 a[64:67], v[48:51], v[24:27], a[64:67]
    v_mfma_f32_16x16x32_bf16 a[68:71], v[52:55], v[24:27], a[68:71]
    v_mfma_f32_16x16x32_bf16 a[72:75], v[32:35], v[28:31], a[72:75]
    v_mfma_f32_16x16x32_bf16 a[76:79], v[36:39], v[28:31], a[76:79]
    v_mfma_f32_16x16x32_bf16 a[80:83], v[40:43], v[28:31], a[80:83]
    v_mfma_f32_16x16x32_bf16 a[84:87], v[44:47], v[28:31], a[84:87]
    v_mfma_f32_16x16x32_bf16 a[88:91], v[48:51], v[28:31], a[88:91]
    v_mfma_f32_16x16x32_bf16 a[92:95], v[52:55], v[28:31], a[92:95]
    s_waitcnt vmcnt(0)
    v_mfma_f32_16x16x32_bf16 a[0:3], v[72:75], v[56:59], a[0:3]
    v_mfma_f32_16x16x32_bf16 a[4:7], v[76:79], v[56:59], a[4:7]
    v_mfma_f32_16x16x32_bf16 a[8:11], v[80:83], v[56:59], a[8:11]
    v_mfma_f32_16x16x32_bf16 a[12:15], v[84:87], v[56:59], a[12:15]
    v_mfma_f32_16x16x32_bf16 a[16:19], v[88:91], v[56:59], a[16:19]
    v_mfma_f32_16x16x32_bf16 a[20:23], v[92:95], v[56:59], a[20:23]
    v_mfma_f32_16x16x32_bf16 a[24:27], v[72:75], v[60:63], a[24:27]
    v_mfma_f32_16x16x32_bf16 a[28:31], v[76:79], v[60:63], a[28:31]
    v_mfma_f32_16x16x32_bf16 a[32:35], v[80:83], v[60:63], a[32:35]
    v_mfma_f32_16x16x32_bf16 a[36:39], v[84:87], v[60:63], a[36:39]
    v_mfma_f32_16x16x32_bf16 a[40:43], v[88:91], v[60:63], a[40:43]
    v_mfma_f32_16x16x32_bf16 a[44:47], v[92:95], v[60:63], a[44:47]
    v_mfma_f32_16x16x32_bf16 a[48:51], v[72:75], v[64:67], a[48:51]
    v_mfma_f32_16x16x32_bf16 a[52:55], v[76:79], v[64:67], a[52:55]
    v_mfma_f32_16x16x32_bf16 a[56:59], v[80:83], v[64:67], a[56:59]
    v_mfma_f32_16x16x32_bf16 a[60:63], v[84:87], v[64:67], a[60:63]
    v_mfma_f32_16x16x32_bf16 a[64:67], v[88:91], v[64:67], a[64:67]
    v_mfma_f32_16x16x32_bf16 a[68:71], v[92:95], v[64:67], a[68:71]
    v_mfma_f32_16x16x32_bf16 a[72:75], v[72:75], v[68:71], a[72:75]
    v_mfma_f32_16x16x32_bf16 a[76:79], v[76:79], v[68:71], a[76:79]
    v_mfma_f32_16x16x32_bf16 a[80:83], v[80:83], v[68:71], a[80:83]
    v_mfma_f32_16x16x32_bf16 a[84:87], v[84:87], v[68:71], a[84:87]
    v_mfma_f32_16x16x32_bf16 a[88:91], v[88:91], v[68:71], a[88:91]
    v_mfma_f32_16x16x32_bf16 a[92:95], v[92:95], v[68:71], a[92:95]
    s_nop 7
    s_add_u32 s32, s3, 1
    s_and_b32 s32, s32, 3
    s_mul_i32 s32, s32, 18432
    v_add_u32 v5, s32, v4
    ds_write_b128 v5, a[24:27] offset:0
    ds_write_b128 v5, a[28:31] offset:1024
    ds_write_b128 v5, a[32:35] offset:2048
    ds_write_b128 v5, a[36:39] offset:3072
    ds_write_b128 v5, a[40:43] offset:4096
    ds_write_b128 v5, a[44:47] offset:5120
    s_add_u32 s32, s3, 2
    s_and_b32 s32, s32, 3
    s_mul_i32 s32, s32, 18432
    v_add_u32 v5, s32, v4
    ds_write_b128 v5, a[48:51] offset:6144
    ds_write_b128 v5, a[52:55] offset:7168
    ds_write_b128 v5, a[56:59] offset:8192
    ds_write_b128 v5, a[60:63] offset:9216
    ds_write_b128 v5, a[64:67] offset:10240
    ds_write_b128 v5, a[68:71] offset:11264
    s_add_u32 s32, s3, 3
    s_and_b32 s32, s32, 3
    s_mul_i32 s32, s32, 18432
    v_add_u32 v5, s32, v4
    ds_write_b128 v5, a[72:75] offset:12288
    ds_write_b128 v5, a[76:79] offset:13312
    ds_write_b128 v5, a[80:83] offset:14336
    ds_write_b128 v5, a[84:87] offset:15360
    ds_write_b128 v5, a[88:91] offset:16384
    ds_write_b128 v5, a[92:95] offset:17408
    v_accvgpr_read_b32 v16, a0
    v_accvgpr_read_b32 v17, a1
    v_accvgpr_read_b32 v18, a2
    v_accvgpr_read_b32 v19, a3
    v_accvgpr_read_b32 v20, a4
    v_accvgpr_read_b32 v21, a5
    v_accvgpr_read_b32 v22, a6
    v_accvgpr_read_b32 v23, a7
    v_accvgpr_read_b32 v24, a8
    v_accvgpr_read_b32 v25, a9
    v_accvgpr_read_b32 v26, a10
    v_accvgpr_read_b32 v27, a11
    v_accvgpr_read_b32 v28, a12
    v_accvgpr_read_b32 v29, a13
    v_accvgpr_read_b32 v30, a14
    v_accvgpr_read_b32 v31, a15
    v_accvgpr_read_b32 v32, a16
    v_accvgpr_read_b32 v33, a17
    v_accvgpr_read_b32 v34, a18
    v_accvgpr_read_b32 v35, a19
    v_accvgpr_read_b32 v36, a20
    v_accvgpr_read_b32 v37, a21
    v_accvgpr_read_b32 v38, a22
    v_accvgpr_read_b32 v39, a23
    s_mul_i32 s32, s3, 18432
    v_add_u32 v5, s32, v4
    s_waitcnt lgkmcnt(0)
    s_barrier
    ds_read_b128 v[40:43], v5 offset:0
    ds_read_b128 v[44:47], v5 offset:1024
    ds_read_b128 v[48:51], v5 offset:2048
    ds_read_b128 v[52:55], v5 offset:3072
    ds_read_b128 v[56:59], v5 offset:4096
    ds_read_b128 v[60:63], v5 offset:5120
    ds_read_b128 v[64:67], v5 offset:6144
    ds_read_b128 v[68:71], v5 offset:7168
    ds_read_b128 v[72:75], v5 offset:8192
    ds_read_b128 v[76:79], v5 offset:9216
    ds_read_b128 v[80:83], v5 offset:10240
    ds_read_b128 v[84:87], v5 offset:11264
    ds_read_b128 v[88:91], v5 offset:12288
    ds_read_b128 v[92:95], v5 offset:13312
    ds_read_b128 v[96:99], v5 offset:14336
    ds_read_b128 v[100:103], v5 offset:15360
    ds_read_b128 v[104:107], v5 offset:16384
    ds_read_b128 v[108:111], v5 offset:17408
    s_lshl_b32 s32, s37, 6
    s_lshl_b32 s33, s3, 4
    s_add_u32 s32, s32, s33
    v_add_u32 v6, s32, v2
    v_mul_u32_u24 v6, 2304, v6
    v_mad_u32_u24 v6, v3, 48, v6
    s_mul_i32 s32, s38, 192
    s_waitcnt lgkmcnt(12)
    v_add_f32 v16, v16, v40
    v_add_f32 v17, v17, v41
    v_add_f32 v18, v18, v42
    v_add_f32 v19, v19, v43
    v_add_f32 v20, v20, v44
    v_add_f32 v21, v21, v45
    v_add_f32 v22, v22, v46
    v_add_f32 v23, v23, v47
    v_add_f32 v24, v24, v48
    v_add_f32 v25, v25, v49
    v_add_f32 v26, v26, v50
    v_add_f32 v27, v27, v51
    v_add_f32 v28, v28, v52
    v_add_f32 v29, v29, v53
    v_add_f32 v30, v30, v54
    v_add_f32 v31, v31, v55
    v_add_f32 v32, v32, v56
    v_add_f32 v33, v33, v57
    v_add_f32 v34, v34, v58
    v_add_f32 v35, v35, v59
    v_add_f32 v36, v36, v60
    v_add_f32 v37, v37, v61
    v_add_f32 v38, v38, v62
    v_add_f32 v39, v39, v63
    s_waitcnt lgkmcnt(6)
    v_add_f32 v16, v16, v64
    v_add_f32 v17, v17, v65
    v_add_f32 v18, v18, v66
    v_add_f32 v19, v19, v67
    v_add_f32 v20, v20, v68
    v_add_f32 v21, v21, v69
    v_add_f32 v22, v22, v70
    v_add_f32 v23, v23, v71
    v_add_f32 v24, v24, v72
    v_add_f32 v25, v25, v73
    v_add_f32 v26, v26, v74
    v_add_f32 v27, v27, v75
    v_add_f32 v28, v28, v76
    v_add_f32 v29, v29, v77
    v_add_f32 v30, v30, v78
    v_add_f32 v31, v31, v79
    v_add_f32 v32, v32, v80
    v_add_f32 v33, v33, v81
    v_add_f32 v34, v34, v82
    v_add_f32 v35, v35, v83
    v_add_f32 v36, v36, v84
    v_add_f32 v37, v37, v85
    v_add_f32 v38, v38, v86
    v_add_f32 v39, v39, v87
    s_waitcnt lgkmcnt(0)
    v_add_f32 v16, v16, v88
    v_add_f32 v17, v17, v89
    v_add_f32 v18, v18, v90
    v_add_f32 v19, v19, v91
    v_add_f32 v20, v20, v92
    v_add_f32 v21, v21, v93
    v_add_f32 v22, v22, v94
    v_add_f32 v23, v23, v95
    v_add_f32 v24, v24, v96
    v_add_f32 v25, v25, v97
    v_add_f32 v26, v26, v98
    v_add_f32 v27, v27, v99
    v_add_f32 v28, v28, v100
    v_add_f32 v29, v29, v101
    v_add_f32 v30, v30, v102
    v_add_f32 v31, v31, v103
    v_add_f32 v32, v32, v104
    v_add_f32 v33, v33, v105
    v_add_f32 v34, v34, v106
    v_add_f32 v35, v35, v107
    v_add_f32 v36, v36, v108
    v_add_f32 v37, v37, v109
    v_add_f32 v38, v38, v110
    v_add_f32 v39, v39, v111
    v_cvt_pk_bf16_f32 v40, v16, v20
    v_cvt_pk_bf16_f32 v41, v24, v28
    v_cvt_pk_bf16_f32 v42, v32, v36
    v_cvt_pk_bf16_f32 v43, v17, v21
    v_cvt_pk_bf16_f32 v44, v25, v29
    v_cvt_pk_bf16_f32 v45, v33, v37
    v_cvt_pk_bf16_f32 v46, v18, v22
    v_cvt_pk_bf16_f32 v47, v26, v30
    v_cvt_pk_bf16_f32 v48, v34, v38
    v_cvt_pk_bf16_f32 v49, v19, v23
    v_cvt_pk_bf16_f32 v50, v27, v31
    v_cvt_pk_bf16_f32 v51, v35, v39
    buffer_store_dwordx4 v[40:43], v6, s[8:11], s32 offen offset:0
    buffer_store_dwordx4 v[44:47], v6, s[8:11], s32 offen offset:16
    buffer_store_dwordx4 v[48:51], v6, s[8:11], s32 offen offset:32
    s_endpgm
k3_B:
    v_and_b32 v9, 31, v1
    v_lshrrev_b32 v10, 5, v1
    s_lshl_b32 s37, s35, 3
    s_add_u32 s37, s37, s36
    s_sub_u32 s37, s37, 24
    s_lshl_b32 s32, s37, 4
    s_lshl_b32 s33, s3, 2
    s_add_u32 s32, s32, s33
    s_mul_i32 s39, s32, 5120
    s_add_u32 s39, s39, 56623104
    s_mul_i32 s40, s3, 40960
    s_add_u32 s40, s40, 65011712
    v_bfe_u32 v5, v9, 2, 1
    v_mov_b32 v6, 0x7fff0000
    v_cmp_eq_u32 vcc, v5, v10
    v_and_b32 v5, 27, v9
    s_nop 0
    v_cndmask_b32 v11, v6, v4, vcc
    v_cmp_gt_u32 vcc, 3, v5
    s_nop 1
    v_cndmask_b32 v12, v6, v11, vcc
    buffer_load_dwordx4 v[16:19], v4, s[20:23], s39 offen offset:0
    buffer_load_dwordx4 v[20:23], v4, s[20:23], s39 offen offset:1024
    buffer_load_dwordx4 v[24:27], v4, s[20:23], s39 offen offset:2048
    buffer_load_dwordx4 v[28:31], v4, s[20:23], s39 offen offset:3072
    s_add_u32 s39, s39, 4096
    buffer_load_dwordx4 v[32:35], v4, s[20:23], s39 offen offset:0
    buffer_load_dwordx4 v[96:99], v11, s[20:23], s40 offen offset:0
    buffer_load_dwordx4 v[100:103], v11, s[20:23], s40 offen offset:1024
    buffer_load_dwordx4 v[104:107], v11, s[20:23], s40 offen offset:2048
    buffer_load_dwordx4 v[108:111], v11, s[20:23], s40 offen offset:3072
    s_add_u32 s40, s40, 4096
    buffer_load_dwordx4 v[112:115], v11, s[20:23], s40 offen offset:0
    buffer_load_dwordx4 v[116:119], v12, s[20:23], s40 offen offset:1024
    buffer_load_dwordx4 v[120:123], v12, s[20:23], s40 offen offset:2048
    buffer_load_dwordx4 v[124:127], v12, s[20:23], s40 offen offset:3072
    s_add_u32 s40, s40, 4096
    buffer_load_dwordx4 v[128:131], v12, s[20:23], s40 offen offset:0
    buffer_load_dwordx4 v[132:135], v12, s[20:23], s40 offen offset:1024
    buffer_load_dwordx4 v[36:39], v4, s[20:23], s39 offen offset:1024
    buffer_load_dwordx4 v[40:43], v4, s[20:23], s39 offen offset:2048
    buffer_load_dwordx4 v[44:47], v4, s[20:23], s39 offen offset:3072
    s_add_u32 s39, s39, 4096
    buffer_load_dwordx4 v[48:51], v4, s[20:23], s39 offen offset:0
    buffer_load_dwordx4 v[52:55], v4, s[20:23], s39 offen offset:1024
    buffer_load_dwordx4 v[136:139], v11, s[20:23], s40 offen offset:2048
    buffer_load_dwordx4 v[140:143], v11, s[20:23], s40 offen offset:3072
    s_add_u32 s40, s40, 4096
    buffer_load_dwordx4 v[144:147], v11, s[20:23], s40 offen offset:0
    buffer_load_dwordx4 v[148:151], v11, s[20:23], s40 offen offset:1024
    buffer_load_dwordx4 v[152:155], v11, s[20:23], s40 offen offset:2048
    buffer_load_dwordx4 v[156:159], v12, s[20:23], s40 offen offset:3072
    s_add_u32 s40, s40, 4096
    buffer_load_dwordx4 v[160:163], v12, s[20:23], s40 offen offset:0
    buffer_load_dwordx4 v[164:167], v12, s[20:23], s40 offen offset:1024
    buffer_load_dwordx4 v[168:171], v12, s[20:23], s40 offen offset:2048
    buffer_load_dwordx4 v[172:175], v12, s[20:23], s40 offen offset:3072
    s_add_u32 s40, s40, 4096
    buffer_load_dwordx4 v[56:59], v4, s[20:23], s39 offen offset:2048
    buffer_load_dwordx4 v[60:63], v4, s[20:23], s39 offen offset:3072
    s_add_u32 s39, s39, 4096
    buffer_load_dwordx4 v[64:67], v4, s[20:23], s39 offen offset:0
    buffer_load_dwordx4 v[68:71], v4, s[20:23], s39 offen offset:1024
    buffer_load_dwordx4 v[72:75], v4, s[20:23], s39 offen offset:2048
    buffer_load_dwordx4 v[176:179], v11, s[20:23], s40 offen offset:0
    buffer_load_dwordx4 v[180:183], v11, s[20:23], s40 offen offset:1024
    buffer_load_dwordx4 v[184:187], v11, s[20:23], s40 offen offset:2048
    buffer_load_dwordx4 v[188:191], v11, s[20:23], s40 offen offset:3072
    s_add_u32 s40, s40, 4096
    buffer_load_dwordx4 v[192:195], v11, s[20:23], s40 offen offset:0
    buffer_load_dwordx4 v[196:199], v12, s[20:23], s40 offen offset:1024
    buffer_load_dwordx4 v[200:203], v12, s[20:23], s40 offen offset:2048
    buffer_load_dwordx4 v[204:207], v12, s[20:23], s40 offen offset:3072
    s_add_u32 s40, s40, 4096
    buffer_load_dwordx4 v[208:211], v12, s[20:23], s40 offen offset:0
    buffer_load_dwordx4 v[212:215], v12, s[20:23], s40 offen offset:1024
    buffer_load_dwordx4 v[76:79], v4, s[20:23], s39 offen offset:3072
    s_add_u32 s39, s39, 4096
    buffer_load_dwordx4 v[80:83], v4, s[20:23], s39 offen offset:0
    buffer_load_dwordx4 v[84:87], v4, s[20:23], s39 offen offset:1024
    buffer_load_dwordx4 v[88:91], v4, s[20:23], s39 offen offset:2048
    buffer_load_dwordx4 v[92:95], v4, s[20:23], s39 offen offset:3072
    s_add_u32 s39, s39, 4096
    buffer_load_dwordx4 v[216:219], v11, s[20:23], s40 offen offset:2048
    buffer_load_dwordx4 v[220:223], v11, s[20:23], s40 offen offset:3072
    s_add_u32 s40, s40, 4096
    buffer_load_dwordx4 v[224:227], v11, s[20:23], s40 offen offset:0
    buffer_load_dwordx4 v[228:231], v11, s[20:23], s40 offen offset:1024
    buffer_load_dwordx4 v[232:235], v11, s[20:23], s40 offen offset:2048
    buffer_load_dwordx4 v[236:239], v12, s[20:23], s40 offen offset:3072
    s_add_u32 s40, s40, 4096
    buffer_load_dwordx4 v[240:243], v12, s[20:23], s40 offen offset:0
    buffer_load_dwordx4 v[244:247], v12, s[20:23], s40 offen offset:1024
    buffer_load_dwordx4 v[248:251], v12, s[20:23], s40 offen offset:2048
    buffer_load_dwordx4 v[252:255], v12, s[20:23], s40 offen offset:3072
    s_add_u32 s40, s40, 4096
    s_add_u32 s32, s3, 0
    s_lshl_b32 s32, s32, 10
    v_add_u32 v11, s32, v4
    s_add_u32 s32, s3, 4
    s_lshl_b32 s32, s32, 10
    v_add_u32 v12, s32, v4
    s_add_u32 s32, s3, 8
    s_lshl_b32 s32, s32, 10
    v_add_u32 v13, s32, v4
    s_add_u32 s32, s3, 12
    s_lshl_b32 s32, s32, 10
    v_add_u32 v7, s32, v4
    s_add_u32 s32, s3, 16
    s_lshl_b32 s32, s32, 10
    s_cmp_lt_u32 s3, 2
    s_cselect_b32 s32, s32, 0x7fff0000
    v_add_u32 v8, s32, v4
    s_waitcnt vmcnt(45)
    v_mov_b32 v114, 0
    v_mov_b32 v115, 0
    v_mov_b32 v134, 0
    v_mov_b32 v135, 0
    v_mfma_f32_32x32x16_bf16 a[0:15], v[96:99], v[16:19], 0
    v_mfma_f32_32x32x16_bf16 a[0:15], v[100:103], v[20:23], a[0:15]
    v_mfma_f32_32x32x16_bf16 a[0:15], v[104:107], v[24:27], a[0:15]
    v_mfma_f32_32x32x16_bf16 a[0:15], v[108:111], v[28:31], a[0:15]
    v_mfma_f32_32x32x16_bf16 a[0:15], v[112:115], v[32:35], a[0:15]
    v_mfma_f32_32x32x16_bf16 a[16:31], v[116:119], v[16:19], 0
    v_mfma_f32_32x32x16_bf16 a[16:31], v[120:123], v[20:23], a[16:31]
    v_mfma_f32_32x32x16_bf16 a[16:31], v[124:127], v[24:27], a[16:31]
    v_mfma_f32_32x32x16_bf16 a[16:31], v[128:131], v[28:31], a[16:31]
    v_mfma_f32_32x32x16_bf16 a[16:31], v[132:135], v[32:35], a[16:31]
    s_waitcnt vmcnt(30)
    v_mov_b32 v154, 0
    v_mov_b32 v155, 0
    v_mov_b32 v174, 0
    v_mov_b32 v175, 0
    v_mfma_f32_32x32x16_bf16 a[32:47], v[136:139], v[36:39], 0
    v_mfma_f32_32x32x16_bf16 a[32:47], v[140:143], v[40:43], a[32:47]
    v_mfma_f32_32x32x16_bf16 a[32:47], v[144:147], v[44:47], a[32:47]
    v_mfma_f32_32x32x16_bf16 a[32:47], v[148:151], v[48:51], a[32:47]
    v_mfma_f32_32x32x16_bf16 a[32:47], v[152:155], v[52:55], a[32:47]
    v_mfma_f32_32x32x16_bf16 a[48:63], v[156:159], v[36:39], 0
    v_mfma_f32_32x32x16_bf16 a[48:63], v[160:163], v[40:43], a[48:63]
    v_mfma_f32_32x32x16_bf16 a[48:63], v[164:167], v[44:47], a[48:63]
    v_mfma_f32_32x32x16_bf16 a[48:63], v[168:171], v[48:51], a[48:63]
    v_mfma_f32_32x32x16_bf16 a[48:63], v[172:175], v[52:55], a[48:63]
    s_waitcnt vmcnt(15)
    v_mov_b32 v194, 0
    v_mov_b32 v195, 0
    v_mov_b32 v214, 0
    v_mov_b32 v215, 0
    v_mfma_f32_32x32x16_bf16 a[64:79], v[176:179], v[56:59], 0
    v_mfma_f32_32x32x16_bf16 a[64:79], v[180:183], v[60:63], a[64:79]
    v_mfma_f32_32x32x16_bf16 a[64:79], v[184:187], v[64:67], a[64:79]
    v_mfma_f32_32x32x16_bf16 a[64:79], v[188:191], v[68:71], a[64:79]
    v_mfma_f32_32x32x16_bf16 a[64:79], v[192:195], v[72:75], a[64:79]
    v_mfma_f32_32x32x16_bf16 a[80:95], v[196:199], v[56:59], 0
    v_mfma_f32_32x32x16_bf16 a[80:95], v[200:203], v[60:63], a[80:95]
    v_mfma_f32_32x32x16_bf16 a[80:95], v[204:207], v[64:67], a[80:95]
    v_mfma_f32_32x32x16_bf16 a[80:95], v[208:211], v[68:71], a[80:95]
    v_mfma_f32_32x32x16_bf16 a[80:95], v[212:215], v[72:75], a[80:95]
    s_waitcnt vmcnt(0)
    v_mov_b32 v234, 0
    v_mov_b32 v235, 0
    v_mov_b32 v254, 0
    v_mov_b32 v255, 0
    v_mfma_f32_32x32x16_bf16 a[96:111], v[216:219], v[76:79], 0
    v_mfma_f32_32x32x16_bf16 a[96:111], v[220:223], v[80:83], a[96:111]
    v_mfma_f32_32x32x16_bf16 a[96:111], v[224:227], v[84:87], a[96:111]
    v_mfma_f32_32x32x16_bf16 a[96:111], v[228:231], v[88:91], a[96:111]
    v_mfma_f32_32x32x16_bf16 a[96:111], v[232:235], v[92:95], a[96:111]
    v_mfma_f32_32x32x16_bf16 a[112:127], v[236:239], v[76:79], 0
    v_mfma_f32_32x32x16_bf16 a[112:127], v[240:243], v[80:83], a[112:127]
    v_mfma_f32_32x32x16_bf16 a[112:127], v[244:247], v[84:87], a[112:127]
    v_mfma_f32_32x32x16_bf16 a[112:127], v[248:251], v[88:91], a[112:127]
    v_mfma_f32_32x32x16_bf16 a[112:127], v[252:255], v[92:95], a[112:127]
    s_mov_b32 s40, 66060288
    s_nop 7
    buffer_load_dwordx4 v[56:59], v11, s[20:23], s40 offen
    buffer_load_dwordx4 v[60:63], v12, s[20:23], s40 offen
    buffer_load_dwordx4 v[64:67], v13, s[20:23], s40 offen
    buffer_load_dwordx4 v[68:71], v7, s[20:23], s40 offen
    buffer_load_dwordx4 v[72:75], v8, s[20:23], s40 offen
    s_add_u32 s40, s40, 18432
    buffer_load_dwordx4 v[76:79], v11, s[20:23], s40 offen
    buffer_load_dwordx4 v[80:83], v12, s[20:23], s40 offen
    buffer_load_dwordx4 v[84:87], v13, s[20:23], s40 offen
    buffer_load_dwordx4 v[88:91], v7, s[20:23], s40 offen
    buffer_load_dwordx4 v[92:95], v8, s[20:23], s40 offen
    s_add_u32 s40, s40, 18432
    buffer_load_dwordx4 v[96:99], v11, s[20:23], s40 offen
    buffer_load_dwordx4 v[100:103], v12, s[20:23], s40 offen
    buffer_load_dwordx4 v[104:107], v13, s[20:23], s40 offen
    buffer_load_dwordx4 v[108:111], v7, s[20:23], s40 offen
    buffer_load_dwordx4 v[112:115], v8, s[20:23], s40 offen
    s_add_u32 s40, s40, 18432
    buffer_load_dwordx4 v[116:119], v11, s[20:23], s40 offen
    buffer_load_dwordx4 v[120:123], v12, s[20:23], s40 offen
    buffer_load_dwordx4 v[124:127], v13, s[20:23], s40 offen
    buffer_load_dwordx4 v[128:131], v7, s[20:23], s40 offen
    buffer_load_dwordx4 v[132:135], v8, s[20:23], s40 offen
    s_add_u32 s40, s40, 18432
    buffer_load_dwordx4 v[136:139], v11, s[20:23], s40 offen
    buffer_load_dwordx4 v[140:143], v12, s[20:23], s40 offen
    buffer_load_dwordx4 v[144:147], v13, s[20:23], s40 offen
    buffer_load_dwordx4 v[148:151], v7, s[20:23], s40 offen
    buffer_load_dwordx4 v[152:155], v8, s[20:23], s40 offen
    s_add_u32 s40, s40, 18432
    buffer_load_dwordx4 v[156:159], v11, s[20:23], s40 offen
    buffer_load_dwordx4 v[160:163], v12, s[20:23], s40 offen
    buffer_load_dwordx4 v[164:167], v13, s[20:23], s40 offen
    buffer_load_dwordx4 v[168:171], v7, s[20:23], s40 offen
    buffer_load_dwordx4 v[172:175], v8, s[20:23], s40 offen
    s_add_u32 s40, s40, 18432
    buffer_load_dwordx4 v[176:179], v11, s[20:23], s40 offen
    buffer_load_dwordx4 v[180:183], v12, s[20:23], s40 offen
    buffer_load_dwordx4 v[184:187], v13, s[20:23], s40 offen
    buffer_load_dwordx4 v[188:191], v7, s[20:23], s40 offen
    buffer_load_dwordx4 v[192:195], v8, s[20:23], s40 offen
    s_add_u32 s40, s40, 18432
    buffer_load_dwordx4 v[196:199], v11, s[20:23], s40 offen
    buffer_load_dwordx4 v[200:203], v12, s[20:23], s40 offen
    buffer_load_dwordx4 v[204:207], v13, s[20:23], s40 offen
    buffer_load_dwordx4 v[208:211], v7, s[20:23], s40 offen
    buffer_load_dwordx4 v[212:215], v8, s[20:23], s40 offen
    s_add_u32 s40, s40, 18432
    buffer_load_dwordx4 v[216:219], v11, s[20:23], s40 offen
    buffer_load_dwordx4 v[220:223], v12, s[20:23], s40 offen
    buffer_load_dwordx4 v[224:227], v13, s[20:23], s40 offen
    buffer_load_dwordx4 v[228:231], v7, s[20:23], s40 offen
    buffer_load_dwordx4 v[232:235], v8, s[20:23], s40 offen
    s_add_u32 s40, s40, 18432
    v_accvgpr_read_b32 v52, a18
    s_nop 0
    v_add_f32 v52, 0x358637bd, v52
    v_rcp_f32 v52, v52
    v_accvgpr_read_b32 v53, a0
    v_accvgpr_read_b32 v54, a1
    v_mul_f32 v53, v52, v53
    v_mul_f32 v54, v52, v54
    v_cvt_pk_bf16_f32 v16, v53, v54
    v_accvgpr_read_b32 v53, a2
    v_accvgpr_read_b32 v54, a3
    v_mul_f32 v53, v52, v53
    v_mul_f32 v54, v52, v54
    v_cvt_pk_bf16_f32 v17, v53, v54
    v_accvgpr_read_b32 v53, a4
    v_accvgpr_read_b32 v54, a5
    v_mul_f32 v53, v52, v53
    v_mul_f32 v54, v52, v54
    v_cvt_pk_bf16_f32 v18, v53, v54
    v_accvgpr_read_b32 v53, a6
    v_accvgpr_read_b32 v54, a7
    v_mul_f32 v53, v52, v53
    v_mul_f32 v54, v52, v54
    v_cvt_pk_bf16_f32 v19, v53, v54
    v_accvgpr_read_b32 v53, a8
    v_accvgpr_read_b32 v54, a9
    v_mul_f32 v53, v52, v53
    v_mul_f32 v54, v52, v54
    v_cvt_pk_bf16_f32 v20, v53, v54
    v_accvgpr_read_b32 v53, a10
    v_accvgpr_read_b32 v54, a11
    v_mul_f32 v53, v52, v53
    v_mul_f32 v54, v52, v54
    v_cvt_pk_bf16_f32 v21, v53, v54
    v_accvgpr_read_b32 v53, a12
    v_accvgpr_read_b32 v54, a13
    v_mul_f32 v53, v52, v53
    v_mul_f32 v54, v52, v54
    v_cvt_pk_bf16_f32 v22, v53, v54
    v_accvgpr_read_b32 v53, a14
    v_accvgpr_read_b32 v54, a15
    v_mul_f32 v53, v52, v53
    v_mul_f32 v54, v52, v54
    v_cvt_pk_bf16_f32 v23, v53, v54
    v_accvgpr_read_b32 v53, a16
    v_accvgpr_read_b32 v54, a17
    v_mul_f32 v53, v52, v53
    v_mul_f32 v54, v52, v54
    v_cvt_pk_bf16_f32 v24, v53, v54
    v_accvgpr_read_b32 v52, a50
    s_nop 0
    v_add_f32 v52, 0x358637bd, v52
    v_rcp_f32 v52, v52
    v_accvgpr_read_b32 v53, a32
    v_accvgpr_read_b32 v54, a33
    v_mul_f32 v53, v52, v53
    v_mul_f32 v54, v52, v54
    v_cvt_pk_bf16_f32 v25, v53, v54
    v_accvgpr_read_b32 v53, a34
    v_accvgpr_read_b32 v54, a35
    v_mul_f32 v53, v52, v53
    v_mul_f32 v54, v52, v54
    v_cvt_pk_bf16_f32 v26, v53, v54
    v_accvgpr_read_b32 v53, a36
    v_accvgpr_read_b32 v54, a37
    v_mul_f32 v53, v52, v53
    v_mul_f32 v54, v52, v54
    v_cvt_pk_bf16_f32 v27, v53, v54
    v_accvgpr_read_b32 v53, a38
    v_accvgpr_read_b32 v54, a39
    v_mul_f32 v53, v52, v53
    v_mul_f32 v54, v52, v54
    v_cvt_pk_bf16_f32 v28, v53, v54
    v_accvgpr_read_b32 v53, a40
    v_accvgpr_read_b32 v54, a41
    v_mul_f32 v53, v52, v53
    v_mul_f32 v54, v52, v54
    v_cvt_pk_bf16_f32 v29, v53, v54
    v_accvgpr_read_b32 v53, a42
    v_accvgpr_read_b32 v54, a43
    v_mul_f32 v53, v52, v53
    v_mul_f32 v54, v52, v54
    v_cvt_pk_bf16_f32 v30, v53, v54
    v_accvgpr_read_b32 v53, a44
    v_accvgpr_read_b32 v54, a45
    v_mul_f32 v53, v52, v53
    v_mul_f32 v54, v52, v54
    v_cvt_pk_bf16_f32 v31, v53, v54
    v_accvgpr_read_b32 v53, a46
    v_accvgpr_read_b32 v54, a47
    v_mul_f32 v53, v52, v53
    v_mul_f32 v54, v52, v54
    v_cvt_pk_bf16_f32 v32, v53, v54
    v_accvgpr_read_b32 v53, a48
    v_accvgpr_read_b32 v54, a49
    v_mul_f32 v53, v52, v53
    v_mul_f32 v54, v52, v54
    v_cvt_pk_bf16_f32 v33, v53, v54
    v_accvgpr_read_b32 v52, a82
    s_nop 0
    v_add_f32 v52, 0x358637bd, v52
    v_rcp_f32 v52, v52
    v_accvgpr_read_b32 v53, a64
    v_accvgpr_read_b32 v54, a65
    v_mul_f32 v53, v52, v53
    v_mul_f32 v54, v52, v54
    v_cvt_pk_bf16_f32 v34, v53, v54
    v_accvgpr_read_b32 v53, a66
    v_accvgpr_read_b32 v54, a67
    v_mul_f32 v53, v52, v53
    v_mul_f32 v54, v52, v54
    v_cvt_pk_bf16_f32 v35, v53, v54
    v_accvgpr_read_b32 v53, a68
    v_accvgpr_read_b32 v54, a69
    v_mul_f32 v53, v52, v53
    v_mul_f32 v54, v52, v54
    v_cvt_pk_bf16_f32 v36, v53, v54
    v_accvgpr_read_b32 v53, a70
    v_accvgpr_read_b32 v54, a71
    v_mul_f32 v53, v52, v53
    v_mul_f32 v54, v52, v54
    v_cvt_pk_bf16_f32 v37, v53, v54
    v_accvgpr_read_b32 v53, a72
    v_accvgpr_read_b32 v54, a73
    v_mul_f32 v53, v52, v53
    v_mul_f32 v54, v52, v54
    v_cvt_pk_bf16_f32 v38, v53, v54
    v_accvgpr_read_b32 v53, a74
    v_accvgpr_read_b32 v54, a75
    v_mul_f32 v53, v52, v53
    v_mul_f32 v54, v52, v54
    v_cvt_pk_bf16_f32 v39, v53, v54
    v_accvgpr_read_b32 v53, a76
    v_accvgpr_read_b32 v54, a77
    v_mul_f32 v53, v52, v53
    v_mul_f32 v54, v52, v54
    v_cvt_pk_bf16_f32 v40, v53, v54
    v_accvgpr_read_b32 v53, a78
    v_accvgpr_read_b32 v54, a79
    v_mul_f32 v53, v52, v53
    v_mul_f32 v54, v52, v54
    v_cvt_pk_bf16_f32 v41, v53, v54
    v_accvgpr_read_b32 v53, a80
    v_accvgpr_read_b32 v54, a81
    v_mul_f32 v53, v52, v53
    v_mul_f32 v54, v52, v54
    v_cvt_pk_bf16_f32 v42, v53, v54
    v_accvgpr_read_b32 v52, a114
    s_nop 0
    v_add_f32 v52, 0x358637bd, v52
    v_rcp_f32 v52, v52
    v_accvgpr_read_b32 v53, a96
    v_accvgpr_read_b32 v54, a97
    v_mul_f32 v53, v52, v53
    v_mul_f32 v54, v52, v54
    v_cvt_pk_bf16_f32 v43, v53, v54
    v_accvgpr_read_b32 v53, a98
    v_accvgpr_read_b32 v54, a99
    v_mul_f32 v53, v52, v53
    v_mul_f32 v54, v52, v54
    v_cvt_pk_bf16_f32 v44, v53, v54
    v_accvgpr_read_b32 v53, a100
    v_accvgpr_read_b32 v54, a101
    v_mul_f32 v53, v52, v53
    v_mul_f32 v54, v52, v54
    v_cvt_pk_bf16_f32 v45, v53, v54
    v_accvgpr_read_b32 v53, a102
    v_accvgpr_read_b32 v54, a103
    v_mul_f32 v53, v52, v53
    v_mul_f32 v54, v52, v54
    v_cvt_pk_bf16_f32 v46, v53, v54
    v_accvgpr_read_b32 v53, a104
    v_accvgpr_read_b32 v54, a105
    v_mul_f32 v53, v52, v53
    v_mul_f32 v54, v52, v54
    v_cvt_pk_bf16_f32 v47, v53, v54
    v_accvgpr_read_b32 v53, a106
    v_accvgpr_read_b32 v54, a107
    v_mul_f32 v53, v52, v53
    v_mul_f32 v54, v52, v54
    v_cvt_pk_bf16_f32 v48, v53, v54
    v_accvgpr_read_b32 v53, a108
    v_accvgpr_read_b32 v54, a109
    v_mul_f32 v53, v52, v53
    v_mul_f32 v54, v52, v54
    v_cvt_pk_bf16_f32 v49, v53, v54
    v_accvgpr_read_b32 v53, a110
    v_accvgpr_read_b32 v54, a111
    v_mul_f32 v53, v52, v53
    v_mul_f32 v54, v52, v54
    v_cvt_pk_bf16_f32 v50, v53, v54
    v_accvgpr_read_b32 v53, a112
    v_accvgpr_read_b32 v54, a113
    v_mul_f32 v53, v52, v53
    v_mul_f32 v54, v52, v54
    v_cvt_pk_bf16_f32 v51, v53, v54
    s_mul_i32 s32, s3, 9216
    v_add_u32 v5, s32, v4
    ds_write_b128 v5, v[16:19] offset:0
    ds_write_b128 v5, v[20:23] offset:1024
    ds_write_b128 v5, v[24:27] offset:2048
    ds_write_b128 v5, v[28:31] offset:3072
    ds_write_b128 v5, v[32:35] offset:4096
    ds_write_b128 v5, v[36:39] offset:5120
    ds_write_b128 v5, v[40:43] offset:6144
    ds_write_b128 v5, v[44:47] offset:7168
    ds_write_b128 v5, v[48:51] offset:8192
    s_waitcnt lgkmcnt(0)
    s_barrier
    ds_read_b128 v[16:19], v4 offset:0
    ds_read_b128 v[20:23], v4 offset:1024
    ds_read_b128 v[24:27], v4 offset:2048
    ds_read_b128 v[28:31], v4 offset:3072
    ds_read_b128 v[32:35], v4 offset:4096
    ds_read_b128 v[36:39], v4 offset:5120
    s_waitcnt vmcnt(40) lgkmcnt(5)
    v_mfma_f32_32x32x16_bf16 a[128:143], v[56:59], v[16:19], 0
    buffer_load_dwordx4 v[236:239], v11, s[20:23], s40 offen
    ds_read_b128 v[40:43], v4 offset:6144
    v_mfma_f32_32x32x16_bf16 a[144:159], v[60:63], v[16:19], 0
    buffer_load_dwordx4 v[240:243], v12, s[20:23], s40 offen
    v_mfma_f32_32x32x16_bf16 a[160:175], v[64:67], v[16:19], 0
    buffer_load_dwordx4 v[244:247], v13, s[20:23], s40 offen
    v_mfma_f32_32x32x16_bf16 a[176:191], v[68:71], v[16:19], 0
    buffer_load_dwordx4 v[248:251], v7, s[20:23], s40 offen
    v_mfma_f32_32x32x16_bf16 a[192:207], v[72:75], v[16:19], 0
    buffer_load_dwordx4 v[252:255], v8, s[20:23], s40 offen
    s_add_u32 s40, s40, 18432
    s_waitcnt vmcnt(40) lgkmcnt(5)
    v_mfma_f32_32x32x16_bf16 a[128:143], v[76:79], v[20:23], a[128:143]
    buffer_load_dwordx4 v[56:59], v11, s[20:23], s40 offen
    ds_read_b128 v[44:47], v4 offset:7168
    v_mfma_f32_32x32x16_bf16 a[144:159], v[80:83], v[20:23], a[144:159]
    buffer_load_dwordx4 v[60:63], v12, s[20:23], s40 offen
    v_mfma_f32_32x32x16_bf16 a[160:175], v[84:87], v[20:23], a[160:175]
    buffer_load_dwordx4 v[64:67], v13, s[20:23], s40 offen
    v_mfma_f32_32x32x16_bf16 a[176:191], v[88:91], v[20:23], a[176:191]
    buffer_load_dwordx4 v[68:71], v7, s[20:23], s40 offen
    v_mfma_f32_32x32x16_bf16 a[192:207], v[92:95], v[20:23], a[192:207]
    buffer_load_dwordx4 v[72:75], v8, s[20:23], s40 offen
    s_add_u32 s40, s40, 18432
    s_waitcnt vmcnt(40) lgkmcnt(5)
    v_mfma_f32_32x32x16_bf16 a[128:143], v[96:99], v[24:27], a[128:143]
    buffer_load_dwordx4 v[76:79], v11, s[20:23], s40 offen
    ds_read_b128 v[16:19], v4 offset:8192
    v_mfma_f32_32x32x16_bf16 a[144:159], v[100:103], v[24:27], a[144:159]
    buffer_load_dwordx4 v[80:83], v12, s[20:23], s40 offen
    v_mfma_f32_32x32x16_bf16 a[160:175], v[104:107], v[24:27], a[160:175]
    buffer_load_dwordx4 v[84:87], v13, s[20:23], s40 offen
    v_mfma_f32_32x32x16_bf16 a[176:191], v[108:111], v[24:27], a[176:191]
    buffer_load_dwordx4 v[88:91], v7, s[20:23], s40 offen
    v_mfma_f32_32x32x16_bf16 a[192:207], v[112:115], v[24:27], a[192:207]
    buffer_load_dwordx4 v[92:95], v8, s[20:23], s40 offen
    s_add_u32 s40, s40, 18432
    s_waitcnt vmcnt(40) lgkmcnt(5)
    v_mfma_f32_32x32x16_bf16 a[128:143], v[116:119], v[28:31], a[128:143]
    buffer_load_dwordx4 v[96:99], v11, s[20:23], s40 offen
    ds_read_b128 v[20:23], v4 offset:9216
    v_mfma_f32_32x32x16_bf16 a[144:159], v[120:123], v[28:31], a[144:159]
    buffer_load_dwordx4 v[100:103], v12, s[20:23], s40 offen
    v_mfma_f32_32x32x16_bf16 a[160:175], v[124:127], v[28:31], a[160:175]
    buffer_load_dwordx4 v[104:107], v13, s[20:23], s40 offen
    v_mfma_f32_32x32x16_bf16 a[176:191], v[128:131], v[28:31], a[176:191]
    buffer_load_dwordx4 v[108:111], v7, s[20:23], s40 offen
    v_mfma_f32_32x32x16_bf16 a[192:207], v[132:135], v[28:31], a[192:207]
    buffer_load_dwordx4 v[112:115], v8, s[20:23], s40 offen
    s_add_u32 s40, s40, 18432
    s_waitcnt vmcnt(40) lgkmcnt(5)
    v_mfma_f32_32x32x16_bf16 a[128:143], v[136:139], v[32:35], a[128:143]
    buffer_load_dwordx4 v[116:119], v11, s[20:23], s40 offen
    ds_read_b128 v[24:27], v4 offset:10240
    v_mfma_f32_32x32x16_bf16 a[144:159], v[140:143], v[32:35], a[144:159]
    buffer_load_dwordx4 v[120:123], v12, s[20:23], s40 offen
    v_mfma_f32_32x32x16_bf16 a[160:175], v[144:147], v[32:35], a[160:175]
    buffer_load_dwordx4 v[124:127], v13, s[20:23], s40 offen
    v_mfma_f32_32x32x16_bf16 a[176:191], v[148:151], v[32:35], a[176:191]
    buffer_load_dwordx4 v[128:131], v7, s[20:23], s40 offen
    v_mfma_f32_32x32x16_bf16 a[192:207], v[152:155], v[32:35], a[192:207]
    buffer_load_dwordx4 v[132:135], v8, s[20:23], s40 offen
    s_add_u32 s40, s40, 18432
    s_waitcnt vmcnt(40) lgkmcnt(5)
    v_mfma_f32_32x32x16_bf16 a[128:143], v[156:159], v[36:39], a[128:143]
    buffer_load_dwordx4 v[136:139], v11, s[20:23], s40 offen
    ds_read_b128 v[28:31], v4 offset:11264
    v_mfma_f32_32x32x16_bf16 a[144:159], v[160:163], v[36:39], a[144:159]
    buffer_load_dwordx4 v[140:143], v12, s[20:23], s40 offen
    v_mfma_f32_32x32x16_bf16 a[160:175], v[164:167], v[36:39], a[160:175]
    buffer_load_dwordx4 v[144:147], v13, s[20:23], s40 offen
    v_mfma_f32_32x32x16_bf16 a[176:191], v[168:171], v[36:39], a[176:191]
    buffer_load_dwordx4 v[148:151], v7, s[20:23], s40 offen
    v_mfma_f32_32x32x16_bf16 a[192:207], v[172:175], v[36:39], a[192:207]
    buffer_load_dwordx4 v[152:155], v8, s[20:23], s40 offen
    s_add_u32 s40, s40, 18432
    s_waitcnt vmcnt(40) lgkmcnt(5)
    v_mfma_f32_32x32x16_bf16 a[128:143], v[176:179], v[40:43], a[128:143]
    buffer_load_dwordx4 v[156:159], v11, s[20:23], s40 offen
    ds_read_b128 v[32:35], v4 offset:12288
    v_mfma_f32_32x32x16_bf16 a[144:159], v[180:183], v[40:43], a[144:159]
    buffer_load_dwordx4 v[160:163], v12, s[20:23], s40 offen
    v_mfma_f32_32x32x16_bf16 a[160:175], v[184:187], v[40:43], a[160:175]
    buffer_load_dwordx4 v[164:167], v13, s[20:23], s40 offen
    v_mfma_f32_32x32x16_bf16 a[176:191], v[188:191], v[40:43], a[176:191]
    buffer_load_dwordx4 v[168:171], v7, s[20:23], s40 offen
    v_mfma_f32_32x32x16_bf16 a[192:207], v[192:195], v[40:43], a[192:207]
    buffer_load_dwordx4 v[172:175], v8, s[20:23], s40 offen
    s_add_u32 s40, s40, 18432
    s_waitcnt vmcnt(40) lgkmcnt(5)
    v_mfma_f32_32x32x16_bf16 a[128:143], v[196:199], v[44:47], a[128:143]
    buffer_load_dwordx4 v[176:179], v11, s[20:23], s40 offen
    ds_read_b128 v[36:39], v4 offset:13312
    v_mfma_f32_32x32x16_bf16 a[144:159], v[200:203], v[44:47], a[144:159]
    buffer_load_dwordx4 v[180:183], v12, s[20:23], s40 offen
    v_mfma_f32_32x32x16_bf16 a[160:175], v[204:207], v[44:47], a[160:175]
    buffer_load_dwordx4 v[184:187], v13, s[20:23], s40 offen
    v_mfma_f32_32x32x16_bf16 a[176:191], v[208:211], v[44:47], a[176:191]
    buffer_load_dwordx4 v[188:191], v7, s[20:23], s40 offen
    v_mfma_f32_32x32x16_bf16 a[192:207], v[212:215], v[44:47], a[192:207]
    buffer_load_dwordx4 v[192:195], v8, s[20:23], s40 offen
    s_add_u32 s40, s40, 18432
    s_waitcnt vmcnt(40) lgkmcnt(5)
    v_mfma_f32_32x32x16_bf16 a[128:143], v[216:219], v[16:19], a[128:143]
    buffer_load_dwordx4 v[196:199], v11, s[20:23], s40 offen
    ds_read_b128 v[40:43], v4 offset:14336
    v_mfma_f32_32x32x16_bf16 a[144:159], v[220:223], v[16:19], a[144:159]
    buffer_load_dwordx4 v[200:203], v12, s[20:23], s40 offen
    v_mfma_f32_32x32x16_bf16 a[160:175], v[224:227], v[16:19], a[160:175]
    buffer_load_dwordx4 v[204:207], v13, s[20:23], s40 offen
    v_mfma_f32_32x32x16_bf16 a[176:191], v[228:231], v[16:19], a[176:191]
    buffer_load_dwordx4 v[208:211], v7, s[20:23], s40 offen
    v_mfma_f32_32x32x16_bf16 a[192:207], v[232:235], v[16:19], a[192:207]
    buffer_load_dwordx4 v[212:215], v8, s[20:23], s40 offen
    s_add_u32 s40, s40, 18432
    s_waitcnt vmcnt(40) lgkmcnt(5)
    v_mfma_f32_32x32x16_bf16 a[128:143], v[236:239], v[20:23], a[128:143]
    buffer_load_dwordx4 v[216:219], v11, s[20:23], s40 offen
    ds_read_b128 v[44:47], v4 offset:15360
    v_mfma_f32_32x32x16_bf16 a[144:159], v[240:243], v[20:23], a[144:159]
    buffer_load_dwordx4 v[220:223], v12, s[20:23], s40 offen
    v_mfma_f32_32x32x16_bf16 a[160:175], v[244:247], v[20:23], a[160:175]
    buffer_load_dwordx4 v[224:227], v13, s[20:23], s40 offen
    v_mfma_f32_32x32x16_bf16 a[176:191], v[248:251], v[20:23], a[176:191]
    buffer_load_dwordx4 v[228:231], v7, s[20:23], s40 offen
    v_mfma_f32_32x32x16_bf16 a[192:207], v[252:255], v[20:23], a[192:207]
    buffer_load_dwordx4 v[232:235], v8, s[20:23], s40 offen
    s_add_u32 s40, s40, 18432
    s_waitcnt vmcnt(40) lgkmcnt(5)
    v_mfma_f32_32x32x16_bf16 a[128:143], v[56:59], v[24:27], a[128:143]
    buffer_load_dwordx4 v[236:239], v11, s[20:23], s40 offen
    ds_read_b128 v[16:19], v4 offset:16384
    v_mfma_f32_32x32x16_bf16 a[144:159], v[60:63], v[24:27], a[144:159]
    buffer_load_dwordx4 v[240:243], v12, s[20:23], s40 offen
    v_mfma_f32_32x32x16_bf16 a[160:175], v[64:67], v[24:27], a[160:175]
    buffer_load_dwordx4 v[244:247], v13, s[20:23], s40 offen
    v_mfma_f32_32x32x16_bf16 a[176:191], v[68:71], v[24:27], a[176:191]
    buffer_load_dwordx4 v[248:251], v7, s[20:23], s40 offen
    v_mfma_f32_32x32x16_bf16 a[192:207], v[72:75], v[24:27], a[192:207]
    buffer_load_dwordx4 v[252:255], v8, s[20:23], s40 offen
    s_add_u32 s40, s40, 18432
    s_waitcnt vmcnt(40) lgkmcnt(5)
    v_mfma_f32_32x32x16_bf16 a[128:143], v[76:79], v[28:31], a[128:143]
    buffer_load_dwordx4 v[56:59], v11, s[20:23], s40 offen
    ds_read_b128 v[20:23], v4 offset:17408
    v_mfma_f32_32x32x16_bf16 a[144:159], v[80:83], v[28:31], a[144:159]
    buffer_load_dwordx4 v[60:63], v12, s[20:23], s40 offen
    v_mfma_f32_32x32x16_bf16 a[160:175], v[84:87], v[28:31], a[160:175]
    buffer_load_dwordx4 v[64:67], v13, s[20:23], s40 offen
    v_mfma_f32_32x32x16_bf16 a[176:191], v[88:91], v[28:31], a[176:191]
    buffer_load_dwordx4 v[68:71], v7, s[20:23], s40 offen
    v_mfma_f32_32x32x16_bf16 a[192:207], v[92:95], v[28:31], a[192:207]
    buffer_load_dwordx4 v[72:75], v8, s[20:23], s40 offen
    s_add_u32 s40, s40, 18432
    s_waitcnt vmcnt(40) lgkmcnt(5)
    v_mfma_f32_32x32x16_bf16 a[128:143], v[96:99], v[32:35], a[128:143]
    buffer_load_dwordx4 v[76:79], v11, s[20:23], s40 offen
    ds_read_b128 v[24:27], v4 offset:18432
    v_mfma_f32_32x32x16_bf16 a[144:159], v[100:103], v[32:35], a[144:159]
    buffer_load_dwordx4 v[80:83], v12, s[20:23], s40 offen
    v_mfma_f32_32x32x16_bf16 a[160:175], v[104:107], v[32:35], a[160:175]
    buffer_load_dwordx4 v[84:87], v13, s[20:23], s40 offen
    v_mfma_f32_32x32x16_bf16 a[176:191], v[108:111], v[32:35], a[176:191]
    buffer_load_dwordx4 v[88:91], v7, s[20:23], s40 offen
    v_mfma_f32_32x32x16_bf16 a[192:207], v[112:115], v[32:35], a[192:207]
    buffer_load_dwordx4 v[92:95], v8, s[20:23], s40 offen
    s_add_u32 s40, s40, 18432
    s_waitcnt vmcnt(40) lgkmcnt(5)
    v_mfma_f32_32x32x16_bf16 a[128:143], v[116:119], v[36:39], a[128:143]
    buffer_load_dwordx4 v[96:99], v11, s[20:23], s40 offen
    ds_read_b128 v[28:31], v4 offset:19456
    v_mfma_f32_32x32x16_bf16 a[144:159], v[120:123], v[36:39], a[144:159]
    buffer_load_dwordx4 v[100:103], v12, s[20:23], s40 offen
    v_mfma_f32_32x32x16_bf16 a[160:175], v[124:127], v[36:39], a[160:175]
    buffer_load_dwordx4 v[104:107], v13, s[20:23], s40 offen
    v_mfma_f32_32x32x16_bf16 a[176:191], v[128:131], v[36:39], a[176:191]
    buffer_load_dwordx4 v[108:111], v7, s[20:23], s40 offen
    v_mfma_f32_32x32x16_bf16 a[192:207], v[132:135], v[36:39], a[192:207]
    buffer_load_dwordx4 v[112:115], v8, s[20:23], s40 offen
    s_add_u32 s40, s40, 18432
    s_waitcnt vmcnt(40) lgkmcnt(5)
    v_mfma_f32_32x32x16_bf16 a[128:143], v[136:139], v[40:43], a[128:143]
    buffer_load_dwordx4 v[116:119], v11, s[20:23], s40 offen
    ds_read_b128 v[32:35], v4 offset:20480
    v_mfma_f32_32x32x16_bf16 a[144:159], v[140:143], v[40:43], a[144:159]
    buffer_load_dwordx4 v[120:123], v12, s[20:23], s40 offen
    v_mfma_f32_32x32x16_bf16 a[160:175], v[144:147], v[40:43], a[160:175]
    buffer_load_dwordx4 v[124:127], v13, s[20:23], s40 offen
    v_mfma_f32_32x32x16_bf16 a[176:191], v[148:151], v[40:43], a[176:191]
    buffer_load_dwordx4 v[128:131], v7, s[20:23], s40 offen
    v_mfma_f32_32x32x16_bf16 a[192:207], v[152:155], v[40:43], a[192:207]
    buffer_load_dwordx4 v[132:135], v8, s[20:23], s40 offen
    s_add_u32 s40, s40, 18432
    s_waitcnt vmcnt(40) lgkmcnt(5)
    v_mfma_f32_32x32x16_bf16 a[128:143], v[156:159], v[44:47], a[128:143]
    buffer_load_dwordx4 v[136:139], v11, s[20:23], s40 offen
    ds_read_b128 v[36:39], v4 offset:21504
    v_mfma_f32_32x32x16_bf16 a[144:159], v[160:163], v[44:47], a[144:159]
    buffer_load_dwordx4 v[140:143], v12, s[20:23], s40 offen
    v_mfma_f32_32x32x16_bf16 a[160:175], v[164:167], v[44:47], a[160:175]
    buffer_load_dwordx4 v[144:147], v13, s[20:23], s40 offen
    v_mfma_f32_32x32x16_bf16 a[176:191], v[168:171], v[44:47], a[176:191]
    buffer_load_dwordx4 v[148:151], v7, s[20:23], s40 offen
    v_mfma_f32_32x32x16_bf16 a[192:207], v[172:175], v[44:47], a[192:207]
    buffer_load_dwordx4 v[152:155], v8, s[20:23], s40 offen
    s_add_u32 s40, s40, 18432
    s_waitcnt vmcnt(40) lgkmcnt(5)
    v_mfma_f32_32x32x16_bf16 a[128:143], v[176:179], v[16:19], a[128:143]
    buffer_load_dwordx4 v[156:159], v11, s[20:23], s40 offen
    ds_read_b128 v[40:43], v4 offset:22528
    v_mfma_f32_32x32x16_bf16 a[144:159], v[180:183], v[16:19], a[144:159]
    buffer_load_dwordx4 v[160:163], v12, s[20:23], s40 offen
    v_mfma_f32_32x32x16_bf16 a[160:175], v[184:187], v[16:19], a[160:175]
    buffer_load_dwordx4 v[164:167], v13, s[20:23], s40 offen
    v_mfma_f32_32x32x16_bf16 a[176:191], v[188:191], v[16:19], a[176:191]
    buffer_load_dwordx4 v[168:171], v7, s[20:23], s40 offen
    v_mfma_f32_32x32x16_bf16 a[192:207], v[192:195], v[16:19], a[192:207]
    buffer_load_dwordx4 v[172:175], v8, s[20:23], s40 offen
    s_add_u32 s40, s40, 18432
    s_waitcnt vmcnt(40) lgkmcnt(5)
    v_mfma_f32_32x32x16_bf16 a[128:143], v[196:199], v[20:23], a[128:143]
    buffer_load_dwordx4 v[176:179], v11, s[20:23], s40 offen
    ds_read_b128 v[44:47], v4 offset:23552
    v_mfma_f32_32x32x16_bf16 a[144:159], v[200:203], v[20:23], a[144:159]
    buffer_load_dwordx4 v[180:183], v12, s[20:23], s40 offen
    v_mfma_f32_32x32x16_bf16 a[160:175], v[204:207], v[20:23], a[160:175]
    buffer_load_dwordx4 v[184:187], v13, s[20:23], s40 offen
    v_mfma_f32_32x32x16_bf16 a[176:191], v[208:211], v[20:23], a[176:191]
    buffer_load_dwordx4 v[188:191], v7, s[20:23], s40 offen
    v_mfma_f32_32x32x16_bf16 a[192:207], v[212:215], v[20:23], a[192:207]
    buffer_load_dwordx4 v[192:195], v8, s[20:23], s40 offen
    s_add_u32 s40, s40, 18432
    s_waitcnt vmcnt(40) lgkmcnt(5)
    v_mfma_f32_32x32x16_bf16 a[128:143], v[216:219], v[24:27], a[128:143]
    buffer_load_dwordx4 v[196:199], v11, s[20:23], s40 offen
    ds_read_b128 v[16:19], v4 offset:24576
    v_mfma_f32_32x32x16_bf16 a[144:159], v[220:223], v[24:27], a[144:159]
    buffer_load_dwordx4 v[200:203], v12, s[20:23], s40 offen
    v_mfma_f32_32x32x16_bf16 a[160:175], v[224:227], v[24:27], a[160:175]
    buffer_load_dwordx4 v[204:207], v13, s[20:23], s40 offen
    v_mfma_f32_32x32x16_bf16 a[176:191], v[228:231], v[24:27], a[176:191]
    buffer_load_dwordx4 v[208:211], v7, s[20:23], s40 offen
    v_mfma_f32_32x32x16_bf16 a[192:207], v[232:235], v[24:27], a[192:207]
    buffer_load_dwordx4 v[212:215], v8, s[20:23], s40 offen
    s_add_u32 s40, s40, 18432
    s_waitcnt vmcnt(40) lgkmcnt(5)
    v_mfma_f32_32x32x16_bf16 a[128:143], v[236:239], v[28:31], a[128:143]
    buffer_load_dwordx4 v[216:219], v11, s[20:23], s40 offen
    ds_read_b128 v[20:23], v4 offset:25600
    v_mfma_f32_32x32x16_bf16 a[144:159], v[240:243], v[28:31], a[144:159]
    buffer_load_dwordx4 v[220:223], v12, s[20:23], s40 offen
    v_mfma_f32_32x32x16_bf16 a[160:175], v[244:247], v[28:31], a[160:175]
    buffer_load_dwordx4 v[224:227], v13, s[20:23], s40 offen
    v_mfma_f32_32x32x16_bf16 a[176:191], v[248:251], v[28:31], a[176:191]
    buffer_load_dwordx4 v[228:231], v7, s[20:23], s40 offen
    v_mfma_f32_32x32x16_bf16 a[192:207], v[252:255], v[28:31], a[192:207]
    buffer_load_dwordx4 v[232:235], v8, s[20:23], s40 offen
    s_add_u32 s40, s40, 18432
    s_waitcnt vmcnt(40) lgkmcnt(5)
    v_mfma_f32_32x32x16_bf16 a[128:143], v[56:59], v[32:35], a[128:143]
    buffer_load_dwordx4 v[236:239], v11, s[20:23], s40 offen
    ds_read_b128 v[24:27], v4 offset:26624
    v_mfma_f32_32x32x16_bf16 a[144:159], v[60:63], v[32:35], a[144:159]
    buffer_load_dwordx4 v[240:243], v12, s[20:23], s40 offen
    v_mfma_f32_32x32x16_bf16 a[160:175], v[64:67], v[32:35], a[160:175]
    buffer_load_dwordx4 v[244:247], v13, s[20:23], s40 offen
    v_mfma_f32_32x32x16_bf16 a[176:191], v[68:71], v[32:35], a[176:191]
    buffer_load_dwordx4 v[248:251], v7, s[20:23], s40 offen
    v_mfma_f32_32x32x16_bf16 a[192:207], v[72:75], v[32:35], a[192:207]
    buffer_load_dwordx4 v[252:255], v8, s[20:23], s40 offen
    s_add_u32 s40, s40, 18432
    s_waitcnt vmcnt(40) lgkmcnt(5)
    v_mfma_f32_32x32x16_bf16 a[128:143], v[76:79], v[36:39], a[128:143]
    buffer_load_dwordx4 v[56:59], v11, s[20:23], s40 offen
    ds_read_b128 v[28:31], v4 offset:27648
    v_mfma_f32_32x32x16_bf16 a[144:159], v[80:83], v[36:39], a[144:159]
    buffer_load_dwordx4 v[60:63], v12, s[20:23], s40 offen
    v_mfma_f32_32x32x16_bf16 a[160:175], v[84:87], v[36:39], a[160:175]
    buffer_load_dwordx4 v[64:67], v13, s[20:23], s40 offen
    v_mfma_f32_32x32x16_bf16 a[176:191], v[88:91], v[36:39], a[176:191]
    buffer_load_dwordx4 v[68:71], v7, s[20:23], s40 offen
    v_mfma_f32_32x32x16_bf16 a[192:207], v[92:95], v[36:39], a[192:207]
    buffer_load_dwordx4 v[72:75], v8, s[20:23], s40 offen
    s_add_u32 s40, s40, 18432
    s_waitcnt vmcnt(40) lgkmcnt(5)
    v_mfma_f32_32x32x16_bf16 a[128:143], v[96:99], v[40:43], a[128:143]
    buffer_load_dwordx4 v[76:79], v11, s[20:23], s40 offen
    ds_read_b128 v[32:35], v4 offset:28672
    v_mfma_f32_32x32x16_bf16 a[144:159], v[100:103], v[40:43], a[144:159]
    buffer_load_dwordx4 v[80:83], v12, s[20:23], s40 offen
    v_mfma_f32_32x32x16_bf16 a[160:175], v[104:107], v[40:43], a[160:175]
    buffer_load_dwordx4 v[84:87], v13, s[20:23], s40 offen
    v_mfma_f32_32x32x16_bf16 a[176:191], v[108:111], v[40:43], a[176:191]
    buffer_load_dwordx4 v[88:91], v7, s[20:23], s40 offen
    v_mfma_f32_32x32x16_bf16 a[192:207], v[112:115], v[40:43], a[192:207]
    buffer_load_dwordx4 v[92:95], v8, s[20:23], s40 offen
    s_add_u32 s40, s40, 18432
    s_waitcnt vmcnt(40) lgkmcnt(5)
    v_mfma_f32_32x32x16_bf16 a[128:143], v[116:119], v[44:47], a[128:143]
    buffer_load_dwordx4 v[96:99], v11, s[20:23], s40 offen
    ds_read_b128 v[36:39], v4 offset:29696
    v_mfma_f32_32x32x16_bf16 a[144:159], v[120:123], v[44:47], a[144:159]
    buffer_load_dwordx4 v[100:103], v12, s[20:23], s40 offen
    v_mfma_f32_32x32x16_bf16 a[160:175], v[124:127], v[44:47], a[160:175]
    buffer_load_dwordx4 v[104:107], v13, s[20:23], s40 offen
    v_mfma_f32_32x32x16_bf16 a[176:191], v[128:131], v[44:47], a[176:191]
    buffer_load_dwordx4 v[108:111], v7, s[20:23], s40 offen
    v_mfma_f32_32x32x16_bf16 a[192:207], v[132:135], v[44:47], a[192:207]
    buffer_load_dwordx4 v[112:115], v8, s[20:23], s40 offen
    s_add_u32 s40, s40, 18432
    s_waitcnt vmcnt(40) lgkmcnt(5)
    v_mfma_f32_32x32x16_bf16 a[128:143], v[136:139], v[16:19], a[128:143]
    buffer_load_dwordx4 v[116:119], v11, s[20:23], s40 offen
    ds_read_b128 v[40:43], v4 offset:30720
    v_mfma_f32_32x32x16_bf16 a[144:159], v[140:143], v[16:19], a[144:159]
    buffer_load_dwordx4 v[120:123], v12, s[20:23], s40 offen
    v_mfma_f32_32x32x16_bf16 a[160:175], v[144:147], v[16:19], a[160:175]
    buffer_load_dwordx4 v[124:127], v13, s[20:23], s40 offen
    v_mfma_f32_32x32x16_bf16 a[176:191], v[148:151], v[16:19], a[176:191]
    buffer_load_dwordx4 v[128:131], v7, s[20:23], s40 offen
    v_mfma_f32_32x32x16_bf16 a[192:207], v[152:155], v[16:19], a[192:207]
    buffer_load_dwordx4 v[132:135], v8, s[20:23], s40 offen
    s_add_u32 s40, s40, 18432
    s_waitcnt vmcnt(40) lgkmcnt(5)
    v_mfma_f32_32x32x16_bf16 a[128:143], v[156:159], v[20:23], a[128:143]
    buffer_load_dwordx4 v[136:139], v11, s[20:23], s40 offen
    ds_read_b128 v[44:47], v4 offset:31744
    v_mfma_f32_32x32x16_bf16 a[144:159], v[160:163], v[20:23], a[144:159]
    buffer_load_dwordx4 v[140:143], v12, s[20:23], s40 offen
    v_mfma_f32_32x32x16_bf16 a[160:175], v[164:167], v[20:23], a[160:175]
    buffer_load_dwordx4 v[144:147], v13, s[20:23], s40 offen
    v_mfma_f32_32x32x16_bf16 a[176:191], v[168:171], v[20:23], a[176:191]
    buffer_load_dwordx4 v[148:151], v7, s[20:23], s40 offen
    v_mfma_f32_32x32x16_bf16 a[192:207], v[172:175], v[20:23], a[192:207]
    buffer_load_dwordx4 v[152:155], v8, s[20:23], s40 offen
    s_add_u32 s40, s40, 18432
    s_waitcnt vmcnt(40) lgkmcnt(5)
    v_mfma_f32_32x32x16_bf16 a[128:143], v[176:179], v[24:27], a[128:143]
    buffer_load_dwordx4 v[156:159], v11, s[20:23], s40 offen
    ds_read_b128 v[16:19], v4 offset:32768
    v_mfma_f32_32x32x16_bf16 a[144:159], v[180:183], v[24:27], a[144:159]
    buffer_load_dwordx4 v[160:163], v12, s[20:23], s40 offen
    v_mfma_f32_32x32x16_bf16 a[160:175], v[184:187], v[24:27], a[160:175]
    buffer_load_dwordx4 v[164:167], v13, s[20:23], s40 offen
    v_mfma_f32_32x32x16_bf16 a[176:191], v[188:191], v[24:27], a[176:191]
    buffer_load_dwordx4 v[168:171], v7, s[20:23], s40 offen
    v_mfma_f32_32x32x16_bf16 a[192:207], v[192:195], v[24:27], a[192:207]
    buffer_load_dwordx4 v[172:175], v8, s[20:23], s40 offen
    s_add_u32 s40, s40, 18432
    s_waitcnt vmcnt(40) lgkmcnt(5)
    v_mfma_f32_32x32x16_bf16 a[128:143], v[196:199], v[28:31], a[128:143]
    ds_read_b128 v[20:23], v4 offset:33792
    v_mfma_f32_32x32x16_bf16 a[144:159], v[200:203], v[28:31], a[144:159]
    v_mfma_f32_32x32x16_bf16 a[160:175], v[204:207], v[28:31], a[160:175]
    v_mfma_f32_32x32x16_bf16 a[176:191], v[208:211], v[28:31], a[176:191]
    v_mfma_f32_32x32x16_bf16 a[192:207], v[212:215], v[28:31], a[192:207]
    s_waitcnt vmcnt(35) lgkmcnt(5)
    v_mfma_f32_32x32x16_bf16 a[128:143], v[216:219], v[32:35], a[128:143]
    ds_read_b128 v[24:27], v4 offset:34816
    v_mfma_f32_32x32x16_bf16 a[144:159], v[220:223], v[32:35], a[144:159]
    v_mfma_f32_32x32x16_bf16 a[160:175], v[224:227], v[32:35], a[160:175]
    v_mfma_f32_32x32x16_bf16 a[176:191], v[228:231], v[32:35], a[176:191]
    v_mfma_f32_32x32x16_bf16 a[192:207], v[232:235], v[32:35], a[192:207]
    s_waitcnt vmcnt(30) lgkmcnt(5)
    v_mfma_f32_32x32x16_bf16 a[128:143], v[236:239], v[36:39], a[128:143]
    ds_read_b128 v[28:31], v4 offset:35840
    v_mfma_f32_32x32x16_bf16 a[144:159], v[240:243], v[36:39], a[144:159]
    v_mfma_f32_32x32x16_bf16 a[160:175], v[244:247], v[36:39], a[160:175]
    v_mfma_f32_32x32x16_bf16 a[176:191], v[248:251], v[36:39], a[176:191]
    v_mfma_f32_32x32x16_bf16 a[192:207], v[252:255], v[36:39], a[192:207]
    s_waitcnt vmcnt(25) lgkmcnt(5)
    v_mfma_f32_32x32x16_bf16 a[128:143], v[56:59], v[40:43], a[128:143]
    v_mfma_f32_32x32x16_bf16 a[144:159], v[60:63], v[40:43], a[144:159]
    v_mfma_f32_32x32x16_bf16 a[160:175], v[64:67], v[40:43], a[160:175]
    v_mfma_f32_32x32x16_bf16 a[176:191], v[68:71], v[40:43], a[176:191]
    v_mfma_f32_32x32x16_bf16 a[192:207], v[72:75], v[40:43], a[192:207]
    s_waitcnt vmcnt(20) lgkmcnt(4)
    v_mfma_f32_32x32x16_bf16 a[128:143], v[76:79], v[44:47], a[128:143]
    v_mfma_f32_32x32x16_bf16 a[144:159], v[80:83], v[44:47], a[144:159]
    v_mfma_f32_32x32x16_bf16 a[160:175], v[84:87], v[44:47], a[160:175]
    v_mfma_f32_32x32x16_bf16 a[176:191], v[88:91], v[44:47], a[176:191]
    v_mfma_f32_32x32x16_bf16 a[192:207], v[92:95], v[44:47], a[192:207]
    s_waitcnt vmcnt(15) lgkmcnt(3)
    v_mfma_f32_32x32x16_bf16 a[128:143], v[96:99], v[16:19], a[128:143]
    v_mfma_f32_32x32x16_bf16 a[144:159], v[100:103], v[16:19], a[144:159]
    v_mfma_f32_32x32x16_bf16 a[160:175], v[104:107], v[16:19], a[160:175]
    v_mfma_f32_32x32x16_bf16 a[176:191], v[108:111], v[16:19], a[176:191]
    v_mfma_f32_32x32x16_bf16 a[192:207], v[112:115], v[16:19], a[192:207]
    s_waitcnt vmcnt(10) lgkmcnt(2)
    v_mfma_f32_32x32x16_bf16 a[128:143], v[116:119], v[20:23], a[128:143]
    v_mfma_f32_32x32x16_bf16 a[144:159], v[120:123], v[20:23], a[144:159]
    v_mfma_f32_32x32x16_bf16 a[160:175], v[124:127], v[20:23], a[160:175]
    v_mfma_f32_32x32x16_bf16 a[176:191], v[128:131], v[20:23], a[176:191]
    v_mfma_f32_32x32x16_bf16 a[192:207], v[132:135], v[20:23], a[192:207]
    s_waitcnt vmcnt(5) lgkmcnt(1)
    v_mfma_f32_32x32x16_bf16 a[128:143], v[136:139], v[24:27], a[128:143]
    v_mfma_f32_32x32x16_bf16 a[144:159], v[140:143], v[24:27], a[144:159]
    v_mfma_f32_32x32x16_bf16 a[160:175], v[144:147], v[24:27], a[160:175]
    v_mfma_f32_32x32x16_bf16 a[176:191], v[148:151], v[24:27], a[176:191]
    v_mfma_f32_32x32x16_bf16 a[192:207], v[152:155], v[24:27], a[192:207]
    s_waitcnt vmcnt(0) lgkmcnt(0)
    v_mfma_f32_32x32x16_bf16 a[128:143], v[156:159], v[28:31], a[128:143]
    v_mfma_f32_32x32x16_bf16 a[144:159], v[160:163], v[28:31], a[144:159]
    v_mfma_f32_32x32x16_bf16 a[160:175], v[164:167], v[28:31], a[160:175]
    v_mfma_f32_32x32x16_bf16 a[176:191], v[168:171], v[28:31], a[176:191]
    v_mfma_f32_32x32x16_bf16 a[192:207], v[172:175], v[28:31], a[192:207]
    s_lshl_b32 s32, s37, 5
    v_add_u32 v6, s32, v9
    v_mul_u32_u24 v6, 2304, v6
    v_lshl_add_u32 v6, v10, 3, v6
    s_lshl_b32 s32, s3, 6
    s_add_u32 s32, s32, 1152
    s_nop 7
    v_accvgpr_read_b32 v56, a128
    v_accvgpr_read_b32 v57, a129
    v_accvgpr_read_b32 v58, a130
    v_accvgpr_read_b32 v59, a131
    v_cvt_pk_bf16_f32 v56, v56, v57
    v_cvt_pk_bf16_f32 v57, v58, v59
    buffer_store_dwordx2 v[56:57], v6, s[8:11], s32 offen offset:0
    v_accvgpr_read_b32 v60, a132
    v_accvgpr_read_b32 v61, a133
    v_accvgpr_read_b32 v62, a134
    v_accvgpr_read_b32 v63, a135
    v_cvt_pk_bf16_f32 v60, v60, v61
    v_cvt_pk_bf16_f32 v61, v62, v63
    buffer_store_dwordx2 v[60:61], v6, s[8:11], s32 offen offset:16
    v_accvgpr_read_b32 v64, a136
    v_accvgpr_read_b32 v65, a137
    v_accvgpr_read_b32 v66, a138
    v_accvgpr_read_b32 v67, a139
    v_cvt_pk_bf16_f32 v64, v64, v65
    v_cvt_pk_bf16_f32 v65, v66, v67
    buffer_store_dwordx2 v[64:65], v6, s[8:11], s32 offen offset:32
    v_accvgpr_read_b32 v68, a140
    v_accvgpr_read_b32 v69, a141
    v_accvgpr_read_b32 v70, a142
    v_accvgpr_read_b32 v71, a143
    v_cvt_pk_bf16_f32 v68, v68, v69
    v_cvt_pk_bf16_f32 v69, v70, v71
    buffer_store_dwordx2 v[68:69], v6, s[8:11], s32 offen offset:48
    v_accvgpr_read_b32 v72, a144
    v_accvgpr_read_b32 v73, a145
    v_accvgpr_read_b32 v74, a146
    v_accvgpr_read_b32 v75, a147
    v_cvt_pk_bf16_f32 v72, v72, v73
    v_cvt_pk_bf16_f32 v73, v74, v75
    buffer_store_dwordx2 v[72:73], v6, s[8:11], s32 offen offset:256
    v_accvgpr_read_b32 v76, a148
    v_accvgpr_read_b32 v77, a149
    v_accvgpr_read_b32 v78, a150
    v_accvgpr_read_b32 v79, a151
    v_cvt_pk_bf16_f32 v76, v76, v77
    v_cvt_pk_bf16_f32 v77, v78, v79
    buffer_store_dwordx2 v[76:77], v6, s[8:11], s32 offen offset:272
    v_accvgpr_read_b32 v80, a152
    v_accvgpr_read_b32 v81, a153
    v_accvgpr_read_b32 v82, a154
    v_accvgpr_read_b32 v83, a155
    v_cvt_pk_bf16_f32 v80, v80, v81
    v_cvt_pk_bf16_f32 v81, v82, v83
    buffer_store_dwordx2 v[80:81], v6, s[8:11], s32 offen offset:288
    v_accvgpr_read_b32 v84, a156
    v_accvgpr_read_b32 v85, a157
    v_accvgpr_read_b32 v86, a158
    v_accvgpr_read_b32 v87, a159
    v_cvt_pk_bf16_f32 v84, v84, v85
    v_cvt_pk_bf16_f32 v85, v86, v87
    buffer_store_dwordx2 v[84:85], v6, s[8:11], s32 offen offset:304
    v_accvgpr_read_b32 v88, a160
    v_accvgpr_read_b32 v89, a161
    v_accvgpr_read_b32 v90, a162
    v_accvgpr_read_b32 v91, a163
    v_cvt_pk_bf16_f32 v88, v88, v89
    v_cvt_pk_bf16_f32 v89, v90, v91
    buffer_store_dwordx2 v[88:89], v6, s[8:11], s32 offen offset:512
    v_accvgpr_read_b32 v92, a164
    v_accvgpr_read_b32 v93, a165
    v_accvgpr_read_b32 v94, a166
    v_accvgpr_read_b32 v95, a167
    v_cvt_pk_bf16_f32 v92, v92, v93
    v_cvt_pk_bf16_f32 v93, v94, v95
    buffer_store_dwordx2 v[92:93], v6, s[8:11], s32 offen offset:528
    v_accvgpr_read_b32 v96, a168
    v_accvgpr_read_b32 v97, a169
    v_accvgpr_read_b32 v98, a170
    v_accvgpr_read_b32 v99, a171
    v_cvt_pk_bf16_f32 v96, v96, v97
    v_cvt_pk_bf16_f32 v97, v98, v99
    buffer_store_dwordx2 v[96:97], v6, s[8:11], s32 offen offset:544
    v_accvgpr_read_b32 v100, a172
    v_accvgpr_read_b32 v101, a173
    v_accvgpr_read_b32 v102, a174
    v_accvgpr_read_b32 v103, a175
    v_cvt_pk_bf16_f32 v100, v100, v101
    v_cvt_pk_bf16_f32 v101, v102, v103
    buffer_store_dwordx2 v[100:101], v6, s[8:11], s32 offen offset:560
    v_accvgpr_read_b32 v104, a176
    v_accvgpr_read_b32 v105, a177
    v_accvgpr_read_b32 v106, a178
    v_accvgpr_read_b32 v107, a179
    v_cvt_pk_bf16_f32 v104, v104, v105
    v_cvt_pk_bf16_f32 v105, v106, v107
    buffer_store_dwordx2 v[104:105], v6, s[8:11], s32 offen offset:768
    v_accvgpr_read_b32 v108, a180
    v_accvgpr_read_b32 v109, a181
    v_accvgpr_read_b32 v110, a182
    v_accvgpr_read_b32 v111, a183
    v_cvt_pk_bf16_f32 v108, v108, v109
    v_cvt_pk_bf16_f32 v109, v110, v111
    buffer_store_dwordx2 v[108:109], v6, s[8:11], s32 offen offset:784
    v_accvgpr_read_b32 v112, a184
    v_accvgpr_read_b32 v113, a185
    v_accvgpr_read_b32 v114, a186
    v_accvgpr_read_b32 v115, a187
    v_cvt_pk_bf16_f32 v112, v112, v113
    v_cvt_pk_bf16_f32 v113, v114, v115
    buffer_store_dwordx2 v[112:113], v6, s[8:11], s32 offen offset:800
    v_accvgpr_read_b32 v116, a188
    v_accvgpr_read_b32 v117, a189
    v_accvgpr_read_b32 v118, a190
    v_accvgpr_read_b32 v119, a191
    v_cvt_pk_bf16_f32 v116, v116, v117
    v_cvt_pk_bf16_f32 v117, v118, v119
    buffer_store_dwordx2 v[116:117], v6, s[8:11], s32 offen offset:816
    s_cmp_ge_u32 s3, 2
    s_cbranch_scc1 k3_done
    v_accvgpr_read_b32 v120, a192
    v_accvgpr_read_b32 v121, a193
    v_accvgpr_read_b32 v122, a194
    v_accvgpr_read_b32 v123, a195
    v_cvt_pk_bf16_f32 v120, v120, v121
    v_cvt_pk_bf16_f32 v121, v122, v123
    buffer_store_dwordx2 v[120:121], v6, s[8:11], s32 offen offset:1024
    v_accvgpr_read_b32 v124, a196
    v_accvgpr_read_b32 v125, a197
    v_accvgpr_read_b32 v126, a198
    v_accvgpr_read_b32 v127, a199
    v_cvt_pk_bf16_f32 v124, v124, v125
    v_cvt_pk_bf16_f32 v125, v126, v127
    buffer_store_dwordx2 v[124:125], v6, s[8:11], s32 offen offset:1040
    v_accvgpr_read_b32 v128, a200
    v_accvgpr_read_b32 v129, a201
    v_accvgpr_read_b32 v130, a202
    v_accvgpr_read_b32 v131, a203
    v_cvt_pk_bf16_f32 v128, v128, v129
    v_cvt_pk_bf16_f32 v129, v130, v131
    buffer_store_dwordx2 v[128:129], v6, s[8:11], s32 offen offset:1056
    v_accvgpr_read_b32 v132, a204
    v_accvgpr_read_b32 v133, a205
    v_accvgpr_read_b32 v134, a206
    v_accvgpr_read_b32 v135, a207
    v_cvt_pk_bf16_f32 v132, v132, v133
    v_cvt_pk_bf16_f32 v133, v134, v135
    buffer_store_dwordx2 v[132:133], v6, s[8:11], s32 offen offset:1072
k3_done:
k3_end:
    s_endpgm
code_end:
    s_nop 0
.section .rodata,"a"
.p2align 6
.amdhsa_kernel kf_kernel
  .amdhsa_next_free_vgpr 256
  .amdhsa_next_free_sgpr 102
  .amdhsa_accum_offset 256
  .amdhsa_group_segment_fixed_size 0
  .amdhsa_kernarg_size 104
  .amdhsa_user_sgpr_count 2
  .amdhsa_user_sgpr_kernarg_segment_ptr 1
  .amdhsa_system_sgpr_workgroup_id_x 1
.end_amdhsa_kernel
.p2align 6
.amdhsa_kernel k3_kernel
  .amdhsa_next_free_vgpr 464
  .amdhsa_next_free_sgpr 102
  .amdhsa_accum_offset 256
  .amdhsa_group_segment_fixed_size 0
  .amdhsa_kernarg_size 104
  .amdhsa_user_sgpr_count 2
  .amdhsa_user_sgpr_kernarg_segment_ptr 1
  .amdhsa_system_sgpr_workgroup_id_x 1
.end_amdhsa_kernel
```
